```python
import torch

def _softmax(x, axis=-1):
    return torch.softmax(x, dim=axis)
def _gelu(x):
    return torch.nn.functional.gelu(x, approximate="tanh")
def _silu(x):
    return torch.nn.functional.silu(x)
def _sigmoid(x):
    return torch.sigmoid(x)
def _layernorm(x, axis=-1, eps=1e-5):
    m = x.mean(dim=axis, keepdim=True)
    v = x.var(dim=axis, keepdim=True, unbiased=False)
    return (x - m) / torch.sqrt(v + eps)
def _scatter_add(tgt, idx, src, axis=0):
    return tgt.clone().index_add_(axis, idx, src)
def _segment_sum(src, seg, n):
    out = torch.zeros((n,) + src.shape[1:], dtype=src.dtype)
    return out.index_add_(0, seg, src)
def _pad(x, pw):
    flat = tuple(v for pair in reversed(pw) for v in pair)
    return torch.nn.functional.pad(x, flat)

kernel_name = 'parallel_sum__mha_block__glu_gated_bilinear__prompt'

def setup_inputs():

    _w = (lambda a: (lambda t: t.to(torch.bfloat16) if t.is_floating_point() else t)(torch.as_tensor(a)))
    def _A_setup():
        B, S, D, H = 1, 2048, 576, 32
        return {
            "x": _w((lambda *s: torch.randn(*s, dtype=torch.bfloat16) * 0.05)(B, S, D)),
            "wqkv": _w((lambda *s: torch.randn(*s, dtype=torch.bfloat16) * 0.05)(D, 3 * D)),
            "wo": _w((lambda *s: torch.randn(*s, dtype=torch.bfloat16) * 0.05)(D, D)),
        }
    _A_in = _A_setup()

    def _B_setup():
        B, S, D, F = 1, 2048, 576, 4608
        return {
            "x": _w((lambda *s: torch.randn(*s, dtype=torch.bfloat16) * 0.05)(B, S, D)),
            "w_gate": _w((lambda *s: torch.randn(*s, dtype=torch.bfloat16) * 0.4)(D, F) * (D ** -0.5)),
            "w_up": _w((lambda *s: torch.randn(*s, dtype=torch.bfloat16) * 0.4)(D, F) * (D ** -0.5)),
            "w_down": _w((lambda *s: torch.randn(*s, dtype=torch.bfloat16) * 0.4)(F, D) * (F ** -0.5)),
        }
    _B_in = _B_setup()

    return {
        "A_x": _A_in["x"],
        "A_wqkv": _A_in["wqkv"],
        "A_wo": _A_in["wo"],
        "B_x": _B_in["x"],
        "B_w_gate": _B_in["w_gate"],
        "B_w_up": _B_in["w_up"],
        "B_w_down": _B_in["w_down"],
    }

def reference(A_x, A_wqkv, A_wo, B_x, B_w_gate, B_w_up, B_w_down):
    def _A_ref(x, wqkv, wo):
        B, S, D = x.shape
        H = 32
        Dh = D // H
        qkv = (lambda x, *d: x.permute(*d))((x @ wqkv).reshape(B, S, 3, H, Dh), 2, 0, 3, 1, 4)
        q, k, v = qkv[0], qkv[1], qkv[2]
        scores = torch.einsum("bhqd,bhkd->bhqk", q, k) * (Dh ** -0.5)
        p = _softmax(scores, axis=-1)
        o = torch.einsum("bhqk,bhkd->bhqd", p, v)
        return (lambda x, *d: x.permute(*d))(o, 0, 2, 1, 3).reshape(B, S, D) @ wo

    def _B_ref(x, w_gate, w_up, w_down):
        g = torch.einsum("bsd,df->bsf", x, w_gate)
        u = torch.einsum("bsd,df->bsf", x, w_up)
        h = g * u
        return torch.einsum("bsf,fd->bsd", h, w_down)

    x = A_x
    xn = _layernorm(x, axis=-1)
    return x + _A_ref(xn, A_wqkv, A_wo) + _B_ref(xn, B_w_gate, B_w_up, B_w_down)
```

```asm
; @launch grid=(256,1,1) block=(256,1,1) lds=163840
.amdgcn_target "amdgcn-amd-amdhsa--gfx950"
.text
.globl parallel_sum__mha_block__glu_gated_bilinear__prompt_kernel
.p2align 8
.type parallel_sum__mha_block__glu_gated_bilinear__prompt_kernel,@function
parallel_sum__mha_block__glu_gated_bilinear__prompt_kernel:
    s_cmp_ge_u32 s2, 256
    s_cbranch_scc1 L_end
    s_load_dwordx16 s[48:63], s[0:1], 0
    s_load_dwordx4 s[44:47], s[0:1], 64
    v_lshrrev_b32 v32, 6, v0
    v_and_b32 v33, 63, v0
    v_readfirstlane_b32 s3, v32
    s_and_b32 s6, s2, 7
    s_lshr_b32 s4, s2, 5
    s_bfe_u32 s7, s2, 0x20003
    s_lshl_b32 s5, s6, 2
    s_add_u32 s5, s5, s7
    v_lshlrev_b32 v1, 4, v33
    s_cmp_eq_u32 s3, 3
    s_cbranch_scc1 L_helper
    v_lshrrev_b32 v140, 3, v33
    v_and_b32 v141, 7, v33
    v_mul_u32_u24 v142, 1152, v140
    v_lshl_add_u32 v142, v141, 4, v142
    s_lshl_b32 s94, s4, 5
    s_add_u32 s94, s94, s5
    s_mul_i32 s94, s94, 9216
    s_lshl_b32 s97, s3, 7
    s_add_u32 s94, s94, s97
    s_waitcnt lgkmcnt(0)
    s_mov_b32 s36, s48
    s_mov_b32 s37, s49
    s_mov_b32 s38, 2359296
    s_mov_b32 s39, 0x20000
    buffer_load_dwordx4 v[96:99], v142, s[36:39], s94 offen offset:0
    buffer_load_dwordx4 v[100:103], v142, s[36:39], s94 offen offset:384
    buffer_load_dwordx4 v[104:107], v142, s[36:39], s94 offen offset:768
    s_mov_b32 s8, s46
    s_mov_b32 s9, s47
    s_mov_b32 s10, 60817408
    s_mov_b32 s11, 0x20000
    v_mov_b32 v38, 49733632
    buffer_load_dword v43, v38, s[8:11], 0 offen sc1
    v_mov_b32 v37, 1073741824
    v_cmp_eq_u32 vcc, 0, v33
    s_nop 1
    v_cndmask_b32 v5, v37, 0, vcc
    v_lshrrev_b32 v156, 2, v141
    v_lshlrev_b32 v156, 12, v156
    v_and_b32 v157, 3, v141
    v_lshl_add_u32 v156, v157, 8, v156
    v_lshl_add_u32 v143, v140, 4, v156
    s_lshl_b32 s83, s4, 2
    s_lshr_b32 s96, s5, 3
    s_add_u32 s83, s83, s96
    s_mul_i32 s83, s83, 73728
    s_bfe_u32 s96, s5, 0x20001
    s_lshl_b32 s96, s96, 10
    s_add_u32 s83, s83, s96
    s_and_b32 s96, s5, 1
    s_lshl_b32 s96, s96, 7
    s_add_u32 s83, s83, s96
    s_lshl_b32 s100, s3, 13
    s_add_u32 s83, s83, s100
    s_add_u32 s100, s83, 24576
    s_add_u32 s96, s83, 49152
    s_mov_b32 s101, 0xffff0000
    v_lshlrev_b32 v144, 4, v140
    v_add_u32 v144, 162816, v144
    s_lshl_b32 s98, s3, 2
    v_add_u32 v145, s98, v144
    s_waitcnt vmcnt(1)
    v_lshlrev_b32 v112, 16, v96
    v_and_b32 v113, s101, v96
    v_lshlrev_b32 v114, 16, v97
    v_and_b32 v115, s101, v97
    v_lshlrev_b32 v116, 16, v98
    v_and_b32 v117, s101, v98
    v_lshlrev_b32 v118, 16, v99
    v_and_b32 v119, s101, v99
    v_lshlrev_b32 v120, 16, v100
    v_and_b32 v121, s101, v100
    v_lshlrev_b32 v122, 16, v101
    v_and_b32 v123, s101, v101
    v_lshlrev_b32 v124, 16, v102
    v_and_b32 v125, s101, v102
    v_lshlrev_b32 v126, 16, v103
    v_and_b32 v127, s101, v103
    v_lshlrev_b32 v128, 16, v104
    v_and_b32 v129, s101, v104
    v_lshlrev_b32 v130, 16, v105
    v_and_b32 v131, s101, v105
    v_lshlrev_b32 v132, 16, v106
    v_and_b32 v133, s101, v106
    v_lshlrev_b32 v134, 16, v107
    v_and_b32 v135, s101, v107
    v_add_f32 v146, v112, v116
    v_add_f32 v147, v113, v117
    v_add_f32 v148, v114, v118
    v_add_f32 v149, v115, v119
    v_add_f32 v146, v146, v120
    v_add_f32 v147, v147, v121
    v_add_f32 v148, v148, v122
    v_add_f32 v149, v149, v123
    v_add_f32 v146, v146, v124
    v_add_f32 v147, v147, v125
    v_add_f32 v148, v148, v126
    v_add_f32 v149, v149, v127
    v_add_f32 v146, v146, v128
    v_add_f32 v147, v147, v129
    v_add_f32 v148, v148, v130
    v_add_f32 v149, v149, v131
    v_add_f32 v146, v146, v132
    v_add_f32 v147, v147, v133
    v_add_f32 v148, v148, v134
    v_add_f32 v149, v149, v135
    v_add_f32 v146, v146, v147
    v_add_f32 v148, v148, v149
    v_add_f32 v146, v146, v148
    s_nop 1
    v_add_f32_dpp v146, v146, v146 quad_perm:[1,0,3,2] row_mask:0xf bank_mask:0xf
    s_nop 1
    v_add_f32_dpp v146, v146, v146 quad_perm:[2,3,0,1] row_mask:0xf bank_mask:0xf
    s_nop 1
    v_add_f32_dpp v146, v146, v146 row_half_mirror row_mask:0xf bank_mask:0xf
    ds_write_b32 v145, v146 offset:0
    s_waitcnt lgkmcnt(0)
    s_barrier
    ds_read_b96 v[146:148], v144 offset:0
    s_waitcnt lgkmcnt(0)
    v_add_f32 v146, v146, v147
    v_add_f32 v146, v146, v148
    v_mul_f32 v146, 0x3ae38e39, v146
    v_mov_b32 v150, v146
    v_sub_f32 v152, v112, v150
    v_mul_f32 v146, v152, v152
    v_sub_f32 v153, v113, v150
    v_mul_f32 v147, v153, v153
    v_sub_f32 v154, v114, v150
    v_mul_f32 v148, v154, v154
    v_sub_f32 v155, v115, v150
    v_mul_f32 v149, v155, v155
    v_sub_f32 v152, v116, v150
    v_fmac_f32 v146, v152, v152
    v_sub_f32 v153, v117, v150
    v_fmac_f32 v147, v153, v153
    v_sub_f32 v154, v118, v150
    v_fmac_f32 v148, v154, v154
    v_sub_f32 v155, v119, v150
    v_fmac_f32 v149, v155, v155
    v_sub_f32 v152, v120, v150
    v_fmac_f32 v146, v152, v152
    v_sub_f32 v153, v121, v150
    v_fmac_f32 v147, v153, v153
    v_sub_f32 v154, v122, v150
    v_fmac_f32 v148, v154, v154
    v_sub_f32 v155, v123, v150
    v_fmac_f32 v149, v155, v155
    v_sub_f32 v152, v124, v150
    v_fmac_f32 v146, v152, v152
    v_sub_f32 v153, v125, v150
    v_fmac_f32 v147, v153, v153
    v_sub_f32 v154, v126, v150
    v_fmac_f32 v148, v154, v154
    v_sub_f32 v155, v127, v150
    v_fmac_f32 v149, v155, v155
    v_sub_f32 v152, v128, v150
    v_fmac_f32 v146, v152, v152
    v_sub_f32 v153, v129, v150
    v_fmac_f32 v147, v153, v153
    v_sub_f32 v154, v130, v150
    v_fmac_f32 v148, v154, v154
    v_sub_f32 v155, v131, v150
    v_fmac_f32 v149, v155, v155
    v_sub_f32 v152, v132, v150
    v_fmac_f32 v146, v152, v152
    v_sub_f32 v153, v133, v150
    v_fmac_f32 v147, v153, v153
    v_sub_f32 v154, v134, v150
    v_fmac_f32 v148, v154, v154
    v_sub_f32 v155, v135, v150
    v_fmac_f32 v149, v155, v155
    v_cvt_pk_bf16_f32 v150, v150, v150
    v_and_b32 v150, s101, v150
    v_add_f32 v146, v146, v147
    v_add_f32 v148, v148, v149
    v_add_f32 v146, v146, v148
    s_nop 1
    v_add_f32_dpp v146, v146, v146 quad_perm:[1,0,3,2] row_mask:0xf bank_mask:0xf
    s_nop 1
    v_add_f32_dpp v146, v146, v146 quad_perm:[2,3,0,1] row_mask:0xf bank_mask:0xf
    s_nop 1
    v_add_f32_dpp v146, v146, v146 row_half_mirror row_mask:0xf bank_mask:0xf
    ds_write_b32 v145, v146 offset:128
    v_sub_f32 v112, v112, v150
    v_sub_f32 v113, v113, v150
    v_cvt_pk_bf16_f32 v96, v112, v113
    v_lshlrev_b32 v112, 16, v96
    v_and_b32 v113, s101, v96
    v_sub_f32 v114, v114, v150
    v_sub_f32 v115, v115, v150
    v_cvt_pk_bf16_f32 v97, v114, v115
    v_lshlrev_b32 v114, 16, v97
    v_and_b32 v115, s101, v97
    v_sub_f32 v116, v116, v150
    v_sub_f32 v117, v117, v150
    v_cvt_pk_bf16_f32 v98, v116, v117
    v_lshlrev_b32 v116, 16, v98
    v_and_b32 v117, s101, v98
    v_sub_f32 v118, v118, v150
    v_sub_f32 v119, v119, v150
    v_cvt_pk_bf16_f32 v99, v118, v119
    v_lshlrev_b32 v118, 16, v99
    v_and_b32 v119, s101, v99
    s_waitcnt lgkmcnt(0)
    s_barrier
    ds_read_b96 v[146:148], v144 offset:128
    v_sub_f32 v120, v120, v150
    v_sub_f32 v121, v121, v150
    v_cvt_pk_bf16_f32 v100, v120, v121
    v_lshlrev_b32 v120, 16, v100
    v_and_b32 v121, s101, v100
    v_sub_f32 v122, v122, v150
    v_sub_f32 v123, v123, v150
    v_cvt_pk_bf16_f32 v101, v122, v123
    v_lshlrev_b32 v122, 16, v101
    v_and_b32 v123, s101, v101
    v_sub_f32 v124, v124, v150
    v_sub_f32 v125, v125, v150
    v_cvt_pk_bf16_f32 v102, v124, v125
    v_lshlrev_b32 v124, 16, v102
    v_and_b32 v125, s101, v102
    v_sub_f32 v126, v126, v150
    v_sub_f32 v127, v127, v150
    v_cvt_pk_bf16_f32 v103, v126, v127
    v_lshlrev_b32 v126, 16, v103
    v_and_b32 v127, s101, v103
    s_waitcnt lgkmcnt(0)
    v_add_f32 v146, v146, v147
    v_add_f32 v146, v146, v148
    v_mul_f32 v146, 0x3ae38e39, v146
    v_cvt_pk_bf16_f32 v146, v146, v146
    v_and_b32 v146, s101, v146
    v_add_f32 v146, 0x3727c5ac, v146
    v_cvt_pk_bf16_f32 v146, v146, v146
    v_and_b32 v146, s101, v146
    v_sqrt_f32 v146, v146
    s_nop 0
    v_cvt_pk_bf16_f32 v146, v146, v146
    v_and_b32 v146, s101, v146
    v_rcp_f32 v146, v146
    v_sub_f32 v128, v128, v150
    v_sub_f32 v129, v129, v150
    v_cvt_pk_bf16_f32 v104, v128, v129
    v_lshlrev_b32 v128, 16, v104
    v_and_b32 v129, s101, v104
    v_sub_f32 v130, v130, v150
    v_sub_f32 v131, v131, v150
    v_cvt_pk_bf16_f32 v105, v130, v131
    v_lshlrev_b32 v130, 16, v105
    v_and_b32 v131, s101, v105
    v_sub_f32 v132, v132, v150
    v_sub_f32 v133, v133, v150
    v_cvt_pk_bf16_f32 v106, v132, v133
    v_lshlrev_b32 v132, 16, v106
    v_and_b32 v133, s101, v106
    v_sub_f32 v134, v134, v150
    v_sub_f32 v135, v135, v150
    v_cvt_pk_bf16_f32 v107, v134, v135
    v_lshlrev_b32 v134, 16, v107
    v_and_b32 v135, s101, v107
    v_mul_f32 v112, v112, v146
    v_mul_f32 v113, v113, v146
    v_cvt_pk_bf16_f32 v96, v112, v113
    v_mul_f32 v114, v114, v146
    v_mul_f32 v115, v115, v146
    v_cvt_pk_bf16_f32 v97, v114, v115
    v_mul_f32 v116, v116, v146
    v_mul_f32 v117, v117, v146
    v_cvt_pk_bf16_f32 v98, v116, v117
    v_mul_f32 v118, v118, v146
    v_mul_f32 v119, v119, v146
    v_cvt_pk_bf16_f32 v99, v118, v119
    buffer_store_dwordx4 v[96:99], v143, s[8:11], s83 offen sc1
    v_mul_f32 v120, v120, v146
    v_mul_f32 v121, v121, v146
    v_cvt_pk_bf16_f32 v100, v120, v121
    v_mul_f32 v122, v122, v146
    v_mul_f32 v123, v123, v146
    v_cvt_pk_bf16_f32 v101, v122, v123
    v_mul_f32 v124, v124, v146
    v_mul_f32 v125, v125, v146
    v_cvt_pk_bf16_f32 v102, v124, v125
    v_mul_f32 v126, v126, v146
    v_mul_f32 v127, v127, v146
    v_cvt_pk_bf16_f32 v103, v126, v127
    buffer_store_dwordx4 v[100:103], v143, s[8:11], s100 offen sc1
    v_mul_f32 v128, v128, v146
    v_mul_f32 v129, v129, v146
    v_cvt_pk_bf16_f32 v104, v128, v129
    v_mul_f32 v130, v130, v146
    v_mul_f32 v131, v131, v146
    v_cvt_pk_bf16_f32 v105, v130, v131
    v_mul_f32 v132, v132, v146
    v_mul_f32 v133, v133, v146
    v_cvt_pk_bf16_f32 v106, v132, v133
    v_mul_f32 v134, v134, v146
    v_mul_f32 v135, v135, v146
    v_cvt_pk_bf16_f32 v107, v134, v135
    buffer_store_dwordx4 v[104:107], v143, s[8:11], s96 offen sc1
    s_waitcnt vmcnt(3)
    v_readfirstlane_b32 s40, v43
    s_nop 0
    s_mul_i32 s40, s40, 0x9e3779b1
    s_add_u32 s40, s40, 0x7f4a7c15
    s_mov_b32 s12, s56
    s_mov_b32 s13, s57
    s_mov_b32 s14, 5308416
    s_mov_b32 s15, 0x20000
    s_sub_u32 s16, s58, 1024
    s_subb_u32 s17, s59, 0
    s_mov_b32 s18, 5309440
    s_mov_b32 s19, 0x20000
    v_lshrrev_b32 v37, 3, v0
    v_bfe_u32 v38, v37, 2, 2
    v_lshlrev_b32 v38, 3, v38
    v_lshrrev_b32 v39, 4, v37
    v_lshl_add_u32 v38, v39, 2, v38
    v_and_b32 v39, 3, v37
    v_add_u32 v38, v38, v39
    v_mul_u32_u24 v38, 9216, v38
    v_and_b32 v39, 6, v37
    v_and_b32 v40, 7, v0
    v_xor_b32 v39, v39, v40
    v_lshl_add_u32 v23, v39, 4, v38
    v_mul_u32_u24 v38, 1152, v37
    v_lshl_add_u32 v25, v39, 4, v38
    s_lshl_b32 s64, s3, 11
    s_mul_i32 s65, s6, 1152
    s_lshl_b32 s94, s7, 8
    s_add_u32 s66, s65, s94
    s_add_u32 s67, s66, 5308416
    s_mul_i32 s73, s7, 0
    s_lshr_b32 s73, s73, 1
    s_mul_i32 s94, s73, 294912
    s_add_u32 s65, s66, s94
    s_lshl_b32 s94, s4, 2
    s_lshr_b32 s95, s5, 3
    s_add_u32 s94, s94, s95
    s_lshl_b32 s94, s94, 7
    s_and_b32 s95, s5, 7
    s_mul_i32 s95, s95, 3
    s_add_u32 s95, s95, s3
    s_lshl_b32 s95, s95, 2
    s_add_u32 s94, s94, s95
    s_add_u32 s41, s94, 49737728
    v_mov_b32 v37, s40
    s_waitcnt vmcnt(0)
    buffer_store_dword v37, v5, s[8:11], s41 offen offset:0 sc1
    s_branch L_join
    s_nop 1
L_helper:
    s_waitcnt lgkmcnt(0)
    s_mov_b32 s36, s48
    s_mov_b32 s37, s49
    s_mov_b32 s38, 2359296
    s_mov_b32 s39, 0x20000
    s_getpc_b64 s[98:99]
L_pc:
    s_lshr_b32 s94, s2, 3
    s_lshl_b32 s94, s94, 12
    v_and_b32 v37, 31, v33
    v_lshlrev_b32 v37, 7, v37
    v_add_u32 v37, s94, v37
    v_min_u32 v37, L_codeend-L_pc-4, v37
    global_load_dword v84, v37, s[98:99]
    s_mov_b32 s8, s46
    s_mov_b32 s9, s47
    s_mov_b32 s10, 60817408
    s_mov_b32 s11, 0x20000
    v_mov_b32 v38, 49733632
    buffer_load_dword v43, v38, s[8:11], 0 offen sc1
    v_mov_b32 v37, 1073741824
    v_cmp_eq_u32 vcc, 0, v33
    s_nop 1
    v_cndmask_b32 v5, v37, 0, vcc
    s_mul_i32 s95, s4, 36
    v_min_u32 v37, 35, v33
    v_add_u32 v37, s95, v37
    v_mul_u32_u24 v38, 9216, v37
    s_mul_i32 s95, s6, 1152
    s_lshl_b32 s94, s7, 8
    s_add_u32 s95, s95, s94
    v_add_u32 v80, s95, v38
    v_add_u32 v85, 2654208, v80
    s_mov_b32 s12, s56
    s_mov_b32 s13, s57
    s_mov_b32 s14, 5308416
    s_mov_b32 s15, 0x20000
    s_sub_u32 s16, s58, 1024
    s_subb_u32 s17, s59, 0
    s_mov_b32 s18, 5309440
    s_mov_b32 s19, 0x20000
    v_lshrrev_b32 v37, 3, v0
    v_bfe_u32 v38, v37, 2, 2
    v_lshlrev_b32 v38, 3, v38
    v_lshrrev_b32 v39, 4, v37
    v_lshl_add_u32 v38, v39, 2, v38
    v_and_b32 v39, 3, v37
    v_add_u32 v38, v38, v39
    v_mul_u32_u24 v38, 9216, v38
    v_and_b32 v39, 6, v37
    v_and_b32 v40, 7, v0
    v_xor_b32 v39, v39, v40
    v_lshl_add_u32 v23, v39, 4, v38
    v_mul_u32_u24 v38, 1152, v37
    v_lshl_add_u32 v25, v39, 4, v38
    s_lshl_b32 s64, s3, 11
    s_mul_i32 s65, s6, 1152
    s_lshl_b32 s94, s7, 8
    s_add_u32 s66, s65, s94
    s_add_u32 s67, s66, 5308416
    s_mul_i32 s73, s7, 0
    s_lshr_b32 s73, s73, 1
    s_mul_i32 s94, s73, 294912
    s_add_u32 s65, s66, s94
    s_waitcnt vmcnt(0)
    v_readfirstlane_b32 s40, v43
    s_nop 0
    s_mul_i32 s40, s40, 0x9e3779b1
    s_add_u32 s40, s40, 0x7f4a7c15
    global_load_dword v84, v80, s[56:57]
    global_load_dword v84, v80, s[58:59]
    s_barrier
    s_barrier
    s_nop 1
L_join:
    s_add_u32 m0, s64, 0
    s_nop 0
    buffer_load_dwordx4 v23, s[12:15], s65 offen lds
    buffer_load_dwordx4 v23, s[16:19], s65 offen offset:1024 lds
    s_add_u32 s65, s65, 294912
    s_add_u32 m0, s64, 8192
    s_nop 0
    buffer_load_dwordx4 v23, s[12:15], s65 offen lds
    buffer_load_dwordx4 v23, s[16:19], s65 offen offset:1024 lds
    s_add_u32 s65, s65, 294912
    s_add_u32 m0, s64, 16384
    s_nop 0
    buffer_load_dwordx4 v23, s[12:15], s65 offen lds
    buffer_load_dwordx4 v23, s[16:19], s65 offen offset:1024 lds
    s_add_u32 s65, s65, 294912
    s_add_u32 m0, s64, 24576
    s_nop 0
    buffer_load_dwordx4 v23, s[12:15], s65 offen lds
    buffer_load_dwordx4 v23, s[16:19], s65 offen offset:1024 lds
    s_add_u32 s65, s65, 294912
    s_add_u32 m0, s64, 32768
    s_nop 0
    buffer_load_dwordx4 v23, s[12:15], s65 offen lds
    buffer_load_dwordx4 v23, s[16:19], s65 offen offset:1024 lds
    s_add_u32 s65, s65, 294912
    s_add_u32 m0, s64, 40960
    s_nop 0
    buffer_load_dwordx4 v23, s[12:15], s65 offen lds
    buffer_load_dwordx4 v23, s[16:19], s65 offen offset:1024 lds
    s_add_u32 s65, s65, 294912
    s_add_u32 m0, s64, 49152
    s_nop 0
    buffer_load_dwordx4 v23, s[12:15], s65 offen lds
    buffer_load_dwordx4 v23, s[16:19], s65 offen offset:1024 lds
    s_add_u32 s65, s65, 294912
    s_add_u32 m0, s64, 57344
    s_nop 0
    buffer_load_dwordx4 v23, s[12:15], s65 offen lds
    buffer_load_dwordx4 v23, s[16:19], s65 offen offset:1024 lds
    s_add_u32 s65, s65, 294912
    s_add_u32 m0, s64, 65536
    s_nop 0
    buffer_load_dwordx4 v23, s[12:15], s65 offen lds
    buffer_load_dwordx4 v23, s[16:19], s65 offen offset:1024 lds
    s_add_u32 s65, s65, 294912
    v_and_b32 v33, 63, v0
    v_lshrrev_b32 v34, 4, v33
    v_bfe_u32 v35, v33, 2, 2
    v_and_b32 v36, 3, v33
    v_lshlrev_b32 v2, 3, v33
    v_add_u32 v3, 4096, v2
    v_lshl_add_u32 v37, v34, 2, v35
    v_lshrrev_b32 v38, 3, v37
    v_lshlrev_b32 v38, 11, v38
    v_and_b32 v8, 7, v37
    v_lshl_add_u32 v38, v8, 7, v38
    v_lshl_add_u32 v38, v36, 3, v38
    v_bfe_u32 v37, v37, 1, 2
    v_xor_b32 v8, 0, v37
    v_lshl_add_u32 v8, v8, 5, v38
    v_xor_b32 v9, 1, v37
    v_lshl_add_u32 v9, v9, 5, v38
    v_xor_b32 v10, 2, v37
    v_lshl_add_u32 v10, v10, 5, v38
    v_xor_b32 v11, 3, v37
    v_lshl_add_u32 v11, v11, 5, v38
    v_and_b32 v37, 31, v33
    v_lshlrev_b32 v4, 2, v37
    s_lshl_b32 s94, s4, 2
    s_add_u32 s94, s94, s3
    s_lshl_b32 s97, s94, 7
    s_add_u32 s97, s97, 49737728
    s_lshl_b32 s72, s73, 12
    s_mov_b32 s70, s73
    s_mul_i32 s73, s94, 73728
    s_add_u32 s72, s72, s73
    s_add_u32 s74, s73, 73728
    s_lshl_b32 s94, s4, 2
    s_add_u32 s94, s94, s3
    s_mul_i32 s95, s94, 9
    v_min_u32 v37, 8, v33
    v_add_u32 v37, s95, v37
    v_mul_u32_u24 v37, 9216, v37
    v_add_u32 v80, s66, v37
    v_add_u32 v85, 2654208, v80
    s_lshr_b32 s94, s2, 3
    s_lshl_b32 s94, s94, 2
    s_add_u32 s94, s94, s3
    s_mul_i32 s95, s94, 5
    v_min_u32 v37, 4, v33
    v_add_u32 v37, s95, v37
    v_min_u32 v37, 575, v37
    v_mul_u32_u24 v37, 9216, v37
    s_mul_i32 s95, s6, 1152
    s_add_u32 s95, s95, 1024
    v_add_u32 v81, s95, v37
    s_mul_i32 s95, s94, 7
    v_min_u32 v37, 6, v33
    v_add_u32 v37, s95, v37
    v_min_u32 v37, 863, v37
    v_mul_u32_u24 v38, 10923, v37
    v_lshrrev_b32 v38, 16, v38
    v_mul_u32_u24 v39, 6, v38
    v_sub_u32 v37, v37, v39
    v_mul_u32_u24 v38, 3456, v38
    v_lshrrev_b32 v39, 1, v37
    v_mul_u32_u24 v39, 1152, v39
    v_add_u32 v38, v38, v39
    v_and_b32 v37, 1, v37
    v_lshl_add_u32 v38, v37, 7, v38
    s_mul_i32 s95, s6, 144
    v_add_u32 v82, s95, v38
    s_mul_i32 s95, s94, 11
    v_min_u32 v37, 10, v33
    v_add_u32 v37, s95, v37
    v_min_u32 v37, 1295, v37
    s_mul_i32 s95, s6, 663552
    v_lshlrev_b32 v37, 7, v37
    v_add_u32 v83, s95, v37
    s_cmp_lt_u32 s3, 3
    s_cbranch_scc0 L_w3
    s_mov_b32 s20, s50
    s_mov_b32 s21, s51
    s_mov_b32 s22, 1990656
    s_mov_b32 s23, 0x20000
    s_add_u32 s24, s50, 12800
    s_addc_u32 s25, s51, 0
    s_mov_b32 s26, 1977856
    s_mov_b32 s27, 0x20000
    s_mul_i32 s68, s3, 1152
    s_mul_i32 s94, s5, 36
    s_add_u32 s68, s68, s94
    s_mov_b32 s71, 110592
    v_lshrrev_b32 v37, 2, v33
    v_bfe_u32 v38, v37, 2, 2
    v_lshlrev_b32 v38, 3, v38
    v_lshrrev_b32 v39, 4, v37
    v_lshl_add_u32 v38, v39, 2, v38
    v_and_b32 v39, 3, v37
    v_add_u32 v38, v38, v39
    v_mul_u32_u24 v38, 3456, v38
    v_bfe_u32 v39, v37, 2, 1
    v_lshlrev_b32 v39, 1, v39
    v_xor_b32 v39, v39, v36
    s_mov_b32 s94, 20
    s_cmp_eq_u32 s3, 1
    s_cselect_b32 s95, 3, 2
    v_lshlrev_b32 v40, 4, v39
    v_mov_b32 v41, 1073741824
    v_mov_b32 v42, s94
    v_cmp_gt_u32 vcc, 2, v39
    s_nop 1
    v_cndmask_b32 v40, v41, v40, vcc
    v_cmp_eq_u32 vcc, s95, v39
    s_nop 1
    v_cndmask_b32 v40, v40, v42, vcc
    v_add_u32 v24, v38, v40
    s_branch L_wj
    s_nop 3
L_w3:
    s_mov_b32 s20, s56
    s_mov_b32 s21, s57
    s_mov_b32 s22, 5308416
    s_mov_b32 s23, 0x20000
    s_sub_u32 s24, s58, 1024
    s_subb_u32 s25, s59, 0
    s_mov_b32 s26, 5309440
    s_mov_b32 s27, 0x20000
    s_mul_i32 s68, s6, 1152
    s_lshl_b32 s94, s7, 5
    s_add_u32 s68, s68, s94
    s_add_u32 s68, s68, 1024
    s_mov_b32 s71, 294912
    v_lshrrev_b32 v37, 1, v33
    v_bfe_u32 v38, v37, 2, 2
    v_lshlrev_b32 v38, 3, v38
    v_lshrrev_b32 v39, 4, v37
    v_lshl_add_u32 v38, v39, 2, v38
    v_and_b32 v39, 3, v37
    v_add_u32 v38, v38, v39
    v_mul_u32_u24 v38, 9216, v38
    v_and_b32 v39, 1, v33
    v_lshl_add_u32 v24, v39, 4, v38
    s_nop 4
L_wj:
    s_mov_b32 s69, s68
    s_mul_i32 s94, s71, s70
    s_add_u32 s68, s69, s94
    s_mul_i32 s94, s71, 18
    s_add_u32 s70, s69, s94
    s_waitcnt vmcnt(12)
    s_barrier
    ds_read_b64_tr_b16 v[64:65], v8 offset:0
    ds_read_b64_tr_b16 v[66:67], v8 offset:4096
    ds_read_b64_tr_b16 v[68:69], v8 offset:1024
    ds_read_b64_tr_b16 v[70:71], v8 offset:5120
    ds_read_b64_tr_b16 v[72:73], v9 offset:0
    ds_read_b64_tr_b16 v[74:75], v9 offset:4096
    buffer_load_dword v6, v4, s[8:11], s97 offen sc1
    s_waitcnt vmcnt(0)
    v_cmp_eq_u32 vcc, s40, v6
    s_nop 0
    s_and_b32 vcc_lo, vcc_lo, 16777215
    s_cmp_eq_u32 vcc_lo, 16777215
    s_cbranch_scc0 L_spin0
L_back0:
    buffer_load_dwordx4 a[0:3], v1, s[8:11], s72 offen offset:0 sc1
    buffer_load_dwordx4 a[4:7], v1, s[8:11], s72 offen offset:1024 sc1
    buffer_load_dwordx4 a[8:11], v1, s[8:11], s72 offen offset:2048 sc1
    buffer_load_dwordx4 a[12:15], v1, s[8:11], s72 offen offset:3072 sc1
    s_add_u32 s72, s72, 4096
    buffer_load_dwordx4 a[16:19], v1, s[8:11], s72 offen offset:0 sc1
    buffer_load_dwordx4 a[20:23], v1, s[8:11], s72 offen offset:1024 sc1
    buffer_load_dwordx4 a[24:27], v1, s[8:11], s72 offen offset:2048 sc1
    buffer_load_dwordx4 a[28:31], v1, s[8:11], s72 offen offset:3072 sc1
    s_add_u32 s72, s72, 4096
    buffer_load_dwordx4 a[32:35], v1, s[8:11], s72 offen offset:0 sc1
    buffer_load_dwordx4 a[36:39], v1, s[8:11], s72 offen offset:1024 sc1
    buffer_load_dwordx4 a[40:43], v1, s[8:11], s72 offen offset:2048 sc1
    buffer_load_dwordx4 a[44:47], v1, s[8:11], s72 offen offset:3072 sc1
    s_add_u32 s72, s72, 4096
    s_mov_b64 exec, 0
    s_cmp_eq_u32 s3, 0
    s_cbranch_scc1 L_page1
    s_cmp_eq_u32 s3, 1
    s_cbranch_scc1 L_page2
    s_cmp_eq_u32 s3, 2
    s_cbranch_scc1 L_page3
    s_branch L_page4
    s_nop 1
L_spin0:
    s_mov_b32 s96, 0
    s_nop 1
L_spinl0:
    buffer_load_dword v6, v4, s[8:11], s97 offen sc1
    s_add_u32 s96, s96, 1
    s_waitcnt vmcnt(0)
    s_cmp_gt_u32 s96, 131072
    s_cbranch_scc1 L_back0
    v_cmp_eq_u32 vcc, s40, v6
    s_nop 0
    s_and_b32 vcc_lo, vcc_lo, 16777215
    s_cmp_eq_u32 vcc_lo, 16777215
    s_cbranch_scc1 L_back0
    s_branch L_spinl0
    s_nop 1
L_spin1:
    s_mov_b32 s96, 0
    s_nop 1
L_spinl1:
    buffer_load_dword v6, v4, s[8:11], s41 offen sc1
    s_add_u32 s96, s96, 1
    s_waitcnt vmcnt(0)
    s_cmp_gt_u32 s96, 131072
    s_cbranch_scc1 L_back1
    v_cmp_eq_u32 vcc, s40, v6
    s_nop 0
    s_cmp_eq_u32 vcc_lo, -1
    s_cbranch_scc1 L_back1
    s_branch L_spinl1
    s_nop 1
L_spin2:
    s_mov_b32 s96, 0
    s_nop 1
L_spinl2:
    buffer_load_dword v6, v4, s[8:11], s88 offen sc1
    s_add_u32 s96, s96, 1
    s_waitcnt vmcnt(0)
    s_cmp_gt_u32 s96, 131072
    s_cbranch_scc1 L_back2
    v_cmp_eq_u32 vcc, s40, v6
    s_nop 0
    s_and_b32 vcc_lo, vcc_lo, 15
    s_cmp_eq_u32 vcc_lo, 15
    s_cbranch_scc1 L_back2
    s_branch L_spinl2
    s_nop 1
L_spin3:
    s_mov_b32 s96, 0
    s_nop 1
L_spinl3:
    buffer_load_dword v6, v4, s[8:11], s88 offen sc1
    s_add_u32 s96, s96, 1
    s_waitcnt vmcnt(0)
    s_cmp_gt_u32 s96, 131072
    s_cbranch_scc1 L_back3
    v_cmp_eq_u32 vcc, s40, v6
    s_nop 0
    s_and_b32 vcc_lo, vcc_lo, 240
    s_cmp_eq_u32 vcc_lo, 240
    s_cbranch_scc1 L_back3
    s_branch L_spinl3
    s_nop 1
L_spin4:
    s_mov_b32 s96, 0
    s_nop 1
L_spinl4:
    buffer_load_dword v6, v4, s[8:11], s88 offen sc1
    s_add_u32 s96, s96, 1
    s_waitcnt vmcnt(0)
    s_cmp_gt_u32 s96, 131072
    s_cbranch_scc1 L_back4
    v_cmp_eq_u32 vcc, s40, v6
    s_nop 0
    s_and_b32 vcc_lo, vcc_lo, 3840
    s_cmp_eq_u32 vcc_lo, 3840
    s_cbranch_scc1 L_back4
    s_branch L_spinl4
    s_nop 1
L_spin5:
    s_mov_b32 s96, 0
    s_nop 1
L_spinl5:
    buffer_load_dword v254, v4, s[8:11], s89 offen sc1
    s_add_u32 s96, s96, 1
    s_waitcnt vmcnt(0)
    s_cmp_gt_u32 s96, 131072
    s_cbranch_scc1 L_back5
    v_cmp_eq_u32 vcc, s40, v254
    s_nop 0
    s_cmp_eq_u32 vcc_lo, -1
    s_cbranch_scc1 L_back5
    s_branch L_spinl5
    s_nop 1
L_spin6:
    s_mov_b32 s96, 0
    s_nop 1
L_spinl6:
    buffer_load_dword v6, v4, s[8:11], s90 offen sc1
    s_add_u32 s96, s96, 1
    s_waitcnt vmcnt(0)
    s_cmp_gt_u32 s96, 131072
    s_cbranch_scc1 L_back6
    v_cmp_eq_u32 vcc, s40, v6
    s_nop 0
    s_and_b32 vcc_lo, vcc_lo, 255
    s_cmp_eq_u32 vcc_lo, 255
    s_cbranch_scc1 L_back6
    s_branch L_spinl6
    s_nop 1
L_slow:
    v_lshlrev_b32 v249, 1, v4
    v_mov_b32 v96, 0xff800000
    v_mov_b32 v128, 0xff800000
    s_mul_i32 s94, s5, 151552
    s_add_u32 s94, s94, 21233664
    s_add_u32 s95, s94, 16384
    s_add_u32 s97, s94, 18432
    s_mov_b32 s96, 0
    s_nop 1
L_slow_max:
    buffer_load_dwordx2 v[76:77], v249, s[8:11], s95 offen sc1
    buffer_load_dwordx4 v[64:67], v1, s[8:11], s94 offen offset:0 sc1
    buffer_load_dwordx4 v[68:71], v248, s[8:11], s97 offen offset:0 sc1
    buffer_load_dwordx4 v[72:75], v248, s[8:11], s97 offen offset:608 sc1
    s_waitcnt vmcnt(0)
    v_mfma_f32_32x32x16_bf16 v[112:127], v[64:67], v[80:83], 0
    v_mfma_f32_32x32x16_bf16 v[144:159], v[64:67], v[84:87], 0
    v_mfma_f32_32x32x8bf16_1k v[112:127], v[76:77], v[88:89], v[112:127]
    v_mfma_f32_32x32x8bf16_1k v[144:159], v[76:77], v[92:93], v[144:159]
    s_nop 10
    v_max3_f32 v96, v96, v112, v113
    v_max3_f32 v96, v96, v114, v115
    v_max3_f32 v96, v96, v116, v117
    v_max3_f32 v96, v96, v118, v119
    v_max3_f32 v96, v96, v120, v121
    v_max3_f32 v96, v96, v122, v123
    v_max3_f32 v96, v96, v124, v125
    v_max3_f32 v96, v96, v126, v127
    v_max3_f32 v128, v128, v144, v145
    v_max3_f32 v128, v128, v146, v147
    v_max3_f32 v128, v128, v148, v149
    v_max3_f32 v128, v128, v150, v151
    v_max3_f32 v128, v128, v152, v153
    v_max3_f32 v128, v128, v154, v155
    v_max3_f32 v128, v128, v156, v157
    v_max3_f32 v128, v128, v158, v159
    s_nop 4
    buffer_load_dwordx4 v[64:67], v1, s[8:11], s94 offen offset:1024 sc1
    buffer_load_dwordx4 v[68:71], v248, s[8:11], s97 offen offset:1216 sc1
    buffer_load_dwordx4 v[72:75], v248, s[8:11], s97 offen offset:1824 sc1
    s_waitcnt vmcnt(0)
    v_mfma_f32_32x32x16_bf16 v[176:191], v[64:67], v[80:83], 0
    v_mfma_f32_32x32x16_bf16 v[208:223], v[64:67], v[84:87], 0
    v_mfma_f32_32x32x8bf16_1k v[176:191], v[76:77], v[90:91], v[176:191]
    v_mfma_f32_32x32x8bf16_1k v[208:223], v[76:77], v[94:95], v[208:223]
    s_nop 10
    v_max3_f32 v96, v96, v176, v177
    v_max3_f32 v96, v96, v178, v179
    v_max3_f32 v96, v96, v180, v181
    v_max3_f32 v96, v96, v182, v183
    v_max3_f32 v96, v96, v184, v185
    v_max3_f32 v96, v96, v186, v187
    v_max3_f32 v96, v96, v188, v189
    v_max3_f32 v96, v96, v190, v191
    v_max3_f32 v128, v128, v208, v209
    v_max3_f32 v128, v128, v210, v211
    v_max3_f32 v128, v128, v212, v213
    v_max3_f32 v128, v128, v214, v215
    v_max3_f32 v128, v128, v216, v217
    v_max3_f32 v128, v128, v218, v219
    v_max3_f32 v128, v128, v220, v221
    v_max3_f32 v128, v128, v222, v223
    s_nop 4
    s_add_u32 s94, s94, 2048
    s_add_u32 s95, s95, 256
    s_add_u32 s97, s97, 2432
    s_add_u32 s96, s96, 1
    s_and_b32 s98, s96, 7
    s_cbranch_scc1 L_slow_max
    s_add_u32 s94, s94, 21504
    s_add_u32 s95, s95, 35840
    s_add_u32 s97, s97, 18432
    s_cmp_lt_u32 s96, 32
    s_cbranch_scc1 L_slow_max
    s_nop 1
    v_mov_b32 v97, v96
    s_nop 1
    v_permlane32_swap_b32 v96, v97
    v_max_f32 v96, v96, v97
    v_sub_f32 v96, 0, v96
    v_mov_b32 v97, v96
    v_mov_b32 v98, v96
    v_mov_b32 v99, v96
    v_mov_b32 v100, v96
    v_mov_b32 v101, v96
    v_mov_b32 v102, v96
    v_mov_b32 v103, v96
    v_mov_b32 v104, v96
    v_mov_b32 v105, v96
    v_mov_b32 v106, v96
    v_mov_b32 v107, v96
    v_mov_b32 v108, v96
    v_mov_b32 v109, v96
    v_mov_b32 v110, v96
    v_mov_b32 v111, v96
    v_mov_b32 v129, v128
    s_nop 1
    v_permlane32_swap_b32 v128, v129
    v_max_f32 v128, v128, v129
    v_sub_f32 v128, 0, v128
    v_mov_b32 v129, v128
    v_mov_b32 v130, v128
    v_mov_b32 v131, v128
    v_mov_b32 v132, v128
    v_mov_b32 v133, v128
    v_mov_b32 v134, v128
    v_mov_b32 v135, v128
    v_mov_b32 v136, v128
    v_mov_b32 v137, v128
    v_mov_b32 v138, v128
    v_mov_b32 v139, v128
    v_mov_b32 v140, v128
    v_mov_b32 v141, v128
    v_mov_b32 v142, v128
    v_mov_b32 v143, v128
    v_mov_b32 v32, 0
    v_mov_b32 v33, 0
    v_mov_b32 v34, 0
    v_mov_b32 v35, 0
    v_mov_b32 v36, 0
    v_mov_b32 v37, 0
    v_mov_b32 v38, 0
    v_mov_b32 v39, 0
    v_mov_b32 v40, 0
    v_mov_b32 v41, 0
    v_mov_b32 v42, 0
    v_mov_b32 v43, 0
    v_mov_b32 v44, 0
    v_mov_b32 v45, 0
    v_mov_b32 v46, 0
    v_mov_b32 v47, 0
    v_mov_b32 v48, 0
    v_mov_b32 v49, 0
    v_mov_b32 v50, 0
    v_mov_b32 v51, 0
    v_mov_b32 v52, 0
    v_mov_b32 v53, 0
    v_mov_b32 v54, 0
    v_mov_b32 v55, 0
    v_mov_b32 v56, 0
    v_mov_b32 v57, 0
    v_mov_b32 v58, 0
    v_mov_b32 v59, 0
    v_mov_b32 v60, 0
    v_mov_b32 v61, 0
    v_mov_b32 v62, 0
    v_mov_b32 v63, 0
    s_mul_i32 s94, s5, 151552
    s_add_u32 s94, s94, 21233664
    s_add_u32 s95, s94, 16384
    s_add_u32 s97, s94, 18432
    s_mov_b32 s96, 0
    s_nop 1
L_slow_sum:
    buffer_load_dwordx2 v[76:77], v249, s[8:11], s95 offen sc1
    buffer_load_dwordx4 v[64:67], v1, s[8:11], s94 offen offset:0 sc1
    buffer_load_dwordx4 v[68:71], v248, s[8:11], s97 offen offset:0 sc1
    buffer_load_dwordx4 v[72:75], v248, s[8:11], s97 offen offset:608 sc1
    s_waitcnt vmcnt(0)
    v_mfma_f32_32x32x16_bf16 v[112:127], v[64:67], v[80:83], v[96:111]
    v_mfma_f32_32x32x16_bf16 v[144:159], v[64:67], v[84:87], v[128:143]
    v_mfma_f32_32x32x8bf16_1k v[112:127], v[76:77], v[88:89], v[112:127]
    v_mfma_f32_32x32x8bf16_1k v[144:159], v[76:77], v[92:93], v[144:159]
    s_nop 10
    v_exp_f32 v112, v112
    v_exp_f32 v113, v113
    v_exp_f32 v114, v114
    v_exp_f32 v115, v115
    v_exp_f32 v116, v116
    v_exp_f32 v117, v117
    v_exp_f32 v118, v118
    v_exp_f32 v119, v119
    v_exp_f32 v120, v120
    v_exp_f32 v121, v121
    v_exp_f32 v122, v122
    v_exp_f32 v123, v123
    v_exp_f32 v124, v124
    v_exp_f32 v125, v125
    v_exp_f32 v126, v126
    v_exp_f32 v127, v127
    v_exp_f32 v144, v144
    v_exp_f32 v145, v145
    v_exp_f32 v146, v146
    v_exp_f32 v147, v147
    v_exp_f32 v148, v148
    v_exp_f32 v149, v149
    v_exp_f32 v150, v150
    v_exp_f32 v151, v151
    v_exp_f32 v152, v152
    v_exp_f32 v153, v153
    v_exp_f32 v154, v154
    v_exp_f32 v155, v155
    v_exp_f32 v156, v156
    v_exp_f32 v157, v157
    v_exp_f32 v158, v158
    v_exp_f32 v159, v159
    v_smfmac_f32_32x32x32_bf16 v[32:47], v[68:71], v[112:119], v253
    v_smfmac_f32_32x32x32_bf16 v[32:47], v[72:75], v[120:127], v253
    v_smfmac_f32_32x32x32_bf16 v[48:63], v[68:71], v[144:151], v253
    v_smfmac_f32_32x32x32_bf16 v[48:63], v[72:75], v[152:159], v253
    s_nop 11
    buffer_load_dwordx4 v[64:67], v1, s[8:11], s94 offen offset:1024 sc1
    buffer_load_dwordx4 v[68:71], v248, s[8:11], s97 offen offset:1216 sc1
    buffer_load_dwordx4 v[72:75], v248, s[8:11], s97 offen offset:1824 sc1
    s_waitcnt vmcnt(0)
    v_mfma_f32_32x32x16_bf16 v[176:191], v[64:67], v[80:83], v[96:111]
    v_mfma_f32_32x32x16_bf16 v[208:223], v[64:67], v[84:87], v[128:143]
    v_mfma_f32_32x32x8bf16_1k v[176:191], v[76:77], v[90:91], v[176:191]
    v_mfma_f32_32x32x8bf16_1k v[208:223], v[76:77], v[94:95], v[208:223]
    s_nop 10
    v_exp_f32 v176, v176
    v_exp_f32 v177, v177
    v_exp_f32 v178, v178
    v_exp_f32 v179, v179
    v_exp_f32 v180, v180
    v_exp_f32 v181, v181
    v_exp_f32 v182, v182
    v_exp_f32 v183, v183
    v_exp_f32 v184, v184
    v_exp_f32 v185, v185
    v_exp_f32 v186, v186
    v_exp_f32 v187, v187
    v_exp_f32 v188, v188
    v_exp_f32 v189, v189
    v_exp_f32 v190, v190
    v_exp_f32 v191, v191
    v_exp_f32 v208, v208
    v_exp_f32 v209, v209
    v_exp_f32 v210, v210
    v_exp_f32 v211, v211
    v_exp_f32 v212, v212
    v_exp_f32 v213, v213
    v_exp_f32 v214, v214
    v_exp_f32 v215, v215
    v_exp_f32 v216, v216
    v_exp_f32 v217, v217
    v_exp_f32 v218, v218
    v_exp_f32 v219, v219
    v_exp_f32 v220, v220
    v_exp_f32 v221, v221
    v_exp_f32 v222, v222
    v_exp_f32 v223, v223
    v_smfmac_f32_32x32x32_bf16 v[32:47], v[68:71], v[176:183], v253
    v_smfmac_f32_32x32x32_bf16 v[32:47], v[72:75], v[184:191], v253
    v_smfmac_f32_32x32x32_bf16 v[48:63], v[68:71], v[208:215], v253
    v_smfmac_f32_32x32x32_bf16 v[48:63], v[72:75], v[216:223], v253
    s_nop 11
    s_add_u32 s94, s94, 2048
    s_add_u32 s95, s95, 256
    s_add_u32 s97, s97, 2432
    s_add_u32 s96, s96, 1
    s_and_b32 s98, s96, 7
    s_cbranch_scc1 L_slow_sum
    s_add_u32 s94, s94, 21504
    s_add_u32 s95, s95, 35840
    s_add_u32 s97, s97, 18432
    s_cmp_lt_u32 s96, 32
    s_cbranch_scc1 L_slow_sum
    s_nop 1
    s_branch L_fin
    s_nop 1
L_spin7:
    s_mov_b32 s96, 0
    s_nop 1
L_spinl7:
    buffer_load_dword v6, v4, s[8:11], s91 offen sc1
    s_add_u32 s96, s96, 1
    s_waitcnt vmcnt(0)
    s_cmp_gt_u32 s96, 131072
    s_cbranch_scc1 L_back7
    v_cmp_eq_u32 vcc, s40, v6
    s_nop 0
    s_cmp_eq_u32 vcc_lo, -1
    s_cbranch_scc1 L_back7
    s_branch L_spinl7
.p2align 12
    s_nop 1
L_pagedone:
    s_mov_b64 exec, -1
    s_waitcnt vmcnt(8)
    s_waitcnt lgkmcnt(4)
    v_mfma_f32_16x16x32_bf16 v[96:99], v[64:67], a[0:3], 0
    ds_read_b64_tr_b16 v[76:77], v9 offset:1024
    v_mfma_f32_16x16x32_bf16 v[100:103], v[64:67], a[4:7], 0
    ds_read_b64_tr_b16 v[78:79], v9 offset:5120
    s_lshl_b32 s88, s4, 3
    v_mfma_f32_16x16x32_bf16 v[104:107], v[64:67], a[8:11], 0
    buffer_load_dwordx4 a[48:51], v1, s[8:11], s72 offen offset:0 sc1
    v_mfma_f32_16x16x32_bf16 v[108:111], v[64:67], a[12:15], 0
    s_waitcnt lgkmcnt(4)
    s_add_u32 s88, s88, s6
    s_lshl_b32 s88, s88, 2
    v_mfma_f32_16x16x32_bf16 v[124:127], v[68:71], a[12:15], 0
    ds_read_b64_tr_b16 v[64:65], v10 offset:0
    s_add_u32 s88, s88, s3
    v_mfma_f32_16x16x32_bf16 v[120:123], v[68:71], a[8:11], 0
    ds_read_b64_tr_b16 v[66:67], v10 offset:4096
    s_lshl_b32 s88, s88, 7
    v_mfma_f32_16x16x32_bf16 v[116:119], v[68:71], a[4:7], 0
    buffer_load_dwordx4 a[52:55], v1, s[8:11], s72 offen offset:1024 sc1
    v_mfma_f32_16x16x32_bf16 v[112:115], v[68:71], a[0:3], 0
    s_waitcnt lgkmcnt(4)
    s_add_u32 s88, s88, 49676288
    s_lshl_b32 s94, s7, 2
    v_mfma_f32_16x16x32_bf16 v[128:131], v[72:75], a[0:3], 0
    ds_read_b64_tr_b16 v[68:69], v10 offset:1024
    s_add_u32 s84, s88, s94
    v_mfma_f32_16x16x32_bf16 v[132:135], v[72:75], a[4:7], 0
    ds_read_b64_tr_b16 v[70:71], v10 offset:5120
    s_lshl_b32 s89, s5, 7
    v_mfma_f32_16x16x32_bf16 v[136:139], v[72:75], a[8:11], 0
    buffer_load_dwordx4 a[56:59], v1, s[8:11], s72 offen offset:2048 sc1
    v_mfma_f32_16x16x32_bf16 v[140:143], v[72:75], a[12:15], 0
    s_waitcnt lgkmcnt(4)
    s_add_u32 s89, s89, 49709056
    s_lshl_b32 s94, s4, 2
    v_mfma_f32_16x16x32_bf16 v[156:159], v[76:79], a[12:15], 0
    ds_read_b64_tr_b16 v[72:73], v11 offset:0
    s_add_u32 s94, s94, s3
    v_mfma_f32_16x16x32_bf16 v[152:155], v[76:79], a[8:11], 0
    ds_read_b64_tr_b16 v[74:75], v11 offset:4096
    s_lshl_b32 s94, s94, 2
    v_mfma_f32_16x16x32_bf16 v[148:151], v[76:79], a[4:7], 0
    buffer_load_dwordx4 a[60:63], v1, s[8:11], s72 offen offset:3072 sc1
    v_mfma_f32_16x16x32_bf16 v[144:147], v[76:79], a[0:3], 0
    s_waitcnt lgkmcnt(4)
    s_add_u32 s72, s72, 4096
    s_add_u32 s85, s89, s94
    v_mfma_f32_16x16x32_bf16 v[160:163], v[64:67], a[0:3], 0
    ds_read_b64_tr_b16 v[76:77], v11 offset:1024
    s_lshl_b32 s86, s4, 2
    v_mfma_f32_16x16x32_bf16 v[164:167], v[64:67], a[4:7], 0
    ds_read_b64_tr_b16 v[78:79], v11 offset:5120
    s_add_u32 s86, s86, s7
    v_mfma_f32_16x16x32_bf16 v[168:171], v[64:67], a[8:11], 0
    buffer_load_dwordx4 a[64:67], v1, s[8:11], s72 offen offset:0 sc1
    v_mfma_f32_16x16x32_bf16 v[172:175], v[64:67], a[12:15], 0
    s_waitcnt lgkmcnt(4)
    s_lshl_b32 s86, s86, 2
    s_add_u32 s86, s86, s3
    v_mfma_f32_16x16x32_bf16 v[188:191], v[68:71], a[12:15], 0
    ds_read_b64_tr_b16 v[64:65], v8 offset:8192
    s_lshl_b32 s86, s86, 7
    v_mfma_f32_16x16x32_bf16 v[184:187], v[68:71], a[8:11], 0
    ds_read_b64_tr_b16 v[66:67], v8 offset:12288
    s_add_u32 s86, s86, 49713152
    v_mfma_f32_16x16x32_bf16 v[180:183], v[68:71], a[4:7], 0
    buffer_load_dwordx4 a[68:71], v1, s[8:11], s72 offen offset:1024 sc1
    v_mfma_f32_16x16x32_bf16 v[176:179], v[68:71], a[0:3], 0
    s_waitcnt lgkmcnt(4)
    s_lshl_b32 s94, s6, 2
    s_add_u32 s86, s86, s94
    v_mfma_f32_16x16x32_bf16 v[192:195], v[72:75], a[0:3], 0
    ds_read_b64_tr_b16 v[68:69], v8 offset:9216
    s_lshr_b32 s95, s4, 1
    v_mfma_f32_16x16x32_bf16 v[196:199], v[72:75], a[4:7], 0
    ds_read_b64_tr_b16 v[70:71], v8 offset:13312
    s_lshl_b32 s90, s6, 2
    v_mfma_f32_16x16x32_bf16 v[200:203], v[72:75], a[8:11], 0
    buffer_load_dwordx4 a[72:75], v1, s[8:11], s72 offen offset:2048 sc1
    v_mfma_f32_16x16x32_bf16 v[204:207], v[72:75], a[12:15], 0
    s_waitcnt lgkmcnt(4)
    s_add_u32 s90, s90, s95
    s_lshl_b32 s90, s90, 2
    v_mfma_f32_16x16x32_bf16 v[220:223], v[76:79], a[12:15], 0
    ds_read_b64_tr_b16 v[72:73], v9 offset:8192
    s_add_u32 s90, s90, s7
    v_mfma_f32_16x16x32_bf16 v[216:219], v[76:79], a[8:11], 0
    ds_read_b64_tr_b16 v[74:75], v9 offset:12288
    s_lshl_b32 s90, s90, 7
    v_mfma_f32_16x16x32_bf16 v[212:215], v[76:79], a[4:7], 0
    s_add_u32 s90, s90, 49713152
    s_lshl_b32 s87, s4, 2
    s_add_u32 s87, s87, s3
    v_mfma_f32_16x16x32_bf16 v[208:211], v[76:79], a[0:3], 0
    s_waitcnt vmcnt(11)
    s_waitcnt lgkmcnt(4)
    s_lshl_b32 s87, s87, 7
    v_mfma_f32_16x16x32_bf16 v[96:99], v[64:67], a[16:19], v[96:99]
    ds_read_b64_tr_b16 v[76:77], v9 offset:9216
    s_add_u32 s87, s87, 49729536
    v_mfma_f32_16x16x32_bf16 v[100:103], v[64:67], a[20:23], v[100:103]
    ds_read_b64_tr_b16 v[78:79], v9 offset:13312
    s_lshl_b32 s94, s5, 2
    v_mfma_f32_16x16x32_bf16 v[104:107], v[64:67], a[24:27], v[104:107]
    buffer_load_dwordx4 a[76:79], v1, s[8:11], s72 offen offset:3072 sc1
    v_mfma_f32_16x16x32_bf16 v[108:111], v[64:67], a[28:31], v[108:111]
    s_waitcnt lgkmcnt(4)
    s_add_u32 s72, s72, 4096
    s_add_u32 s87, s87, s94
    v_mfma_f32_16x16x32_bf16 v[124:127], v[68:71], a[28:31], v[124:127]
    ds_read_b64_tr_b16 v[64:65], v10 offset:8192
    s_lshl_b32 s91, s6, 2
    v_mfma_f32_16x16x32_bf16 v[120:123], v[68:71], a[24:27], v[120:123]
    ds_read_b64_tr_b16 v[66:67], v10 offset:12288
    s_add_u32 s91, s91, s7
    v_mfma_f32_16x16x32_bf16 v[116:119], v[68:71], a[20:23], v[116:119]
    global_load_dword v84, v80, s[56:57] offset:128
    v_mfma_f32_16x16x32_bf16 v[112:115], v[68:71], a[16:19], v[112:115]
    s_waitcnt lgkmcnt(4)
    s_lshl_b32 s91, s91, 7
    s_add_u32 s91, s91, 49729536
    v_mfma_f32_16x16x32_bf16 v[128:131], v[72:75], a[16:19], v[128:131]
    ds_read_b64_tr_b16 v[68:69], v10 offset:9216
    v_add_u32 v12, 0x10000, v8
    v_mfma_f32_16x16x32_bf16 v[132:135], v[72:75], a[20:23], v[132:135]
    ds_read_b64_tr_b16 v[70:71], v10 offset:13312
    v_add_u32 v13, 0x10000, v9
    v_mfma_f32_16x16x32_bf16 v[136:139], v[72:75], a[24:27], v[136:139]
    global_load_dword v84, v80, s[58:59] offset:128
    v_mfma_f32_16x16x32_bf16 v[140:143], v[72:75], a[28:31], v[140:143]
    s_waitcnt lgkmcnt(4)
    v_add_u32 v14, 0x10000, v10
    v_add_u32 v15, 0x10000, v11
    v_mfma_f32_16x16x32_bf16 v[156:159], v[76:79], a[28:31], v[156:159]
    ds_read_b64_tr_b16 v[72:73], v11 offset:8192
    v_lshl_add_u32 v37, v34, 2, v35
    v_mfma_f32_16x16x32_bf16 v[152:155], v[76:79], a[24:27], v[152:155]
    ds_read_b64_tr_b16 v[74:75], v11 offset:12288
    v_bfe_u32 v38, v37, 2, 1
    v_mfma_f32_16x16x32_bf16 v[148:151], v[76:79], a[20:23], v[148:151]
    buffer_load_dwordx4 a[80:83], v1, s[8:11], s72 offen offset:0 sc1
    v_mfma_f32_16x16x32_bf16 v[144:147], v[76:79], a[16:19], v[144:147]
    s_waitcnt lgkmcnt(4)
    v_lshlrev_b32 v39, 6, v37
    v_lshl_add_u32 v39, v36, 3, v39
    v_mfma_f32_16x16x32_bf16 v[160:163], v[64:67], a[16:19], v[160:163]
    ds_read_b64_tr_b16 v[76:77], v11 offset:9216
    v_lshl_add_u32 v16, v38, 5, v39
    v_mfma_f32_16x16x32_bf16 v[164:167], v[64:67], a[20:23], v[164:167]
    ds_read_b64_tr_b16 v[78:79], v11 offset:13312
    v_xor_b32 v38, 1, v38
    v_mfma_f32_16x16x32_bf16 v[168:171], v[64:67], a[24:27], v[168:171]
    buffer_load_dwordx4 a[84:87], v1, s[8:11], s72 offen offset:1024 sc1
    v_mfma_f32_16x16x32_bf16 v[172:175], v[64:67], a[28:31], v[172:175]
    s_waitcnt lgkmcnt(4)
    v_lshlrev_b32 v39, 6, v37
    v_lshl_add_u32 v39, v38, 5, v39
    v_mfma_f32_16x16x32_bf16 v[188:191], v[68:71], a[28:31], v[188:191]
    ds_read_b64_tr_b16 v[64:65], v8 offset:16384
    v_min_u32 v40, 2, v36
    v_mfma_f32_16x16x32_bf16 v[184:187], v[68:71], a[24:27], v[184:187]
    ds_read_b64_tr_b16 v[66:67], v8 offset:20480
    v_lshl_add_u32 v39, v40, 11, v39
    v_mfma_f32_16x16x32_bf16 v[180:183], v[68:71], a[20:23], v[180:183]
    buffer_load_dwordx4 a[88:91], v1, s[8:11], s72 offen offset:2048 sc1
    v_mfma_f32_16x16x32_bf16 v[176:179], v[68:71], a[16:19], v[176:179]
    s_waitcnt lgkmcnt(4)
    v_and_b32 v40, 1, v40
    v_lshl_add_u32 v39, v40, 4, v39
    v_mfma_f32_16x16x32_bf16 v[192:195], v[72:75], a[16:19], v[192:195]
    ds_read_b64_tr_b16 v[68:69], v8 offset:17408
    v_add_u32 v17, 8, v39
    v_mfma_f32_16x16x32_bf16 v[196:199], v[72:75], a[20:23], v[196:199]
    ds_read_b64_tr_b16 v[70:71], v8 offset:21504
    v_lshlrev_b32 v39, 5, v37
    v_mfma_f32_16x16x32_bf16 v[200:203], v[72:75], a[24:27], v[200:203]
    v_lshl_add_u32 v18, v36, 3, v39
    v_add_u32 v19, 0x10000, v16
    v_mfma_f32_16x16x32_bf16 v[204:207], v[72:75], a[28:31], v[204:207]
    s_waitcnt lgkmcnt(4)
    buffer_load_dwordx4 a[92:95], v1, s[8:11], s72 offen offset:3072 sc1
    v_mfma_f32_16x16x32_bf16 v[220:223], v[76:79], a[28:31], v[220:223]
    s_add_u32 s72, s72, 4096
    ds_read_b64_tr_b16 v[72:73], v9 offset:16384
    v_add_u32 v20, 0x10000, v17
    v_mfma_f32_16x16x32_bf16 v[216:219], v[76:79], a[24:27], v[216:219]
    ds_read_b64_tr_b16 v[74:75], v9 offset:20480
    v_add_u32 v21, 0x10000, v18
    v_mfma_f32_16x16x32_bf16 v[212:215], v[76:79], a[20:23], v[212:215]
    v_add_u32 v22, 131072, v18
    s_mov_b32 s28, s60
    v_mfma_f32_16x16x32_bf16 v[208:211], v[76:79], a[16:19], v[208:211]
    s_waitcnt vmcnt(14)
    s_waitcnt lgkmcnt(4)
    s_mov_b32 s29, s61
    v_mfma_f32_16x16x32_bf16 v[96:99], v[64:67], a[32:35], v[96:99]
    ds_read_b64_tr_b16 v[76:77], v9 offset:17408
    s_mov_b32 s30, 5308416
    v_mfma_f32_16x16x32_bf16 v[100:103], v[64:67], a[36:39], v[100:103]
    ds_read_b64_tr_b16 v[78:79], v9 offset:21504
    s_mov_b32 s31, 0x20000
    v_mfma_f32_16x16x32_bf16 v[104:107], v[64:67], a[40:43], v[104:107]
    global_load_dword v84, v85, s[56:57]
    v_mfma_f32_16x16x32_bf16 v[108:111], v[64:67], a[44:47], v[108:111]
    s_waitcnt lgkmcnt(4)
    s_sub_u32 s32, s60, 896
    s_subb_u32 s33, s61, 0
    s_mov_b32 s34, 5309312
    v_mfma_f32_16x16x32_bf16 v[124:127], v[68:71], a[44:47], v[124:127]
    ds_read_b64_tr_b16 v[64:65], v10 offset:16384
    s_mov_b32 s35, 0x20000
    v_mfma_f32_16x16x32_bf16 v[120:123], v[68:71], a[40:43], v[120:123]
    ds_read_b64_tr_b16 v[66:67], v10 offset:20480
    v_lshrrev_b32 v37, 1, v33
    v_mfma_f32_16x16x32_bf16 v[116:119], v[68:71], a[36:39], v[116:119]
    global_load_dword v84, v85, s[58:59]
    v_mfma_f32_16x16x32_bf16 v[112:115], v[68:71], a[32:35], v[112:115]
    s_waitcnt lgkmcnt(4)
    v_mul_u32_u24 v38, 1152, v37
    v_and_b32 v39, 1, v0
    v_mfma_f32_16x16x32_bf16 v[128:131], v[72:75], a[32:35], v[128:131]
    ds_read_b64_tr_b16 v[68:69], v10 offset:17408
    v_lshl_add_u32 v26, v39, 4, v38
    v_mfma_f32_16x16x32_bf16 v[132:135], v[72:75], a[36:39], v[132:135]
    ds_read_b64_tr_b16 v[70:71], v10 offset:21504
    s_mul_i32 s94, s6, 663552
    v_mfma_f32_16x16x32_bf16 v[136:139], v[72:75], a[40:43], v[136:139]
    buffer_load_dwordx4 a[96:99], v1, s[8:11], s72 offen offset:0 sc1
    v_mfma_f32_16x16x32_bf16 v[140:143], v[72:75], a[44:47], v[140:143]
    s_waitcnt lgkmcnt(4)
    s_lshl_b32 s95, s7, 8
    s_add_u32 s80, s94, s95
    v_mfma_f32_16x16x32_bf16 v[156:159], v[76:79], a[44:47], v[156:159]
    ds_read_b64_tr_b16 v[72:73], v11 offset:16384
    s_mul_i32 s95, s7, 224
    v_mfma_f32_16x16x32_bf16 v[152:155], v[76:79], a[40:43], v[152:155]
    ds_read_b64_tr_b16 v[74:75], v11 offset:20480
    s_sub_u32 s95, 1024, s95
    v_mfma_f32_16x16x32_bf16 v[148:151], v[76:79], a[36:39], v[148:151]
    v_add_u32 v26, s95, v26
    s_lshl_b32 s81, s3, 10
    v_mfma_f32_16x16x32_bf16 v[144:147], v[76:79], a[32:35], v[144:147]
    s_waitcnt lgkmcnt(4)
    buffer_load_dwordx4 a[100:103], v1, s[8:11], s72 offen offset:1024 sc1
    v_mfma_f32_16x16x32_bf16 v[160:163], v[64:67], a[32:35], v[160:163]
    ds_read_b64_tr_b16 v[76:77], v11 offset:17408
    s_add_u32 s94, s7, 0
    v_mfma_f32_16x16x32_bf16 v[164:167], v[64:67], a[36:39], v[164:167]
    ds_read_b64_tr_b16 v[78:79], v11 offset:21504
    s_and_b32 s94, s94, 3
    v_mfma_f32_16x16x32_bf16 v[168:171], v[64:67], a[40:43], v[168:171]
    s_mul_i32 s94, s94, 147456
    s_add_u32 s44, s80, s94
    s_add_u32 s94, s7, 1
    v_mfma_f32_16x16x32_bf16 v[172:175], v[64:67], a[44:47], v[172:175]
    s_waitcnt lgkmcnt(4)
    s_barrier
    s_and_b32 s94, s94, 3
    v_mfma_f32_16x16x32_bf16 v[188:191], v[68:71], a[44:47], v[188:191]
    ds_read_b64_tr_b16 v[64:65], v8 offset:24576
    s_mul_i32 s94, s94, 147456
    v_mfma_f32_16x16x32_bf16 v[184:187], v[68:71], a[40:43], v[184:187]
    ds_read_b64_tr_b16 v[66:67], v8 offset:28672
    s_add_u32 s45, s80, s94
    v_mfma_f32_16x16x32_bf16 v[180:183], v[68:71], a[36:39], v[180:183]
    buffer_load_dwordx4 a[104:107], v1, s[8:11], s72 offen offset:2048 sc1
    v_mfma_f32_16x16x32_bf16 v[176:179], v[68:71], a[32:35], v[176:179]
    s_waitcnt lgkmcnt(4)
    s_add_u32 s94, s7, 2
    s_and_b32 s94, s94, 3
    v_mfma_f32_16x16x32_bf16 v[192:195], v[72:75], a[32:35], v[192:195]
    ds_read_b64_tr_b16 v[68:69], v8 offset:25600
    s_mul_i32 s94, s94, 147456
    v_mfma_f32_16x16x32_bf16 v[196:199], v[72:75], a[36:39], v[196:199]
    ds_read_b64_tr_b16 v[70:71], v8 offset:29696
    s_add_u32 s48, s80, s94
    v_mfma_f32_16x16x32_bf16 v[200:203], v[72:75], a[40:43], v[200:203]
    buffer_load_dwordx4 a[108:111], v1, s[8:11], s72 offen offset:3072 sc1
    v_mfma_f32_16x16x32_bf16 v[204:207], v[72:75], a[44:47], v[204:207]
    s_waitcnt lgkmcnt(4)
    s_add_u32 s72, s72, 4096
    s_add_u32 s94, s7, 3
    v_mfma_f32_16x16x32_bf16 v[220:223], v[76:79], a[44:47], v[220:223]
    s_add_u32 m0, s64, 73728
    ds_read_b64_tr_b16 v[72:73], v9 offset:24576
    s_and_b32 s94, s94, 3
    v_mfma_f32_16x16x32_bf16 v[216:219], v[76:79], a[40:43], v[216:219]
    ds_read_b64_tr_b16 v[74:75], v9 offset:28672
    s_mul_i32 s94, s94, 147456
    v_mfma_f32_16x16x32_bf16 v[212:215], v[76:79], a[36:39], v[212:215]
    buffer_load_dwordx4 v23, s[12:15], s65 offen lds
    v_mfma_f32_16x16x32_bf16 v[208:211], v[76:79], a[32:35], v[208:211]
    s_waitcnt vmcnt(17)
    s_waitcnt lgkmcnt(4)
    s_add_u32 s49, s80, s94
    v_mfma_f32_16x16x32_bf16 v[96:99], v[64:67], a[48:51], v[96:99]
    ds_read_b64_tr_b16 v[76:77], v9 offset:25600
    s_lshl_b32 s94, s4, 3
    v_mfma_f32_16x16x32_bf16 v[100:103], v[64:67], a[52:55], v[100:103]
    ds_read_b64_tr_b16 v[78:79], v9 offset:29696
    s_add_u32 s94, s94, s6
    v_mfma_f32_16x16x32_bf16 v[104:107], v[64:67], a[56:59], v[104:107]
    buffer_load_dwordx4 v23, s[16:19], s65 offen offset:1024 lds
    v_mfma_f32_16x16x32_bf16 v[108:111], v[64:67], a[60:63], v[108:111]
    s_waitcnt lgkmcnt(4)
    s_add_u32 s65, s65, 294912
    s_lshl_b32 s94, s94, 2
    v_mfma_f32_16x16x32_bf16 v[124:127], v[68:71], a[60:63], v[124:127]
    s_add_u32 m0, s64, 81920
    ds_read_b64_tr_b16 v[64:65], v10 offset:24576
    s_add_u32 s94, s94, s3
    v_mfma_f32_16x16x32_bf16 v[120:123], v[68:71], a[56:59], v[120:123]
    ds_read_b64_tr_b16 v[66:67], v10 offset:28672
    s_mul_i32 s94, s94, 73728
    v_mfma_f32_16x16x32_bf16 v[116:119], v[68:71], a[52:55], v[116:119]
    buffer_load_dwordx4 v23, s[12:15], s65 offen lds
    v_mfma_f32_16x16x32_bf16 v[112:115], v[68:71], a[48:51], v[112:115]
    s_waitcnt lgkmcnt(4)
    s_add_u32 s82, s94, 2359296
    s_lshl_b32 s95, s7, 14
    v_mfma_f32_16x16x32_bf16 v[128:131], v[72:75], a[48:51], v[128:131]
    ds_read_b64_tr_b16 v[68:69], v10 offset:25600
    s_add_u32 s75, s82, s95
    v_mfma_f32_16x16x32_bf16 v[132:135], v[72:75], a[52:55], v[132:135]
    ds_read_b64_tr_b16 v[70:71], v10 offset:29696
    s_add_u32 s76, s75, 4096
    v_mfma_f32_16x16x32_bf16 v[136:139], v[72:75], a[56:59], v[136:139]
    buffer_load_dwordx4 v23, s[16:19], s65 offen offset:1024 lds
    v_mfma_f32_16x16x32_bf16 v[140:143], v[72:75], a[60:63], v[140:143]
    s_waitcnt lgkmcnt(4)
    s_add_u32 s65, s65, 294912
    s_lshr_b32 s95, s7, 1
    v_mfma_f32_16x16x32_bf16 v[156:159], v[76:79], a[60:63], v[156:159]
    s_add_u32 m0, s64, 90112
    ds_read_b64_tr_b16 v[72:73], v11 offset:24576
    s_add_u32 s95, s95, 16
    v_mfma_f32_16x16x32_bf16 v[152:155], v[76:79], a[56:59], v[152:155]
    ds_read_b64_tr_b16 v[74:75], v11 offset:28672
    s_lshl_b32 s95, s95, 12
    v_mfma_f32_16x16x32_bf16 v[148:151], v[76:79], a[52:55], v[148:151]
    buffer_load_dwordx4 v23, s[12:15], s65 offen lds
    v_mfma_f32_16x16x32_bf16 v[144:147], v[76:79], a[48:51], v[144:147]
    s_waitcnt lgkmcnt(4)
    s_add_u32 s77, s82, s95
    s_and_b32 s95, s7, 1
    v_mfma_f32_16x16x32_bf16 v[160:163], v[64:67], a[48:51], v[160:163]
    ds_read_b64_tr_b16 v[76:77], v11 offset:25600
    s_lshl_b32 s95, s95, 9
    v_mfma_f32_16x16x32_bf16 v[164:167], v[64:67], a[52:55], v[164:167]
    ds_read_b64_tr_b16 v[78:79], v11 offset:29696
    s_add_u32 s77, s77, s95
    v_mfma_f32_16x16x32_bf16 v[168:171], v[64:67], a[56:59], v[168:171]
    buffer_load_dwordx4 v23, s[16:19], s65 offen offset:1024 lds
    v_mfma_f32_16x16x32_bf16 v[172:175], v[64:67], a[60:63], v[172:175]
    s_waitcnt lgkmcnt(4)
    s_add_u32 s65, s65, 294912
    s_mul_i32 s54, s5, 151552
    v_mfma_f32_16x16x32_bf16 v[188:191], v[68:71], a[60:63], v[188:191]
    ds_read_b64_tr_b16 v[64:65], v8 offset:32768
    s_add_u32 s54, s54, 21233664
    v_mfma_f32_16x16x32_bf16 v[184:187], v[68:71], a[56:59], v[184:187]
    ds_read_b64_tr_b16 v[66:67], v8 offset:36864
    s_lshr_b32 s95, s4, 1
    v_mfma_f32_16x16x32_bf16 v[180:183], v[68:71], a[52:55], v[180:183]
    buffer_load_dwordx4 a[112:115], v1, s[8:11], s72 offen offset:0 sc1
    v_mfma_f32_16x16x32_bf16 v[176:179], v[68:71], a[48:51], v[176:179]
    s_waitcnt lgkmcnt(4)
    s_mul_i32 s95, s95, 37888
    s_add_u32 s94, s54, s95
    v_mfma_f32_16x16x32_bf16 v[192:195], v[72:75], a[48:51], v[192:195]
    ds_read_b64_tr_b16 v[68:69], v8 offset:33792
    s_and_b32 s95, s4, 1
    v_mfma_f32_16x16x32_bf16 v[196:199], v[72:75], a[52:55], v[196:199]
    ds_read_b64_tr_b16 v[70:71], v8 offset:37888
    s_lshl_b32 s95, s95, 2
    v_mfma_f32_16x16x32_bf16 v[200:203], v[72:75], a[56:59], v[200:203]
    s_add_u32 s95, s95, s3
    s_lshl_b32 s100, s95, 11
    s_add_u32 s78, s94, s100
    v_mfma_f32_16x16x32_bf16 v[204:207], v[72:75], a[60:63], v[204:207]
    s_waitcnt lgkmcnt(4)
    buffer_load_dwordx4 a[116:119], v1, s[8:11], s72 offen offset:1024 sc1
    v_mfma_f32_16x16x32_bf16 v[220:223], v[76:79], a[60:63], v[220:223]
    ds_read_b64_tr_b16 v[72:73], v9 offset:32768
    s_lshl_b32 s100, s95, 8
    v_mfma_f32_16x16x32_bf16 v[216:219], v[76:79], a[56:59], v[216:219]
    ds_read_b64_tr_b16 v[74:75], v9 offset:36864
    s_add_u32 s100, s100, s94
    v_mfma_f32_16x16x32_bf16 v[212:215], v[76:79], a[52:55], v[212:215]
    s_add_u32 s100, s100, 16384
    s_mul_i32 s101, s95, 2432
    s_add_u32 s101, s101, s94
    v_mfma_f32_16x16x32_bf16 v[208:211], v[76:79], a[48:51], v[208:211]
    s_waitcnt vmcnt(20)
    s_waitcnt lgkmcnt(4)
    s_add_u32 s101, s101, 18432
    v_mfma_f32_16x16x32_bf16 v[96:99], v[64:67], a[64:67], v[96:99]
    ds_read_b64_tr_b16 v[76:77], v9 offset:33792
    s_mov_b32 s46, s101
    v_mfma_f32_16x16x32_bf16 v[100:103], v[64:67], a[68:71], v[100:103]
    ds_read_b64_tr_b16 v[78:79], v9 offset:37888
    s_mul_i32 s101, s3, 2432
    v_mfma_f32_16x16x32_bf16 v[104:107], v[64:67], a[72:75], v[104:107]
    buffer_load_dwordx4 a[120:123], v1, s[8:11], s72 offen offset:2048 sc1
    v_mfma_f32_16x16x32_bf16 v[108:111], v[64:67], a[76:79], v[108:111]
    s_waitcnt lgkmcnt(4)
    s_add_u32 s101, s101, 151552
    s_mov_b32 s47, s101
    v_mfma_f32_16x16x32_bf16 v[124:127], v[68:71], a[76:79], v[124:127]
    ds_read_b64_tr_b16 v[64:65], v10 offset:32768
    s_mov_b32 s79, 0x3eae1a93
    v_mfma_f32_16x16x32_bf16 v[120:123], v[68:71], a[72:75], v[120:123]
    ds_read_b64_tr_b16 v[66:67], v10 offset:36864
    v_and_b32 v37, 15, v33
    v_mfma_f32_16x16x32_bf16 v[116:119], v[68:71], a[68:71], v[116:119]
    buffer_load_dwordx4 a[124:127], v1, s[8:11], s72 offen offset:3072 sc1
    v_mfma_f32_16x16x32_bf16 v[112:115], v[68:71], a[64:67], v[112:115]
    s_waitcnt lgkmcnt(4)
    s_add_u32 s72, s72, 4096
    v_mov_b32 v38, 1073741824
    v_mfma_f32_16x16x32_bf16 v[128:131], v[72:75], a[64:67], v[128:131]
    ds_read_b64_tr_b16 v[68:69], v10 offset:33792
    v_mov_b32 v40, s100
    v_mfma_f32_16x16x32_bf16 v[132:135], v[72:75], a[68:71], v[132:135]
    ds_read_b64_tr_b16 v[70:71], v10 offset:37888
    v_cmp_eq_u32 vcc, 1, v34
    v_mfma_f32_16x16x32_bf16 v[136:139], v[72:75], a[72:75], v[136:139]
    buffer_load_dwordx4 a[128:131], v1, s[8:11], s72 offen offset:0 sc1
    v_mfma_f32_16x16x32_bf16 v[140:143], v[72:75], a[76:79], v[140:143]
    s_waitcnt lgkmcnt(4)
    v_cndmask_b32 v40, v38, v40, vcc
    v_lshl_add_u32 v27, v37, 3, v40
    v_mfma_f32_16x16x32_bf16 v[156:159], v[76:79], a[76:79], v[156:159]
    ds_read_b64_tr_b16 v[72:73], v11 offset:32768
    v_mov_b32 v39, 1.0
    v_mfma_f32_16x16x32_bf16 v[152:155], v[76:79], a[72:75], v[152:155]
    ds_read_b64_tr_b16 v[74:75], v11 offset:36864
    v_mov_b32 v40, s79
    v_mfma_f32_16x16x32_bf16 v[148:151], v[76:79], a[68:71], v[148:151]
    buffer_load_dwordx4 a[132:135], v1, s[8:11], s72 offen offset:1024 sc1
    v_mfma_f32_16x16x32_bf16 v[144:147], v[76:79], a[64:67], v[144:147]
    s_waitcnt lgkmcnt(4)
    v_cmp_eq_u32 vcc, 0, v34
    s_nop 1
    v_cndmask_b32 v31, v39, v40, vcc
    v_mfma_f32_16x16x32_bf16 v[160:163], v[64:67], a[64:67], v[160:163]
    ds_read_b64_tr_b16 v[76:77], v11 offset:33792
    v_lshrrev_b32 v39, 3, v37
    v_mfma_f32_16x16x32_bf16 v[164:167], v[64:67], a[68:71], v[164:167]
    ds_read_b64_tr_b16 v[78:79], v11 offset:37888
    v_mul_u32_u24 v39, 304, v39
    v_mfma_f32_16x16x32_bf16 v[168:171], v[64:67], a[72:75], v[168:171]
    buffer_load_dwordx4 a[136:139], v1, s[8:11], s72 offen offset:2048 sc1
    v_mfma_f32_16x16x32_bf16 v[172:175], v[64:67], a[76:79], v[172:175]
    s_waitcnt lgkmcnt(4)
    v_and_b32 v40, 7, v37
    v_lshl_add_u32 v39, v40, 1, v39
    v_mfma_f32_16x16x32_bf16 v[188:191], v[68:71], a[76:79], v[188:191]
    ds_read_b64_tr_b16 v[64:65], v8 offset:40960
    v_add_u32 v39, s101, v39
    v_mfma_f32_16x16x32_bf16 v[184:187], v[68:71], a[72:75], v[184:187]
    ds_read_b64_tr_b16 v[66:67], v8 offset:45056
    v_add_u32 v40, 256, v39
    v_mfma_f32_16x16x32_bf16 v[180:183], v[68:71], a[68:71], v[180:183]
    buffer_load_dwordx4 a[140:143], v1, s[8:11], s72 offen offset:3072 sc1
    v_mfma_f32_16x16x32_bf16 v[176:179], v[68:71], a[64:67], v[176:179]
    s_waitcnt lgkmcnt(4)
    s_add_u32 s72, s72, 4096
    v_add_u32 v41, 288, v39
    v_mfma_f32_16x16x32_bf16 v[192:195], v[72:75], a[64:67], v[192:195]
    ds_read_b64_tr_b16 v[68:69], v8 offset:41984
    v_add_u32 v42, 272, v39
    v_mfma_f32_16x16x32_bf16 v[196:199], v[72:75], a[68:71], v[196:199]
    ds_read_b64_tr_b16 v[70:71], v8 offset:46080
    v_cmp_eq_u32 vcc, 2, v34
    v_mfma_f32_16x16x32_bf16 v[200:203], v[72:75], a[72:75], v[200:203]
    buffer_load_dwordx4 a[144:147], v1, s[8:11], s72 offen offset:0 sc1
    v_mfma_f32_16x16x32_bf16 v[204:207], v[72:75], a[76:79], v[204:207]
    s_waitcnt lgkmcnt(4)
    v_cndmask_b32 v28, v38, v40, vcc
    v_cndmask_b32 v29, v38, v42, vcc
    v_mfma_f32_16x16x32_bf16 v[220:223], v[76:79], a[76:79], v[220:223]
    ds_read_b64_tr_b16 v[72:73], v9 offset:40960
    v_cmp_eq_u32 s[92:93], 3, v34
    v_mfma_f32_16x16x32_bf16 v[216:219], v[76:79], a[72:75], v[216:219]
    ds_read_b64_tr_b16 v[74:75], v9 offset:45056
    v_cndmask_b32 v28, v28, v41, s[92:93]
    v_mfma_f32_16x16x32_bf16 v[212:215], v[76:79], a[68:71], v[212:215]
    buffer_load_dwordx4 a[148:151], v1, s[8:11], s72 offen offset:1024 sc1
    v_mfma_f32_16x16x32_bf16 v[208:211], v[76:79], a[64:67], v[208:211]
    s_waitcnt vmcnt(22)
    s_waitcnt lgkmcnt(4)
    v_and_b32 v39, 1, v34
    v_mfma_f32_16x16x32_bf16 v[96:99], v[64:67], a[80:83], v[96:99]
    ds_read_b64_tr_b16 v[76:77], v9 offset:41984
    v_mul_u32_u24 v39, 608, v39
    v_mfma_f32_16x16x32_bf16 v[100:103], v[64:67], a[84:87], v[100:103]
    ds_read_b64_tr_b16 v[78:79], v9 offset:46080
    v_lshrrev_b32 v40, 1, v34
    v_mfma_f32_16x16x32_bf16 v[104:107], v[64:67], a[88:91], v[104:107]
    buffer_load_dwordx4 a[152:155], v1, s[8:11], s72 offen offset:2048 sc1
    v_mfma_f32_16x16x32_bf16 v[108:111], v[64:67], a[92:95], v[108:111]
    s_waitcnt lgkmcnt(4)
    v_mul_u32_u24 v40, 304, v40
    v_add3_u32 v39, v39, v40, s101
    v_mfma_f32_16x16x32_bf16 v[124:127], v[68:71], a[92:95], v[124:127]
    ds_read_b64_tr_b16 v[64:65], v10 offset:40960
    v_lshl_add_u32 v30, v37, 4, v39
    v_mfma_f32_16x16x32_bf16 v[120:123], v[68:71], a[88:91], v[120:123]
    ds_read_b64_tr_b16 v[66:67], v10 offset:45056
    s_mul_i32 s94, s3, 9216
    v_mfma_f32_16x16x32_bf16 v[116:119], v[68:71], a[84:87], v[116:119]
    buffer_load_dwordx4 a[156:159], v1, s[8:11], s72 offen offset:3072 sc1
    v_mfma_f32_16x16x32_bf16 v[112:115], v[68:71], a[80:83], v[112:115]
    s_waitcnt lgkmcnt(4)
    s_add_u32 s72, s72, 4096
    s_add_u32 s54, s54, s94
    v_mfma_f32_16x16x32_bf16 v[128:131], v[72:75], a[80:83], v[128:131]
    ds_read_b64_tr_b16 v[68:69], v10 offset:41984
    s_mov_b32 s55, 161792
    v_mfma_f32_16x16x32_bf16 v[132:135], v[72:75], a[84:87], v[132:135]
    ds_read_b64_tr_b16 v[70:71], v10 offset:46080
    s_mul_i32 s42, s5, 165888
    v_mfma_f32_16x16x32_bf16 v[136:139], v[72:75], a[88:91], v[136:139]
    global_load_dword v84, v82, s[50:51]
    v_mfma_f32_16x16x32_bf16 v[140:143], v[72:75], a[92:95], v[140:143]
    s_waitcnt lgkmcnt(4)
    s_add_u32 s42, s42, 54525952
    s_lshl_b32 s41, s5, 7
    v_mfma_f32_16x16x32_bf16 v[156:159], v[76:79], a[92:95], v[156:159]
    ds_read_b64_tr_b16 v[72:73], v11 offset:40960
    s_add_u32 s41, s41, 49741824
    v_mfma_f32_16x16x32_bf16 v[152:155], v[76:79], a[88:91], v[152:155]
    ds_read_b64_tr_b16 v[74:75], v11 offset:45056
    s_lshl_b32 s94, s4, 2
    v_mfma_f32_16x16x32_bf16 v[148:151], v[76:79], a[84:87], v[148:151]
    buffer_load_dwordx4 a[160:163], v1, s[8:11], s72 offen offset:0 sc1
    v_mfma_f32_16x16x32_bf16 v[144:147], v[76:79], a[80:83], v[144:147]
    s_waitcnt lgkmcnt(4)
    s_add_u32 s94, s94, s3
    s_lshl_b32 s94, s94, 2
    v_mfma_f32_16x16x32_bf16 v[160:163], v[64:67], a[80:83], v[160:163]
    ds_read_b64_tr_b16 v[76:77], v11 offset:41984
    s_add_u32 s43, s41, s94
    v_mfma_f32_16x16x32_bf16 v[164:167], v[64:67], a[84:87], v[164:167]
    ds_read_b64_tr_b16 v[78:79], v11 offset:46080
    v_mfma_f32_16x16x32_bf16 v[168:171], v[64:67], a[88:91], v[168:171]
    buffer_load_dwordx4 a[164:167], v1, s[8:11], s72 offen offset:1024 sc1
    v_mfma_f32_16x16x32_bf16 v[172:175], v[64:67], a[92:95], v[172:175]
    s_waitcnt lgkmcnt(4)
    s_barrier
    v_mfma_f32_16x16x32_bf16 v[188:191], v[68:71], a[92:95], v[188:191]
    ds_read_b64_tr_b16 v[64:65], v8 offset:49152
    v_mfma_f32_16x16x32_bf16 v[184:187], v[68:71], a[88:91], v[184:187]
    ds_read_b64_tr_b16 v[66:67], v8 offset:53248
    v_mfma_f32_16x16x32_bf16 v[180:183], v[68:71], a[84:87], v[180:183]
    buffer_load_dwordx4 a[168:171], v1, s[8:11], s72 offen offset:2048 sc1
    v_mfma_f32_16x16x32_bf16 v[176:179], v[68:71], a[80:83], v[176:179]
    s_waitcnt lgkmcnt(4)
    v_mfma_f32_16x16x32_bf16 v[192:195], v[72:75], a[80:83], v[192:195]
    ds_read_b64_tr_b16 v[68:69], v8 offset:50176
    v_mfma_f32_16x16x32_bf16 v[196:199], v[72:75], a[84:87], v[196:199]
    ds_read_b64_tr_b16 v[70:71], v8 offset:54272
    v_mfma_f32_16x16x32_bf16 v[200:203], v[72:75], a[88:91], v[200:203]
    buffer_load_dwordx4 a[172:175], v1, s[8:11], s72 offen offset:3072 sc1
    v_mfma_f32_16x16x32_bf16 v[204:207], v[72:75], a[92:95], v[204:207]
    s_waitcnt lgkmcnt(4)
    s_add_u32 s72, s72, 4096
    v_mfma_f32_16x16x32_bf16 v[220:223], v[76:79], a[92:95], v[220:223]
    ds_read_b64_tr_b16 v[72:73], v9 offset:49152
    v_add_u32 v82, 497664, v82
    v_mfma_f32_16x16x32_bf16 v[216:219], v[76:79], a[88:91], v[216:219]
    ds_read_b64_tr_b16 v[74:75], v9 offset:53248
    v_mfma_f32_16x16x32_bf16 v[212:215], v[76:79], a[84:87], v[212:215]
    global_load_dword v84, v82, s[50:51]
    v_mfma_f32_16x16x32_bf16 v[208:211], v[76:79], a[80:83], v[208:211]
    s_waitcnt vmcnt(24)
    s_waitcnt lgkmcnt(4)
    v_mfma_f32_16x16x32_bf16 v[96:99], v[64:67], a[96:99], v[96:99]
    s_add_u32 m0, s64, 98304
    ds_read_b64_tr_b16 v[76:77], v9 offset:50176
    v_mfma_f32_16x16x32_bf16 v[100:103], v[64:67], a[100:103], v[100:103]
    ds_read_b64_tr_b16 v[78:79], v9 offset:54272
    v_mfma_f32_16x16x32_bf16 v[104:107], v[64:67], a[104:107], v[104:107]
    buffer_load_dwordx4 v23, s[12:15], s65 offen lds
    v_mfma_f32_16x16x32_bf16 v[108:111], v[64:67], a[108:111], v[108:111]
    s_waitcnt lgkmcnt(4)
    v_mfma_f32_16x16x32_bf16 v[124:127], v[68:71], a[108:111], v[124:127]
    ds_read_b64_tr_b16 v[64:65], v10 offset:49152
    v_mfma_f32_16x16x32_bf16 v[120:123], v[68:71], a[104:107], v[120:123]
    ds_read_b64_tr_b16 v[66:67], v10 offset:53248
    v_mfma_f32_16x16x32_bf16 v[116:119], v[68:71], a[100:103], v[116:119]
    buffer_load_dwordx4 v23, s[16:19], s65 offen offset:1024 lds
    v_mfma_f32_16x16x32_bf16 v[112:115], v[68:71], a[96:99], v[112:115]
L_page1:
    s_cbranch_execz L_page5
    s_waitcnt lgkmcnt(4)
    s_add_u32 s65, s65, 294912
    v_mfma_f32_16x16x32_bf16 v[128:131], v[72:75], a[96:99], v[128:131]
    s_add_u32 m0, s64, 106496
    ds_read_b64_tr_b16 v[68:69], v10 offset:50176
    v_mfma_f32_16x16x32_bf16 v[132:135], v[72:75], a[100:103], v[132:135]
    ds_read_b64_tr_b16 v[70:71], v10 offset:54272
    v_mfma_f32_16x16x32_bf16 v[136:139], v[72:75], a[104:107], v[136:139]
    buffer_load_dwordx4 v23, s[12:15], s65 offen lds
    v_mfma_f32_16x16x32_bf16 v[140:143], v[72:75], a[108:111], v[140:143]
    s_waitcnt lgkmcnt(4)
    v_mfma_f32_16x16x32_bf16 v[156:159], v[76:79], a[108:111], v[156:159]
    ds_read_b64_tr_b16 v[72:73], v11 offset:49152
    v_mfma_f32_16x16x32_bf16 v[152:155], v[76:79], a[104:107], v[152:155]
    ds_read_b64_tr_b16 v[74:75], v11 offset:53248
    v_mfma_f32_16x16x32_bf16 v[148:151], v[76:79], a[100:103], v[148:151]
    buffer_load_dwordx4 v23, s[16:19], s65 offen offset:1024 lds
    v_mfma_f32_16x16x32_bf16 v[144:147], v[76:79], a[96:99], v[144:147]
    s_waitcnt lgkmcnt(4)
    s_add_u32 s65, s65, 294912
    v_mfma_f32_16x16x32_bf16 v[160:163], v[64:67], a[96:99], v[160:163]
    s_add_u32 m0, s64, 114688
    ds_read_b64_tr_b16 v[76:77], v11 offset:50176
    v_mfma_f32_16x16x32_bf16 v[164:167], v[64:67], a[100:103], v[164:167]
    ds_read_b64_tr_b16 v[78:79], v11 offset:54272
    v_mfma_f32_16x16x32_bf16 v[168:171], v[64:67], a[104:107], v[168:171]
    buffer_load_dwordx4 v23, s[12:15], s65 offen lds
    v_mfma_f32_16x16x32_bf16 v[172:175], v[64:67], a[108:111], v[172:175]
    s_waitcnt lgkmcnt(4)
    v_mfma_f32_16x16x32_bf16 v[188:191], v[68:71], a[108:111], v[188:191]
    ds_read_b64_tr_b16 v[64:65], v8 offset:57344
    v_mfma_f32_16x16x32_bf16 v[184:187], v[68:71], a[104:107], v[184:187]
    ds_read_b64_tr_b16 v[66:67], v8 offset:61440
    v_mfma_f32_16x16x32_bf16 v[180:183], v[68:71], a[100:103], v[180:183]
    buffer_load_dwordx4 v23, s[16:19], s65 offen offset:1024 lds
    v_mfma_f32_16x16x32_bf16 v[176:179], v[68:71], a[96:99], v[176:179]
    s_waitcnt lgkmcnt(4)
    s_add_u32 s65, s65, 294912
    v_mfma_f32_16x16x32_bf16 v[192:195], v[72:75], a[96:99], v[192:195]
    ds_read_b64_tr_b16 v[68:69], v8 offset:58368
    v_mfma_f32_16x16x32_bf16 v[196:199], v[72:75], a[100:103], v[196:199]
    ds_read_b64_tr_b16 v[70:71], v8 offset:62464
    v_mfma_f32_16x16x32_bf16 v[200:203], v[72:75], a[104:107], v[200:203]
    buffer_load_dwordx4 a[176:179], v1, s[8:11], s72 offen offset:0 sc1
    v_mfma_f32_16x16x32_bf16 v[204:207], v[72:75], a[108:111], v[204:207]
    s_waitcnt lgkmcnt(4)
    v_mfma_f32_16x16x32_bf16 v[220:223], v[76:79], a[108:111], v[220:223]
    ds_read_b64_tr_b16 v[72:73], v9 offset:57344
    v_mfma_f32_16x16x32_bf16 v[216:219], v[76:79], a[104:107], v[216:219]
    ds_read_b64_tr_b16 v[74:75], v9 offset:61440
    v_mfma_f32_16x16x32_bf16 v[212:215], v[76:79], a[100:103], v[212:215]
    v_mfma_f32_16x16x32_bf16 v[208:211], v[76:79], a[96:99], v[208:211]
    s_waitcnt vmcnt(21)
    s_waitcnt lgkmcnt(4)
    v_mfma_f32_16x16x32_bf16 v[96:99], v[64:67], a[112:115], v[96:99]
    ds_read_b64_tr_b16 v[76:77], v9 offset:58368
    v_mfma_f32_16x16x32_bf16 v[100:103], v[64:67], a[116:119], v[100:103]
    ds_read_b64_tr_b16 v[78:79], v9 offset:62464
    v_mfma_f32_16x16x32_bf16 v[104:107], v[64:67], a[120:123], v[104:107]
    buffer_load_dwordx4 a[180:183], v1, s[8:11], s72 offen offset:1024 sc1
    v_mfma_f32_16x16x32_bf16 v[108:111], v[64:67], a[124:127], v[108:111]
    s_waitcnt lgkmcnt(4)
    v_mfma_f32_16x16x32_bf16 v[124:127], v[68:71], a[124:127], v[124:127]
    ds_read_b64_tr_b16 v[64:65], v10 offset:57344
    v_mfma_f32_16x16x32_bf16 v[120:123], v[68:71], a[120:123], v[120:123]
    ds_read_b64_tr_b16 v[66:67], v10 offset:61440
    v_mfma_f32_16x16x32_bf16 v[116:119], v[68:71], a[116:119], v[116:119]
    buffer_load_dwordx4 a[184:187], v1, s[8:11], s72 offen offset:2048 sc1
    v_mfma_f32_16x16x32_bf16 v[112:115], v[68:71], a[112:115], v[112:115]
    s_waitcnt lgkmcnt(4)
    v_mfma_f32_16x16x32_bf16 v[128:131], v[72:75], a[112:115], v[128:131]
    ds_read_b64_tr_b16 v[68:69], v10 offset:58368
    v_mfma_f32_16x16x32_bf16 v[132:135], v[72:75], a[116:119], v[132:135]
    ds_read_b64_tr_b16 v[70:71], v10 offset:62464
    v_mfma_f32_16x16x32_bf16 v[136:139], v[72:75], a[120:123], v[136:139]
    buffer_load_dwordx4 a[188:191], v1, s[8:11], s72 offen offset:3072 sc1
    v_mfma_f32_16x16x32_bf16 v[140:143], v[72:75], a[124:127], v[140:143]
    s_waitcnt lgkmcnt(4)
    s_add_u32 s72, s72, 4096
    v_mfma_f32_16x16x32_bf16 v[156:159], v[76:79], a[124:127], v[156:159]
    ds_read_b64_tr_b16 v[72:73], v11 offset:57344
    v_mfma_f32_16x16x32_bf16 v[152:155], v[76:79], a[120:123], v[152:155]
    ds_read_b64_tr_b16 v[74:75], v11 offset:61440
    v_mfma_f32_16x16x32_bf16 v[148:151], v[76:79], a[116:119], v[148:151]
    buffer_load_dwordx4 a[192:195], v1, s[8:11], s72 offen offset:0 sc1
    v_mfma_f32_16x16x32_bf16 v[144:147], v[76:79], a[112:115], v[144:147]
    s_waitcnt lgkmcnt(4)
    v_mfma_f32_16x16x32_bf16 v[160:163], v[64:67], a[112:115], v[160:163]
    ds_read_b64_tr_b16 v[76:77], v11 offset:58368
    v_mfma_f32_16x16x32_bf16 v[164:167], v[64:67], a[116:119], v[164:167]
    ds_read_b64_tr_b16 v[78:79], v11 offset:62464
    v_mfma_f32_16x16x32_bf16 v[168:171], v[64:67], a[120:123], v[168:171]
    v_mfma_f32_16x16x32_bf16 v[172:175], v[64:67], a[124:127], v[172:175]
    s_waitcnt lgkmcnt(4)
    buffer_load_dwordx4 a[196:199], v1, s[8:11], s72 offen offset:1024 sc1
    v_mfma_f32_16x16x32_bf16 v[188:191], v[68:71], a[124:127], v[188:191]
    ds_read_b64_tr_b16 v[64:65], v12 offset:0
    v_mfma_f32_16x16x32_bf16 v[184:187], v[68:71], a[120:123], v[184:187]
    ds_read_b64_tr_b16 v[66:67], v12 offset:4096
    v_mfma_f32_16x16x32_bf16 v[180:183], v[68:71], a[116:119], v[180:183]
    v_mfma_f32_16x16x32_bf16 v[176:179], v[68:71], a[112:115], v[176:179]
    s_waitcnt lgkmcnt(4)
    v_mfma_f32_16x16x32_bf16 v[192:195], v[72:75], a[112:115], v[192:195]
    ds_read_b64_tr_b16 v[68:69], v12 offset:1024
    v_mfma_f32_16x16x32_bf16 v[196:199], v[72:75], a[116:119], v[196:199]
    ds_read_b64_tr_b16 v[70:71], v12 offset:5120
    v_mfma_f32_16x16x32_bf16 v[200:203], v[72:75], a[120:123], v[200:203]
    v_mfma_f32_16x16x32_bf16 v[204:207], v[72:75], a[124:127], v[204:207]
    s_waitcnt lgkmcnt(4)
    buffer_load_dwordx4 a[200:203], v1, s[8:11], s72 offen offset:2048 sc1
    v_mfma_f32_16x16x32_bf16 v[220:223], v[76:79], a[124:127], v[220:223]
    ds_read_b64_tr_b16 v[72:73], v13 offset:0
    v_mfma_f32_16x16x32_bf16 v[216:219], v[76:79], a[120:123], v[216:219]
    ds_read_b64_tr_b16 v[74:75], v13 offset:4096
    v_mfma_f32_16x16x32_bf16 v[212:215], v[76:79], a[116:119], v[212:215]
    v_mfma_f32_16x16x32_bf16 v[208:211], v[76:79], a[112:115], v[208:211]
    s_waitcnt vmcnt(23)
    s_waitcnt lgkmcnt(4)
    v_mfma_f32_16x16x32_bf16 v[96:99], v[64:67], a[128:131], v[96:99]
    ds_read_b64_tr_b16 v[76:77], v13 offset:1024
    v_mfma_f32_16x16x32_bf16 v[100:103], v[64:67], a[132:135], v[100:103]
    ds_read_b64_tr_b16 v[78:79], v13 offset:5120
    v_mfma_f32_16x16x32_bf16 v[104:107], v[64:67], a[136:139], v[104:107]
    buffer_load_dwordx4 a[204:207], v1, s[8:11], s72 offen offset:3072 sc1
    v_mfma_f32_16x16x32_bf16 v[108:111], v[64:67], a[140:143], v[108:111]
    s_waitcnt lgkmcnt(4)
    s_add_u32 s72, s72, 4096
    v_mfma_f32_16x16x32_bf16 v[124:127], v[68:71], a[140:143], v[124:127]
    ds_read_b64_tr_b16 v[64:65], v14 offset:0
    v_mfma_f32_16x16x32_bf16 v[120:123], v[68:71], a[136:139], v[120:123]
    ds_read_b64_tr_b16 v[66:67], v14 offset:4096
    v_mfma_f32_16x16x32_bf16 v[116:119], v[68:71], a[132:135], v[116:119]
    buffer_load_dwordx4 a[208:211], v1, s[8:11], s72 offen offset:0 sc1
    v_mfma_f32_16x16x32_bf16 v[112:115], v[68:71], a[128:131], v[112:115]
    s_waitcnt lgkmcnt(4)
    v_mfma_f32_16x16x32_bf16 v[128:131], v[72:75], a[128:131], v[128:131]
    ds_read_b64_tr_b16 v[68:69], v14 offset:1024
    v_mfma_f32_16x16x32_bf16 v[132:135], v[72:75], a[132:135], v[132:135]
    ds_read_b64_tr_b16 v[70:71], v14 offset:5120
    v_mfma_f32_16x16x32_bf16 v[136:139], v[72:75], a[136:139], v[136:139]
    v_mfma_f32_16x16x32_bf16 v[140:143], v[72:75], a[140:143], v[140:143]
    s_waitcnt lgkmcnt(4)
    buffer_load_dwordx4 a[212:215], v1, s[8:11], s72 offen offset:1024 sc1
    v_mfma_f32_16x16x32_bf16 v[156:159], v[76:79], a[140:143], v[156:159]
    ds_read_b64_tr_b16 v[72:73], v15 offset:0
    v_mfma_f32_16x16x32_bf16 v[152:155], v[76:79], a[136:139], v[152:155]
    ds_read_b64_tr_b16 v[74:75], v15 offset:4096
    v_mfma_f32_16x16x32_bf16 v[148:151], v[76:79], a[132:135], v[148:151]
    v_mfma_f32_16x16x32_bf16 v[144:147], v[76:79], a[128:131], v[144:147]
    s_waitcnt lgkmcnt(4)
    v_mfma_f32_16x16x32_bf16 v[160:163], v[64:67], a[128:131], v[160:163]
    ds_read_b64_tr_b16 v[76:77], v15 offset:1024
    v_mfma_f32_16x16x32_bf16 v[164:167], v[64:67], a[132:135], v[164:167]
    ds_read_b64_tr_b16 v[78:79], v15 offset:5120
    v_mfma_f32_16x16x32_bf16 v[168:171], v[64:67], a[136:139], v[168:171]
    v_mfma_f32_16x16x32_bf16 v[172:175], v[64:67], a[140:143], v[172:175]
    s_waitcnt lgkmcnt(4)
    s_barrier
    v_mfma_f32_16x16x32_bf16 v[188:191], v[68:71], a[140:143], v[188:191]
    ds_read_b64_tr_b16 v[64:65], v12 offset:8192
    v_mfma_f32_16x16x32_bf16 v[184:187], v[68:71], a[136:139], v[184:187]
    ds_read_b64_tr_b16 v[66:67], v12 offset:12288
    v_mfma_f32_16x16x32_bf16 v[180:183], v[68:71], a[132:135], v[180:183]
    buffer_load_dwordx4 a[216:219], v1, s[8:11], s72 offen offset:2048 sc1
    v_mfma_f32_16x16x32_bf16 v[176:179], v[68:71], a[128:131], v[176:179]
    s_waitcnt lgkmcnt(4)
    v_mfma_f32_16x16x32_bf16 v[192:195], v[72:75], a[128:131], v[192:195]
    ds_read_b64_tr_b16 v[68:69], v12 offset:9216
    v_mfma_f32_16x16x32_bf16 v[196:199], v[72:75], a[132:135], v[196:199]
    ds_read_b64_tr_b16 v[70:71], v12 offset:13312
    v_mfma_f32_16x16x32_bf16 v[200:203], v[72:75], a[136:139], v[200:203]
    buffer_load_dwordx4 a[220:223], v1, s[8:11], s72 offen offset:3072 sc1
    v_mfma_f32_16x16x32_bf16 v[204:207], v[72:75], a[140:143], v[204:207]
    s_waitcnt lgkmcnt(4)
    s_add_u32 s72, s72, 4096
    v_mfma_f32_16x16x32_bf16 v[220:223], v[76:79], a[140:143], v[220:223]
    s_add_u32 m0, s64, 122880
    ds_read_b64_tr_b16 v[72:73], v13 offset:8192
    v_mfma_f32_16x16x32_bf16 v[216:219], v[76:79], a[136:139], v[216:219]
    ds_read_b64_tr_b16 v[74:75], v13 offset:12288
    v_mfma_f32_16x16x32_bf16 v[212:215], v[76:79], a[132:135], v[212:215]
    buffer_load_dwordx4 v23, s[12:15], s65 offen lds
    v_mfma_f32_16x16x32_bf16 v[208:211], v[76:79], a[128:131], v[208:211]
    s_waitcnt vmcnt(25)
    s_waitcnt lgkmcnt(4)
    v_mfma_f32_16x16x32_bf16 v[96:99], v[64:67], a[144:147], v[96:99]
    ds_read_b64_tr_b16 v[76:77], v13 offset:9216
    v_mfma_f32_16x16x32_bf16 v[100:103], v[64:67], a[148:151], v[100:103]
    ds_read_b64_tr_b16 v[78:79], v13 offset:13312
    v_mfma_f32_16x16x32_bf16 v[104:107], v[64:67], a[152:155], v[104:107]
    buffer_load_dwordx4 v23, s[16:19], s65 offen offset:1024 lds
    v_mfma_f32_16x16x32_bf16 v[108:111], v[64:67], a[156:159], v[108:111]
    s_waitcnt lgkmcnt(4)
    s_add_u32 s65, s65, 294912
    v_mfma_f32_16x16x32_bf16 v[124:127], v[68:71], a[156:159], v[124:127]
    s_add_u32 m0, s64, 0
    ds_read_b64_tr_b16 v[64:65], v14 offset:8192
    v_mfma_f32_16x16x32_bf16 v[120:123], v[68:71], a[152:155], v[120:123]
    ds_read_b64_tr_b16 v[66:67], v14 offset:12288
    v_mfma_f32_16x16x32_bf16 v[116:119], v[68:71], a[148:151], v[116:119]
    buffer_load_dwordx4 v23, s[12:15], s65 offen lds
    v_mfma_f32_16x16x32_bf16 v[112:115], v[68:71], a[144:147], v[112:115]
    s_waitcnt lgkmcnt(4)
    v_mfma_f32_16x16x32_bf16 v[128:131], v[72:75], a[144:147], v[128:131]
    ds_read_b64_tr_b16 v[68:69], v14 offset:9216
    v_mfma_f32_16x16x32_bf16 v[132:135], v[72:75], a[148:151], v[132:135]
    ds_read_b64_tr_b16 v[70:71], v14 offset:13312
    v_mfma_f32_16x16x32_bf16 v[136:139], v[72:75], a[152:155], v[136:139]
    buffer_load_dwordx4 v23, s[16:19], s65 offen offset:1024 lds
    v_mfma_f32_16x16x32_bf16 v[140:143], v[72:75], a[156:159], v[140:143]
    s_waitcnt lgkmcnt(4)
    s_add_u32 s65, s65, 294912
    v_mfma_f32_16x16x32_bf16 v[156:159], v[76:79], a[156:159], v[156:159]
    s_add_u32 m0, s64, 8192
    ds_read_b64_tr_b16 v[72:73], v15 offset:8192
    v_mfma_f32_16x16x32_bf16 v[152:155], v[76:79], a[152:155], v[152:155]
    ds_read_b64_tr_b16 v[74:75], v15 offset:12288
    v_mfma_f32_16x16x32_bf16 v[148:151], v[76:79], a[148:151], v[148:151]
    buffer_load_dwordx4 v23, s[12:15], s65 offen lds
    v_mfma_f32_16x16x32_bf16 v[144:147], v[76:79], a[144:147], v[144:147]
    s_waitcnt lgkmcnt(4)
    v_mfma_f32_16x16x32_bf16 v[160:163], v[64:67], a[144:147], v[160:163]
    ds_read_b64_tr_b16 v[76:77], v15 offset:9216
    v_mfma_f32_16x16x32_bf16 v[164:167], v[64:67], a[148:151], v[164:167]
    ds_read_b64_tr_b16 v[78:79], v15 offset:13312
    v_mfma_f32_16x16x32_bf16 v[168:171], v[64:67], a[152:155], v[168:171]
    buffer_load_dwordx4 v23, s[16:19], s65 offen offset:1024 lds
    v_mfma_f32_16x16x32_bf16 v[172:175], v[64:67], a[156:159], v[172:175]
    s_waitcnt lgkmcnt(4)
    s_add_u32 s65, s66, 128
    v_mfma_f32_16x16x32_bf16 v[188:191], v[68:71], a[156:159], v[188:191]
    ds_read_b64_tr_b16 v[64:65], v12 offset:16384
    v_mfma_f32_16x16x32_bf16 v[184:187], v[68:71], a[152:155], v[184:187]
    ds_read_b64_tr_b16 v[66:67], v12 offset:20480
    v_mfma_f32_16x16x32_bf16 v[180:183], v[68:71], a[148:151], v[180:183]
    buffer_load_dwordx4 a[224:227], v1, s[8:11], s72 offen offset:0 sc1
    v_mfma_f32_16x16x32_bf16 v[176:179], v[68:71], a[144:147], v[176:179]
    s_waitcnt lgkmcnt(4)
    v_mfma_f32_16x16x32_bf16 v[192:195], v[72:75], a[144:147], v[192:195]
    ds_read_b64_tr_b16 v[68:69], v12 offset:17408
    v_mfma_f32_16x16x32_bf16 v[196:199], v[72:75], a[148:151], v[196:199]
    ds_read_b64_tr_b16 v[70:71], v12 offset:21504
    v_mfma_f32_16x16x32_bf16 v[200:203], v[72:75], a[152:155], v[200:203]
    buffer_load_dwordx4 a[228:231], v1, s[8:11], s72 offen offset:1024 sc1
    v_mfma_f32_16x16x32_bf16 v[204:207], v[72:75], a[156:159], v[204:207]
    s_waitcnt lgkmcnt(4)
    v_mfma_f32_16x16x32_bf16 v[220:223], v[76:79], a[156:159], v[220:223]
    ds_read_b64_tr_b16 v[72:73], v13 offset:16384
    v_mfma_f32_16x16x32_bf16 v[216:219], v[76:79], a[152:155], v[216:219]
    ds_read_b64_tr_b16 v[74:75], v13 offset:20480
    v_mfma_f32_16x16x32_bf16 v[212:215], v[76:79], a[148:151], v[212:215]
    buffer_load_dwordx4 a[232:235], v1, s[8:11], s72 offen offset:2048 sc1
    v_mfma_f32_16x16x32_bf16 v[208:211], v[76:79], a[144:147], v[208:211]
    s_waitcnt vmcnt(28)
    s_waitcnt lgkmcnt(4)
    v_mfma_f32_16x16x32_bf16 v[96:99], v[64:67], a[160:163], v[96:99]
    ds_read_b64_tr_b16 v[76:77], v13 offset:17408
    v_mfma_f32_16x16x32_bf16 v[100:103], v[64:67], a[164:167], v[100:103]
    ds_read_b64_tr_b16 v[78:79], v13 offset:21504
    v_mfma_f32_16x16x32_bf16 v[104:107], v[64:67], a[168:171], v[104:107]
    buffer_load_dwordx4 a[236:239], v1, s[8:11], s72 offen offset:3072 sc1
    v_mfma_f32_16x16x32_bf16 v[108:111], v[64:67], a[172:175], v[108:111]
    s_waitcnt lgkmcnt(4)
    s_add_u32 s72, s72, 4096
    v_mfma_f32_16x16x32_bf16 v[124:127], v[68:71], a[172:175], v[124:127]
    ds_read_b64_tr_b16 v[64:65], v14 offset:16384
    v_mfma_f32_16x16x32_bf16 v[120:123], v[68:71], a[168:171], v[120:123]
    ds_read_b64_tr_b16 v[66:67], v14 offset:20480
    v_mfma_f32_16x16x32_bf16 v[116:119], v[68:71], a[164:167], v[116:119]
    global_load_dword v84, v81, s[56:57]
    v_mfma_f32_16x16x32_bf16 v[112:115], v[68:71], a[160:163], v[112:115]
    s_waitcnt lgkmcnt(4)
    v_mfma_f32_16x16x32_bf16 v[128:131], v[72:75], a[160:163], v[128:131]
    ds_read_b64_tr_b16 v[68:69], v14 offset:17408
    v_mfma_f32_16x16x32_bf16 v[132:135], v[72:75], a[164:167], v[132:135]
    ds_read_b64_tr_b16 v[70:71], v14 offset:21504
    v_mfma_f32_16x16x32_bf16 v[136:139], v[72:75], a[168:171], v[136:139]
    global_load_dword v84, v81, s[58:59]
    v_mfma_f32_16x16x32_bf16 v[140:143], v[72:75], a[172:175], v[140:143]
    s_waitcnt lgkmcnt(4)
    v_mfma_f32_16x16x32_bf16 v[156:159], v[76:79], a[172:175], v[156:159]
    ds_read_b64_tr_b16 v[72:73], v15 offset:16384
    v_mfma_f32_16x16x32_bf16 v[152:155], v[76:79], a[168:171], v[152:155]
    ds_read_b64_tr_b16 v[74:75], v15 offset:20480
    v_mfma_f32_16x16x32_bf16 v[148:151], v[76:79], a[164:167], v[148:151]
    buffer_load_dwordx4 a[240:243], v1, s[8:11], s72 offen offset:0 sc1
    v_mfma_f32_16x16x32_bf16 v[144:147], v[76:79], a[160:163], v[144:147]
    s_waitcnt lgkmcnt(4)
    v_mfma_f32_16x16x32_bf16 v[160:163], v[64:67], a[160:163], v[160:163]
    ds_read_b64_tr_b16 v[76:77], v15 offset:17408
    v_mfma_f32_16x16x32_bf16 v[164:167], v[64:67], a[164:167], v[164:167]
    ds_read_b64_tr_b16 v[78:79], v15 offset:21504
    v_mfma_f32_16x16x32_bf16 v[168:171], v[64:67], a[168:171], v[168:171]
    v_mfma_f32_16x16x32_bf16 v[172:175], v[64:67], a[172:175], v[172:175]
    s_waitcnt lgkmcnt(4)
    buffer_load_dwordx4 a[244:247], v1, s[8:11], s72 offen offset:1024 sc1
    v_mfma_f32_16x16x32_bf16 v[188:191], v[68:71], a[172:175], v[188:191]
    ds_read_b64_tr_b16 v[64:65], v12 offset:24576
    v_mfma_f32_16x16x32_bf16 v[184:187], v[68:71], a[168:171], v[184:187]
    ds_read_b64_tr_b16 v[66:67], v12 offset:28672
    v_mfma_f32_16x16x32_bf16 v[180:183], v[68:71], a[164:167], v[180:183]
    v_mfma_f32_16x16x32_bf16 v[176:179], v[68:71], a[160:163], v[176:179]
    s_waitcnt lgkmcnt(4)
    v_mfma_f32_16x16x32_bf16 v[192:195], v[72:75], a[160:163], v[192:195]
    ds_read_b64_tr_b16 v[68:69], v12 offset:25600
    v_mfma_f32_16x16x32_bf16 v[196:199], v[72:75], a[164:167], v[196:199]
    ds_read_b64_tr_b16 v[70:71], v12 offset:29696
    v_mfma_f32_16x16x32_bf16 v[200:203], v[72:75], a[168:171], v[200:203]
    v_mfma_f32_16x16x32_bf16 v[204:207], v[72:75], a[172:175], v[204:207]
    s_waitcnt lgkmcnt(4)
    buffer_load_dwordx4 a[248:251], v1, s[8:11], s72 offen offset:2048 sc1
    v_mfma_f32_16x16x32_bf16 v[220:223], v[76:79], a[172:175], v[220:223]
    ds_read_b64_tr_b16 v[72:73], v13 offset:24576
    v_mfma_f32_16x16x32_bf16 v[216:219], v[76:79], a[168:171], v[216:219]
    ds_read_b64_tr_b16 v[74:75], v13 offset:28672
    v_mfma_f32_16x16x32_bf16 v[212:215], v[76:79], a[164:167], v[212:215]
    v_mfma_f32_16x16x32_bf16 v[208:211], v[76:79], a[160:163], v[208:211]
    s_waitcnt vmcnt(23)
    s_waitcnt lgkmcnt(4)
    v_mfma_f32_16x16x32_bf16 v[96:99], v[64:67], a[176:179], v[96:99]
    ds_read_b64_tr_b16 v[76:77], v13 offset:25600
    v_mfma_f32_16x16x32_bf16 v[100:103], v[64:67], a[180:183], v[100:103]
    ds_read_b64_tr_b16 v[78:79], v13 offset:29696
    v_mfma_f32_16x16x32_bf16 v[104:107], v[64:67], a[184:187], v[104:107]
    buffer_load_dwordx4 a[252:255], v1, s[8:11], s72 offen offset:3072 sc1
    v_mfma_f32_16x16x32_bf16 v[108:111], v[64:67], a[188:191], v[108:111]
    s_waitcnt lgkmcnt(4)
    s_add_u32 s72, s72, 4096
    v_mfma_f32_16x16x32_bf16 v[124:127], v[68:71], a[188:191], v[124:127]
    ds_read_b64_tr_b16 v[64:65], v14 offset:24576
    v_mfma_f32_16x16x32_bf16 v[120:123], v[68:71], a[184:187], v[120:123]
    ds_read_b64_tr_b16 v[66:67], v14 offset:28672
    v_mfma_f32_16x16x32_bf16 v[116:119], v[68:71], a[180:183], v[116:119]
    buffer_load_dwordx4 v[224:227], v1, s[8:11], s72 offen offset:0 sc1
    v_mfma_f32_16x16x32_bf16 v[112:115], v[68:71], a[176:179], v[112:115]
    s_waitcnt lgkmcnt(4)
    v_mfma_f32_16x16x32_bf16 v[128:131], v[72:75], a[176:179], v[128:131]
    ds_read_b64_tr_b16 v[68:69], v14 offset:25600
    v_mfma_f32_16x16x32_bf16 v[132:135], v[72:75], a[180:183], v[132:135]
    ds_read_b64_tr_b16 v[70:71], v14 offset:29696
    v_mfma_f32_16x16x32_bf16 v[136:139], v[72:75], a[184:187], v[136:139]
    v_mfma_f32_16x16x32_bf16 v[140:143], v[72:75], a[188:191], v[140:143]
    s_waitcnt lgkmcnt(4)
    buffer_load_dwordx4 v[228:231], v1, s[8:11], s72 offen offset:1024 sc1
    v_mfma_f32_16x16x32_bf16 v[156:159], v[76:79], a[188:191], v[156:159]
    ds_read_b64_tr_b16 v[72:73], v15 offset:24576
    v_mfma_f32_16x16x32_bf16 v[152:155], v[76:79], a[184:187], v[152:155]
    ds_read_b64_tr_b16 v[74:75], v15 offset:28672
    v_mfma_f32_16x16x32_bf16 v[148:151], v[76:79], a[180:183], v[148:151]
    v_mfma_f32_16x16x32_bf16 v[144:147], v[76:79], a[176:179], v[144:147]
    s_waitcnt lgkmcnt(4)
    v_mfma_f32_16x16x32_bf16 v[160:163], v[64:67], a[176:179], v[160:163]
    ds_read_b64_tr_b16 v[76:77], v15 offset:25600
    v_mfma_f32_16x16x32_bf16 v[164:167], v[64:67], a[180:183], v[164:167]
    ds_read_b64_tr_b16 v[78:79], v15 offset:29696
    v_mfma_f32_16x16x32_bf16 v[168:171], v[64:67], a[184:187], v[168:171]
    v_mfma_f32_16x16x32_bf16 v[172:175], v[64:67], a[188:191], v[172:175]
    s_waitcnt lgkmcnt(4)
    s_barrier
    v_mfma_f32_16x16x32_bf16 v[188:191], v[68:71], a[188:191], v[188:191]
    ds_read_b64_tr_b16 v[64:65], v12 offset:32768
    v_mfma_f32_16x16x32_bf16 v[184:187], v[68:71], a[184:187], v[184:187]
    ds_read_b64_tr_b16 v[66:67], v12 offset:36864
    v_mfma_f32_16x16x32_bf16 v[180:183], v[68:71], a[180:183], v[180:183]
    buffer_load_dwordx4 v[232:235], v1, s[8:11], s72 offen offset:2048 sc1
    v_mfma_f32_16x16x32_bf16 v[176:179], v[68:71], a[176:179], v[176:179]
    s_waitcnt lgkmcnt(4)
    v_mfma_f32_16x16x32_bf16 v[192:195], v[72:75], a[176:179], v[192:195]
    ds_read_b64_tr_b16 v[68:69], v12 offset:33792
    v_mfma_f32_16x16x32_bf16 v[196:199], v[72:75], a[180:183], v[196:199]
    ds_read_b64_tr_b16 v[70:71], v12 offset:37888
    v_mfma_f32_16x16x32_bf16 v[200:203], v[72:75], a[184:187], v[200:203]
    buffer_load_dwordx4 v[236:239], v1, s[8:11], s72 offen offset:3072 sc1
    v_mfma_f32_16x16x32_bf16 v[204:207], v[72:75], a[188:191], v[204:207]
    s_waitcnt lgkmcnt(4)
    s_add_u32 s72, s72, 4096
    v_mfma_f32_16x16x32_bf16 v[220:223], v[76:79], a[188:191], v[220:223]
    s_add_u32 m0, s64, 16384
    ds_read_b64_tr_b16 v[72:73], v13 offset:32768
    v_mfma_f32_16x16x32_bf16 v[216:219], v[76:79], a[184:187], v[216:219]
    ds_read_b64_tr_b16 v[74:75], v13 offset:36864
    v_mfma_f32_16x16x32_bf16 v[212:215], v[76:79], a[180:183], v[212:215]
    buffer_load_dwordx4 v23, s[12:15], s65 offen lds
    v_mfma_f32_16x16x32_bf16 v[208:211], v[76:79], a[176:179], v[208:211]
    s_waitcnt vmcnt(25)
    s_waitcnt lgkmcnt(4)
    v_mfma_f32_16x16x32_bf16 v[96:99], v[64:67], a[192:195], v[96:99]
    ds_read_b64_tr_b16 v[76:77], v13 offset:33792
    v_mfma_f32_16x16x32_bf16 v[100:103], v[64:67], a[196:199], v[100:103]
    ds_read_b64_tr_b16 v[78:79], v13 offset:37888
    v_mfma_f32_16x16x32_bf16 v[104:107], v[64:67], a[200:203], v[104:107]
    buffer_load_dwordx4 v23, s[16:19], s65 offen offset:1024 lds
    v_mfma_f32_16x16x32_bf16 v[108:111], v[64:67], a[204:207], v[108:111]
    s_waitcnt lgkmcnt(4)
    s_add_u32 s65, s65, 294912
    v_mfma_f32_16x16x32_bf16 v[124:127], v[68:71], a[204:207], v[124:127]
    s_add_u32 m0, s64, 24576
    ds_read_b64_tr_b16 v[64:65], v14 offset:32768
    v_mfma_f32_16x16x32_bf16 v[120:123], v[68:71], a[200:203], v[120:123]
    ds_read_b64_tr_b16 v[66:67], v14 offset:36864
    v_mfma_f32_16x16x32_bf16 v[116:119], v[68:71], a[196:199], v[116:119]
    buffer_load_dwordx4 v23, s[12:15], s65 offen lds
    v_mfma_f32_16x16x32_bf16 v[112:115], v[68:71], a[192:195], v[112:115]
    s_waitcnt lgkmcnt(4)
    v_mfma_f32_16x16x32_bf16 v[128:131], v[72:75], a[192:195], v[128:131]
    ds_read_b64_tr_b16 v[68:69], v14 offset:33792
    v_mfma_f32_16x16x32_bf16 v[132:135], v[72:75], a[196:199], v[132:135]
    ds_read_b64_tr_b16 v[70:71], v14 offset:37888
    v_mfma_f32_16x16x32_bf16 v[136:139], v[72:75], a[200:203], v[136:139]
    buffer_load_dwordx4 v23, s[16:19], s65 offen offset:1024 lds
    v_mfma_f32_16x16x32_bf16 v[140:143], v[72:75], a[204:207], v[140:143]
    s_waitcnt lgkmcnt(4)
    s_add_u32 s65, s65, 294912
    v_mfma_f32_16x16x32_bf16 v[156:159], v[76:79], a[204:207], v[156:159]
    s_add_u32 m0, s64, 32768
    ds_read_b64_tr_b16 v[72:73], v15 offset:32768
    v_mfma_f32_16x16x32_bf16 v[152:155], v[76:79], a[200:203], v[152:155]
    ds_read_b64_tr_b16 v[74:75], v15 offset:36864
    v_mfma_f32_16x16x32_bf16 v[148:151], v[76:79], a[196:199], v[148:151]
    buffer_load_dwordx4 v23, s[12:15], s65 offen lds
    v_mfma_f32_16x16x32_bf16 v[144:147], v[76:79], a[192:195], v[144:147]
    s_waitcnt lgkmcnt(4)
    v_mfma_f32_16x16x32_bf16 v[160:163], v[64:67], a[192:195], v[160:163]
    ds_read_b64_tr_b16 v[76:77], v15 offset:33792
    v_mfma_f32_16x16x32_bf16 v[164:167], v[64:67], a[196:199], v[164:167]
    ds_read_b64_tr_b16 v[78:79], v15 offset:37888
    v_mfma_f32_16x16x32_bf16 v[168:171], v[64:67], a[200:203], v[168:171]
    buffer_load_dwordx4 v23, s[16:19], s65 offen offset:1024 lds
    v_mfma_f32_16x16x32_bf16 v[172:175], v[64:67], a[204:207], v[172:175]
    s_waitcnt lgkmcnt(4)
    s_add_u32 s65, s65, 294912
    v_mfma_f32_16x16x32_bf16 v[188:191], v[68:71], a[204:207], v[188:191]
    ds_read_b64_tr_b16 v[64:65], v12 offset:40960
    v_mfma_f32_16x16x32_bf16 v[184:187], v[68:71], a[200:203], v[184:187]
    ds_read_b64_tr_b16 v[66:67], v12 offset:45056
    v_mfma_f32_16x16x32_bf16 v[180:183], v[68:71], a[196:199], v[180:183]
    buffer_load_dwordx4 v[240:243], v1, s[8:11], s72 offen offset:0 sc1
    v_mfma_f32_16x16x32_bf16 v[176:179], v[68:71], a[192:195], v[176:179]
    s_waitcnt lgkmcnt(4)
    v_mfma_f32_16x16x32_bf16 v[192:195], v[72:75], a[192:195], v[192:195]
    ds_read_b64_tr_b16 v[68:69], v12 offset:41984
    v_mfma_f32_16x16x32_bf16 v[196:199], v[72:75], a[196:199], v[196:199]
    ds_read_b64_tr_b16 v[70:71], v12 offset:46080
    v_mfma_f32_16x16x32_bf16 v[200:203], v[72:75], a[200:203], v[200:203]
    buffer_load_dwordx4 v[244:247], v1, s[8:11], s72 offen offset:1024 sc1
    v_mfma_f32_16x16x32_bf16 v[204:207], v[72:75], a[204:207], v[204:207]
    s_waitcnt lgkmcnt(4)
    v_mfma_f32_16x16x32_bf16 v[220:223], v[76:79], a[204:207], v[220:223]
    ds_read_b64_tr_b16 v[72:73], v13 offset:40960
    v_mfma_f32_16x16x32_bf16 v[216:219], v[76:79], a[200:203], v[216:219]
    ds_read_b64_tr_b16 v[74:75], v13 offset:45056
    v_mfma_f32_16x16x32_bf16 v[212:215], v[76:79], a[196:199], v[212:215]
    buffer_load_dwordx4 v[248:251], v1, s[8:11], s72 offen offset:2048 sc1
    v_mfma_f32_16x16x32_bf16 v[208:211], v[76:79], a[192:195], v[208:211]
    s_waitcnt vmcnt(29)
    s_waitcnt lgkmcnt(4)
    v_mfma_f32_16x16x32_bf16 v[96:99], v[64:67], a[208:211], v[96:99]
    ds_read_b64_tr_b16 v[76:77], v13 offset:41984
    v_mfma_f32_16x16x32_bf16 v[100:103], v[64:67], a[212:215], v[100:103]
    ds_read_b64_tr_b16 v[78:79], v13 offset:46080
    v_mfma_f32_16x16x32_bf16 v[104:107], v[64:67], a[216:219], v[104:107]
    v_mfma_f32_16x16x32_bf16 v[108:111], v[64:67], a[220:223], v[108:111]
    s_waitcnt lgkmcnt(4)
    buffer_load_dwordx4 v[252:255], v1, s[8:11], s72 offen offset:3072 sc1
    v_mfma_f32_16x16x32_bf16 v[124:127], v[68:71], a[220:223], v[124:127]
    ds_read_b64_tr_b16 v[64:65], v14 offset:40960
    v_mfma_f32_16x16x32_bf16 v[120:123], v[68:71], a[216:219], v[120:123]
    ds_read_b64_tr_b16 v[66:67], v14 offset:45056
    v_mfma_f32_16x16x32_bf16 v[116:119], v[68:71], a[212:215], v[116:119]
    v_mfma_f32_16x16x32_bf16 v[112:115], v[68:71], a[208:211], v[112:115]
    s_waitcnt lgkmcnt(4)
    v_mfma_f32_16x16x32_bf16 v[128:131], v[72:75], a[208:211], v[128:131]
    ds_read_b64_tr_b16 v[68:69], v14 offset:41984
    v_mfma_f32_16x16x32_bf16 v[132:135], v[72:75], a[212:215], v[132:135]
    ds_read_b64_tr_b16 v[70:71], v14 offset:46080
    v_mfma_f32_16x16x32_bf16 v[136:139], v[72:75], a[216:219], v[136:139]
    v_mfma_f32_16x16x32_bf16 v[140:143], v[72:75], a[220:223], v[140:143]
    s_waitcnt lgkmcnt(4)
    global_load_dword v84, v85, s[56:57] offset:128
    v_mfma_f32_16x16x32_bf16 v[156:159], v[76:79], a[220:223], v[156:159]
    ds_read_b64_tr_b16 v[72:73], v15 offset:40960
    v_mfma_f32_16x16x32_bf16 v[152:155], v[76:79], a[216:219], v[152:155]
    ds_read_b64_tr_b16 v[74:75], v15 offset:45056
    v_mfma_f32_16x16x32_bf16 v[148:151], v[76:79], a[212:215], v[148:151]
    v_mfma_f32_16x16x32_bf16 v[144:147], v[76:79], a[208:211], v[144:147]
    s_waitcnt lgkmcnt(4)
    v_mfma_f32_16x16x32_bf16 v[160:163], v[64:67], a[208:211], v[160:163]
    ds_read_b64_tr_b16 v[76:77], v15 offset:41984
    v_mfma_f32_16x16x32_bf16 v[164:167], v[64:67], a[212:215], v[164:167]
    ds_read_b64_tr_b16 v[78:79], v15 offset:46080
    v_mfma_f32_16x16x32_bf16 v[168:171], v[64:67], a[216:219], v[168:171]
    v_mfma_f32_16x16x32_bf16 v[172:175], v[64:67], a[220:223], v[172:175]
    s_waitcnt lgkmcnt(4)
    global_load_dword v84, v85, s[58:59] offset:128
    v_mfma_f32_16x16x32_bf16 v[188:191], v[68:71], a[220:223], v[188:191]
    ds_read_b64_tr_b16 v[64:65], v12 offset:49152
    v_mfma_f32_16x16x32_bf16 v[184:187], v[68:71], a[216:219], v[184:187]
    ds_read_b64_tr_b16 v[66:67], v12 offset:53248
    v_mfma_f32_16x16x32_bf16 v[180:183], v[68:71], a[212:215], v[180:183]
    v_mfma_f32_16x16x32_bf16 v[176:179], v[68:71], a[208:211], v[176:179]
    s_waitcnt lgkmcnt(4)
    v_mfma_f32_16x16x32_bf16 v[192:195], v[72:75], a[208:211], v[192:195]
    ds_read_b64_tr_b16 v[68:69], v12 offset:50176
    v_mfma_f32_16x16x32_bf16 v[196:199], v[72:75], a[212:215], v[196:199]
    ds_read_b64_tr_b16 v[70:71], v12 offset:54272
    v_mfma_f32_16x16x32_bf16 v[200:203], v[72:75], a[216:219], v[200:203]
    v_mfma_f32_16x16x32_bf16 v[204:207], v[72:75], a[220:223], v[204:207]
    s_waitcnt lgkmcnt(4)
    v_mfma_f32_16x16x32_bf16 v[220:223], v[76:79], a[220:223], v[220:223]
    ds_read_b64_tr_b16 v[72:73], v13 offset:49152
    v_mfma_f32_16x16x32_bf16 v[216:219], v[76:79], a[216:219], v[216:219]
    ds_read_b64_tr_b16 v[74:75], v13 offset:53248
    v_mfma_f32_16x16x32_bf16 v[212:215], v[76:79], a[212:215], v[212:215]
    v_mfma_f32_16x16x32_bf16 v[208:211], v[76:79], a[208:211], v[208:211]
    s_waitcnt vmcnt(22)
    s_waitcnt lgkmcnt(4)
    v_mfma_f32_16x16x32_bf16 v[96:99], v[64:67], a[224:227], v[96:99]
    ds_read_b64_tr_b16 v[76:77], v13 offset:50176
    v_mfma_f32_16x16x32_bf16 v[100:103], v[64:67], a[228:231], v[100:103]
    ds_read_b64_tr_b16 v[78:79], v13 offset:54272
    v_add_u32 v82, 497664, v82
    v_mfma_f32_16x16x32_bf16 v[104:107], v[64:67], a[232:235], v[104:107]
    global_load_dword v84, v82, s[50:51]
    v_mfma_f32_16x16x32_bf16 v[108:111], v[64:67], a[236:239], v[108:111]
    s_waitcnt lgkmcnt(4)
    v_add_u32 v82, 497664, v82
    v_mfma_f32_16x16x32_bf16 v[124:127], v[68:71], a[236:239], v[124:127]
    ds_read_b64_tr_b16 v[64:65], v14 offset:49152
    v_mfma_f32_16x16x32_bf16 v[120:123], v[68:71], a[232:235], v[120:123]
    ds_read_b64_tr_b16 v[66:67], v14 offset:53248
    v_mfma_f32_16x16x32_bf16 v[116:119], v[68:71], a[228:231], v[116:119]
    v_mfma_f32_16x16x32_bf16 v[112:115], v[68:71], a[224:227], v[112:115]
    s_waitcnt lgkmcnt(4)
    v_mfma_f32_16x16x32_bf16 v[128:131], v[72:75], a[224:227], v[128:131]
    ds_read_b64_tr_b16 v[68:69], v14 offset:50176
    v_mfma_f32_16x16x32_bf16 v[132:135], v[72:75], a[228:231], v[132:135]
    ds_read_b64_tr_b16 v[70:71], v14 offset:54272
    v_mfma_f32_16x16x32_bf16 v[136:139], v[72:75], a[232:235], v[136:139]
    global_load_dword v84, v82, s[50:51]
    v_mfma_f32_16x16x32_bf16 v[140:143], v[72:75], a[236:239], v[140:143]
    s_waitcnt lgkmcnt(4)
    s_add_u32 s70, s4, 0
    v_mfma_f32_16x16x32_bf16 v[156:159], v[76:79], a[236:239], v[156:159]
    s_mul_i32 s68, s70, s71
    ds_read_b64_tr_b16 v[72:73], v15 offset:49152
    v_mfma_f32_16x16x32_bf16 v[152:155], v[76:79], a[232:235], v[152:155]
    s_add_u32 s68, s68, s69
    ds_read_b64_tr_b16 v[74:75], v15 offset:53248
    v_mfma_f32_16x16x32_bf16 v[148:151], v[76:79], a[228:231], v[148:151]
    s_add_u32 m0, s64, 131072
    v_mfma_f32_16x16x32_bf16 v[144:147], v[76:79], a[224:227], v[144:147]
L_page2:
    s_cbranch_execz L_page6
    s_waitcnt lgkmcnt(4)
    v_mfma_f32_16x16x32_bf16 v[160:163], v[64:67], a[224:227], v[160:163]
    ds_read_b64_tr_b16 v[76:77], v15 offset:50176
    v_mfma_f32_16x16x32_bf16 v[164:167], v[64:67], a[228:231], v[164:167]
    ds_read_b64_tr_b16 v[78:79], v15 offset:54272
    v_mfma_f32_16x16x32_bf16 v[168:171], v[64:67], a[232:235], v[168:171]
    buffer_load_dwordx4 v24, s[20:23], s68 offen offset:0 lds
    v_mfma_f32_16x16x32_bf16 v[172:175], v[64:67], a[236:239], v[172:175]
    s_waitcnt lgkmcnt(4)
    s_barrier
    v_mfma_f32_16x16x32_bf16 v[188:191], v[68:71], a[236:239], v[188:191]
    ds_read_b64_tr_b16 v[64:65], v12 offset:57344
    v_mfma_f32_16x16x32_bf16 v[184:187], v[68:71], a[232:235], v[184:187]
    s_add_u32 m0, s64, 40960
    ds_read_b64_tr_b16 v[66:67], v12 offset:61440
    v_mfma_f32_16x16x32_bf16 v[180:183], v[68:71], a[228:231], v[180:183]
    buffer_load_dwordx4 v23, s[12:15], s65 offen lds
    v_mfma_f32_16x16x32_bf16 v[176:179], v[68:71], a[224:227], v[176:179]
    s_waitcnt lgkmcnt(4)
    v_mfma_f32_16x16x32_bf16 v[192:195], v[72:75], a[224:227], v[192:195]
    ds_read_b64_tr_b16 v[68:69], v12 offset:58368
    v_mfma_f32_16x16x32_bf16 v[196:199], v[72:75], a[228:231], v[196:199]
    ds_read_b64_tr_b16 v[70:71], v12 offset:62464
    v_mfma_f32_16x16x32_bf16 v[200:203], v[72:75], a[232:235], v[200:203]
    buffer_load_dwordx4 v23, s[16:19], s65 offen offset:1024 lds
    v_mfma_f32_16x16x32_bf16 v[204:207], v[72:75], a[236:239], v[204:207]
    s_waitcnt lgkmcnt(4)
    s_add_u32 s65, s65, 294912
    v_mfma_f32_16x16x32_bf16 v[220:223], v[76:79], a[236:239], v[220:223]
    s_add_u32 m0, s64, 49152
    ds_read_b64_tr_b16 v[72:73], v13 offset:57344
    v_mfma_f32_16x16x32_bf16 v[216:219], v[76:79], a[232:235], v[216:219]
    ds_read_b64_tr_b16 v[74:75], v13 offset:61440
    v_mfma_f32_16x16x32_bf16 v[212:215], v[76:79], a[228:231], v[212:215]
    buffer_load_dwordx4 v23, s[12:15], s65 offen lds
    v_mfma_f32_16x16x32_bf16 v[208:211], v[76:79], a[224:227], v[208:211]
    s_waitcnt vmcnt(22)
    s_waitcnt lgkmcnt(4)
    v_mfma_f32_16x16x32_bf16 v[96:99], v[64:67], a[240:243], v[96:99]
    ds_read_b64_tr_b16 v[76:77], v13 offset:58368
    v_mfma_f32_16x16x32_bf16 v[100:103], v[64:67], a[244:247], v[100:103]
    ds_read_b64_tr_b16 v[78:79], v13 offset:62464
    v_mfma_f32_16x16x32_bf16 v[104:107], v[64:67], a[248:251], v[104:107]
    buffer_load_dwordx4 v23, s[16:19], s65 offen offset:1024 lds
    v_mfma_f32_16x16x32_bf16 v[108:111], v[64:67], a[252:255], v[108:111]
    s_waitcnt lgkmcnt(4)
    s_add_u32 s65, s65, 294912
    v_mfma_f32_16x16x32_bf16 v[124:127], v[68:71], a[252:255], v[124:127]
    s_add_u32 m0, s64, 57344
    ds_read_b64_tr_b16 v[64:65], v14 offset:57344
    v_mfma_f32_16x16x32_bf16 v[120:123], v[68:71], a[248:251], v[120:123]
    ds_read_b64_tr_b16 v[66:67], v14 offset:61440
    v_mfma_f32_16x16x32_bf16 v[116:119], v[68:71], a[244:247], v[116:119]
    buffer_load_dwordx4 v23, s[12:15], s65 offen lds
    v_mfma_f32_16x16x32_bf16 v[112:115], v[68:71], a[240:243], v[112:115]
    s_waitcnt lgkmcnt(4)
    v_mfma_f32_16x16x32_bf16 v[128:131], v[72:75], a[240:243], v[128:131]
    ds_read_b64_tr_b16 v[68:69], v14 offset:58368
    v_mfma_f32_16x16x32_bf16 v[132:135], v[72:75], a[244:247], v[132:135]
    ds_read_b64_tr_b16 v[70:71], v14 offset:62464
    v_mfma_f32_16x16x32_bf16 v[136:139], v[72:75], a[248:251], v[136:139]
    buffer_load_dwordx4 v23, s[16:19], s65 offen offset:1024 lds
    v_mfma_f32_16x16x32_bf16 v[140:143], v[72:75], a[252:255], v[140:143]
    s_waitcnt lgkmcnt(4)
    s_add_u32 s65, s65, 294912
    v_mfma_f32_16x16x32_bf16 v[156:159], v[76:79], a[252:255], v[156:159]
    s_add_u32 m0, s64, 65536
    ds_read_b64_tr_b16 v[72:73], v15 offset:57344
    v_mfma_f32_16x16x32_bf16 v[152:155], v[76:79], a[248:251], v[152:155]
    ds_read_b64_tr_b16 v[74:75], v15 offset:61440
    v_mfma_f32_16x16x32_bf16 v[148:151], v[76:79], a[244:247], v[148:151]
    buffer_load_dwordx4 v23, s[12:15], s65 offen lds
    v_mfma_f32_16x16x32_bf16 v[144:147], v[76:79], a[240:243], v[144:147]
    s_waitcnt lgkmcnt(4)
    v_mfma_f32_16x16x32_bf16 v[160:163], v[64:67], a[240:243], v[160:163]
    ds_read_b64_tr_b16 v[76:77], v15 offset:58368
    v_mfma_f32_16x16x32_bf16 v[164:167], v[64:67], a[244:247], v[164:167]
    ds_read_b64_tr_b16 v[78:79], v15 offset:62464
    v_mfma_f32_16x16x32_bf16 v[168:171], v[64:67], a[248:251], v[168:171]
    buffer_load_dwordx4 v23, s[16:19], s65 offen offset:1024 lds
    v_mfma_f32_16x16x32_bf16 v[172:175], v[64:67], a[252:255], v[172:175]
    s_waitcnt lgkmcnt(4)
    s_add_u32 s65, s65, 294912
    v_mfma_f32_16x16x32_bf16 v[188:191], v[68:71], a[252:255], v[188:191]
    s_add_u32 m0, s64, 73728
    ds_read_b64_tr_b16 v[64:65], v8 offset:0
    v_mfma_f32_16x16x32_bf16 v[184:187], v[68:71], a[248:251], v[184:187]
    ds_read_b64_tr_b16 v[66:67], v8 offset:4096
    v_mfma_f32_16x16x32_bf16 v[180:183], v[68:71], a[244:247], v[180:183]
    buffer_load_dwordx4 v23, s[12:15], s65 offen lds
    v_mfma_f32_16x16x32_bf16 v[176:179], v[68:71], a[240:243], v[176:179]
    s_waitcnt lgkmcnt(4)
    v_mfma_f32_16x16x32_bf16 v[192:195], v[72:75], a[240:243], v[192:195]
    ds_read_b64_tr_b16 v[68:69], v8 offset:1024
    v_mfma_f32_16x16x32_bf16 v[196:199], v[72:75], a[244:247], v[196:199]
    ds_read_b64_tr_b16 v[70:71], v8 offset:5120
    v_mfma_f32_16x16x32_bf16 v[200:203], v[72:75], a[248:251], v[200:203]
    buffer_load_dwordx4 v23, s[16:19], s65 offen offset:1024 lds
    v_mfma_f32_16x16x32_bf16 v[204:207], v[72:75], a[252:255], v[204:207]
    s_waitcnt lgkmcnt(4)
    s_add_u32 s65, s65, 294912
    v_mfma_f32_16x16x32_bf16 v[220:223], v[76:79], a[252:255], v[220:223]
    s_add_u32 m0, s64, 81920
    ds_read_b64_tr_b16 v[72:73], v8 offset:8192
    v_mfma_f32_16x16x32_bf16 v[216:219], v[76:79], a[248:251], v[216:219]
    ds_read_b64_tr_b16 v[74:75], v8 offset:12288
    v_mfma_f32_16x16x32_bf16 v[212:215], v[76:79], a[244:247], v[212:215]
    v_mfma_f32_16x16x32_bf16 v[208:211], v[76:79], a[240:243], v[208:211]
    s_waitcnt vmcnt(25)
    s_waitcnt lgkmcnt(4)
    v_mfma_f32_16x16x32_bf16 v[96:99], v[64:67], v[224:227], v[96:99]
    ds_read_b64_tr_b16 v[76:77], v8 offset:9216
    v_mfma_f32_16x16x32_bf16 v[100:103], v[64:67], v[228:231], v[100:103]
    ds_read_b64_tr_b16 v[78:79], v8 offset:13312
    v_mfma_f32_16x16x32_bf16 v[104:107], v[64:67], v[232:235], v[104:107]
    buffer_load_dwordx4 v23, s[12:15], s65 offen lds
    v_mfma_f32_16x16x32_bf16 v[108:111], v[64:67], v[236:239], v[108:111]
    s_waitcnt lgkmcnt(4)
    v_mfma_f32_16x16x32_bf16 v[124:127], v[68:71], v[236:239], v[124:127]
    ds_read_b64_tr_b16 v[64:65], v9 offset:0
    v_mfma_f32_16x16x32_bf16 v[120:123], v[68:71], v[232:235], v[120:123]
    ds_read_b64_tr_b16 v[66:67], v9 offset:4096
    v_mfma_f32_16x16x32_bf16 v[116:119], v[68:71], v[228:231], v[116:119]
    v_mfma_f32_16x16x32_bf16 v[112:115], v[68:71], v[224:227], v[112:115]
    s_waitcnt vmcnt(16)
    s_waitcnt lgkmcnt(4)
    v_mfma_f32_16x16x32_bf16 v[96:99], v[72:75], v[240:243], v[96:99]
    ds_read_b64_tr_b16 v[68:69], v9 offset:1024
    v_mfma_f32_16x16x32_bf16 v[100:103], v[72:75], v[244:247], v[100:103]
    ds_read_b64_tr_b16 v[70:71], v9 offset:5120
    v_mfma_f32_16x16x32_bf16 v[104:107], v[72:75], v[248:251], v[104:107]
    buffer_load_dwordx4 v23, s[16:19], s65 offen offset:1024 lds
    v_mfma_f32_16x16x32_bf16 v[108:111], v[72:75], v[252:255], v[108:111]
    s_waitcnt lgkmcnt(4)
    s_add_u32 s65, s65, 294912
    v_mfma_f32_16x16x32_bf16 v[124:127], v[76:79], v[252:255], v[124:127]
    s_add_u32 m0, s64, 131072
    ds_read_b64_tr_b16 v[72:73], v9 offset:8192
    v_mfma_f32_16x16x32_bf16 v[120:123], v[76:79], v[248:251], v[120:123]
    ds_read_b64_tr_b16 v[74:75], v9 offset:12288
    v_mfma_f32_16x16x32_bf16 v[116:119], v[76:79], v[244:247], v[116:119]
    buffer_load_dwordx4 v24, s[24:27], s68 offen offset:1024 lds
    v_mfma_f32_16x16x32_bf16 v[112:115], v[76:79], v[240:243], v[112:115]
    s_waitcnt lgkmcnt(4)
    s_add_u32 s70, s4, 8
    v_mfma_f32_16x16x32_bf16 v[128:131], v[64:67], v[224:227], v[128:131]
    s_mul_i32 s68, s70, s71
    ds_read_b64_tr_b16 v[76:77], v9 offset:9216
    v_mfma_f32_16x16x32_bf16 v[132:135], v[64:67], v[228:231], v[132:135]
    s_add_u32 s68, s68, s69
    ds_read_b64_tr_b16 v[78:79], v9 offset:13312
    v_mfma_f32_16x16x32_bf16 v[136:139], v[64:67], v[232:235], v[136:139]
    s_add_u32 m0, s64, 139264
    v_mul_f32 v96, v96, v112
    v_mul_f32 v97, v97, v113
    v_mfma_f32_16x16x32_bf16 v[140:143], v[64:67], v[236:239], v[140:143]
    s_waitcnt lgkmcnt(4)
    buffer_load_dwordx4 v24, s[20:23], s68 offen offset:0 lds
    v_mfma_f32_16x16x32_bf16 v[156:159], v[68:71], v[236:239], v[156:159]
    ds_read_b64_tr_b16 v[64:65], v10 offset:0
    s_waitcnt vmcnt(14)
    v_mfma_f32_16x16x32_bf16 v[152:155], v[68:71], v[232:235], v[152:155]
    s_add_u32 s94, s64, 131072
    ds_read_b64_tr_b16 v[66:67], v10 offset:4096
    v_add_u32 v86, s94, v1
    v_mfma_f32_16x16x32_bf16 v[148:151], v[68:71], v[228:231], v[148:151]
    ds_read_b128 v[86:89], v86
    v_mul_f32 v98, v98, v114
    v_mfma_f32_16x16x32_bf16 v[144:147], v[68:71], v[224:227], v[144:147]
    s_waitcnt lgkmcnt(5)
    s_add_u32 s95, s4, 0
    v_mul_f32 v99, v99, v115
    v_mfma_f32_16x16x32_bf16 v[128:131], v[72:75], v[240:243], v[128:131]
    s_mul_i32 s94, s95, 9216
    ds_read_b64_tr_b16 v[68:69], v10 offset:1024
    v_cvt_pk_bf16_f32 v32, v96, v97
    v_mfma_f32_16x16x32_bf16 v[132:135], v[72:75], v[244:247], v[132:135]
    s_add_u32 s94, s94, s42
    ds_read_b64_tr_b16 v[70:71], v10 offset:5120
    v_cvt_pk_bf16_f32 v33, v98, v99
    v_mfma_f32_16x16x32_bf16 v[136:139], v[72:75], v[248:251], v[136:139]
    s_add_u32 s94, s94, s64
    s_waitcnt lgkmcnt(2)
    v_mul_f32 v100, v100, v116
    v_mfma_f32_16x16x32_bf16 v[140:143], v[72:75], v[252:255], v[140:143]
    buffer_store_dwordx4 v[86:89], v1, s[8:11], s94 offen offset:0 sc1
    v_mfma_f32_16x16x32_bf16 v[156:159], v[76:79], v[252:255], v[156:159]
    s_add_u32 m0, s64, 139264
    ds_read_b64_tr_b16 v[72:73], v10 offset:8192
    v_mul_f32 v101, v101, v117
    v_mfma_f32_16x16x32_bf16 v[152:155], v[76:79], v[248:251], v[152:155]
    ds_read_b64_tr_b16 v[74:75], v10 offset:12288
    v_mul_f32 v102, v102, v118
    v_mfma_f32_16x16x32_bf16 v[148:151], v[76:79], v[244:247], v[148:151]
    v_mul_f32 v103, v103, v119
    v_cvt_pk_bf16_f32 v36, v100, v101
    v_mfma_f32_16x16x32_bf16 v[144:147], v[76:79], v[240:243], v[144:147]
    v_cvt_pk_bf16_f32 v37, v102, v103
    v_mul_f32 v104, v104, v120
    v_mfma_f32_16x16x32_bf16 v[160:163], v[64:67], v[224:227], v[160:163]
    ds_read_b64_tr_b16 v[76:77], v10 offset:9216
    v_mul_f32 v105, v105, v121
    v_mfma_f32_16x16x32_bf16 v[164:167], v[64:67], v[228:231], v[164:167]
    ds_read_b64_tr_b16 v[78:79], v10 offset:13312
    v_mul_f32 v106, v106, v122
    v_mfma_f32_16x16x32_bf16 v[168:171], v[64:67], v[232:235], v[168:171]
    v_mul_f32 v107, v107, v123
    v_cvt_pk_bf16_f32 v40, v104, v105
    v_mfma_f32_16x16x32_bf16 v[172:175], v[64:67], v[236:239], v[172:175]
    s_waitcnt lgkmcnt(4)
    buffer_load_dwordx4 v24, s[24:27], s68 offen offset:1024 lds
    v_mfma_f32_16x16x32_bf16 v[188:191], v[68:71], v[236:239], v[188:191]
    ds_read_b64_tr_b16 v[64:65], v11 offset:0
    v_cvt_pk_bf16_f32 v41, v106, v107
    v_mfma_f32_16x16x32_bf16 v[184:187], v[68:71], v[232:235], v[184:187]
    ds_read_b64_tr_b16 v[66:67], v11 offset:4096
    v_mul_f32 v108, v108, v124
    v_mfma_f32_16x16x32_bf16 v[180:183], v[68:71], v[228:231], v[180:183]
    v_mul_f32 v109, v109, v125
    v_mul_f32 v110, v110, v126
    v_mfma_f32_16x16x32_bf16 v[176:179], v[68:71], v[224:227], v[176:179]
    s_waitcnt lgkmcnt(4)
    v_mul_f32 v111, v111, v127
    v_cvt_pk_bf16_f32 v44, v108, v109
    v_mfma_f32_16x16x32_bf16 v[160:163], v[72:75], v[240:243], v[160:163]
    ds_read_b64_tr_b16 v[68:69], v11 offset:1024
    v_cvt_pk_bf16_f32 v45, v110, v111
    v_mfma_f32_16x16x32_bf16 v[164:167], v[72:75], v[244:247], v[164:167]
    ds_read_b64_tr_b16 v[70:71], v11 offset:5120
    v_mul_f32 v128, v128, v144
    v_mfma_f32_16x16x32_bf16 v[168:171], v[72:75], v[248:251], v[168:171]
    v_mul_f32 v129, v129, v145
    v_mul_f32 v130, v130, v146
    v_mfma_f32_16x16x32_bf16 v[172:175], v[72:75], v[252:255], v[172:175]
    s_waitcnt lgkmcnt(4)
    v_mul_f32 v131, v131, v147
    v_cvt_pk_bf16_f32 v34, v128, v129
    v_mfma_f32_16x16x32_bf16 v[188:191], v[76:79], v[252:255], v[188:191]
    ds_read_b64_tr_b16 v[72:73], v11 offset:8192
    v_cvt_pk_bf16_f32 v35, v130, v131
    v_mfma_f32_16x16x32_bf16 v[184:187], v[76:79], v[248:251], v[184:187]
    ds_read_b64_tr_b16 v[74:75], v11 offset:12288
    v_mul_f32 v132, v132, v148
    v_mfma_f32_16x16x32_bf16 v[180:183], v[76:79], v[244:247], v[180:183]
    v_mul_f32 v133, v133, v149
    v_mul_f32 v134, v134, v150
    v_mfma_f32_16x16x32_bf16 v[176:179], v[76:79], v[240:243], v[176:179]
    s_waitcnt lgkmcnt(4)
    v_mul_f32 v135, v135, v151
    v_cvt_pk_bf16_f32 v38, v132, v133
    v_mfma_f32_16x16x32_bf16 v[192:195], v[64:67], v[224:227], v[192:195]
    ds_read_b64_tr_b16 v[76:77], v11 offset:9216
    v_cvt_pk_bf16_f32 v39, v134, v135
    v_mfma_f32_16x16x32_bf16 v[196:199], v[64:67], v[228:231], v[196:199]
    ds_read_b64_tr_b16 v[78:79], v11 offset:13312
    v_mul_f32 v136, v136, v152
    v_mfma_f32_16x16x32_bf16 v[200:203], v[64:67], v[232:235], v[200:203]
    v_mul_f32 v137, v137, v153
    v_mul_f32 v138, v138, v154
    v_mfma_f32_16x16x32_bf16 v[204:207], v[64:67], v[236:239], v[204:207]
    s_waitcnt lgkmcnt(4)
    s_barrier
    v_mul_f32 v139, v139, v155
    v_mfma_f32_16x16x32_bf16 v[220:223], v[68:71], v[236:239], v[220:223]
    ds_read_b64_tr_b16 v[64:65], v8 offset:16384
    v_cvt_pk_bf16_f32 v42, v136, v137
    v_mfma_f32_16x16x32_bf16 v[216:219], v[68:71], v[232:235], v[216:219]
    s_add_u32 m0, s64, 90112
    ds_read_b64_tr_b16 v[66:67], v8 offset:20480
    v_cvt_pk_bf16_f32 v43, v138, v139
    v_mfma_f32_16x16x32_bf16 v[212:215], v[68:71], v[228:231], v[212:215]
    buffer_load_dwordx4 v23, s[12:15], s65 offen lds
    v_mfma_f32_16x16x32_bf16 v[208:211], v[68:71], v[224:227], v[208:211]
    s_waitcnt lgkmcnt(4)
    v_mul_f32 v140, v140, v156
    v_mul_f32 v141, v141, v157
    v_mfma_f32_16x16x32_bf16 v[192:195], v[72:75], v[240:243], v[192:195]
    ds_read_b64_tr_b16 v[68:69], v8 offset:17408
    v_mul_f32 v142, v142, v158
    v_mfma_f32_16x16x32_bf16 v[196:199], v[72:75], v[244:247], v[196:199]
    ds_read_b64_tr_b16 v[70:71], v8 offset:21504
    v_mul_f32 v143, v143, v159
    v_mfma_f32_16x16x32_bf16 v[200:203], v[72:75], v[248:251], v[200:203]
    buffer_load_dwordx4 v23, s[16:19], s65 offen offset:1024 lds
    v_mfma_f32_16x16x32_bf16 v[204:207], v[72:75], v[252:255], v[204:207]
    s_waitcnt lgkmcnt(4)
    s_add_u32 s65, s65, 294912
    v_cvt_pk_bf16_f32 v46, v140, v141
    v_mfma_f32_16x16x32_bf16 v[220:223], v[76:79], v[252:255], v[220:223]
    s_add_u32 m0, s64, 98304
    ds_read_b64_tr_b16 v[72:73], v8 offset:24576
    v_cvt_pk_bf16_f32 v47, v142, v143
    v_mfma_f32_16x16x32_bf16 v[216:219], v[76:79], v[248:251], v[216:219]
    ds_read_b64_tr_b16 v[74:75], v8 offset:28672
    v_mul_f32 v160, v160, v176
    v_mfma_f32_16x16x32_bf16 v[212:215], v[76:79], v[244:247], v[212:215]
    buffer_load_dwordx4 v23, s[12:15], s65 offen lds
    v_mfma_f32_16x16x32_bf16 v[208:211], v[76:79], v[240:243], v[208:211]
    s_waitcnt lgkmcnt(4)
    v_mul_f32 v161, v161, v177
    v_mul_f32 v162, v162, v178
    v_mfma_f32_16x16x32_bf16 v[96:99], v[64:67], a[0:3], 0
    ds_read_b64_tr_b16 v[76:77], v8 offset:25600
    v_mul_f32 v163, v163, v179
    v_mfma_f32_16x16x32_bf16 v[100:103], v[64:67], a[4:7], 0
    ds_read_b64_tr_b16 v[78:79], v8 offset:29696
    v_cvt_pk_bf16_f32 v48, v160, v161
    v_mfma_f32_16x16x32_bf16 v[104:107], v[64:67], a[8:11], 0
    buffer_load_dwordx4 v23, s[16:19], s65 offen offset:1024 lds
    v_mfma_f32_16x16x32_bf16 v[108:111], v[64:67], a[12:15], 0
    s_waitcnt lgkmcnt(4)
    s_add_u32 s65, s65, 294912
    v_cvt_pk_bf16_f32 v49, v162, v163
    v_mfma_f32_16x16x32_bf16 v[124:127], v[68:71], a[12:15], 0
    s_add_u32 m0, s64, 106496
    ds_read_b64_tr_b16 v[64:65], v9 offset:16384
    v_mul_f32 v164, v164, v180
    v_mfma_f32_16x16x32_bf16 v[120:123], v[68:71], a[8:11], 0
    ds_read_b64_tr_b16 v[66:67], v9 offset:20480
    v_mul_f32 v165, v165, v181
    v_mfma_f32_16x16x32_bf16 v[116:119], v[68:71], a[4:7], 0
    buffer_load_dwordx4 v23, s[12:15], s65 offen lds
    v_mfma_f32_16x16x32_bf16 v[112:115], v[68:71], a[0:3], 0
    s_waitcnt lgkmcnt(4)
    v_mul_f32 v166, v166, v182
    v_mul_f32 v167, v167, v183
    v_mfma_f32_16x16x32_bf16 v[96:99], v[72:75], a[16:19], v[96:99]
    ds_read_b64_tr_b16 v[68:69], v9 offset:17408
    v_cvt_pk_bf16_f32 v52, v164, v165
    v_mfma_f32_16x16x32_bf16 v[100:103], v[72:75], a[20:23], v[100:103]
    ds_read_b64_tr_b16 v[70:71], v9 offset:21504
    v_cvt_pk_bf16_f32 v53, v166, v167
    v_mfma_f32_16x16x32_bf16 v[104:107], v[72:75], a[24:27], v[104:107]
    buffer_load_dwordx4 v23, s[16:19], s65 offen offset:1024 lds
    v_mfma_f32_16x16x32_bf16 v[108:111], v[72:75], a[28:31], v[108:111]
    s_waitcnt lgkmcnt(4)
    s_add_u32 s65, s65, 294912
    v_mul_f32 v168, v168, v184
    v_mfma_f32_16x16x32_bf16 v[124:127], v[76:79], a[28:31], v[124:127]
    s_add_u32 m0, s64, 114688
    ds_read_b64_tr_b16 v[72:73], v9 offset:24576
    v_mul_f32 v169, v169, v185
    v_mfma_f32_16x16x32_bf16 v[120:123], v[76:79], a[24:27], v[120:123]
    ds_read_b64_tr_b16 v[74:75], v9 offset:28672
    v_mul_f32 v170, v170, v186
    v_mfma_f32_16x16x32_bf16 v[116:119], v[76:79], a[20:23], v[116:119]
    buffer_load_dwordx4 v23, s[12:15], s65 offen lds
    v_mfma_f32_16x16x32_bf16 v[112:115], v[76:79], a[16:19], v[112:115]
    s_waitcnt lgkmcnt(4)
    v_mul_f32 v171, v171, v187
    v_cvt_pk_bf16_f32 v56, v168, v169
    v_mfma_f32_16x16x32_bf16 v[128:131], v[64:67], a[0:3], 0
    ds_read_b64_tr_b16 v[76:77], v9 offset:25600
    v_cvt_pk_bf16_f32 v57, v170, v171
    v_mfma_f32_16x16x32_bf16 v[132:135], v[64:67], a[4:7], 0
    ds_read_b64_tr_b16 v[78:79], v9 offset:29696
    v_mul_f32 v172, v172, v188
    v_mfma_f32_16x16x32_bf16 v[136:139], v[64:67], a[8:11], 0
    buffer_load_dwordx4 v23, s[16:19], s65 offen offset:1024 lds
    v_mfma_f32_16x16x32_bf16 v[140:143], v[64:67], a[12:15], 0
    s_waitcnt lgkmcnt(4)
    s_add_u32 s65, s65, 294912
    v_mul_f32 v173, v173, v189
    v_mfma_f32_16x16x32_bf16 v[156:159], v[68:71], a[12:15], 0
    s_add_u32 m0, s64, 122880
    ds_read_b64_tr_b16 v[64:65], v10 offset:16384
    v_mul_f32 v174, v174, v190
    v_mfma_f32_16x16x32_bf16 v[152:155], v[68:71], a[8:11], 0
    ds_read_b64_tr_b16 v[66:67], v10 offset:20480
    v_mul_f32 v175, v175, v191
    v_mfma_f32_16x16x32_bf16 v[148:151], v[68:71], a[4:7], 0
    buffer_load_dwordx4 v23, s[12:15], s65 offen lds
    v_mfma_f32_16x16x32_bf16 v[144:147], v[68:71], a[0:3], 0
    s_waitcnt lgkmcnt(4)
    v_cvt_pk_bf16_f32 v60, v172, v173
    v_cvt_pk_bf16_f32 v61, v174, v175
    v_mfma_f32_16x16x32_bf16 v[128:131], v[72:75], a[16:19], v[128:131]
    ds_read_b64_tr_b16 v[68:69], v10 offset:17408
    v_mul_f32 v192, v192, v208
    v_mfma_f32_16x16x32_bf16 v[132:135], v[72:75], a[20:23], v[132:135]
    ds_read_b64_tr_b16 v[70:71], v10 offset:21504
    v_mul_f32 v193, v193, v209
    v_mfma_f32_16x16x32_bf16 v[136:139], v[72:75], a[24:27], v[136:139]
    buffer_load_dwordx4 v23, s[16:19], s65 offen offset:1024 lds
    v_mfma_f32_16x16x32_bf16 v[140:143], v[72:75], a[28:31], v[140:143]
    s_waitcnt lgkmcnt(4)
    s_add_u32 s65, s65, 294912
    v_mul_f32 v194, v194, v210
    v_mfma_f32_16x16x32_bf16 v[156:159], v[76:79], a[28:31], v[156:159]
    s_add_u32 m0, s64, 0
    ds_read_b64_tr_b16 v[72:73], v10 offset:24576
    v_mul_f32 v195, v195, v211
    v_mfma_f32_16x16x32_bf16 v[152:155], v[76:79], a[24:27], v[152:155]
    ds_read_b64_tr_b16 v[74:75], v10 offset:28672
    v_cvt_pk_bf16_f32 v50, v192, v193
    v_mfma_f32_16x16x32_bf16 v[148:151], v[76:79], a[20:23], v[148:151]
    buffer_load_dwordx4 v23, s[12:15], s65 offen lds
    v_mfma_f32_16x16x32_bf16 v[144:147], v[76:79], a[16:19], v[144:147]
    s_waitcnt lgkmcnt(4)
    v_cvt_pk_bf16_f32 v51, v194, v195
    v_mul_f32 v196, v196, v212
    v_mfma_f32_16x16x32_bf16 v[160:163], v[64:67], a[0:3], 0
    ds_read_b64_tr_b16 v[76:77], v10 offset:25600
    v_mul_f32 v197, v197, v213
    v_mfma_f32_16x16x32_bf16 v[164:167], v[64:67], a[4:7], 0
    ds_read_b64_tr_b16 v[78:79], v10 offset:29696
    v_mul_f32 v198, v198, v214
    v_mfma_f32_16x16x32_bf16 v[168:171], v[64:67], a[8:11], 0
    buffer_load_dwordx4 v23, s[16:19], s65 offen offset:1024 lds
    v_mfma_f32_16x16x32_bf16 v[172:175], v[64:67], a[12:15], 0
    s_waitcnt lgkmcnt(4)
    s_add_u32 s65, s65, 294912
    v_mul_f32 v199, v199, v215
    v_mfma_f32_16x16x32_bf16 v[188:191], v[68:71], a[12:15], 0
    ds_read_b64_tr_b16 v[64:65], v11 offset:16384
    s_waitcnt vmcnt(15)
    v_mfma_f32_16x16x32_bf16 v[184:187], v[68:71], a[8:11], 0
    s_add_u32 s94, s64, 132096
    ds_read_b64_tr_b16 v[66:67], v11 offset:20480
    v_add_u32 v90, s94, v1
    v_mfma_f32_16x16x32_bf16 v[180:183], v[68:71], a[4:7], 0
    ds_read_b128 v[90:93], v90
    v_cvt_pk_bf16_f32 v54, v196, v197
    v_mfma_f32_16x16x32_bf16 v[176:179], v[68:71], a[0:3], 0
    s_waitcnt lgkmcnt(5)
    s_add_u32 s95, s4, 0
    v_cvt_pk_bf16_f32 v55, v198, v199
    v_mfma_f32_16x16x32_bf16 v[160:163], v[72:75], a[16:19], v[160:163]
    s_mul_i32 s94, s95, 9216
    ds_read_b64_tr_b16 v[68:69], v11 offset:17408
    v_mul_f32 v200, v200, v216
    v_mfma_f32_16x16x32_bf16 v[164:167], v[72:75], a[20:23], v[164:167]
    s_add_u32 s94, s94, s42
    ds_read_b64_tr_b16 v[70:71], v11 offset:21504
    v_mul_f32 v201, v201, v217
    v_mfma_f32_16x16x32_bf16 v[168:171], v[72:75], a[24:27], v[168:171]
    s_add_u32 s94, s94, s64
    s_waitcnt lgkmcnt(2)
    v_mul_f32 v202, v202, v218
    v_mfma_f32_16x16x32_bf16 v[172:175], v[72:75], a[28:31], v[172:175]
    buffer_store_dwordx4 v[90:93], v1, s[8:11], s94 offen offset:1024 sc1
    v_mfma_f32_16x16x32_bf16 v[188:191], v[76:79], a[28:31], v[188:191]
    s_add_u32 s70, s4, 16
    ds_read_b64_tr_b16 v[72:73], v11 offset:24576
    v_mul_f32 v203, v203, v219
    v_mfma_f32_16x16x32_bf16 v[184:187], v[76:79], a[24:27], v[184:187]
    s_mul_i32 s68, s70, s71
    ds_read_b64_tr_b16 v[74:75], v11 offset:28672
    v_cvt_pk_bf16_f32 v58, v200, v201
    v_mfma_f32_16x16x32_bf16 v[180:183], v[76:79], a[20:23], v[180:183]
    s_add_u32 s68, s68, s69
    s_cmp_lt_u32 s70, 18
    s_cselect_b32 s68, s68, 1073741824
    v_cvt_pk_bf16_f32 v59, v202, v203
    v_mfma_f32_16x16x32_bf16 v[176:179], v[76:79], a[16:19], v[176:179]
    s_add_u32 m0, s64, 147456
    v_mul_f32 v204, v204, v220
    v_mul_f32 v205, v205, v221
    v_mul_f32 v206, v206, v222
    v_mul_f32 v207, v207, v223
    v_cvt_pk_bf16_f32 v62, v204, v205
    v_cvt_pk_bf16_f32 v63, v206, v207
    v_mfma_f32_16x16x32_bf16 v[192:195], v[64:67], a[0:3], 0
    ds_read_b64_tr_b16 v[76:77], v11 offset:25600
    v_mfma_f32_16x16x32_bf16 v[196:199], v[64:67], a[4:7], 0
    ds_read_b64_tr_b16 v[78:79], v11 offset:29696
    v_mfma_f32_16x16x32_bf16 v[200:203], v[64:67], a[8:11], 0
    buffer_load_dwordx4 v24, s[20:23], s68 offen offset:0 lds
    v_mfma_f32_16x16x32_bf16 v[204:207], v[64:67], a[12:15], 0
    s_waitcnt lgkmcnt(4)
    s_lshl_b32 s94, s2, 2
    v_mfma_f32_16x16x32_bf16 v[220:223], v[68:71], a[12:15], 0
    s_add_u32 s94, s94, s3
    ds_read_b64_tr_b16 v[64:65], v8 offset:32768
    v_mfma_f32_16x16x32_bf16 v[216:219], v[68:71], a[8:11], 0
    s_mul_i32 s94, s94, 6
    ds_read_b64_tr_b16 v[66:67], v8 offset:36864
    v_and_b32 v80, 63, v0
    v_mfma_f32_16x16x32_bf16 v[212:215], v[68:71], a[4:7], 0
    v_min_u32 v80, 5, v80
    v_mfma_f32_16x16x32_bf16 v[208:211], v[68:71], a[0:3], 0
    s_waitcnt lgkmcnt(4)
    v_add_u32 v80, s94, v80
    v_mfma_f32_16x16x32_bf16 v[192:195], v[72:75], a[16:19], v[192:195]
    ds_read_b64_tr_b16 v[68:69], v8 offset:33792
    v_min_u32 v80, 5183, v80
    v_mfma_f32_16x16x32_bf16 v[196:199], v[72:75], a[20:23], v[196:199]
    ds_read_b64_tr_b16 v[70:71], v8 offset:37888
    v_lshlrev_b32 v80, 7, v80
    v_mfma_f32_16x16x32_bf16 v[200:203], v[72:75], a[24:27], v[200:203]
    global_load_dword v84, v80, s[52:53]
    v_mfma_f32_16x16x32_bf16 v[204:207], v[72:75], a[28:31], v[204:207]
    s_waitcnt lgkmcnt(4)
    s_waitcnt vmcnt(17)
    v_mfma_f32_16x16x32_bf16 v[220:223], v[76:79], a[28:31], v[220:223]
    s_add_u32 s94, s64, 139264
    ds_read_b64_tr_b16 v[72:73], v9 offset:32768
    v_add_u32 v86, s94, v1
    v_mfma_f32_16x16x32_bf16 v[216:219], v[76:79], a[24:27], v[216:219]
    ds_read_b64_tr_b16 v[74:75], v9 offset:36864
    ds_read_b128 v[86:89], v86
    v_mfma_f32_16x16x32_bf16 v[212:215], v[76:79], a[20:23], v[212:215]
    s_add_u32 s95, s4, 8
    s_mul_i32 s94, s95, 9216
    v_mfma_f32_16x16x32_bf16 v[208:211], v[76:79], a[16:19], v[208:211]
    s_waitcnt lgkmcnt(5)
    s_add_u32 s94, s94, s42
    v_mfma_f32_16x16x32_bf16 v[96:99], v[64:67], a[32:35], v[96:99]
    s_add_u32 s94, s94, s64
    ds_read_b64_tr_b16 v[76:77], v9 offset:33792
    s_waitcnt lgkmcnt(1)
    v_mfma_f32_16x16x32_bf16 v[100:103], v[64:67], a[36:39], v[100:103]
    ds_read_b64_tr_b16 v[78:79], v9 offset:37888
    v_mfma_f32_16x16x32_bf16 v[104:107], v[64:67], a[40:43], v[104:107]
    buffer_store_dwordx4 v[86:89], v1, s[8:11], s94 offen offset:0 sc1
    v_mfma_f32_16x16x32_bf16 v[108:111], v[64:67], a[44:47], v[108:111]
    s_add_u32 m0, s64, 147456
    v_mfma_f32_16x16x32_bf16 v[124:127], v[68:71], a[44:47], v[124:127]
    ds_read_b64_tr_b16 v[64:65], v10 offset:32768
    v_mfma_f32_16x16x32_bf16 v[120:123], v[68:71], a[40:43], v[120:123]
    ds_read_b64_tr_b16 v[66:67], v10 offset:36864
    v_mfma_f32_16x16x32_bf16 v[116:119], v[68:71], a[36:39], v[116:119]
    v_mfma_f32_16x16x32_bf16 v[112:115], v[68:71], a[32:35], v[112:115]
    buffer_load_dwordx4 v24, s[24:27], s68 offen offset:1024 lds
    v_mfma_f32_16x16x32_bf16 v[128:131], v[72:75], a[32:35], v[128:131]
    ds_read_b64_tr_b16 v[68:69], v10 offset:33792
    s_waitcnt vmcnt(17)
    v_mfma_f32_16x16x32_bf16 v[132:135], v[72:75], a[36:39], v[132:135]
    s_add_u32 s94, s64, 140288
    ds_read_b64_tr_b16 v[70:71], v10 offset:37888
    v_add_u32 v90, s94, v1
    v_mfma_f32_16x16x32_bf16 v[136:139], v[72:75], a[40:43], v[136:139]
    ds_read_b128 v[90:93], v90
    v_mfma_f32_16x16x32_bf16 v[140:143], v[72:75], a[44:47], v[140:143]
    s_waitcnt lgkmcnt(5)
    s_add_u32 s95, s4, 8
    v_mfma_f32_16x16x32_bf16 v[156:159], v[76:79], a[44:47], v[156:159]
    s_mul_i32 s94, s95, 9216
    ds_read_b64_tr_b16 v[72:73], v11 offset:32768
    v_mfma_f32_16x16x32_bf16 v[152:155], v[76:79], a[40:43], v[152:155]
    s_add_u32 s94, s94, s42
    ds_read_b64_tr_b16 v[74:75], v11 offset:36864
    v_mfma_f32_16x16x32_bf16 v[148:151], v[76:79], a[36:39], v[148:151]
    s_add_u32 s94, s94, s64
    s_waitcnt lgkmcnt(2)
    v_mfma_f32_16x16x32_bf16 v[144:147], v[76:79], a[32:35], v[144:147]
    buffer_store_dwordx4 v[90:93], v1, s[8:11], s94 offen offset:1024 sc1
    v_mfma_f32_16x16x32_bf16 v[160:163], v[64:67], a[32:35], v[160:163]
    s_lshl_b32 s70, s3, 3
    ds_read_b64_tr_b16 v[76:77], v11 offset:33792
    v_mfma_f32_16x16x32_bf16 v[164:167], v[64:67], a[36:39], v[164:167]
    s_add_u32 s70, s70, s4
    ds_read_b64_tr_b16 v[78:79], v11 offset:37888
    v_mfma_f32_16x16x32_bf16 v[168:171], v[64:67], a[40:43], v[168:171]
    s_mul_i32 s68, s70, 36864
    s_add_u32 s68, s68, s80
    v_mfma_f32_16x16x32_bf16 v[172:175], v[64:67], a[44:47], v[172:175]
    s_barrier
    s_cmp_lt_u32 s70, 18
    s_cselect_b32 s68, s68, 1073741824
    v_mfma_f32_16x16x32_bf16 v[188:191], v[68:71], a[44:47], v[188:191]
    s_add_u32 m0, s81, 155648
    ds_read_b64_tr_b16 v[64:65], v8 offset:40960
    v_mfma_f32_16x16x32_bf16 v[184:187], v[68:71], a[40:43], v[184:187]
    ds_read_b64_tr_b16 v[66:67], v8 offset:45056
    v_mfma_f32_16x16x32_bf16 v[180:183], v[68:71], a[36:39], v[180:183]
    buffer_load_dwordx4 v26, s[28:31], s68 offen lds
    v_mfma_f32_16x16x32_bf16 v[176:179], v[68:71], a[32:35], v[176:179]
    s_waitcnt lgkmcnt(4)
    s_add_u32 m0, s64, 8192
    v_mfma_f32_16x16x32_bf16 v[192:195], v[72:75], a[32:35], v[192:195]
    ds_read_b64_tr_b16 v[68:69], v8 offset:41984
    v_mfma_f32_16x16x32_bf16 v[196:199], v[72:75], a[36:39], v[196:199]
    ds_read_b64_tr_b16 v[70:71], v8 offset:46080
    v_mfma_f32_16x16x32_bf16 v[200:203], v[72:75], a[40:43], v[200:203]
    buffer_load_dwordx4 v23, s[12:15], s65 offen lds
    v_mfma_f32_16x16x32_bf16 v[204:207], v[72:75], a[44:47], v[204:207]
    s_waitcnt lgkmcnt(4)
    v_mfma_f32_16x16x32_bf16 v[220:223], v[76:79], a[44:47], v[220:223]
    ds_read_b64_tr_b16 v[72:73], v9 offset:40960
    v_mfma_f32_16x16x32_bf16 v[216:219], v[76:79], a[40:43], v[216:219]
    ds_read_b64_tr_b16 v[74:75], v9 offset:45056
    v_mfma_f32_16x16x32_bf16 v[212:215], v[76:79], a[36:39], v[212:215]
    buffer_load_dwordx4 v23, s[16:19], s65 offen offset:1024 lds
    v_mfma_f32_16x16x32_bf16 v[208:211], v[76:79], a[32:35], v[208:211]
    s_waitcnt lgkmcnt(4)
    s_add_u32 s65, s65, 294912
    v_mfma_f32_16x16x32_bf16 v[96:99], v[64:67], a[48:51], v[96:99]
    s_add_u32 m0, s64, 16384
    ds_read_b64_tr_b16 v[76:77], v9 offset:41984
    v_mfma_f32_16x16x32_bf16 v[100:103], v[64:67], a[52:55], v[100:103]
    ds_read_b64_tr_b16 v[78:79], v9 offset:46080
L_page3:
    s_cbranch_execz L_page7
    v_mfma_f32_16x16x32_bf16 v[104:107], v[64:67], a[56:59], v[104:107]
    buffer_load_dwordx4 v23, s[12:15], s65 offen lds
    v_mfma_f32_16x16x32_bf16 v[108:111], v[64:67], a[60:63], v[108:111]
    s_waitcnt lgkmcnt(4)
    v_mfma_f32_16x16x32_bf16 v[124:127], v[68:71], a[60:63], v[124:127]
    ds_read_b64_tr_b16 v[64:65], v10 offset:40960
    v_mfma_f32_16x16x32_bf16 v[120:123], v[68:71], a[56:59], v[120:123]
    ds_read_b64_tr_b16 v[66:67], v10 offset:45056
    v_mfma_f32_16x16x32_bf16 v[116:119], v[68:71], a[52:55], v[116:119]
    buffer_load_dwordx4 v23, s[16:19], s65 offen offset:1024 lds
    v_mfma_f32_16x16x32_bf16 v[112:115], v[68:71], a[48:51], v[112:115]
    s_waitcnt lgkmcnt(4)
    s_add_u32 s65, s65, 294912
    v_mfma_f32_16x16x32_bf16 v[128:131], v[72:75], a[48:51], v[128:131]
    s_add_u32 m0, s64, 24576
    ds_read_b64_tr_b16 v[68:69], v10 offset:41984
    v_mfma_f32_16x16x32_bf16 v[132:135], v[72:75], a[52:55], v[132:135]
    ds_read_b64_tr_b16 v[70:71], v10 offset:46080
    v_mfma_f32_16x16x32_bf16 v[136:139], v[72:75], a[56:59], v[136:139]
    v_mfma_f32_16x16x32_bf16 v[140:143], v[72:75], a[60:63], v[140:143]
    s_waitcnt lgkmcnt(4)
    buffer_load_dwordx4 v23, s[12:15], s65 offen lds
    v_mfma_f32_16x16x32_bf16 v[156:159], v[76:79], a[60:63], v[156:159]
    ds_read_b64_tr_b16 v[72:73], v11 offset:40960
    v_mfma_f32_16x16x32_bf16 v[152:155], v[76:79], a[56:59], v[152:155]
    ds_read_b64_tr_b16 v[74:75], v11 offset:45056
    v_mfma_f32_16x16x32_bf16 v[148:151], v[76:79], a[52:55], v[148:151]
    v_mfma_f32_16x16x32_bf16 v[144:147], v[76:79], a[48:51], v[144:147]
    s_waitcnt lgkmcnt(4)
    v_mfma_f32_16x16x32_bf16 v[160:163], v[64:67], a[48:51], v[160:163]
    ds_read_b64_tr_b16 v[76:77], v11 offset:41984
    v_mfma_f32_16x16x32_bf16 v[164:167], v[64:67], a[52:55], v[164:167]
    ds_read_b64_tr_b16 v[78:79], v11 offset:46080
    v_mfma_f32_16x16x32_bf16 v[168:171], v[64:67], a[56:59], v[168:171]
    v_mfma_f32_16x16x32_bf16 v[172:175], v[64:67], a[60:63], v[172:175]
    s_waitcnt lgkmcnt(4)
    buffer_load_dwordx4 v23, s[16:19], s65 offen offset:1024 lds
    v_mfma_f32_16x16x32_bf16 v[188:191], v[68:71], a[60:63], v[188:191]
    ds_read_b64_tr_b16 v[64:65], v8 offset:49152
    s_waitcnt vmcnt(11)
    v_mfma_f32_16x16x32_bf16 v[184:187], v[68:71], a[56:59], v[184:187]
    s_add_u32 s94, s64, 147456
    ds_read_b64_tr_b16 v[66:67], v8 offset:53248
    v_add_u32 v86, s94, v1
    v_mfma_f32_16x16x32_bf16 v[180:183], v[68:71], a[52:55], v[180:183]
    ds_read_b128 v[86:89], v86
    v_mfma_f32_16x16x32_bf16 v[176:179], v[68:71], a[48:51], v[176:179]
    s_waitcnt lgkmcnt(5)
    s_add_u32 s95, s4, 16
    v_mfma_f32_16x16x32_bf16 v[192:195], v[72:75], a[48:51], v[192:195]
    s_mul_i32 s94, s95, 9216
    ds_read_b64_tr_b16 v[68:69], v8 offset:50176
    v_mfma_f32_16x16x32_bf16 v[196:199], v[72:75], a[52:55], v[196:199]
    s_add_u32 s94, s94, s42
    ds_read_b64_tr_b16 v[70:71], v8 offset:54272
    v_mfma_f32_16x16x32_bf16 v[200:203], v[72:75], a[56:59], v[200:203]
    s_add_u32 s94, s94, s64
    s_cmp_lt_u32 s95, 18
    s_cselect_b32 s94, s94, 1073741824
    v_mfma_f32_16x16x32_bf16 v[204:207], v[72:75], a[60:63], v[204:207]
    s_waitcnt lgkmcnt(5)
    s_waitcnt lgkmcnt(2)
    v_mfma_f32_16x16x32_bf16 v[220:223], v[76:79], a[60:63], v[220:223]
    ds_read_b64_tr_b16 v[72:73], v9 offset:49152
    v_mfma_f32_16x16x32_bf16 v[216:219], v[76:79], a[56:59], v[216:219]
    ds_read_b64_tr_b16 v[74:75], v9 offset:53248
    v_mfma_f32_16x16x32_bf16 v[212:215], v[76:79], a[52:55], v[212:215]
    buffer_store_dwordx4 v[86:89], v1, s[8:11], s94 offen offset:0 sc1
    v_mfma_f32_16x16x32_bf16 v[208:211], v[76:79], a[48:51], v[208:211]
    v_mfma_f32_16x16x32_bf16 v[96:99], v[64:67], a[64:67], v[96:99]
    ds_read_b64_tr_b16 v[76:77], v9 offset:50176
    v_mfma_f32_16x16x32_bf16 v[100:103], v[64:67], a[68:71], v[100:103]
    ds_read_b64_tr_b16 v[78:79], v9 offset:54272
    s_waitcnt vmcnt(9)
    v_mfma_f32_16x16x32_bf16 v[104:107], v[64:67], a[72:75], v[104:107]
    s_add_u32 s94, s64, 148480
    v_add_u32 v90, s94, v1
    v_mfma_f32_16x16x32_bf16 v[108:111], v[64:67], a[76:79], v[108:111]
    s_waitcnt lgkmcnt(4)
    ds_read_b128 v[90:93], v90
    v_mfma_f32_16x16x32_bf16 v[124:127], v[68:71], a[76:79], v[124:127]
    s_add_u32 s95, s4, 16
    ds_read_b64_tr_b16 v[64:65], v10 offset:49152
    v_mfma_f32_16x16x32_bf16 v[120:123], v[68:71], a[72:75], v[120:123]
    s_mul_i32 s94, s95, 9216
    ds_read_b64_tr_b16 v[66:67], v10 offset:53248
    v_mfma_f32_16x16x32_bf16 v[116:119], v[68:71], a[68:71], v[116:119]
    s_add_u32 s94, s94, s42
    s_add_u32 s94, s94, s64
    v_mfma_f32_16x16x32_bf16 v[112:115], v[68:71], a[64:67], v[112:115]
    s_waitcnt lgkmcnt(5)
    s_cmp_lt_u32 s95, 18
    s_cselect_b32 s94, s94, 1073741824
    v_mfma_f32_16x16x32_bf16 v[128:131], v[72:75], a[64:67], v[128:131]
    ds_read_b64_tr_b16 v[68:69], v10 offset:50176
    s_waitcnt lgkmcnt(3)
    v_mfma_f32_16x16x32_bf16 v[132:135], v[72:75], a[68:71], v[132:135]
    ds_read_b64_tr_b16 v[70:71], v10 offset:54272
    v_mfma_f32_16x16x32_bf16 v[136:139], v[72:75], a[72:75], v[136:139]
    buffer_store_dwordx4 v[90:93], v1, s[8:11], s94 offen offset:1024 sc1
    v_mfma_f32_16x16x32_bf16 v[140:143], v[72:75], a[76:79], v[140:143]
    v_mfma_f32_16x16x32_bf16 v[156:159], v[76:79], a[76:79], v[156:159]
    ds_read_b64_tr_b16 v[72:73], v11 offset:49152
    v_mfma_f32_16x16x32_bf16 v[152:155], v[76:79], a[72:75], v[152:155]
    ds_read_b64_tr_b16 v[74:75], v11 offset:53248
    v_mfma_f32_16x16x32_bf16 v[148:151], v[76:79], a[68:71], v[148:151]
    v_mfma_f32_16x16x32_bf16 v[144:147], v[76:79], a[64:67], v[144:147]
    s_waitcnt lgkmcnt(4)
    v_mfma_f32_16x16x32_bf16 v[160:163], v[64:67], a[64:67], v[160:163]
    ds_read_b64_tr_b16 v[76:77], v11 offset:50176
    v_mfma_f32_16x16x32_bf16 v[164:167], v[64:67], a[68:71], v[164:167]
    ds_read_b64_tr_b16 v[78:79], v11 offset:54272
    v_mfma_f32_16x16x32_bf16 v[168:171], v[64:67], a[72:75], v[168:171]
    v_mfma_f32_16x16x32_bf16 v[172:175], v[64:67], a[76:79], v[172:175]
    s_waitcnt lgkmcnt(4)
    v_mfma_f32_16x16x32_bf16 v[188:191], v[68:71], a[76:79], v[188:191]
    ds_read_b64_tr_b16 v[64:65], v8 offset:57344
    v_mfma_f32_16x16x32_bf16 v[184:187], v[68:71], a[72:75], v[184:187]
    ds_read_b64_tr_b16 v[66:67], v8 offset:61440
    v_mfma_f32_16x16x32_bf16 v[180:183], v[68:71], a[68:71], v[180:183]
    v_mfma_f32_16x16x32_bf16 v[176:179], v[68:71], a[64:67], v[176:179]
    s_waitcnt lgkmcnt(4)
    v_mfma_f32_16x16x32_bf16 v[192:195], v[72:75], a[64:67], v[192:195]
    ds_read_b64_tr_b16 v[68:69], v8 offset:58368
    v_mfma_f32_16x16x32_bf16 v[196:199], v[72:75], a[68:71], v[196:199]
    ds_read_b64_tr_b16 v[70:71], v8 offset:62464
    v_mfma_f32_16x16x32_bf16 v[200:203], v[72:75], a[72:75], v[200:203]
    v_mfma_f32_16x16x32_bf16 v[204:207], v[72:75], a[76:79], v[204:207]
    s_waitcnt lgkmcnt(4)
    v_mfma_f32_16x16x32_bf16 v[220:223], v[76:79], a[76:79], v[220:223]
    ds_read_b64_tr_b16 v[72:73], v9 offset:57344
    v_mfma_f32_16x16x32_bf16 v[216:219], v[76:79], a[72:75], v[216:219]
    ds_read_b64_tr_b16 v[74:75], v9 offset:61440
    v_mfma_f32_16x16x32_bf16 v[212:215], v[76:79], a[68:71], v[212:215]
    v_mfma_f32_16x16x32_bf16 v[208:211], v[76:79], a[64:67], v[208:211]
    s_waitcnt lgkmcnt(4)
    v_mfma_f32_16x16x32_bf16 v[96:99], v[64:67], a[80:83], v[96:99]
    ds_read_b64_tr_b16 v[76:77], v9 offset:58368
    v_mfma_f32_16x16x32_bf16 v[100:103], v[64:67], a[84:87], v[100:103]
    ds_read_b64_tr_b16 v[78:79], v9 offset:62464
    s_waitcnt vmcnt(8)
    v_mfma_f32_16x16x32_bf16 v[104:107], v[64:67], a[88:91], v[104:107]
    s_add_u32 s94, s81, 155648
    v_add_u32 v86, s94, v1
    v_mfma_f32_16x16x32_bf16 v[108:111], v[64:67], a[92:95], v[108:111]
    s_waitcnt lgkmcnt(4)
    ds_read_b128 v[86:89], v86
    v_mfma_f32_16x16x32_bf16 v[124:127], v[68:71], a[92:95], v[124:127]
    s_lshl_b32 s95, s3, 3
    ds_read_b64_tr_b16 v[64:65], v10 offset:57344
    v_mfma_f32_16x16x32_bf16 v[120:123], v[68:71], a[88:91], v[120:123]
    s_add_u32 s95, s95, s4
    ds_read_b64_tr_b16 v[66:67], v10 offset:61440
    v_mfma_f32_16x16x32_bf16 v[116:119], v[68:71], a[84:87], v[116:119]
    s_mul_i32 s94, s95, 9216
    s_add_u32 s94, s94, s42
    v_mfma_f32_16x16x32_bf16 v[112:115], v[68:71], a[80:83], v[112:115]
    s_waitcnt lgkmcnt(5)
    s_add_u32 s94, s94, 8192
    v_mfma_f32_16x16x32_bf16 v[128:131], v[72:75], a[80:83], v[128:131]
    s_cmp_lt_u32 s95, 18
    s_cselect_b32 s94, s94, 1073741824
    ds_read_b64_tr_b16 v[68:69], v10 offset:58368
    s_waitcnt lgkmcnt(3)
    v_mfma_f32_16x16x32_bf16 v[132:135], v[72:75], a[84:87], v[132:135]
    ds_read_b64_tr_b16 v[70:71], v10 offset:62464
    v_mfma_f32_16x16x32_bf16 v[136:139], v[72:75], a[88:91], v[136:139]
    buffer_store_dwordx4 v[86:89], v1, s[8:11], s94 offen offset:0 sc1
    v_mfma_f32_16x16x32_bf16 v[140:143], v[72:75], a[92:95], v[140:143]
    s_add_u32 s68, s42, s64
    v_mfma_f32_16x16x32_bf16 v[156:159], v[76:79], a[92:95], v[156:159]
    ds_read_b64_tr_b16 v[72:73], v11 offset:57344
    v_mfma_f32_16x16x32_bf16 v[152:155], v[76:79], a[88:91], v[152:155]
    ds_read_b64_tr_b16 v[74:75], v11 offset:61440
    v_mfma_f32_16x16x32_bf16 v[148:151], v[76:79], a[84:87], v[148:151]
    v_mfma_f32_16x16x32_bf16 v[144:147], v[76:79], a[80:83], v[144:147]
    s_waitcnt lgkmcnt(4)
    v_mfma_f32_16x16x32_bf16 v[160:163], v[64:67], a[80:83], v[160:163]
    ds_read_b64_tr_b16 v[76:77], v11 offset:58368
    v_mfma_f32_16x16x32_bf16 v[164:167], v[64:67], a[84:87], v[164:167]
    ds_read_b64_tr_b16 v[78:79], v11 offset:62464
    v_mfma_f32_16x16x32_bf16 v[168:171], v[64:67], a[88:91], v[168:171]
    v_mfma_f32_16x16x32_bf16 v[172:175], v[64:67], a[92:95], v[172:175]
    s_waitcnt lgkmcnt(4)
    s_barrier
    v_mfma_f32_16x16x32_bf16 v[188:191], v[68:71], a[92:95], v[188:191]
    ds_read_b64_tr_b16 v[64:65], v12 offset:0
    v_mfma_f32_16x16x32_bf16 v[184:187], v[68:71], a[88:91], v[184:187]
    ds_read_b64_tr_b16 v[66:67], v12 offset:4096
    v_mfma_f32_16x16x32_bf16 v[180:183], v[68:71], a[84:87], v[180:183]
    v_mfma_f32_16x16x32_bf16 v[176:179], v[68:71], a[80:83], v[176:179]
    s_waitcnt lgkmcnt(4)
    v_mfma_f32_16x16x32_bf16 v[192:195], v[72:75], a[80:83], v[192:195]
    ds_read_b64_tr_b16 v[68:69], v12 offset:1024
    v_mfma_f32_16x16x32_bf16 v[196:199], v[72:75], a[84:87], v[196:199]
    ds_read_b64_tr_b16 v[70:71], v12 offset:5120
    v_mfma_f32_16x16x32_bf16 v[200:203], v[72:75], a[88:91], v[200:203]
    v_mfma_f32_16x16x32_bf16 v[204:207], v[72:75], a[92:95], v[204:207]
    s_waitcnt lgkmcnt(4)
    v_mfma_f32_16x16x32_bf16 v[220:223], v[76:79], a[92:95], v[220:223]
    ds_read_b64_tr_b16 v[72:73], v13 offset:0
    v_mfma_f32_16x16x32_bf16 v[216:219], v[76:79], a[88:91], v[216:219]
    ds_read_b64_tr_b16 v[74:75], v13 offset:4096
    v_mfma_f32_16x16x32_bf16 v[212:215], v[76:79], a[84:87], v[212:215]
    v_mfma_f32_16x16x32_bf16 v[208:211], v[76:79], a[80:83], v[208:211]
    s_waitcnt lgkmcnt(4)
    v_mfma_f32_16x16x32_bf16 v[96:99], v[64:67], a[96:99], v[96:99]
    ds_read_b64_tr_b16 v[76:77], v13 offset:1024
    v_mfma_f32_16x16x32_bf16 v[100:103], v[64:67], a[100:103], v[100:103]
    ds_read_b64_tr_b16 v[78:79], v13 offset:5120
    s_waitcnt vmcnt(0)
    v_mfma_f32_16x16x32_bf16 v[104:107], v[64:67], a[104:107], v[104:107]
    v_mov_b32 v94, s40
    v_mfma_f32_16x16x32_bf16 v[108:111], v[64:67], a[108:111], v[108:111]
    s_waitcnt lgkmcnt(4)
    buffer_store_dword v94, v5, s[8:11], s43 offen offset:0 sc1
    v_mfma_f32_16x16x32_bf16 v[124:127], v[68:71], a[108:111], v[124:127]
    ds_read_b64_tr_b16 v[64:65], v14 offset:0
    v_mfma_f32_16x16x32_bf16 v[120:123], v[68:71], a[104:107], v[120:123]
    ds_read_b64_tr_b16 v[66:67], v14 offset:4096
    v_mfma_f32_16x16x32_bf16 v[116:119], v[68:71], a[100:103], v[116:119]
    v_mfma_f32_16x16x32_bf16 v[112:115], v[68:71], a[96:99], v[112:115]
    s_waitcnt lgkmcnt(4)
    v_mfma_f32_16x16x32_bf16 v[128:131], v[72:75], a[96:99], v[128:131]
    ds_read_b64_tr_b16 v[68:69], v14 offset:1024
    v_mfma_f32_16x16x32_bf16 v[132:135], v[72:75], a[100:103], v[132:135]
    ds_read_b64_tr_b16 v[70:71], v14 offset:5120
    v_mfma_f32_16x16x32_bf16 v[136:139], v[72:75], a[104:107], v[136:139]
    v_mfma_f32_16x16x32_bf16 v[140:143], v[72:75], a[108:111], v[140:143]
    s_waitcnt lgkmcnt(4)
    v_mfma_f32_16x16x32_bf16 v[156:159], v[76:79], a[108:111], v[156:159]
    ds_read_b64_tr_b16 v[72:73], v15 offset:0
    v_mfma_f32_16x16x32_bf16 v[152:155], v[76:79], a[104:107], v[152:155]
    ds_read_b64_tr_b16 v[74:75], v15 offset:4096
    v_mfma_f32_16x16x32_bf16 v[148:151], v[76:79], a[100:103], v[148:151]
    v_mfma_f32_16x16x32_bf16 v[144:147], v[76:79], a[96:99], v[144:147]
    s_waitcnt lgkmcnt(4)
    v_mfma_f32_16x16x32_bf16 v[160:163], v[64:67], a[96:99], v[160:163]
    ds_read_b64_tr_b16 v[76:77], v15 offset:1024
    v_mfma_f32_16x16x32_bf16 v[164:167], v[64:67], a[100:103], v[164:167]
    ds_read_b64_tr_b16 v[78:79], v15 offset:5120
    v_mfma_f32_16x16x32_bf16 v[168:171], v[64:67], a[104:107], v[168:171]
    v_mfma_f32_16x16x32_bf16 v[172:175], v[64:67], a[108:111], v[172:175]
    s_waitcnt lgkmcnt(4)
    v_mfma_f32_16x16x32_bf16 v[188:191], v[68:71], a[108:111], v[188:191]
    ds_read_b64_tr_b16 v[64:65], v12 offset:8192
    v_mfma_f32_16x16x32_bf16 v[184:187], v[68:71], a[104:107], v[184:187]
    ds_read_b64_tr_b16 v[66:67], v12 offset:12288
    v_mfma_f32_16x16x32_bf16 v[180:183], v[68:71], a[100:103], v[180:183]
    v_mfma_f32_16x16x32_bf16 v[176:179], v[68:71], a[96:99], v[176:179]
    s_waitcnt lgkmcnt(4)
    v_mfma_f32_16x16x32_bf16 v[192:195], v[72:75], a[96:99], v[192:195]
    ds_read_b64_tr_b16 v[68:69], v12 offset:9216
    v_mfma_f32_16x16x32_bf16 v[196:199], v[72:75], a[100:103], v[196:199]
    ds_read_b64_tr_b16 v[70:71], v12 offset:13312
    v_mfma_f32_16x16x32_bf16 v[200:203], v[72:75], a[104:107], v[200:203]
    v_mfma_f32_16x16x32_bf16 v[204:207], v[72:75], a[108:111], v[204:207]
    s_waitcnt lgkmcnt(4)
    v_mfma_f32_16x16x32_bf16 v[220:223], v[76:79], a[108:111], v[220:223]
    ds_read_b64_tr_b16 v[72:73], v13 offset:8192
    v_mfma_f32_16x16x32_bf16 v[216:219], v[76:79], a[104:107], v[216:219]
    ds_read_b64_tr_b16 v[74:75], v13 offset:12288
    v_mfma_f32_16x16x32_bf16 v[212:215], v[76:79], a[100:103], v[212:215]
    v_mfma_f32_16x16x32_bf16 v[208:211], v[76:79], a[96:99], v[208:211]
    s_waitcnt lgkmcnt(4)
    v_mfma_f32_16x16x32_bf16 v[96:99], v[64:67], a[112:115], v[96:99]
    ds_read_b64_tr_b16 v[76:77], v13 offset:9216
    v_mfma_f32_16x16x32_bf16 v[100:103], v[64:67], a[116:119], v[100:103]
    ds_read_b64_tr_b16 v[78:79], v13 offset:13312
    v_mfma_f32_16x16x32_bf16 v[104:107], v[64:67], a[120:123], v[104:107]
    buffer_store_dwordx4 v[32:35], v1, s[8:11], s75 offen offset:0 sc1
    v_mfma_f32_16x16x32_bf16 v[108:111], v[64:67], a[124:127], v[108:111]
    s_waitcnt lgkmcnt(4)
    v_mfma_f32_16x16x32_bf16 v[124:127], v[68:71], a[124:127], v[124:127]
    ds_read_b64_tr_b16 v[64:65], v14 offset:8192
    v_mfma_f32_16x16x32_bf16 v[120:123], v[68:71], a[120:123], v[120:123]
    ds_read_b64_tr_b16 v[66:67], v14 offset:12288
    v_mfma_f32_16x16x32_bf16 v[116:119], v[68:71], a[116:119], v[116:119]
    v_mfma_f32_16x16x32_bf16 v[112:115], v[68:71], a[112:115], v[112:115]
    s_waitcnt lgkmcnt(4)
    v_mfma_f32_16x16x32_bf16 v[128:131], v[72:75], a[112:115], v[128:131]
    ds_read_b64_tr_b16 v[68:69], v14 offset:9216
    v_mfma_f32_16x16x32_bf16 v[132:135], v[72:75], a[116:119], v[132:135]
    ds_read_b64_tr_b16 v[70:71], v14 offset:13312
    v_mfma_f32_16x16x32_bf16 v[136:139], v[72:75], a[120:123], v[136:139]
    v_mfma_f32_16x16x32_bf16 v[140:143], v[72:75], a[124:127], v[140:143]
    s_waitcnt lgkmcnt(4)
    v_mfma_f32_16x16x32_bf16 v[156:159], v[76:79], a[124:127], v[156:159]
    ds_read_b64_tr_b16 v[72:73], v15 offset:8192
    v_mfma_f32_16x16x32_bf16 v[152:155], v[76:79], a[120:123], v[152:155]
    ds_read_b64_tr_b16 v[74:75], v15 offset:12288
    v_mfma_f32_16x16x32_bf16 v[148:151], v[76:79], a[116:119], v[148:151]
    v_mfma_f32_16x16x32_bf16 v[144:147], v[76:79], a[112:115], v[144:147]
    s_waitcnt lgkmcnt(4)
    v_mfma_f32_16x16x32_bf16 v[160:163], v[64:67], a[112:115], v[160:163]
    ds_read_b64_tr_b16 v[76:77], v15 offset:9216
    v_mfma_f32_16x16x32_bf16 v[164:167], v[64:67], a[116:119], v[164:167]
    ds_read_b64_tr_b16 v[78:79], v15 offset:13312
    v_mfma_f32_16x16x32_bf16 v[168:171], v[64:67], a[120:123], v[168:171]
    v_mfma_f32_16x16x32_bf16 v[172:175], v[64:67], a[124:127], v[172:175]
    s_waitcnt lgkmcnt(4)
    v_mfma_f32_16x16x32_bf16 v[188:191], v[68:71], a[124:127], v[188:191]
    ds_read_b64_tr_b16 v[64:65], v12 offset:16384
    v_mfma_f32_16x16x32_bf16 v[184:187], v[68:71], a[120:123], v[184:187]
    ds_read_b64_tr_b16 v[66:67], v12 offset:20480
    v_mfma_f32_16x16x32_bf16 v[180:183], v[68:71], a[116:119], v[180:183]
    v_mfma_f32_16x16x32_bf16 v[176:179], v[68:71], a[112:115], v[176:179]
    s_waitcnt lgkmcnt(4)
    v_mfma_f32_16x16x32_bf16 v[192:195], v[72:75], a[112:115], v[192:195]
    ds_read_b64_tr_b16 v[68:69], v12 offset:17408
    v_mfma_f32_16x16x32_bf16 v[196:199], v[72:75], a[116:119], v[196:199]
    ds_read_b64_tr_b16 v[70:71], v12 offset:21504
    v_mfma_f32_16x16x32_bf16 v[200:203], v[72:75], a[120:123], v[200:203]
    v_mfma_f32_16x16x32_bf16 v[204:207], v[72:75], a[124:127], v[204:207]
    s_waitcnt lgkmcnt(4)
    v_mfma_f32_16x16x32_bf16 v[220:223], v[76:79], a[124:127], v[220:223]
    ds_read_b64_tr_b16 v[72:73], v13 offset:16384
    v_mfma_f32_16x16x32_bf16 v[216:219], v[76:79], a[120:123], v[216:219]
    ds_read_b64_tr_b16 v[74:75], v13 offset:20480
    v_mfma_f32_16x16x32_bf16 v[212:215], v[76:79], a[116:119], v[212:215]
    v_mfma_f32_16x16x32_bf16 v[208:211], v[76:79], a[112:115], v[208:211]
    s_waitcnt lgkmcnt(4)
    v_mfma_f32_16x16x32_bf16 v[96:99], v[64:67], a[128:131], v[96:99]
    ds_read_b64_tr_b16 v[76:77], v13 offset:17408
    v_mfma_f32_16x16x32_bf16 v[100:103], v[64:67], a[132:135], v[100:103]
    ds_read_b64_tr_b16 v[78:79], v13 offset:21504
    v_mfma_f32_16x16x32_bf16 v[104:107], v[64:67], a[136:139], v[104:107]
    buffer_store_dwordx4 v[36:39], v1, s[8:11], s75 offen offset:1024 sc1
    v_mfma_f32_16x16x32_bf16 v[108:111], v[64:67], a[140:143], v[108:111]
    s_waitcnt lgkmcnt(4)
    v_mfma_f32_16x16x32_bf16 v[124:127], v[68:71], a[140:143], v[124:127]
    ds_read_b64_tr_b16 v[64:65], v14 offset:16384
    v_mfma_f32_16x16x32_bf16 v[120:123], v[68:71], a[136:139], v[120:123]
    ds_read_b64_tr_b16 v[66:67], v14 offset:20480
    v_mfma_f32_16x16x32_bf16 v[116:119], v[68:71], a[132:135], v[116:119]
    v_mfma_f32_16x16x32_bf16 v[112:115], v[68:71], a[128:131], v[112:115]
    s_waitcnt lgkmcnt(4)
    v_mfma_f32_16x16x32_bf16 v[128:131], v[72:75], a[128:131], v[128:131]
    ds_read_b64_tr_b16 v[68:69], v14 offset:17408
    v_mfma_f32_16x16x32_bf16 v[132:135], v[72:75], a[132:135], v[132:135]
    ds_read_b64_tr_b16 v[70:71], v14 offset:21504
    v_mfma_f32_16x16x32_bf16 v[136:139], v[72:75], a[136:139], v[136:139]
    v_mfma_f32_16x16x32_bf16 v[140:143], v[72:75], a[140:143], v[140:143]
    s_waitcnt lgkmcnt(4)
    v_mfma_f32_16x16x32_bf16 v[156:159], v[76:79], a[140:143], v[156:159]
    ds_read_b64_tr_b16 v[72:73], v15 offset:16384
    v_mfma_f32_16x16x32_bf16 v[152:155], v[76:79], a[136:139], v[152:155]
    ds_read_b64_tr_b16 v[74:75], v15 offset:20480
    v_mfma_f32_16x16x32_bf16 v[148:151], v[76:79], a[132:135], v[148:151]
    v_mfma_f32_16x16x32_bf16 v[144:147], v[76:79], a[128:131], v[144:147]
    s_waitcnt lgkmcnt(4)
    v_mfma_f32_16x16x32_bf16 v[160:163], v[64:67], a[128:131], v[160:163]
    ds_read_b64_tr_b16 v[76:77], v15 offset:17408
    v_mfma_f32_16x16x32_bf16 v[164:167], v[64:67], a[132:135], v[164:167]
    ds_read_b64_tr_b16 v[78:79], v15 offset:21504
    v_mfma_f32_16x16x32_bf16 v[168:171], v[64:67], a[136:139], v[168:171]
    v_mfma_f32_16x16x32_bf16 v[172:175], v[64:67], a[140:143], v[172:175]
    s_waitcnt lgkmcnt(4)
    s_barrier
    v_mfma_f32_16x16x32_bf16 v[188:191], v[68:71], a[140:143], v[188:191]
    ds_read_b64_tr_b16 v[64:65], v12 offset:24576
    v_mfma_f32_16x16x32_bf16 v[184:187], v[68:71], a[136:139], v[184:187]
    ds_read_b64_tr_b16 v[66:67], v12 offset:28672
    v_mfma_f32_16x16x32_bf16 v[180:183], v[68:71], a[132:135], v[180:183]
    v_mfma_f32_16x16x32_bf16 v[176:179], v[68:71], a[128:131], v[176:179]
    s_waitcnt lgkmcnt(4)
    v_mfma_f32_16x16x32_bf16 v[192:195], v[72:75], a[128:131], v[192:195]
    ds_read_b64_tr_b16 v[68:69], v12 offset:25600
    v_mfma_f32_16x16x32_bf16 v[196:199], v[72:75], a[132:135], v[196:199]
    ds_read_b64_tr_b16 v[70:71], v12 offset:29696
    v_mfma_f32_16x16x32_bf16 v[200:203], v[72:75], a[136:139], v[200:203]
    v_mfma_f32_16x16x32_bf16 v[204:207], v[72:75], a[140:143], v[204:207]
    s_waitcnt lgkmcnt(4)
    v_mfma_f32_16x16x32_bf16 v[220:223], v[76:79], a[140:143], v[220:223]
    ds_read_b64_tr_b16 v[72:73], v13 offset:24576
    v_mfma_f32_16x16x32_bf16 v[216:219], v[76:79], a[136:139], v[216:219]
    ds_read_b64_tr_b16 v[74:75], v13 offset:28672
    v_mfma_f32_16x16x32_bf16 v[212:215], v[76:79], a[132:135], v[212:215]
    v_mfma_f32_16x16x32_bf16 v[208:211], v[76:79], a[128:131], v[208:211]
    s_waitcnt lgkmcnt(4)
    v_mfma_f32_16x16x32_bf16 v[96:99], v[64:67], a[144:147], v[96:99]
    ds_read_b64_tr_b16 v[76:77], v13 offset:25600
    v_mfma_f32_16x16x32_bf16 v[100:103], v[64:67], a[148:151], v[100:103]
    ds_read_b64_tr_b16 v[78:79], v13 offset:29696
    v_mfma_f32_16x16x32_bf16 v[104:107], v[64:67], a[152:155], v[104:107]
    buffer_store_dwordx4 v[40:43], v1, s[8:11], s75 offen offset:2048 sc1
    v_mfma_f32_16x16x32_bf16 v[108:111], v[64:67], a[156:159], v[108:111]
    s_waitcnt lgkmcnt(4)
    v_mfma_f32_16x16x32_bf16 v[124:127], v[68:71], a[156:159], v[124:127]
    ds_read_b64_tr_b16 v[64:65], v14 offset:24576
    v_mfma_f32_16x16x32_bf16 v[120:123], v[68:71], a[152:155], v[120:123]
    ds_read_b64_tr_b16 v[66:67], v14 offset:28672
    v_mfma_f32_16x16x32_bf16 v[116:119], v[68:71], a[148:151], v[116:119]
    v_mfma_f32_16x16x32_bf16 v[112:115], v[68:71], a[144:147], v[112:115]
    s_waitcnt lgkmcnt(4)
    v_mfma_f32_16x16x32_bf16 v[128:131], v[72:75], a[144:147], v[128:131]
    ds_read_b64_tr_b16 v[68:69], v14 offset:25600
    v_mfma_f32_16x16x32_bf16 v[132:135], v[72:75], a[148:151], v[132:135]
    ds_read_b64_tr_b16 v[70:71], v14 offset:29696
    v_mfma_f32_16x16x32_bf16 v[136:139], v[72:75], a[152:155], v[136:139]
    v_mfma_f32_16x16x32_bf16 v[140:143], v[72:75], a[156:159], v[140:143]
    s_waitcnt lgkmcnt(4)
    v_mfma_f32_16x16x32_bf16 v[156:159], v[76:79], a[156:159], v[156:159]
    ds_read_b64_tr_b16 v[72:73], v15 offset:24576
    v_mfma_f32_16x16x32_bf16 v[152:155], v[76:79], a[152:155], v[152:155]
    ds_read_b64_tr_b16 v[74:75], v15 offset:28672
    v_mfma_f32_16x16x32_bf16 v[148:151], v[76:79], a[148:151], v[148:151]
    v_mfma_f32_16x16x32_bf16 v[144:147], v[76:79], a[144:147], v[144:147]
    s_waitcnt lgkmcnt(4)
    v_mfma_f32_16x16x32_bf16 v[160:163], v[64:67], a[144:147], v[160:163]
    ds_read_b64_tr_b16 v[76:77], v15 offset:25600
    v_mfma_f32_16x16x32_bf16 v[164:167], v[64:67], a[148:151], v[164:167]
    ds_read_b64_tr_b16 v[78:79], v15 offset:29696
    v_mfma_f32_16x16x32_bf16 v[168:171], v[64:67], a[152:155], v[168:171]
    v_mfma_f32_16x16x32_bf16 v[172:175], v[64:67], a[156:159], v[172:175]
    s_waitcnt lgkmcnt(4)
    v_mfma_f32_16x16x32_bf16 v[188:191], v[68:71], a[156:159], v[188:191]
    ds_read_b64_tr_b16 v[64:65], v12 offset:32768
    v_mfma_f32_16x16x32_bf16 v[184:187], v[68:71], a[152:155], v[184:187]
    ds_read_b64_tr_b16 v[66:67], v12 offset:36864
    v_mfma_f32_16x16x32_bf16 v[180:183], v[68:71], a[148:151], v[180:183]
    v_mfma_f32_16x16x32_bf16 v[176:179], v[68:71], a[144:147], v[176:179]
    s_waitcnt lgkmcnt(4)
    v_mfma_f32_16x16x32_bf16 v[192:195], v[72:75], a[144:147], v[192:195]
    ds_read_b64_tr_b16 v[68:69], v12 offset:33792
    v_mfma_f32_16x16x32_bf16 v[196:199], v[72:75], a[148:151], v[196:199]
    ds_read_b64_tr_b16 v[70:71], v12 offset:37888
    v_mfma_f32_16x16x32_bf16 v[200:203], v[72:75], a[152:155], v[200:203]
    v_mfma_f32_16x16x32_bf16 v[204:207], v[72:75], a[156:159], v[204:207]
    s_waitcnt lgkmcnt(4)
    v_mfma_f32_16x16x32_bf16 v[220:223], v[76:79], a[156:159], v[220:223]
    ds_read_b64_tr_b16 v[72:73], v13 offset:32768
    v_mfma_f32_16x16x32_bf16 v[216:219], v[76:79], a[152:155], v[216:219]
    ds_read_b64_tr_b16 v[74:75], v13 offset:36864
    v_mfma_f32_16x16x32_bf16 v[212:215], v[76:79], a[148:151], v[212:215]
    v_mfma_f32_16x16x32_bf16 v[208:211], v[76:79], a[144:147], v[208:211]
    s_waitcnt lgkmcnt(4)
    v_mfma_f32_16x16x32_bf16 v[96:99], v[64:67], a[160:163], v[96:99]
    ds_read_b64_tr_b16 v[76:77], v13 offset:33792
    v_mfma_f32_16x16x32_bf16 v[100:103], v[64:67], a[164:167], v[100:103]
    ds_read_b64_tr_b16 v[78:79], v13 offset:37888
    v_mfma_f32_16x16x32_bf16 v[104:107], v[64:67], a[168:171], v[104:107]
    buffer_load_dword v6, v4, s[8:11], s41 offen sc1
    v_mfma_f32_16x16x32_bf16 v[108:111], v[64:67], a[172:175], v[108:111]
    s_waitcnt lgkmcnt(4)
    v_mfma_f32_16x16x32_bf16 v[124:127], v[68:71], a[172:175], v[124:127]
    ds_read_b64_tr_b16 v[64:65], v14 offset:32768
    v_mfma_f32_16x16x32_bf16 v[120:123], v[68:71], a[168:171], v[120:123]
    ds_read_b64_tr_b16 v[66:67], v14 offset:36864
    v_mfma_f32_16x16x32_bf16 v[116:119], v[68:71], a[164:167], v[116:119]
    v_mfma_f32_16x16x32_bf16 v[112:115], v[68:71], a[160:163], v[112:115]
    s_waitcnt lgkmcnt(4)
    v_mfma_f32_16x16x32_bf16 v[128:131], v[72:75], a[160:163], v[128:131]
    ds_read_b64_tr_b16 v[68:69], v14 offset:33792
    v_mfma_f32_16x16x32_bf16 v[132:135], v[72:75], a[164:167], v[132:135]
    ds_read_b64_tr_b16 v[70:71], v14 offset:37888
    v_mfma_f32_16x16x32_bf16 v[136:139], v[72:75], a[168:171], v[136:139]
    buffer_store_dwordx4 v[44:47], v1, s[8:11], s75 offen offset:3072 sc1
    v_mfma_f32_16x16x32_bf16 v[140:143], v[72:75], a[172:175], v[140:143]
    s_waitcnt lgkmcnt(4)
    v_mfma_f32_16x16x32_bf16 v[156:159], v[76:79], a[172:175], v[156:159]
    ds_read_b64_tr_b16 v[72:73], v15 offset:32768
    v_mfma_f32_16x16x32_bf16 v[152:155], v[76:79], a[168:171], v[152:155]
    ds_read_b64_tr_b16 v[74:75], v15 offset:36864
    v_mfma_f32_16x16x32_bf16 v[148:151], v[76:79], a[164:167], v[148:151]
    v_mfma_f32_16x16x32_bf16 v[144:147], v[76:79], a[160:163], v[144:147]
    s_waitcnt lgkmcnt(4)
    v_mfma_f32_16x16x32_bf16 v[160:163], v[64:67], a[160:163], v[160:163]
    ds_read_b64_tr_b16 v[76:77], v15 offset:33792
    v_mfma_f32_16x16x32_bf16 v[164:167], v[64:67], a[164:167], v[164:167]
    ds_read_b64_tr_b16 v[78:79], v15 offset:37888
    v_mfma_f32_16x16x32_bf16 v[168:171], v[64:67], a[168:171], v[168:171]
    v_mfma_f32_16x16x32_bf16 v[172:175], v[64:67], a[172:175], v[172:175]
    s_waitcnt lgkmcnt(4)
    v_mfma_f32_16x16x32_bf16 v[188:191], v[68:71], a[172:175], v[188:191]
    ds_read_b64_tr_b16 v[64:65], v12 offset:40960
    v_mfma_f32_16x16x32_bf16 v[184:187], v[68:71], a[168:171], v[184:187]
    ds_read_b64_tr_b16 v[66:67], v12 offset:45056
    v_mfma_f32_16x16x32_bf16 v[180:183], v[68:71], a[164:167], v[180:183]
    v_mfma_f32_16x16x32_bf16 v[176:179], v[68:71], a[160:163], v[176:179]
    s_waitcnt lgkmcnt(4)
    v_mfma_f32_16x16x32_bf16 v[192:195], v[72:75], a[160:163], v[192:195]
    ds_read_b64_tr_b16 v[68:69], v12 offset:41984
    v_mfma_f32_16x16x32_bf16 v[196:199], v[72:75], a[164:167], v[196:199]
    ds_read_b64_tr_b16 v[70:71], v12 offset:46080
    v_mfma_f32_16x16x32_bf16 v[200:203], v[72:75], a[168:171], v[200:203]
    v_mfma_f32_16x16x32_bf16 v[204:207], v[72:75], a[172:175], v[204:207]
    s_waitcnt lgkmcnt(4)
    v_mfma_f32_16x16x32_bf16 v[220:223], v[76:79], a[172:175], v[220:223]
    ds_read_b64_tr_b16 v[72:73], v13 offset:40960
    v_mfma_f32_16x16x32_bf16 v[216:219], v[76:79], a[168:171], v[216:219]
    ds_read_b64_tr_b16 v[74:75], v13 offset:45056
    v_mfma_f32_16x16x32_bf16 v[212:215], v[76:79], a[164:167], v[212:215]
    v_mfma_f32_16x16x32_bf16 v[208:211], v[76:79], a[160:163], v[208:211]
    s_waitcnt lgkmcnt(4)
    v_mfma_f32_16x16x32_bf16 v[96:99], v[64:67], a[176:179], v[96:99]
    ds_read_b64_tr_b16 v[76:77], v13 offset:41984
    v_mfma_f32_16x16x32_bf16 v[100:103], v[64:67], a[180:183], v[100:103]
    ds_read_b64_tr_b16 v[78:79], v13 offset:46080
    s_waitcnt vmcnt(1)
    v_cmp_eq_u32 vcc, s40, v6
    s_nop 0
    s_cmp_eq_u32 vcc_lo, -1
    s_cbranch_scc0 L_spin1
L_back1:
    v_mfma_f32_16x16x32_bf16 v[104:107], v[64:67], a[184:187], v[104:107]
    buffer_store_dwordx4 v[48:51], v1, s[8:11], s76 offen offset:0 sc1
    v_mfma_f32_16x16x32_bf16 v[108:111], v[64:67], a[188:191], v[108:111]
    s_waitcnt lgkmcnt(4)
    v_mfma_f32_16x16x32_bf16 v[124:127], v[68:71], a[188:191], v[124:127]
    ds_read_b64_tr_b16 v[64:65], v14 offset:40960
    v_mfma_f32_16x16x32_bf16 v[120:123], v[68:71], a[184:187], v[120:123]
    ds_read_b64_tr_b16 v[66:67], v14 offset:45056
    v_mfma_f32_16x16x32_bf16 v[116:119], v[68:71], a[180:183], v[116:119]
    v_mfma_f32_16x16x32_bf16 v[112:115], v[68:71], a[176:179], v[112:115]
    s_waitcnt lgkmcnt(4)
    v_mfma_f32_16x16x32_bf16 v[128:131], v[72:75], a[176:179], v[128:131]
    ds_read_b64_tr_b16 v[68:69], v14 offset:41984
    v_mfma_f32_16x16x32_bf16 v[132:135], v[72:75], a[180:183], v[132:135]
    ds_read_b64_tr_b16 v[70:71], v14 offset:46080
    v_mfma_f32_16x16x32_bf16 v[136:139], v[72:75], a[184:187], v[136:139]
    v_mfma_f32_16x16x32_bf16 v[140:143], v[72:75], a[188:191], v[140:143]
    s_waitcnt lgkmcnt(4)
    v_mfma_f32_16x16x32_bf16 v[156:159], v[76:79], a[188:191], v[156:159]
    ds_read_b64_tr_b16 v[72:73], v15 offset:40960
    v_mfma_f32_16x16x32_bf16 v[152:155], v[76:79], a[184:187], v[152:155]
    ds_read_b64_tr_b16 v[74:75], v15 offset:45056
    v_mfma_f32_16x16x32_bf16 v[148:151], v[76:79], a[180:183], v[148:151]
    v_mfma_f32_16x16x32_bf16 v[144:147], v[76:79], a[176:179], v[144:147]
    s_waitcnt lgkmcnt(4)
    v_mfma_f32_16x16x32_bf16 v[160:163], v[64:67], a[176:179], v[160:163]
    ds_read_b64_tr_b16 v[76:77], v15 offset:41984
    v_mfma_f32_16x16x32_bf16 v[164:167], v[64:67], a[180:183], v[164:167]
    ds_read_b64_tr_b16 v[78:79], v15 offset:46080
    v_mfma_f32_16x16x32_bf16 v[168:171], v[64:67], a[184:187], v[168:171]
    v_mfma_f32_16x16x32_bf16 v[172:175], v[64:67], a[188:191], v[172:175]
    s_waitcnt lgkmcnt(4)
    s_barrier
    v_mfma_f32_16x16x32_bf16 v[188:191], v[68:71], a[188:191], v[188:191]
    ds_read_b64_tr_b16 v[64:65], v12 offset:49152
    v_mfma_f32_16x16x32_bf16 v[184:187], v[68:71], a[184:187], v[184:187]
    s_add_u32 m0, s64, 32768
    ds_read_b64_tr_b16 v[66:67], v12 offset:53248
    v_mfma_f32_16x16x32_bf16 v[180:183], v[68:71], a[180:183], v[180:183]
    buffer_load_dwordx4 v1, s[8:11], s68 offen offset:0 sc1 lds
    v_mfma_f32_16x16x32_bf16 v[176:179], v[68:71], a[176:179], v[176:179]
    s_waitcnt lgkmcnt(4)
    v_mfma_f32_16x16x32_bf16 v[192:195], v[72:75], a[176:179], v[192:195]
    ds_read_b64_tr_b16 v[68:69], v12 offset:50176
    v_mfma_f32_16x16x32_bf16 v[196:199], v[72:75], a[180:183], v[196:199]
    ds_read_b64_tr_b16 v[70:71], v12 offset:54272
    v_mfma_f32_16x16x32_bf16 v[200:203], v[72:75], a[184:187], v[200:203]
    buffer_load_dwordx4 v1, s[8:11], s68 offen offset:1024 sc1 lds
    v_mfma_f32_16x16x32_bf16 v[204:207], v[72:75], a[188:191], v[204:207]
    s_waitcnt lgkmcnt(4)
    s_add_u32 s68, s68, 9216
    v_mfma_f32_16x16x32_bf16 v[220:223], v[76:79], a[188:191], v[220:223]
    s_add_u32 m0, s64, 40960
    ds_read_b64_tr_b16 v[72:73], v13 offset:49152
    v_mfma_f32_16x16x32_bf16 v[216:219], v[76:79], a[184:187], v[216:219]
    ds_read_b64_tr_b16 v[74:75], v13 offset:53248
    v_mfma_f32_16x16x32_bf16 v[212:215], v[76:79], a[180:183], v[212:215]
    buffer_load_dwordx4 v1, s[8:11], s68 offen offset:0 sc1 lds
    v_mfma_f32_16x16x32_bf16 v[208:211], v[76:79], a[176:179], v[208:211]
L_page4:
    s_cbranch_execz L_page8
    s_waitcnt lgkmcnt(4)
    v_mfma_f32_16x16x32_bf16 v[96:99], v[64:67], a[192:195], v[96:99]
    ds_read_b64_tr_b16 v[76:77], v13 offset:50176
    v_mfma_f32_16x16x32_bf16 v[100:103], v[64:67], a[196:199], v[100:103]
    ds_read_b64_tr_b16 v[78:79], v13 offset:54272
    v_mfma_f32_16x16x32_bf16 v[104:107], v[64:67], a[200:203], v[104:107]
    buffer_load_dwordx4 v1, s[8:11], s68 offen offset:1024 sc1 lds
    v_mfma_f32_16x16x32_bf16 v[108:111], v[64:67], a[204:207], v[108:111]
    s_waitcnt lgkmcnt(4)
    s_add_u32 s68, s68, 9216
    v_mfma_f32_16x16x32_bf16 v[124:127], v[68:71], a[204:207], v[124:127]
    s_add_u32 m0, s64, 49152
    ds_read_b64_tr_b16 v[64:65], v14 offset:49152
    v_mfma_f32_16x16x32_bf16 v[120:123], v[68:71], a[200:203], v[120:123]
    ds_read_b64_tr_b16 v[66:67], v14 offset:53248
    v_mfma_f32_16x16x32_bf16 v[116:119], v[68:71], a[196:199], v[116:119]
    buffer_load_dwordx4 v1, s[8:11], s68 offen offset:0 sc1 lds
    v_mfma_f32_16x16x32_bf16 v[112:115], v[68:71], a[192:195], v[112:115]
    s_waitcnt lgkmcnt(4)
    v_mfma_f32_16x16x32_bf16 v[128:131], v[72:75], a[192:195], v[128:131]
    ds_read_b64_tr_b16 v[68:69], v14 offset:50176
    v_mfma_f32_16x16x32_bf16 v[132:135], v[72:75], a[196:199], v[132:135]
    ds_read_b64_tr_b16 v[70:71], v14 offset:54272
    v_mfma_f32_16x16x32_bf16 v[136:139], v[72:75], a[200:203], v[136:139]
    buffer_load_dwordx4 v1, s[8:11], s68 offen offset:1024 sc1 lds
    v_mfma_f32_16x16x32_bf16 v[140:143], v[72:75], a[204:207], v[140:143]
    s_waitcnt lgkmcnt(4)
    s_add_u32 s68, s68, 9216
    v_mfma_f32_16x16x32_bf16 v[156:159], v[76:79], a[204:207], v[156:159]
    s_add_u32 m0, s64, 57344
    ds_read_b64_tr_b16 v[72:73], v15 offset:49152
    v_mfma_f32_16x16x32_bf16 v[152:155], v[76:79], a[200:203], v[152:155]
    ds_read_b64_tr_b16 v[74:75], v15 offset:53248
    v_mfma_f32_16x16x32_bf16 v[148:151], v[76:79], a[196:199], v[148:151]
    buffer_load_dwordx4 v1, s[8:11], s68 offen offset:0 sc1 lds
    v_mfma_f32_16x16x32_bf16 v[144:147], v[76:79], a[192:195], v[144:147]
    s_waitcnt lgkmcnt(4)
    v_mfma_f32_16x16x32_bf16 v[160:163], v[64:67], a[192:195], v[160:163]
    ds_read_b64_tr_b16 v[76:77], v15 offset:50176
    v_mfma_f32_16x16x32_bf16 v[164:167], v[64:67], a[196:199], v[164:167]
    ds_read_b64_tr_b16 v[78:79], v15 offset:54272
    v_mfma_f32_16x16x32_bf16 v[168:171], v[64:67], a[200:203], v[168:171]
    buffer_load_dwordx4 v1, s[8:11], s68 offen offset:1024 sc1 lds
    v_mfma_f32_16x16x32_bf16 v[172:175], v[64:67], a[204:207], v[172:175]
    s_waitcnt lgkmcnt(4)
    s_add_u32 s68, s68, 9216
    v_mfma_f32_16x16x32_bf16 v[188:191], v[68:71], a[204:207], v[188:191]
    s_add_u32 m0, s64, 65536
    ds_read_b64_tr_b16 v[64:65], v12 offset:57344
    v_mfma_f32_16x16x32_bf16 v[184:187], v[68:71], a[200:203], v[184:187]
    ds_read_b64_tr_b16 v[66:67], v12 offset:61440
    v_mfma_f32_16x16x32_bf16 v[180:183], v[68:71], a[196:199], v[180:183]
    buffer_load_dwordx4 v1, s[8:11], s68 offen offset:0 sc1 lds
    v_mfma_f32_16x16x32_bf16 v[176:179], v[68:71], a[192:195], v[176:179]
    s_waitcnt lgkmcnt(4)
    v_mfma_f32_16x16x32_bf16 v[192:195], v[72:75], a[192:195], v[192:195]
    ds_read_b64_tr_b16 v[68:69], v12 offset:58368
    v_mfma_f32_16x16x32_bf16 v[196:199], v[72:75], a[196:199], v[196:199]
    ds_read_b64_tr_b16 v[70:71], v12 offset:62464
    v_mfma_f32_16x16x32_bf16 v[200:203], v[72:75], a[200:203], v[200:203]
    buffer_load_dwordx4 v1, s[8:11], s68 offen offset:1024 sc1 lds
    v_mfma_f32_16x16x32_bf16 v[204:207], v[72:75], a[204:207], v[204:207]
    s_waitcnt lgkmcnt(4)
    s_add_u32 s68, s68, 9216
    v_mfma_f32_16x16x32_bf16 v[220:223], v[76:79], a[204:207], v[220:223]
    s_add_u32 m0, s64, 73728
    ds_read_b64_tr_b16 v[72:73], v13 offset:57344
    v_mfma_f32_16x16x32_bf16 v[216:219], v[76:79], a[200:203], v[216:219]
    ds_read_b64_tr_b16 v[74:75], v13 offset:61440
    v_mfma_f32_16x16x32_bf16 v[212:215], v[76:79], a[196:199], v[212:215]
    v_mfma_f32_16x16x32_bf16 v[208:211], v[76:79], a[192:195], v[208:211]
    s_waitcnt lgkmcnt(4)
    buffer_load_dwordx4 v1, s[8:11], s68 offen offset:0 sc1 lds
    v_mfma_f32_16x16x32_bf16 v[96:99], v[64:67], a[208:211], v[96:99]
    ds_read_b64_tr_b16 v[76:77], v13 offset:58368
    v_mfma_f32_16x16x32_bf16 v[100:103], v[64:67], a[212:215], v[100:103]
    ds_read_b64_tr_b16 v[78:79], v13 offset:62464
    v_mfma_f32_16x16x32_bf16 v[104:107], v[64:67], a[216:219], v[104:107]
    v_mfma_f32_16x16x32_bf16 v[108:111], v[64:67], a[220:223], v[108:111]
    s_waitcnt lgkmcnt(4)
    v_mfma_f32_16x16x32_bf16 v[124:127], v[68:71], a[220:223], v[124:127]
    ds_read_b64_tr_b16 v[64:65], v14 offset:57344
    v_mfma_f32_16x16x32_bf16 v[120:123], v[68:71], a[216:219], v[120:123]
    ds_read_b64_tr_b16 v[66:67], v14 offset:61440
    v_mfma_f32_16x16x32_bf16 v[116:119], v[68:71], a[212:215], v[116:119]
    buffer_load_dwordx4 v1, s[8:11], s68 offen offset:1024 sc1 lds
    v_mfma_f32_16x16x32_bf16 v[112:115], v[68:71], a[208:211], v[112:115]
    s_waitcnt lgkmcnt(4)
    s_add_u32 s68, s68, 9216
    v_mfma_f32_16x16x32_bf16 v[128:131], v[72:75], a[208:211], v[128:131]
    ds_read_b64_tr_b16 v[68:69], v14 offset:58368
    v_mfma_f32_16x16x32_bf16 v[132:135], v[72:75], a[212:215], v[132:135]
    ds_read_b64_tr_b16 v[70:71], v14 offset:62464
    v_mfma_f32_16x16x32_bf16 v[136:139], v[72:75], a[216:219], v[136:139]
    v_mfma_f32_16x16x32_bf16 v[140:143], v[72:75], a[220:223], v[140:143]
    s_waitcnt lgkmcnt(4)
    v_mfma_f32_16x16x32_bf16 v[156:159], v[76:79], a[220:223], v[156:159]
    ds_read_b64_tr_b16 v[72:73], v15 offset:57344
    v_mfma_f32_16x16x32_bf16 v[152:155], v[76:79], a[216:219], v[152:155]
    ds_read_b64_tr_b16 v[74:75], v15 offset:61440
    v_mfma_f32_16x16x32_bf16 v[148:151], v[76:79], a[212:215], v[148:151]
    buffer_store_dwordx4 v[52:55], v1, s[8:11], s76 offen offset:1024 sc1
    v_mfma_f32_16x16x32_bf16 v[144:147], v[76:79], a[208:211], v[144:147]
    s_waitcnt lgkmcnt(4)
    v_mfma_f32_16x16x32_bf16 v[160:163], v[64:67], a[208:211], v[160:163]
    ds_read_b64_tr_b16 v[76:77], v15 offset:58368
    v_mfma_f32_16x16x32_bf16 v[164:167], v[64:67], a[212:215], v[164:167]
    ds_read_b64_tr_b16 v[78:79], v15 offset:62464
    v_mfma_f32_16x16x32_bf16 v[168:171], v[64:67], a[216:219], v[168:171]
    v_mfma_f32_16x16x32_bf16 v[172:175], v[64:67], a[220:223], v[172:175]
    s_waitcnt lgkmcnt(4)
    v_mfma_f32_16x16x32_bf16 v[188:191], v[68:71], a[220:223], v[188:191]
    ds_read_b64_tr_b16 v[64:65], v8 offset:0
    v_mfma_f32_16x16x32_bf16 v[184:187], v[68:71], a[216:219], v[184:187]
    ds_read_b64_tr_b16 v[66:67], v8 offset:4096
    v_mfma_f32_16x16x32_bf16 v[180:183], v[68:71], a[212:215], v[180:183]
    buffer_store_dwordx4 v[56:59], v1, s[8:11], s76 offen offset:2048 sc1
    v_mfma_f32_16x16x32_bf16 v[176:179], v[68:71], a[208:211], v[176:179]
    s_waitcnt lgkmcnt(4)
    v_mfma_f32_16x16x32_bf16 v[192:195], v[72:75], a[208:211], v[192:195]
    ds_read_b64_tr_b16 v[68:69], v8 offset:1024
    v_mfma_f32_16x16x32_bf16 v[196:199], v[72:75], a[212:215], v[196:199]
    ds_read_b64_tr_b16 v[70:71], v8 offset:5120
    v_mfma_f32_16x16x32_bf16 v[200:203], v[72:75], a[216:219], v[200:203]
    v_mfma_f32_16x16x32_bf16 v[204:207], v[72:75], a[220:223], v[204:207]
    s_waitcnt lgkmcnt(4)
    v_mfma_f32_16x16x32_bf16 v[220:223], v[76:79], a[220:223], v[220:223]
    ds_read_b64_tr_b16 v[72:73], v9 offset:0
    v_mfma_f32_16x16x32_bf16 v[216:219], v[76:79], a[216:219], v[216:219]
    ds_read_b64_tr_b16 v[74:75], v9 offset:4096
    v_mfma_f32_16x16x32_bf16 v[212:215], v[76:79], a[212:215], v[212:215]
    v_mfma_f32_16x16x32_bf16 v[208:211], v[76:79], a[208:211], v[208:211]
    s_waitcnt lgkmcnt(4)
    v_mfma_f32_16x16x32_bf16 v[96:99], v[64:67], a[224:227], v[96:99]
    ds_read_b64_tr_b16 v[76:77], v9 offset:1024
    v_mfma_f32_16x16x32_bf16 v[100:103], v[64:67], a[228:231], v[100:103]
    ds_read_b64_tr_b16 v[78:79], v9 offset:5120
    v_mfma_f32_16x16x32_bf16 v[104:107], v[64:67], a[232:235], v[104:107]
    buffer_store_dwordx4 v[60:63], v1, s[8:11], s76 offen offset:3072 sc1
    v_mfma_f32_16x16x32_bf16 v[108:111], v[64:67], a[236:239], v[108:111]
    s_waitcnt lgkmcnt(4)
    v_mfma_f32_16x16x32_bf16 v[124:127], v[68:71], a[236:239], v[124:127]
    ds_read_b64_tr_b16 v[64:65], v10 offset:0
    v_mfma_f32_16x16x32_bf16 v[120:123], v[68:71], a[232:235], v[120:123]
    ds_read_b64_tr_b16 v[66:67], v10 offset:4096
    v_mfma_f32_16x16x32_bf16 v[116:119], v[68:71], a[228:231], v[116:119]
    v_mfma_f32_16x16x32_bf16 v[112:115], v[68:71], a[224:227], v[112:115]
    s_waitcnt lgkmcnt(4)
    v_mfma_f32_16x16x32_bf16 v[128:131], v[72:75], a[224:227], v[128:131]
    ds_read_b64_tr_b16 v[68:69], v10 offset:1024
    v_mfma_f32_16x16x32_bf16 v[132:135], v[72:75], a[228:231], v[132:135]
    ds_read_b64_tr_b16 v[70:71], v10 offset:5120
    v_mfma_f32_16x16x32_bf16 v[136:139], v[72:75], a[232:235], v[136:139]
    v_mfma_f32_16x16x32_bf16 v[140:143], v[72:75], a[236:239], v[140:143]
    s_waitcnt lgkmcnt(4)
    v_mfma_f32_16x16x32_bf16 v[156:159], v[76:79], a[236:239], v[156:159]
    ds_read_b64_tr_b16 v[72:73], v11 offset:0
    v_mfma_f32_16x16x32_bf16 v[152:155], v[76:79], a[232:235], v[152:155]
    ds_read_b64_tr_b16 v[74:75], v11 offset:4096
    v_mfma_f32_16x16x32_bf16 v[148:151], v[76:79], a[228:231], v[148:151]
    v_mfma_f32_16x16x32_bf16 v[144:147], v[76:79], a[224:227], v[144:147]
    s_waitcnt lgkmcnt(4)
    v_mfma_f32_16x16x32_bf16 v[160:163], v[64:67], a[224:227], v[160:163]
    ds_read_b64_tr_b16 v[76:77], v11 offset:1024
    v_mfma_f32_16x16x32_bf16 v[164:167], v[64:67], a[228:231], v[164:167]
    ds_read_b64_tr_b16 v[78:79], v11 offset:5120
    v_mfma_f32_16x16x32_bf16 v[168:171], v[64:67], a[232:235], v[168:171]
    v_mfma_f32_16x16x32_bf16 v[172:175], v[64:67], a[236:239], v[172:175]
    s_waitcnt lgkmcnt(4)
    s_barrier
    v_mfma_f32_16x16x32_bf16 v[188:191], v[68:71], a[236:239], v[188:191]
    ds_read_b64_tr_b16 v[64:65], v8 offset:8192
    v_mfma_f32_16x16x32_bf16 v[184:187], v[68:71], a[232:235], v[184:187]
    s_add_u32 m0, s64, 81920
    ds_read_b64_tr_b16 v[66:67], v8 offset:12288
    v_mfma_f32_16x16x32_bf16 v[180:183], v[68:71], a[228:231], v[180:183]
    buffer_load_dwordx4 v1, s[8:11], s68 offen offset:0 sc1 lds
    v_mfma_f32_16x16x32_bf16 v[176:179], v[68:71], a[224:227], v[176:179]
    s_waitcnt lgkmcnt(4)
    v_mfma_f32_16x16x32_bf16 v[192:195], v[72:75], a[224:227], v[192:195]
    ds_read_b64_tr_b16 v[68:69], v8 offset:9216
    v_mfma_f32_16x16x32_bf16 v[196:199], v[72:75], a[228:231], v[196:199]
    ds_read_b64_tr_b16 v[70:71], v8 offset:13312
    v_mfma_f32_16x16x32_bf16 v[200:203], v[72:75], a[232:235], v[200:203]
    buffer_load_dwordx4 v1, s[8:11], s68 offen offset:1024 sc1 lds
    v_mfma_f32_16x16x32_bf16 v[204:207], v[72:75], a[236:239], v[204:207]
    s_waitcnt lgkmcnt(4)
    s_add_u32 s68, s68, 9216
    v_mfma_f32_16x16x32_bf16 v[220:223], v[76:79], a[236:239], v[220:223]
    s_add_u32 m0, s64, 90112
    ds_read_b64_tr_b16 v[72:73], v9 offset:8192
    v_mfma_f32_16x16x32_bf16 v[216:219], v[76:79], a[232:235], v[216:219]
    ds_read_b64_tr_b16 v[74:75], v9 offset:12288
    v_mfma_f32_16x16x32_bf16 v[212:215], v[76:79], a[228:231], v[212:215]
    buffer_load_dwordx4 v1, s[8:11], s68 offen offset:0 sc1 lds
    v_mfma_f32_16x16x32_bf16 v[208:211], v[76:79], a[224:227], v[208:211]
    s_waitcnt lgkmcnt(4)
    v_mfma_f32_16x16x32_bf16 v[96:99], v[64:67], a[240:243], v[96:99]
    ds_read_b64_tr_b16 v[76:77], v9 offset:9216
    v_mfma_f32_16x16x32_bf16 v[100:103], v[64:67], a[244:247], v[100:103]
    ds_read_b64_tr_b16 v[78:79], v9 offset:13312
    v_mfma_f32_16x16x32_bf16 v[104:107], v[64:67], a[248:251], v[104:107]
    buffer_load_dwordx4 v1, s[8:11], s68 offen offset:1024 sc1 lds
    v_mfma_f32_16x16x32_bf16 v[108:111], v[64:67], a[252:255], v[108:111]
    s_waitcnt lgkmcnt(4)
    s_add_u32 s68, s68, 9216
    v_mfma_f32_16x16x32_bf16 v[124:127], v[68:71], a[252:255], v[124:127]
    s_add_u32 m0, s64, 98304
    ds_read_b64_tr_b16 v[64:65], v10 offset:8192
    v_mfma_f32_16x16x32_bf16 v[120:123], v[68:71], a[248:251], v[120:123]
    ds_read_b64_tr_b16 v[66:67], v10 offset:12288
    v_mfma_f32_16x16x32_bf16 v[116:119], v[68:71], a[244:247], v[116:119]
    buffer_load_dwordx4 v1, s[8:11], s68 offen offset:0 sc1 lds
    v_mfma_f32_16x16x32_bf16 v[112:115], v[68:71], a[240:243], v[112:115]
    s_waitcnt lgkmcnt(4)
    v_mfma_f32_16x16x32_bf16 v[128:131], v[72:75], a[240:243], v[128:131]
    ds_read_b64_tr_b16 v[68:69], v10 offset:9216
    v_mfma_f32_16x16x32_bf16 v[132:135], v[72:75], a[244:247], v[132:135]
    ds_read_b64_tr_b16 v[70:71], v10 offset:13312
    v_mfma_f32_16x16x32_bf16 v[136:139], v[72:75], a[248:251], v[136:139]
    buffer_load_dwordx4 v1, s[8:11], s68 offen offset:1024 sc1 lds
    v_mfma_f32_16x16x32_bf16 v[140:143], v[72:75], a[252:255], v[140:143]
    s_waitcnt lgkmcnt(4)
    s_add_u32 s68, s68, 9216
    v_mfma_f32_16x16x32_bf16 v[156:159], v[76:79], a[252:255], v[156:159]
    s_add_u32 m0, s64, 106496
    ds_read_b64_tr_b16 v[72:73], v11 offset:8192
    v_mfma_f32_16x16x32_bf16 v[152:155], v[76:79], a[248:251], v[152:155]
    ds_read_b64_tr_b16 v[74:75], v11 offset:12288
    v_mfma_f32_16x16x32_bf16 v[148:151], v[76:79], a[244:247], v[148:151]
    buffer_load_dwordx4 v1, s[8:11], s68 offen offset:0 sc1 lds
    v_mfma_f32_16x16x32_bf16 v[144:147], v[76:79], a[240:243], v[144:147]
    s_waitcnt lgkmcnt(4)
    v_mfma_f32_16x16x32_bf16 v[160:163], v[64:67], a[240:243], v[160:163]
    ds_read_b64_tr_b16 v[76:77], v11 offset:9216
    v_mfma_f32_16x16x32_bf16 v[164:167], v[64:67], a[244:247], v[164:167]
    ds_read_b64_tr_b16 v[78:79], v11 offset:13312
    v_mfma_f32_16x16x32_bf16 v[168:171], v[64:67], a[248:251], v[168:171]
    buffer_load_dwordx4 v1, s[8:11], s68 offen offset:1024 sc1 lds
    v_mfma_f32_16x16x32_bf16 v[172:175], v[64:67], a[252:255], v[172:175]
    s_waitcnt lgkmcnt(4)
    s_add_u32 s68, s68, 9216
    v_mfma_f32_16x16x32_bf16 v[188:191], v[68:71], a[252:255], v[188:191]
    s_add_u32 m0, s64, 114688
    ds_read_b64_tr_b16 v[64:65], v8 offset:16384
    v_mfma_f32_16x16x32_bf16 v[184:187], v[68:71], a[248:251], v[184:187]
    ds_read_b64_tr_b16 v[66:67], v8 offset:20480
    v_mfma_f32_16x16x32_bf16 v[180:183], v[68:71], a[244:247], v[180:183]
    buffer_load_dwordx4 v1, s[8:11], s68 offen offset:0 sc1 lds
    v_mfma_f32_16x16x32_bf16 v[176:179], v[68:71], a[240:243], v[176:179]
    s_waitcnt lgkmcnt(4)
    v_mfma_f32_16x16x32_bf16 v[192:195], v[72:75], a[240:243], v[192:195]
    ds_read_b64_tr_b16 v[68:69], v8 offset:17408
    v_mfma_f32_16x16x32_bf16 v[196:199], v[72:75], a[244:247], v[196:199]
    ds_read_b64_tr_b16 v[70:71], v8 offset:21504
    v_mfma_f32_16x16x32_bf16 v[200:203], v[72:75], a[248:251], v[200:203]
    v_mfma_f32_16x16x32_bf16 v[204:207], v[72:75], a[252:255], v[204:207]
    s_waitcnt lgkmcnt(4)
    buffer_load_dwordx4 v1, s[8:11], s68 offen offset:1024 sc1 lds
    v_mfma_f32_16x16x32_bf16 v[220:223], v[76:79], a[252:255], v[220:223]
    s_add_u32 s68, s68, 9216
    ds_read_b64_tr_b16 v[72:73], v8 offset:24576
    v_mfma_f32_16x16x32_bf16 v[216:219], v[76:79], a[248:251], v[216:219]
    s_add_u32 m0, s64, 122880
    ds_read_b64_tr_b16 v[74:75], v8 offset:28672
    v_mfma_f32_16x16x32_bf16 v[212:215], v[76:79], a[244:247], v[212:215]
    v_mfma_f32_16x16x32_bf16 v[208:211], v[76:79], a[240:243], v[208:211]
    s_waitcnt lgkmcnt(4)
    v_mfma_f32_16x16x32_bf16 v[96:99], v[64:67], v[224:227], v[96:99]
    ds_read_b64_tr_b16 v[76:77], v8 offset:25600
    v_mfma_f32_16x16x32_bf16 v[100:103], v[64:67], v[228:231], v[100:103]
    ds_read_b64_tr_b16 v[78:79], v8 offset:29696
    v_mfma_f32_16x16x32_bf16 v[104:107], v[64:67], v[232:235], v[104:107]
    v_mfma_f32_16x16x32_bf16 v[108:111], v[64:67], v[236:239], v[108:111]
    s_waitcnt lgkmcnt(4)
    buffer_load_dwordx4 v1, s[8:11], s68 offen offset:0 sc1 lds
    v_mfma_f32_16x16x32_bf16 v[124:127], v[68:71], v[236:239], v[124:127]
    ds_read_b64_tr_b16 v[64:65], v9 offset:16384
    v_mfma_f32_16x16x32_bf16 v[120:123], v[68:71], v[232:235], v[120:123]
    ds_read_b64_tr_b16 v[66:67], v9 offset:20480
    v_mfma_f32_16x16x32_bf16 v[116:119], v[68:71], v[228:231], v[116:119]
    v_mfma_f32_16x16x32_bf16 v[112:115], v[68:71], v[224:227], v[112:115]
    s_waitcnt lgkmcnt(4)
    v_mfma_f32_16x16x32_bf16 v[96:99], v[72:75], v[240:243], v[96:99]
    ds_read_b64_tr_b16 v[68:69], v9 offset:17408
    v_mfma_f32_16x16x32_bf16 v[100:103], v[72:75], v[244:247], v[100:103]
    ds_read_b64_tr_b16 v[70:71], v9 offset:21504
    v_mfma_f32_16x16x32_bf16 v[104:107], v[72:75], v[248:251], v[104:107]
    v_mfma_f32_16x16x32_bf16 v[108:111], v[72:75], v[252:255], v[108:111]
    s_waitcnt lgkmcnt(4)
    buffer_load_dwordx4 v1, s[8:11], s68 offen offset:1024 sc1 lds
    v_mfma_f32_16x16x32_bf16 v[124:127], v[76:79], v[252:255], v[124:127]
    s_add_u32 s68, s68, 9216
    ds_read_b64_tr_b16 v[72:73], v9 offset:24576
    v_mfma_f32_16x16x32_bf16 v[120:123], v[76:79], v[248:251], v[120:123]
    s_add_u32 s75, s75, 8192
    ds_read_b64_tr_b16 v[74:75], v9 offset:28672
    v_mfma_f32_16x16x32_bf16 v[116:119], v[76:79], v[244:247], v[116:119]
    s_add_u32 s76, s76, 8192
    v_mfma_f32_16x16x32_bf16 v[112:115], v[76:79], v[240:243], v[112:115]
    s_waitcnt lgkmcnt(4)
    v_mfma_f32_16x16x32_bf16 v[128:131], v[64:67], v[224:227], v[128:131]
    ds_read_b64_tr_b16 v[76:77], v9 offset:25600
    v_mfma_f32_16x16x32_bf16 v[132:135], v[64:67], v[228:231], v[132:135]
    ds_read_b64_tr_b16 v[78:79], v9 offset:29696
    v_mfma_f32_16x16x32_bf16 v[136:139], v[64:67], v[232:235], v[136:139]
    s_nop 1
    v_mul_f32 v96, v96, v112
    v_mul_f32 v97, v97, v113
    v_mfma_f32_16x16x32_bf16 v[140:143], v[64:67], v[236:239], v[140:143]
    s_waitcnt lgkmcnt(4)
    v_mul_f32 v98, v98, v114
    v_mul_f32 v99, v99, v115
    v_mfma_f32_16x16x32_bf16 v[156:159], v[68:71], v[236:239], v[156:159]
    ds_read_b64_tr_b16 v[64:65], v10 offset:16384
    v_cvt_pk_bf16_f32 v32, v96, v97
    v_mfma_f32_16x16x32_bf16 v[152:155], v[68:71], v[232:235], v[152:155]
    ds_read_b64_tr_b16 v[66:67], v10 offset:20480
    v_cvt_pk_bf16_f32 v33, v98, v99
    v_mfma_f32_16x16x32_bf16 v[148:151], v[68:71], v[228:231], v[148:151]
    v_mul_f32 v100, v100, v116
    v_mul_f32 v101, v101, v117
    v_mfma_f32_16x16x32_bf16 v[144:147], v[68:71], v[224:227], v[144:147]
    s_waitcnt lgkmcnt(4)
    v_mul_f32 v102, v102, v118
    v_mul_f32 v103, v103, v119
    v_mfma_f32_16x16x32_bf16 v[128:131], v[72:75], v[240:243], v[128:131]
    ds_read_b64_tr_b16 v[68:69], v10 offset:17408
    v_cvt_pk_bf16_f32 v36, v100, v101
    v_mfma_f32_16x16x32_bf16 v[132:135], v[72:75], v[244:247], v[132:135]
    ds_read_b64_tr_b16 v[70:71], v10 offset:21504
    v_cvt_pk_bf16_f32 v37, v102, v103
    v_mfma_f32_16x16x32_bf16 v[136:139], v[72:75], v[248:251], v[136:139]
    v_mul_f32 v104, v104, v120
    v_mul_f32 v105, v105, v121
    v_mfma_f32_16x16x32_bf16 v[140:143], v[72:75], v[252:255], v[140:143]
    s_waitcnt lgkmcnt(4)
    v_mul_f32 v106, v106, v122
    v_mul_f32 v107, v107, v123
    v_mfma_f32_16x16x32_bf16 v[156:159], v[76:79], v[252:255], v[156:159]
    ds_read_b64_tr_b16 v[72:73], v10 offset:24576
    v_cvt_pk_bf16_f32 v40, v104, v105
    v_mfma_f32_16x16x32_bf16 v[152:155], v[76:79], v[248:251], v[152:155]
    ds_read_b64_tr_b16 v[74:75], v10 offset:28672
    v_cvt_pk_bf16_f32 v41, v106, v107
    v_mfma_f32_16x16x32_bf16 v[148:151], v[76:79], v[244:247], v[148:151]
    v_mul_f32 v108, v108, v124
    v_mul_f32 v109, v109, v125
    v_mfma_f32_16x16x32_bf16 v[144:147], v[76:79], v[240:243], v[144:147]
    s_waitcnt lgkmcnt(4)
    v_mul_f32 v110, v110, v126
    v_mul_f32 v111, v111, v127
    v_mfma_f32_16x16x32_bf16 v[160:163], v[64:67], v[224:227], v[160:163]
    ds_read_b64_tr_b16 v[76:77], v10 offset:25600
    v_cvt_pk_bf16_f32 v44, v108, v109
    v_mfma_f32_16x16x32_bf16 v[164:167], v[64:67], v[228:231], v[164:167]
    ds_read_b64_tr_b16 v[78:79], v10 offset:29696
    v_cvt_pk_bf16_f32 v45, v110, v111
    v_mfma_f32_16x16x32_bf16 v[168:171], v[64:67], v[232:235], v[168:171]
    v_mul_f32 v128, v128, v144
    v_mul_f32 v129, v129, v145
    v_mfma_f32_16x16x32_bf16 v[172:175], v[64:67], v[236:239], v[172:175]
    s_waitcnt lgkmcnt(4)
    v_mul_f32 v130, v130, v146
    v_mul_f32 v131, v131, v147
    v_mfma_f32_16x16x32_bf16 v[188:191], v[68:71], v[236:239], v[188:191]
    ds_read_b64_tr_b16 v[64:65], v11 offset:16384
    v_cvt_pk_bf16_f32 v34, v128, v129
    v_mfma_f32_16x16x32_bf16 v[184:187], v[68:71], v[232:235], v[184:187]
    ds_read_b64_tr_b16 v[66:67], v11 offset:20480
    v_cvt_pk_bf16_f32 v35, v130, v131
    v_mfma_f32_16x16x32_bf16 v[180:183], v[68:71], v[228:231], v[180:183]
    v_mul_f32 v132, v132, v148
    v_mul_f32 v133, v133, v149
    v_mfma_f32_16x16x32_bf16 v[176:179], v[68:71], v[224:227], v[176:179]
    s_waitcnt lgkmcnt(4)
    v_mul_f32 v134, v134, v150
    v_mul_f32 v135, v135, v151
    v_mfma_f32_16x16x32_bf16 v[160:163], v[72:75], v[240:243], v[160:163]
    ds_read_b64_tr_b16 v[68:69], v11 offset:17408
    v_cvt_pk_bf16_f32 v38, v132, v133
    v_mfma_f32_16x16x32_bf16 v[164:167], v[72:75], v[244:247], v[164:167]
    ds_read_b64_tr_b16 v[70:71], v11 offset:21504
    v_cvt_pk_bf16_f32 v39, v134, v135
    v_mfma_f32_16x16x32_bf16 v[168:171], v[72:75], v[248:251], v[168:171]
    v_mul_f32 v136, v136, v152
    v_mul_f32 v137, v137, v153
    v_mfma_f32_16x16x32_bf16 v[172:175], v[72:75], v[252:255], v[172:175]
    s_waitcnt lgkmcnt(4)
    v_mul_f32 v138, v138, v154
    v_mul_f32 v139, v139, v155
    v_mfma_f32_16x16x32_bf16 v[188:191], v[76:79], v[252:255], v[188:191]
    ds_read_b64_tr_b16 v[72:73], v11 offset:24576
    v_cvt_pk_bf16_f32 v42, v136, v137
    v_mfma_f32_16x16x32_bf16 v[184:187], v[76:79], v[248:251], v[184:187]
    ds_read_b64_tr_b16 v[74:75], v11 offset:28672
    v_cvt_pk_bf16_f32 v43, v138, v139
    v_mfma_f32_16x16x32_bf16 v[180:183], v[76:79], v[244:247], v[180:183]
    v_mul_f32 v140, v140, v156
    v_mul_f32 v141, v141, v157
    v_mfma_f32_16x16x32_bf16 v[176:179], v[76:79], v[240:243], v[176:179]
    s_waitcnt lgkmcnt(4)
    v_mul_f32 v142, v142, v158
    v_mul_f32 v143, v143, v159
    v_mfma_f32_16x16x32_bf16 v[192:195], v[64:67], v[224:227], v[192:195]
    ds_read_b64_tr_b16 v[76:77], v11 offset:25600
    v_cvt_pk_bf16_f32 v46, v140, v141
    v_mfma_f32_16x16x32_bf16 v[196:199], v[64:67], v[228:231], v[196:199]
    ds_read_b64_tr_b16 v[78:79], v11 offset:29696
    v_cvt_pk_bf16_f32 v47, v142, v143
    v_mfma_f32_16x16x32_bf16 v[200:203], v[64:67], v[232:235], v[200:203]
    v_mul_f32 v160, v160, v176
    v_mul_f32 v161, v161, v177
    v_mfma_f32_16x16x32_bf16 v[204:207], v[64:67], v[236:239], v[204:207]
    s_waitcnt lgkmcnt(4)
    s_waitcnt vmcnt(21)
    s_barrier
    v_mfma_f32_16x16x32_bf16 v[220:223], v[68:71], v[236:239], v[220:223]
    ds_read_b64_tr_b16 v[64:65], v18 offset:38912
    v_mul_f32 v162, v162, v178
    v_mfma_f32_16x16x32_bf16 v[216:219], v[68:71], v[232:235], v[216:219]
    s_add_u32 m0, s64, 0
    ds_read_b64_tr_b16 v[66:67], v18 offset:39424
    v_mul_f32 v163, v163, v179
    v_mfma_f32_16x16x32_bf16 v[212:215], v[68:71], v[228:231], v[212:215]
    buffer_load_dwordx4 v1, s[8:11], s68 offen offset:0 sc1 lds
    v_mfma_f32_16x16x32_bf16 v[208:211], v[68:71], v[224:227], v[208:211]
    s_waitcnt lgkmcnt(4)
    v_cvt_pk_bf16_f32 v48, v160, v161
    v_cvt_pk_bf16_f32 v49, v162, v163
    v_mfma_f32_16x16x32_bf16 v[192:195], v[72:75], v[240:243], v[192:195]
    ds_read_b64_tr_b16 v[68:69], v18 offset:39936
    v_mul_f32 v164, v164, v180
    v_mfma_f32_16x16x32_bf16 v[196:199], v[72:75], v[244:247], v[196:199]
    ds_read_b64_tr_b16 v[70:71], v18 offset:40448
    v_mul_f32 v165, v165, v181
    v_mfma_f32_16x16x32_bf16 v[200:203], v[72:75], v[248:251], v[200:203]
    buffer_load_dwordx4 v1, s[8:11], s68 offen offset:1024 sc1 lds
    v_mfma_f32_16x16x32_bf16 v[204:207], v[72:75], v[252:255], v[204:207]
    s_waitcnt lgkmcnt(4)
    s_add_u32 s68, s68, 9216
    v_mul_f32 v166, v166, v182
    v_mfma_f32_16x16x32_bf16 v[220:223], v[76:79], v[252:255], v[220:223]
    s_add_u32 m0, s64, 8192
    ds_read_b64_tr_b16 v[72:73], v18 offset:47104
    v_mul_f32 v167, v167, v183
    v_mfma_f32_16x16x32_bf16 v[216:219], v[76:79], v[248:251], v[216:219]
    ds_read_b64_tr_b16 v[74:75], v18 offset:47616
    v_cvt_pk_bf16_f32 v52, v164, v165
    v_mfma_f32_16x16x32_bf16 v[212:215], v[76:79], v[244:247], v[212:215]
    buffer_load_dwordx4 v1, s[8:11], s68 offen offset:0 sc1 lds
    v_mfma_f32_16x16x32_bf16 v[208:211], v[76:79], v[240:243], v[208:211]
    s_waitcnt lgkmcnt(4)
    v_cvt_pk_bf16_f32 v53, v166, v167
    v_mul_f32 v168, v168, v184
    v_mfma_f32_16x16x32_bf16 v[96:99], v[64:67], a[0:3], 0
    ds_read_b64_tr_b16 v[76:77], v18 offset:48128
    v_mul_f32 v169, v169, v185
    v_mfma_f32_16x16x32_bf16 v[100:103], v[64:67], a[4:7], 0
    ds_read_b64_tr_b16 v[78:79], v18 offset:48640
    v_mul_f32 v170, v170, v186
    v_mfma_f32_16x16x32_bf16 v[104:107], v[64:67], a[8:11], 0
    buffer_load_dwordx4 v1, s[8:11], s68 offen offset:1024 sc1 lds
    v_mfma_f32_16x16x32_bf16 v[108:111], v[64:67], a[12:15], 0
    s_waitcnt lgkmcnt(4)
    s_add_u32 s68, s68, 9216
    v_mul_f32 v171, v171, v187
    v_mfma_f32_16x16x32_bf16 v[124:127], v[68:71], a[12:15], 0
    s_add_u32 m0, s64, 16384
    ds_read_b64_tr_b16 v[64:65], v16 offset:32768
    v_cvt_pk_bf16_f32 v56, v168, v169
    v_mfma_f32_16x16x32_bf16 v[120:123], v[68:71], a[8:11], 0
    ds_read_b64_tr_b16 v[66:67], v16 offset:33792
    v_cvt_pk_bf16_f32 v57, v170, v171
    v_mfma_f32_16x16x32_bf16 v[116:119], v[68:71], a[4:7], 0
    v_mul_f32 v172, v172, v188
    v_mul_f32 v173, v173, v189
    v_mfma_f32_16x16x32_bf16 v[112:115], v[68:71], a[0:3], 0
    s_waitcnt lgkmcnt(4)
    buffer_load_dwordx4 v1, s[8:11], s68 offen offset:0 sc1 lds
    v_mfma_f32_16x16x32_bf16 v[96:99], v[72:75], a[16:19], v[96:99]
    ds_read_b64_tr_b16 v[68:69], v16 offset:34816
    v_mul_f32 v174, v174, v190
    v_mfma_f32_16x16x32_bf16 v[100:103], v[72:75], a[20:23], v[100:103]
    ds_read_b64_tr_b16 v[70:71], v16 offset:35840
    v_mul_f32 v175, v175, v191
    v_mfma_f32_16x16x32_bf16 v[104:107], v[72:75], a[24:27], v[104:107]
    buffer_load_dwordx4 v1, s[8:11], s68 offen offset:1024 sc1 lds
    v_mfma_f32_16x16x32_bf16 v[108:111], v[72:75], a[28:31], v[108:111]
    s_waitcnt lgkmcnt(4)
    s_add_u32 s68, s68, 9216
    v_cvt_pk_bf16_f32 v60, v172, v173
    v_mfma_f32_16x16x32_bf16 v[124:127], v[76:79], a[28:31], v[124:127]
    ds_read_b64_tr_b16 v[72:73], v16 offset:40960
    v_cvt_pk_bf16_f32 v61, v174, v175
    v_mfma_f32_16x16x32_bf16 v[120:123], v[76:79], a[24:27], v[120:123]
    ds_read_b64_tr_b16 v[74:75], v16 offset:41984
    v_mul_f32 v192, v192, v208
    v_mfma_f32_16x16x32_bf16 v[116:119], v[76:79], a[20:23], v[116:119]
    global_load_dword v84, v83, s[60:61]
    v_mfma_f32_16x16x32_bf16 v[112:115], v[76:79], a[16:19], v[112:115]
    s_waitcnt lgkmcnt(4)
    s_waitcnt vmcnt(19)
    v_mul_f32 v193, v193, v209
    v_mfma_f32_16x16x32_bf16 v[128:131], v[64:67], a[0:3], 0
    ds_read_b64_tr_b16 v[76:77], v16 offset:43008
    v_mov_b32 v94, s40
    v_mfma_f32_16x16x32_bf16 v[132:135], v[64:67], a[4:7], 0
    ds_read_b64_tr_b16 v[78:79], v16 offset:44032
    v_mul_f32 v194, v194, v210
    v_mfma_f32_16x16x32_bf16 v[136:139], v[64:67], a[8:11], 0
    v_mul_f32 v195, v195, v211
    v_cvt_pk_bf16_f32 v50, v192, v193
    v_mfma_f32_16x16x32_bf16 v[140:143], v[64:67], a[12:15], 0
    s_waitcnt lgkmcnt(4)
    buffer_store_dword v94, v5, s[8:11], s84 offen offset:0 sc1
    v_mfma_f32_16x16x32_bf16 v[156:159], v[68:71], a[12:15], 0
    ds_read_b64_tr_b16 v[64:65], v16 offset:36864
    v_cvt_pk_bf16_f32 v51, v194, v195
    v_mfma_f32_16x16x32_bf16 v[152:155], v[68:71], a[8:11], 0
    ds_read_b64_tr_b16 v[66:67], v16 offset:37888
    v_mul_f32 v196, v196, v212
    v_mfma_f32_16x16x32_bf16 v[148:151], v[68:71], a[4:7], 0
    v_mul_f32 v197, v197, v213
    v_mul_f32 v198, v198, v214
    v_mfma_f32_16x16x32_bf16 v[144:147], v[68:71], a[0:3], 0
    s_waitcnt lgkmcnt(4)
    v_mul_f32 v199, v199, v215
    v_cvt_pk_bf16_f32 v54, v196, v197
    v_mfma_f32_16x16x32_bf16 v[128:131], v[72:75], a[16:19], v[128:131]
    ds_read_b64_tr_b16 v[68:69], v17 offset:32768
    v_cvt_pk_bf16_f32 v55, v198, v199
    v_mfma_f32_16x16x32_bf16 v[132:135], v[72:75], a[20:23], v[132:135]
    ds_read_b64_tr_b16 v[70:71], v17 offset:33792
    v_mul_f32 v200, v200, v216
    v_mfma_f32_16x16x32_bf16 v[136:139], v[72:75], a[24:27], v[136:139]
    v_mul_f32 v201, v201, v217
    v_mul_f32 v202, v202, v218
    v_mfma_f32_16x16x32_bf16 v[140:143], v[72:75], a[28:31], v[140:143]
    s_waitcnt lgkmcnt(4)
    v_mul_f32 v203, v203, v219
    v_cvt_pk_bf16_f32 v58, v200, v201
    v_mfma_f32_16x16x32_bf16 v[156:159], v[76:79], a[28:31], v[156:159]
    ds_read_b64_tr_b16 v[72:73], v16 offset:45056
    v_cvt_pk_bf16_f32 v59, v202, v203
    v_mfma_f32_16x16x32_bf16 v[152:155], v[76:79], a[24:27], v[152:155]
    ds_read_b64_tr_b16 v[74:75], v16 offset:46080
    v_mul_f32 v204, v204, v220
    v_mfma_f32_16x16x32_bf16 v[148:151], v[76:79], a[20:23], v[148:151]
    v_mul_f32 v205, v205, v221
    v_mul_f32 v206, v206, v222
    v_mfma_f32_16x16x32_bf16 v[144:147], v[76:79], a[16:19], v[144:147]
    s_waitcnt lgkmcnt(4)
    v_mul_f32 v207, v207, v223
    v_cvt_pk_bf16_f32 v62, v204, v205
    v_mfma_f32_16x16x32_bf16 v[160:163], a[0:3], v[64:67], 0
    ds_read_b64_tr_b16 v[76:77], v17 offset:40960
    v_cvt_pk_bf16_f32 v63, v206, v207
    v_mfma_f32_16x16x32_bf16 v[164:167], a[4:7], v[64:67], 0
    ds_read_b64_tr_b16 v[78:79], v17 offset:41984
    v_mfma_f32_16x16x32_bf16 v[168:171], a[8:11], v[64:67], 0
    buffer_store_dwordx4 v[32:35], v1, s[8:11], s75 offen offset:0 sc1
    v_mfma_f32_16x16x32_bf16 v[172:175], a[12:15], v[64:67], 0
    s_waitcnt lgkmcnt(4)
    v_mfma_f32_16x16x32_bf16 v[188:191], v[68:71], a[12:15], 0
    ds_read_b64_tr_b16 v[64:65], v18 offset:55296
    v_mfma_f32_16x16x32_bf16 v[184:187], v[68:71], a[8:11], 0
    ds_read_b64_tr_b16 v[66:67], v18 offset:55808
    v_mfma_f32_16x16x32_bf16 v[180:183], v[68:71], a[4:7], 0
    v_mfma_f32_16x16x32_bf16 v[176:179], v[68:71], a[0:3], 0
    s_waitcnt lgkmcnt(4)
    v_mfma_f32_16x16x32_bf16 v[160:163], a[16:19], v[72:75], v[160:163]
    ds_read_b64_tr_b16 v[68:69], v18 offset:56320
    v_mfma_f32_16x16x32_bf16 v[164:167], a[20:23], v[72:75], v[164:167]
    ds_read_b64_tr_b16 v[70:71], v18 offset:56832
    v_mfma_f32_16x16x32_bf16 v[168:171], a[24:27], v[72:75], v[168:171]
L_page5:
    s_cbranch_execz L_page9
    buffer_store_dwordx4 v[36:39], v1, s[8:11], s75 offen offset:1024 sc1
    v_mfma_f32_16x16x32_bf16 v[172:175], a[28:31], v[72:75], v[172:175]
    s_waitcnt lgkmcnt(4)
    v_mfma_f32_16x16x32_bf16 v[188:191], v[76:79], a[28:31], v[188:191]
    ds_read_b64_tr_b16 v[72:73], v16 offset:49152
    v_mfma_f32_16x16x32_bf16 v[184:187], v[76:79], a[24:27], v[184:187]
    ds_read_b64_tr_b16 v[74:75], v16 offset:50176
    v_mfma_f32_16x16x32_bf16 v[180:183], v[76:79], a[20:23], v[180:183]
    v_mfma_f32_16x16x32_bf16 v[176:179], v[76:79], a[16:19], v[176:179]
    s_waitcnt lgkmcnt(4)
    v_mfma_f32_16x16x32_bf16 v[96:99], v[64:67], a[32:35], v[96:99]
    ds_read_b64_tr_b16 v[76:77], v16 offset:51200
    v_mfma_f32_16x16x32_bf16 v[100:103], v[64:67], a[36:39], v[100:103]
    ds_read_b64_tr_b16 v[78:79], v16 offset:52224
    v_mfma_f32_16x16x32_bf16 v[104:107], v[64:67], a[40:43], v[104:107]
    buffer_store_dwordx4 v[40:43], v1, s[8:11], s75 offen offset:2048 sc1
    v_mfma_f32_16x16x32_bf16 v[108:111], v[64:67], a[44:47], v[108:111]
    s_waitcnt lgkmcnt(4)
    v_mfma_f32_16x16x32_bf16 v[124:127], v[68:71], a[44:47], v[124:127]
    ds_read_b64_tr_b16 v[64:65], v16 offset:53248
    v_mfma_f32_16x16x32_bf16 v[120:123], v[68:71], a[40:43], v[120:123]
    ds_read_b64_tr_b16 v[66:67], v16 offset:54272
    v_mfma_f32_16x16x32_bf16 v[116:119], v[68:71], a[36:39], v[116:119]
    v_mfma_f32_16x16x32_bf16 v[112:115], v[68:71], a[32:35], v[112:115]
    s_waitcnt lgkmcnt(4)
    v_mfma_f32_16x16x32_bf16 v[128:131], v[72:75], a[32:35], v[128:131]
    ds_read_b64_tr_b16 v[68:69], v17 offset:49152
    v_mfma_f32_16x16x32_bf16 v[132:135], v[72:75], a[36:39], v[132:135]
    ds_read_b64_tr_b16 v[70:71], v17 offset:50176
    v_mfma_f32_16x16x32_bf16 v[136:139], v[72:75], a[40:43], v[136:139]
    buffer_store_dwordx4 v[44:47], v1, s[8:11], s75 offen offset:3072 sc1
    v_mfma_f32_16x16x32_bf16 v[140:143], v[72:75], a[44:47], v[140:143]
    s_waitcnt lgkmcnt(4)
    s_barrier
    v_mfma_f32_16x16x32_bf16 v[156:159], v[76:79], a[44:47], v[156:159]
    ds_read_b64_tr_b16 v[72:73], v18 offset:63488
    v_mfma_f32_16x16x32_bf16 v[152:155], v[76:79], a[40:43], v[152:155]
    s_add_u32 m0, s64, 24576
    ds_read_b64_tr_b16 v[74:75], v18 offset:64000
    v_mfma_f32_16x16x32_bf16 v[148:151], v[76:79], a[36:39], v[148:151]
    buffer_load_dwordx4 v1, s[8:11], s68 offen offset:0 sc1 lds
    v_mfma_f32_16x16x32_bf16 v[144:147], v[76:79], a[32:35], v[144:147]
    s_waitcnt lgkmcnt(4)
    v_mfma_f32_16x16x32_bf16 v[160:163], a[32:35], v[64:67], v[160:163]
    ds_read_b64_tr_b16 v[76:77], v18 offset:64512
    v_mfma_f32_16x16x32_bf16 v[164:167], a[36:39], v[64:67], v[164:167]
    ds_read_b64_tr_b16 v[78:79], v18 offset:65024
    v_mfma_f32_16x16x32_bf16 v[168:171], a[40:43], v[64:67], v[168:171]
    buffer_load_dwordx4 v1, s[8:11], s68 offen offset:1024 sc1 lds
    v_mfma_f32_16x16x32_bf16 v[172:175], a[44:47], v[64:67], v[172:175]
    s_waitcnt lgkmcnt(4)
    s_add_u32 s68, s68, 9216
    v_mfma_f32_16x16x32_bf16 v[188:191], v[68:71], a[44:47], v[188:191]
    s_add_u32 m0, s64, 32768
    ds_read_b64_tr_b16 v[64:65], v16 offset:57344
    v_mfma_f32_16x16x32_bf16 v[184:187], v[68:71], a[40:43], v[184:187]
    ds_read_b64_tr_b16 v[66:67], v16 offset:58368
    v_mfma_f32_16x16x32_bf16 v[180:183], v[68:71], a[36:39], v[180:183]
    buffer_load_dwordx4 v1, s[8:11], s68 offen offset:0 sc1 lds
    v_mfma_f32_16x16x32_bf16 v[176:179], v[68:71], a[32:35], v[176:179]
    s_waitcnt lgkmcnt(4)
    v_mfma_f32_16x16x32_bf16 v[96:99], v[72:75], a[48:51], v[96:99]
    ds_read_b64_tr_b16 v[68:69], v16 offset:59392
    v_mfma_f32_16x16x32_bf16 v[100:103], v[72:75], a[52:55], v[100:103]
    ds_read_b64_tr_b16 v[70:71], v16 offset:60416
    v_mfma_f32_16x16x32_bf16 v[104:107], v[72:75], a[56:59], v[104:107]
    buffer_load_dwordx4 v1, s[8:11], s68 offen offset:1024 sc1 lds
    v_mfma_f32_16x16x32_bf16 v[108:111], v[72:75], a[60:63], v[108:111]
    s_waitcnt lgkmcnt(4)
    s_add_u32 s68, s68, 9216
    v_mfma_f32_16x16x32_bf16 v[124:127], v[76:79], a[60:63], v[124:127]
    s_add_u32 m0, s64, 40960
    ds_read_b64_tr_b16 v[72:73], v16 offset:61440
    v_mfma_f32_16x16x32_bf16 v[120:123], v[76:79], a[56:59], v[120:123]
    ds_read_b64_tr_b16 v[74:75], v16 offset:62464
    v_mfma_f32_16x16x32_bf16 v[116:119], v[76:79], a[52:55], v[116:119]
    buffer_load_dwordx4 v1, s[8:11], s68 offen offset:0 sc1 lds
    v_mfma_f32_16x16x32_bf16 v[112:115], v[76:79], a[48:51], v[112:115]
    s_waitcnt lgkmcnt(4)
    v_mfma_f32_16x16x32_bf16 v[128:131], v[64:67], a[48:51], v[128:131]
    ds_read_b64_tr_b16 v[76:77], v17 offset:57344
    v_mfma_f32_16x16x32_bf16 v[132:135], v[64:67], a[52:55], v[132:135]
    ds_read_b64_tr_b16 v[78:79], v17 offset:58368
    v_mfma_f32_16x16x32_bf16 v[136:139], v[64:67], a[56:59], v[136:139]
    buffer_load_dwordx4 v1, s[8:11], s68 offen offset:1024 sc1 lds
    v_mfma_f32_16x16x32_bf16 v[140:143], v[64:67], a[60:63], v[140:143]
    s_waitcnt lgkmcnt(4)
    s_add_u32 s94, s7, 0
    v_mfma_f32_16x16x32_bf16 v[156:159], v[68:71], a[60:63], v[156:159]
    s_and_b32 s94, s94, 3
    ds_read_b64_tr_b16 v[64:65], v21 offset:6144
    v_mfma_f32_16x16x32_bf16 v[152:155], v[68:71], a[56:59], v[152:155]
    s_lshl_b32 s94, s94, 14
    ds_read_b64_tr_b16 v[66:67], v21 offset:6656
    v_mfma_f32_16x16x32_bf16 v[148:151], v[68:71], a[52:55], v[148:151]
    s_add_u32 s72, s82, s94
    s_add_u32 s94, s7, 1
    v_mfma_f32_16x16x32_bf16 v[144:147], v[68:71], a[48:51], v[144:147]
    s_waitcnt lgkmcnt(4)
    s_and_b32 s94, s94, 3
    v_mfma_f32_16x16x32_bf16 v[160:163], a[48:51], v[72:75], v[160:163]
    s_lshl_b32 s94, s94, 14
    ds_read_b64_tr_b16 v[68:69], v21 offset:7168
    v_mfma_f32_16x16x32_bf16 v[164:167], a[52:55], v[72:75], v[164:167]
    s_add_u32 s73, s82, s94
    ds_read_b64_tr_b16 v[70:71], v21 offset:7680
    v_mfma_f32_16x16x32_bf16 v[168:171], a[56:59], v[72:75], v[168:171]
    s_add_u32 s94, s7, 2
    s_and_b32 s94, s94, 3
    v_mfma_f32_16x16x32_bf16 v[172:175], a[60:63], v[72:75], v[172:175]
    s_waitcnt lgkmcnt(4)
    s_lshl_b32 s94, s94, 14
    v_mfma_f32_16x16x32_bf16 v[188:191], v[76:79], a[60:63], v[188:191]
    s_add_u32 s74, s82, s94
    ds_read_b64_tr_b16 v[72:73], v19 offset:0
    v_mfma_f32_16x16x32_bf16 v[184:187], v[76:79], a[56:59], v[184:187]
    s_add_u32 s94, s7, 3
    ds_read_b64_tr_b16 v[74:75], v19 offset:1024
    v_mfma_f32_16x16x32_bf16 v[180:183], v[76:79], a[52:55], v[180:183]
    s_and_b32 s94, s94, 3
    s_lshl_b32 s94, s94, 14
    v_mfma_f32_16x16x32_bf16 v[176:179], v[76:79], a[48:51], v[176:179]
    s_waitcnt lgkmcnt(4)
    s_add_u32 s66, s82, s94
    v_mfma_f32_16x16x32_bf16 v[96:99], v[64:67], a[64:67], v[96:99]
    s_mul_i32 s67, s3, 9216
    ds_read_b64_tr_b16 v[76:77], v19 offset:2048
    v_mfma_f32_16x16x32_bf16 v[100:103], v[64:67], a[68:71], v[100:103]
    s_add_u32 s94, s4, 3
    ds_read_b64_tr_b16 v[78:79], v19 offset:3072
    v_mfma_f32_16x16x32_bf16 v[104:107], v[64:67], a[72:75], v[104:107]
    s_and_b32 s94, s94, 3
    s_mul_i32 s94, s94, 37888
    v_mfma_f32_16x16x32_bf16 v[108:111], v[64:67], a[76:79], v[108:111]
    s_waitcnt lgkmcnt(4)
    s_add_u32 s97, s54, s94
    v_mfma_f32_16x16x32_bf16 v[124:127], v[68:71], a[76:79], v[124:127]
    s_add_u32 s94, s4, 2
    ds_read_b64_tr_b16 v[64:65], v19 offset:4096
    v_mfma_f32_16x16x32_bf16 v[120:123], v[68:71], a[72:75], v[120:123]
    s_and_b32 s94, s94, 3
    ds_read_b64_tr_b16 v[66:67], v19 offset:5120
    v_mfma_f32_16x16x32_bf16 v[116:119], v[68:71], a[68:71], v[116:119]
    s_mul_i32 s94, s94, 37888
    s_add_u32 s1, s54, s94
    v_mfma_f32_16x16x32_bf16 v[112:115], v[68:71], a[64:67], v[112:115]
    s_waitcnt lgkmcnt(4)
    s_add_u32 s94, s4, 1
    v_mfma_f32_16x16x32_bf16 v[128:131], v[72:75], a[64:67], v[128:131]
    s_and_b32 s94, s94, 3
    ds_read_b64_tr_b16 v[68:69], v20 offset:0
    v_mfma_f32_16x16x32_bf16 v[132:135], v[72:75], a[68:71], v[132:135]
    s_mul_i32 s94, s94, 37888
    ds_read_b64_tr_b16 v[70:71], v20 offset:1024
    v_mfma_f32_16x16x32_bf16 v[136:139], v[72:75], a[72:75], v[136:139]
    s_add_u32 s0, s54, s94
    s_add_u32 s94, s4, 0
    v_mfma_f32_16x16x32_bf16 v[140:143], v[72:75], a[76:79], v[140:143]
    s_waitcnt lgkmcnt(4)
    s_and_b32 s94, s94, 3
    v_mfma_f32_16x16x32_bf16 v[156:159], v[76:79], a[76:79], v[156:159]
    s_mul_i32 s94, s94, 37888
    ds_read_b64_tr_b16 v[72:73], v21 offset:14336
    v_mfma_f32_16x16x32_bf16 v[152:155], v[76:79], a[72:75], v[152:155]
    s_add_u32 s54, s54, s94
    ds_read_b64_tr_b16 v[74:75], v21 offset:14848
    v_mfma_f32_16x16x32_bf16 v[148:151], v[76:79], a[68:71], v[148:151]
    s_lshl_b32 s94, s6, 7
    s_lshl_b32 s95, s4, 4
    v_mfma_f32_16x16x32_bf16 v[144:147], v[76:79], a[64:67], v[144:147]
    s_waitcnt lgkmcnt(4)
    s_add_u32 s94, s94, s95
    v_mfma_f32_16x16x32_bf16 v[160:163], a[64:67], v[64:67], v[160:163]
    s_lshl_b32 s95, s3, 2
    ds_read_b64_tr_b16 v[76:77], v21 offset:15360
    v_mfma_f32_16x16x32_bf16 v[164:167], a[68:71], v[64:67], v[164:167]
    s_add_u32 s94, s94, s95
    ds_read_b64_tr_b16 v[78:79], v21 offset:15872
    v_mfma_f32_16x16x32_bf16 v[168:171], a[72:75], v[64:67], v[168:171]
    s_lshl_b32 s94, s94, 2
    s_add_u32 s94, s94, s7
    v_mfma_f32_16x16x32_bf16 v[172:175], a[76:79], v[64:67], v[172:175]
    s_waitcnt lgkmcnt(4)
    s_mul_i32 s94, s94, 4608
    v_mfma_f32_16x16x32_bf16 v[188:191], v[68:71], a[76:79], v[188:191]
    s_add_u32 s68, s94, 30801920
    ds_read_b64_tr_b16 v[64:65], v19 offset:8192
    v_mfma_f32_16x16x32_bf16 v[184:187], v[68:71], a[72:75], v[184:187]
    s_add_u32 s69, s68, 18432
    ds_read_b64_tr_b16 v[66:67], v19 offset:9216
    v_mfma_f32_16x16x32_bf16 v[180:183], v[68:71], a[68:71], v[180:183]
    s_add_u32 s70, s68, 36864
    s_add_u32 s71, s68, 55296
    v_mfma_f32_16x16x32_bf16 v[176:179], v[68:71], a[64:67], v[176:179]
    s_waitcnt lgkmcnt(4)
    v_add_u32 v83, 165888, v83
    v_mfma_f32_16x16x32_bf16 v[96:99], v[72:75], a[80:83], v[96:99]
    ds_read_b64_tr_b16 v[68:69], v19 offset:10240
    v_mfma_f32_16x16x32_bf16 v[100:103], v[72:75], a[84:87], v[100:103]
    ds_read_b64_tr_b16 v[70:71], v19 offset:11264
    v_mfma_f32_16x16x32_bf16 v[104:107], v[72:75], a[88:91], v[104:107]
    global_load_dword v84, v83, s[60:61]
    v_mfma_f32_16x16x32_bf16 v[108:111], v[72:75], a[92:95], v[108:111]
    s_waitcnt lgkmcnt(4)
    v_mfma_f32_16x16x32_bf16 v[124:127], v[76:79], a[92:95], v[124:127]
    ds_read_b64_tr_b16 v[72:73], v19 offset:12288
    v_mfma_f32_16x16x32_bf16 v[120:123], v[76:79], a[88:91], v[120:123]
    ds_read_b64_tr_b16 v[74:75], v19 offset:13312
    v_mfma_f32_16x16x32_bf16 v[116:119], v[76:79], a[84:87], v[116:119]
    buffer_store_dwordx4 v[48:51], v1, s[8:11], s76 offen offset:0 sc1
    v_mfma_f32_16x16x32_bf16 v[112:115], v[76:79], a[80:83], v[112:115]
    s_waitcnt lgkmcnt(4)
    v_mfma_f32_16x16x32_bf16 v[128:131], v[64:67], a[80:83], v[128:131]
    ds_read_b64_tr_b16 v[76:77], v20 offset:8192
    v_mfma_f32_16x16x32_bf16 v[132:135], v[64:67], a[84:87], v[132:135]
    ds_read_b64_tr_b16 v[78:79], v20 offset:9216
    v_mfma_f32_16x16x32_bf16 v[136:139], v[64:67], a[88:91], v[136:139]
    buffer_store_dwordx4 v[52:55], v1, s[8:11], s76 offen offset:1024 sc1
    v_mfma_f32_16x16x32_bf16 v[140:143], v[64:67], a[92:95], v[140:143]
    s_waitcnt lgkmcnt(4)
    s_waitcnt vmcnt(27)
    s_barrier
    v_mfma_f32_16x16x32_bf16 v[156:159], v[68:71], a[92:95], v[156:159]
    ds_read_b64_tr_b16 v[64:65], v21 offset:22528
    v_add_u32 v83, 165888, v83
    v_mfma_f32_16x16x32_bf16 v[152:155], v[68:71], a[88:91], v[152:155]
    ds_read_b64_tr_b16 v[66:67], v21 offset:23040
    v_mfma_f32_16x16x32_bf16 v[148:151], v[68:71], a[84:87], v[148:151]
    global_load_dword v84, v83, s[60:61]
    v_mfma_f32_16x16x32_bf16 v[144:147], v[68:71], a[80:83], v[144:147]
    s_waitcnt lgkmcnt(4)
    v_add_u32 v83, 165888, v83
    v_mfma_f32_16x16x32_bf16 v[160:163], a[80:83], v[72:75], v[160:163]
    ds_read_b64_tr_b16 v[68:69], v21 offset:23552
    v_mfma_f32_16x16x32_bf16 v[164:167], a[84:87], v[72:75], v[164:167]
    ds_read_b64_tr_b16 v[70:71], v21 offset:24064
    v_mfma_f32_16x16x32_bf16 v[168:171], a[88:91], v[72:75], v[168:171]
    v_mfma_f32_16x16x32_bf16 v[172:175], a[92:95], v[72:75], v[172:175]
    s_waitcnt lgkmcnt(4)
    global_load_dword v84, v83, s[60:61]
    v_mfma_f32_16x16x32_bf16 v[188:191], v[76:79], a[92:95], v[188:191]
    ds_read_b64_tr_b16 v[72:73], v19 offset:16384
    v_mfma_f32_16x16x32_bf16 v[184:187], v[76:79], a[88:91], v[184:187]
    ds_read_b64_tr_b16 v[74:75], v19 offset:17408
    v_mfma_f32_16x16x32_bf16 v[180:183], v[76:79], a[84:87], v[180:183]
    v_mfma_f32_16x16x32_bf16 v[176:179], v[76:79], a[80:83], v[176:179]
    s_waitcnt lgkmcnt(4)
    v_mfma_f32_16x16x32_bf16 v[96:99], v[64:67], a[96:99], v[96:99]
    ds_read_b64_tr_b16 v[76:77], v19 offset:18432
    v_mfma_f32_16x16x32_bf16 v[100:103], v[64:67], a[100:103], v[100:103]
    ds_read_b64_tr_b16 v[78:79], v19 offset:19456
    v_mfma_f32_16x16x32_bf16 v[104:107], v[64:67], a[104:107], v[104:107]
    buffer_store_dwordx4 v[56:59], v1, s[8:11], s76 offen offset:2048 sc1
    v_mfma_f32_16x16x32_bf16 v[108:111], v[64:67], a[108:111], v[108:111]
    s_waitcnt lgkmcnt(4)
    v_mfma_f32_16x16x32_bf16 v[124:127], v[68:71], a[108:111], v[124:127]
    ds_read_b64_tr_b16 v[64:65], v19 offset:20480
    v_mfma_f32_16x16x32_bf16 v[120:123], v[68:71], a[104:107], v[120:123]
    ds_read_b64_tr_b16 v[66:67], v19 offset:21504
    v_mfma_f32_16x16x32_bf16 v[116:119], v[68:71], a[100:103], v[116:119]
    v_mfma_f32_16x16x32_bf16 v[112:115], v[68:71], a[96:99], v[112:115]
    s_waitcnt lgkmcnt(4)
    v_mfma_f32_16x16x32_bf16 v[128:131], v[72:75], a[96:99], v[128:131]
    ds_read_b64_tr_b16 v[68:69], v20 offset:16384
    v_mfma_f32_16x16x32_bf16 v[132:135], v[72:75], a[100:103], v[132:135]
    ds_read_b64_tr_b16 v[70:71], v20 offset:17408
    v_mfma_f32_16x16x32_bf16 v[136:139], v[72:75], a[104:107], v[136:139]
    buffer_store_dwordx4 v[60:63], v1, s[8:11], s76 offen offset:3072 sc1
    v_mfma_f32_16x16x32_bf16 v[140:143], v[72:75], a[108:111], v[140:143]
    s_waitcnt lgkmcnt(4)
    v_mfma_f32_16x16x32_bf16 v[156:159], v[76:79], a[108:111], v[156:159]
    ds_read_b64_tr_b16 v[72:73], v21 offset:30720
    v_mfma_f32_16x16x32_bf16 v[152:155], v[76:79], a[104:107], v[152:155]
    ds_read_b64_tr_b16 v[74:75], v21 offset:31232
    v_mfma_f32_16x16x32_bf16 v[148:151], v[76:79], a[100:103], v[148:151]
    v_mfma_f32_16x16x32_bf16 v[144:147], v[76:79], a[96:99], v[144:147]
    s_waitcnt lgkmcnt(4)
    v_mfma_f32_16x16x32_bf16 v[160:163], a[96:99], v[64:67], v[160:163]
    ds_read_b64_tr_b16 v[76:77], v21 offset:31744
    v_mfma_f32_16x16x32_bf16 v[164:167], a[100:103], v[64:67], v[164:167]
    ds_read_b64_tr_b16 v[78:79], v21 offset:32256
    v_mfma_f32_16x16x32_bf16 v[168:171], a[104:107], v[64:67], v[168:171]
    buffer_load_dword v6, v4, s[8:11], s88 offen sc1
    v_mfma_f32_16x16x32_bf16 v[172:175], a[108:111], v[64:67], v[172:175]
    s_waitcnt lgkmcnt(4)
    v_mfma_f32_16x16x32_bf16 v[188:191], v[68:71], a[108:111], v[188:191]
    ds_read_b64_tr_b16 v[64:65], v19 offset:24576
    v_mfma_f32_16x16x32_bf16 v[184:187], v[68:71], a[104:107], v[184:187]
    ds_read_b64_tr_b16 v[66:67], v19 offset:25600
    v_mfma_f32_16x16x32_bf16 v[180:183], v[68:71], a[100:103], v[180:183]
    v_mfma_f32_16x16x32_bf16 v[176:179], v[68:71], a[96:99], v[176:179]
    s_waitcnt lgkmcnt(4)
    v_mfma_f32_16x16x32_bf16 v[96:99], v[72:75], a[112:115], v[96:99]
    ds_read_b64_tr_b16 v[68:69], v19 offset:26624
    v_mfma_f32_16x16x32_bf16 v[100:103], v[72:75], a[116:119], v[100:103]
    ds_read_b64_tr_b16 v[70:71], v19 offset:27648
    v_mfma_f32_16x16x32_bf16 v[104:107], v[72:75], a[120:123], v[104:107]
    v_mfma_f32_16x16x32_bf16 v[108:111], v[72:75], a[124:127], v[108:111]
    s_waitcnt lgkmcnt(4)
    v_mfma_f32_16x16x32_bf16 v[124:127], v[76:79], a[124:127], v[124:127]
    ds_read_b64_tr_b16 v[72:73], v19 offset:28672
    v_mfma_f32_16x16x32_bf16 v[120:123], v[76:79], a[120:123], v[120:123]
    ds_read_b64_tr_b16 v[74:75], v19 offset:29696
    v_mfma_f32_16x16x32_bf16 v[116:119], v[76:79], a[116:119], v[116:119]
    v_mfma_f32_16x16x32_bf16 v[112:115], v[76:79], a[112:115], v[112:115]
    s_waitcnt lgkmcnt(4)
    v_mfma_f32_16x16x32_bf16 v[128:131], v[64:67], a[112:115], v[128:131]
    ds_read_b64_tr_b16 v[76:77], v20 offset:24576
    v_mfma_f32_16x16x32_bf16 v[132:135], v[64:67], a[116:119], v[132:135]
    ds_read_b64_tr_b16 v[78:79], v20 offset:25600
    v_mfma_f32_16x16x32_bf16 v[136:139], v[64:67], a[120:123], v[136:139]
    v_mfma_f32_16x16x32_bf16 v[140:143], v[64:67], a[124:127], v[140:143]
    s_waitcnt lgkmcnt(4)
    v_mfma_f32_16x16x32_bf16 v[156:159], v[68:71], a[124:127], v[156:159]
    ds_read_b64_tr_b16 v[64:65], v21 offset:38912
    v_mfma_f32_16x16x32_bf16 v[152:155], v[68:71], a[120:123], v[152:155]
    ds_read_b64_tr_b16 v[66:67], v21 offset:39424
    v_mfma_f32_16x16x32_bf16 v[148:151], v[68:71], a[116:119], v[148:151]
    v_mfma_f32_16x16x32_bf16 v[144:147], v[68:71], a[112:115], v[144:147]
    s_waitcnt lgkmcnt(4)
    v_mfma_f32_16x16x32_bf16 v[160:163], a[112:115], v[72:75], v[160:163]
    ds_read_b64_tr_b16 v[68:69], v21 offset:39936
    v_mfma_f32_16x16x32_bf16 v[164:167], a[116:119], v[72:75], v[164:167]
    ds_read_b64_tr_b16 v[70:71], v21 offset:40448
    v_mfma_f32_16x16x32_bf16 v[168:171], a[120:123], v[72:75], v[168:171]
    v_mfma_f32_16x16x32_bf16 v[172:175], a[124:127], v[72:75], v[172:175]
    s_waitcnt lgkmcnt(4)
    v_mfma_f32_16x16x32_bf16 v[188:191], v[76:79], a[124:127], v[188:191]
    ds_read_b64_tr_b16 v[72:73], v19 offset:32768
    v_mfma_f32_16x16x32_bf16 v[184:187], v[76:79], a[120:123], v[184:187]
    ds_read_b64_tr_b16 v[74:75], v19 offset:33792
    v_mfma_f32_16x16x32_bf16 v[180:183], v[76:79], a[116:119], v[180:183]
    v_mfma_f32_16x16x32_bf16 v[176:179], v[76:79], a[112:115], v[176:179]
    s_waitcnt lgkmcnt(4)
    v_mfma_f32_16x16x32_bf16 v[96:99], v[64:67], a[128:131], v[96:99]
    ds_read_b64_tr_b16 v[76:77], v19 offset:34816
    v_mfma_f32_16x16x32_bf16 v[100:103], v[64:67], a[132:135], v[100:103]
    ds_read_b64_tr_b16 v[78:79], v19 offset:35840
    v_mfma_f32_16x16x32_bf16 v[104:107], v[64:67], a[136:139], v[104:107]
    v_mfma_f32_16x16x32_bf16 v[108:111], v[64:67], a[140:143], v[108:111]
    s_waitcnt lgkmcnt(4)
    v_mfma_f32_16x16x32_bf16 v[124:127], v[68:71], a[140:143], v[124:127]
    ds_read_b64_tr_b16 v[64:65], v19 offset:36864
    v_mfma_f32_16x16x32_bf16 v[120:123], v[68:71], a[136:139], v[120:123]
    ds_read_b64_tr_b16 v[66:67], v19 offset:37888
    v_mfma_f32_16x16x32_bf16 v[116:119], v[68:71], a[132:135], v[116:119]
    v_mfma_f32_16x16x32_bf16 v[112:115], v[68:71], a[128:131], v[112:115]
    s_waitcnt lgkmcnt(4)
    v_mfma_f32_16x16x32_bf16 v[128:131], v[72:75], a[128:131], v[128:131]
    ds_read_b64_tr_b16 v[68:69], v20 offset:32768
    v_mfma_f32_16x16x32_bf16 v[132:135], v[72:75], a[132:135], v[132:135]
    ds_read_b64_tr_b16 v[70:71], v20 offset:33792
    v_mfma_f32_16x16x32_bf16 v[136:139], v[72:75], a[136:139], v[136:139]
    v_mfma_f32_16x16x32_bf16 v[140:143], v[72:75], a[140:143], v[140:143]
    s_waitcnt lgkmcnt(4)
    s_waitcnt vmcnt(26)
    s_barrier
    v_mfma_f32_16x16x32_bf16 v[156:159], v[76:79], a[140:143], v[156:159]
    ds_read_b64_tr_b16 v[72:73], v21 offset:47104
    v_mfma_f32_16x16x32_bf16 v[152:155], v[76:79], a[136:139], v[152:155]
    s_add_u32 s94, s7, 0
    ds_read_b64_tr_b16 v[74:75], v21 offset:47616
    v_mfma_f32_16x16x32_bf16 v[148:151], v[76:79], a[132:135], v[148:151]
    s_and_b32 s94, s94, 3
    s_lshl_b32 s94, s94, 2
    v_mfma_f32_16x16x32_bf16 v[144:147], v[76:79], a[128:131], v[144:147]
    s_waitcnt lgkmcnt(4)
    s_add_u32 s94, s94, s3
    v_mfma_f32_16x16x32_bf16 v[160:163], a[128:131], v[64:67], v[160:163]
    s_mul_i32 s94, s94, 9216
    ds_read_b64_tr_b16 v[76:77], v21 offset:48128
    v_mfma_f32_16x16x32_bf16 v[164:167], a[132:135], v[64:67], v[164:167]
    s_add_u32 s94, s94, s42
    ds_read_b64_tr_b16 v[78:79], v21 offset:48640
    v_mfma_f32_16x16x32_bf16 v[168:171], a[136:139], v[64:67], v[168:171]
    s_add_u32 s94, s94, 8192
    s_add_u32 m0, s81, 131072
    v_mfma_f32_16x16x32_bf16 v[172:175], a[140:143], v[64:67], v[172:175]
    s_waitcnt lgkmcnt(4)
    buffer_load_dwordx4 v1, s[8:11], s94 offen sc1 lds
    v_mfma_f32_16x16x32_bf16 v[188:191], v[68:71], a[140:143], v[188:191]
    s_add_u32 s65, s44, 0
    ds_read_b64_tr_b16 v[64:65], v19 offset:40960
    v_mfma_f32_16x16x32_bf16 v[184:187], v[68:71], a[136:139], v[184:187]
    s_add_u32 m0, s64, 49152
    ds_read_b64_tr_b16 v[66:67], v19 offset:41984
    v_mfma_f32_16x16x32_bf16 v[180:183], v[68:71], a[132:135], v[180:183]
    buffer_load_dwordx4 v25, s[28:31], s65 offen lds
    v_mfma_f32_16x16x32_bf16 v[176:179], v[68:71], a[128:131], v[176:179]
    s_waitcnt lgkmcnt(4)
    v_mfma_f32_16x16x32_bf16 v[96:99], v[72:75], a[144:147], v[96:99]
    ds_read_b64_tr_b16 v[68:69], v19 offset:43008
    v_mfma_f32_16x16x32_bf16 v[100:103], v[72:75], a[148:151], v[100:103]
    ds_read_b64_tr_b16 v[70:71], v19 offset:44032
    v_mfma_f32_16x16x32_bf16 v[104:107], v[72:75], a[152:155], v[104:107]
    buffer_load_dwordx4 v25, s[32:35], s65 offen offset:1024 lds
    v_mfma_f32_16x16x32_bf16 v[108:111], v[72:75], a[156:159], v[108:111]
    s_waitcnt lgkmcnt(4)
    s_add_u32 s94, s7, 1
    v_mfma_f32_16x16x32_bf16 v[124:127], v[76:79], a[156:159], v[124:127]
    s_and_b32 s94, s94, 3
    ds_read_b64_tr_b16 v[72:73], v19 offset:45056
    v_mfma_f32_16x16x32_bf16 v[120:123], v[76:79], a[152:155], v[120:123]
    s_lshl_b32 s94, s94, 2
    ds_read_b64_tr_b16 v[74:75], v19 offset:46080
    v_mfma_f32_16x16x32_bf16 v[116:119], v[76:79], a[148:151], v[116:119]
    s_add_u32 s94, s94, s3
    s_mul_i32 s94, s94, 9216
    v_mfma_f32_16x16x32_bf16 v[112:115], v[76:79], a[144:147], v[112:115]
    s_waitcnt lgkmcnt(4)
    s_add_u32 s94, s94, s42
    v_mfma_f32_16x16x32_bf16 v[128:131], v[64:67], a[144:147], v[128:131]
    s_add_u32 s94, s94, 8192
    ds_read_b64_tr_b16 v[76:77], v20 offset:40960
    v_mfma_f32_16x16x32_bf16 v[132:135], v[64:67], a[148:151], v[132:135]
    s_add_u32 m0, s81, 135168
    ds_read_b64_tr_b16 v[78:79], v20 offset:41984
    v_mfma_f32_16x16x32_bf16 v[136:139], v[64:67], a[152:155], v[136:139]
    buffer_load_dwordx4 v1, s[8:11], s94 offen sc1 lds
    v_mfma_f32_16x16x32_bf16 v[140:143], v[64:67], a[156:159], v[140:143]
    s_waitcnt lgkmcnt(4)
    s_add_u32 s65, s44, 36864
    v_mfma_f32_16x16x32_bf16 v[156:159], v[68:71], a[156:159], v[156:159]
    s_add_u32 m0, s64, 57344
    ds_read_b64_tr_b16 v[64:65], v21 offset:55296
    v_mfma_f32_16x16x32_bf16 v[152:155], v[68:71], a[152:155], v[152:155]
    ds_read_b64_tr_b16 v[66:67], v21 offset:55808
    v_mfma_f32_16x16x32_bf16 v[148:151], v[68:71], a[148:151], v[148:151]
    v_mfma_f32_16x16x32_bf16 v[144:147], v[68:71], a[144:147], v[144:147]
    s_waitcnt lgkmcnt(4)
    v_mfma_f32_16x16x32_bf16 v[160:163], a[144:147], v[72:75], v[160:163]
    ds_read_b64_tr_b16 v[68:69], v21 offset:56320
    v_mfma_f32_16x16x32_bf16 v[164:167], a[148:151], v[72:75], v[164:167]
    ds_read_b64_tr_b16 v[70:71], v21 offset:56832
    v_mfma_f32_16x16x32_bf16 v[168:171], a[152:155], v[72:75], v[168:171]
    buffer_load_dwordx4 v25, s[28:31], s65 offen lds
    v_mfma_f32_16x16x32_bf16 v[172:175], a[156:159], v[72:75], v[172:175]
    s_waitcnt lgkmcnt(4)
    v_mfma_f32_16x16x32_bf16 v[188:191], v[76:79], a[156:159], v[188:191]
    ds_read_b64_tr_b16 v[72:73], v19 offset:49152
    v_mfma_f32_16x16x32_bf16 v[184:187], v[76:79], a[152:155], v[184:187]
    ds_read_b64_tr_b16 v[74:75], v19 offset:50176
    v_mfma_f32_16x16x32_bf16 v[180:183], v[76:79], a[148:151], v[180:183]
    v_mfma_f32_16x16x32_bf16 v[176:179], v[76:79], a[144:147], v[176:179]
    s_waitcnt lgkmcnt(4)
    v_mfma_f32_16x16x32_bf16 v[96:99], v[64:67], a[160:163], v[96:99]
    ds_read_b64_tr_b16 v[76:77], v19 offset:51200
    v_mfma_f32_16x16x32_bf16 v[100:103], v[64:67], a[164:167], v[100:103]
    ds_read_b64_tr_b16 v[78:79], v19 offset:52224
    v_mfma_f32_16x16x32_bf16 v[104:107], v[64:67], a[168:171], v[104:107]
    buffer_load_dwordx4 v25, s[32:35], s65 offen offset:1024 lds
    v_mfma_f32_16x16x32_bf16 v[108:111], v[64:67], a[172:175], v[108:111]
    s_waitcnt lgkmcnt(4)
    s_waitcnt vmcnt(6)
    v_cmp_eq_u32 vcc, s40, v6
    s_nop 0
    s_and_b32 vcc_lo, vcc_lo, 15
    s_cmp_eq_u32 vcc_lo, 15
    s_cbranch_scc0 L_spin2
L_back2:
    v_mfma_f32_16x16x32_bf16 v[124:127], v[68:71], a[172:175], v[124:127]
    ds_read_b64_tr_b16 v[64:65], v19 offset:53248
    v_mfma_f32_16x16x32_bf16 v[120:123], v[68:71], a[168:171], v[120:123]
    ds_read_b64_tr_b16 v[66:67], v19 offset:54272
    v_mfma_f32_16x16x32_bf16 v[116:119], v[68:71], a[164:167], v[116:119]
    v_mfma_f32_16x16x32_bf16 v[112:115], v[68:71], a[160:163], v[112:115]
    s_waitcnt lgkmcnt(4)
    v_mfma_f32_16x16x32_bf16 v[128:131], v[72:75], a[160:163], v[128:131]
    ds_read_b64_tr_b16 v[68:69], v20 offset:49152
    v_mfma_f32_16x16x32_bf16 v[132:135], v[72:75], a[164:167], v[132:135]
    ds_read_b64_tr_b16 v[70:71], v20 offset:50176
    v_mfma_f32_16x16x32_bf16 v[136:139], v[72:75], a[168:171], v[136:139]
    v_mfma_f32_16x16x32_bf16 v[140:143], v[72:75], a[172:175], v[140:143]
    s_waitcnt lgkmcnt(4)
    v_mfma_f32_16x16x32_bf16 v[156:159], v[76:79], a[172:175], v[156:159]
    ds_read_b64_tr_b16 v[72:73], v21 offset:63488
    v_mfma_f32_16x16x32_bf16 v[152:155], v[76:79], a[168:171], v[152:155]
    ds_read_b64_tr_b16 v[74:75], v21 offset:64000
    v_mfma_f32_16x16x32_bf16 v[148:151], v[76:79], a[164:167], v[148:151]
    v_mfma_f32_16x16x32_bf16 v[144:147], v[76:79], a[160:163], v[144:147]
    s_waitcnt lgkmcnt(4)
    v_mfma_f32_16x16x32_bf16 v[160:163], a[160:163], v[64:67], v[160:163]
    ds_read_b64_tr_b16 v[76:77], v21 offset:64512
    v_mfma_f32_16x16x32_bf16 v[164:167], a[164:167], v[64:67], v[164:167]
    ds_read_b64_tr_b16 v[78:79], v21 offset:65024
    v_mfma_f32_16x16x32_bf16 v[168:171], a[168:171], v[64:67], v[168:171]
    v_mfma_f32_16x16x32_bf16 v[172:175], a[172:175], v[64:67], v[172:175]
    s_waitcnt lgkmcnt(4)
    v_mfma_f32_16x16x32_bf16 v[188:191], v[68:71], a[172:175], v[188:191]
    ds_read_b64_tr_b16 v[64:65], v19 offset:57344
    v_mfma_f32_16x16x32_bf16 v[184:187], v[68:71], a[168:171], v[184:187]
    ds_read_b64_tr_b16 v[66:67], v19 offset:58368
    v_mfma_f32_16x16x32_bf16 v[180:183], v[68:71], a[164:167], v[180:183]
    v_mfma_f32_16x16x32_bf16 v[176:179], v[68:71], a[160:163], v[176:179]
    s_waitcnt lgkmcnt(4)
    v_mfma_f32_16x16x32_bf16 v[96:99], v[72:75], a[176:179], v[96:99]
    ds_read_b64_tr_b16 v[68:69], v19 offset:59392
    v_mfma_f32_16x16x32_bf16 v[100:103], v[72:75], a[180:183], v[100:103]
    ds_read_b64_tr_b16 v[70:71], v19 offset:60416
    v_mfma_f32_16x16x32_bf16 v[104:107], v[72:75], a[184:187], v[104:107]
    v_mov_b32 v94, s40
    v_mfma_f32_16x16x32_bf16 v[108:111], v[72:75], a[188:191], v[108:111]
    s_waitcnt lgkmcnt(4)
    buffer_store_dword v94, v5, s[8:11], s84 offen offset:16 sc1
    v_mfma_f32_16x16x32_bf16 v[124:127], v[76:79], a[188:191], v[124:127]
    ds_read_b64_tr_b16 v[72:73], v19 offset:61440
    v_mfma_f32_16x16x32_bf16 v[120:123], v[76:79], a[184:187], v[120:123]
    ds_read_b64_tr_b16 v[74:75], v19 offset:62464
    v_mfma_f32_16x16x32_bf16 v[116:119], v[76:79], a[180:183], v[116:119]
    v_mfma_f32_16x16x32_bf16 v[112:115], v[76:79], a[176:179], v[112:115]
    s_waitcnt lgkmcnt(4)
    v_mfma_f32_16x16x32_bf16 v[128:131], v[64:67], a[176:179], v[128:131]
    ds_read_b64_tr_b16 v[76:77], v20 offset:57344
    v_mfma_f32_16x16x32_bf16 v[132:135], v[64:67], a[180:183], v[132:135]
    ds_read_b64_tr_b16 v[78:79], v20 offset:58368
    v_mfma_f32_16x16x32_bf16 v[136:139], v[64:67], a[184:187], v[136:139]
    v_mfma_f32_16x16x32_bf16 v[140:143], v[64:67], a[188:191], v[140:143]
    s_waitcnt lgkmcnt(4)
    s_barrier
    v_mfma_f32_16x16x32_bf16 v[156:159], v[68:71], a[188:191], v[156:159]
    ds_read_b64_tr_b16 v[64:65], v18 offset:6144
    v_mfma_f32_16x16x32_bf16 v[152:155], v[68:71], a[184:187], v[152:155]
    s_add_u32 s94, s7, 2
    ds_read_b64_tr_b16 v[66:67], v18 offset:6656
    v_mfma_f32_16x16x32_bf16 v[148:151], v[68:71], a[180:183], v[148:151]
    s_and_b32 s94, s94, 3
    s_lshl_b32 s94, s94, 2
    v_mfma_f32_16x16x32_bf16 v[144:147], v[68:71], a[176:179], v[144:147]
    s_waitcnt lgkmcnt(4)
    s_add_u32 s94, s94, s3
    v_mfma_f32_16x16x32_bf16 v[160:163], a[176:179], v[72:75], v[160:163]
    s_mul_i32 s94, s94, 9216
    ds_read_b64_tr_b16 v[68:69], v18 offset:7168
    v_mfma_f32_16x16x32_bf16 v[164:167], a[180:183], v[72:75], v[164:167]
    s_add_u32 s94, s94, s42
    ds_read_b64_tr_b16 v[70:71], v18 offset:7680
    v_mfma_f32_16x16x32_bf16 v[168:171], a[184:187], v[72:75], v[168:171]
    s_add_u32 s94, s94, 8192
    s_add_u32 m0, s81, 139264
    v_mfma_f32_16x16x32_bf16 v[172:175], a[188:191], v[72:75], v[172:175]
    s_waitcnt lgkmcnt(4)
    buffer_load_dwordx4 v1, s[8:11], s94 offen sc1 lds
    v_mfma_f32_16x16x32_bf16 v[188:191], v[76:79], a[188:191], v[188:191]
    s_add_u32 s65, s45, 0
    ds_read_b64_tr_b16 v[72:73], v16 offset:0
    v_mfma_f32_16x16x32_bf16 v[184:187], v[76:79], a[184:187], v[184:187]
    s_add_u32 m0, s64, 65536
    ds_read_b64_tr_b16 v[74:75], v16 offset:1024
    v_mfma_f32_16x16x32_bf16 v[180:183], v[76:79], a[180:183], v[180:183]
    buffer_load_dwordx4 v25, s[28:31], s65 offen lds
    v_mfma_f32_16x16x32_bf16 v[176:179], v[76:79], a[176:179], v[176:179]
    s_waitcnt lgkmcnt(4)
    v_mfma_f32_16x16x32_bf16 v[96:99], v[64:67], a[192:195], v[96:99]
    ds_read_b64_tr_b16 v[76:77], v16 offset:2048
    v_mfma_f32_16x16x32_bf16 v[100:103], v[64:67], a[196:199], v[100:103]
    ds_read_b64_tr_b16 v[78:79], v16 offset:3072
    v_mfma_f32_16x16x32_bf16 v[104:107], v[64:67], a[200:203], v[104:107]
    buffer_load_dwordx4 v25, s[32:35], s65 offen offset:1024 lds
    v_mfma_f32_16x16x32_bf16 v[108:111], v[64:67], a[204:207], v[108:111]
    s_waitcnt lgkmcnt(4)
    s_add_u32 s94, s7, 3
    v_mfma_f32_16x16x32_bf16 v[124:127], v[68:71], a[204:207], v[124:127]
    s_and_b32 s94, s94, 3
    ds_read_b64_tr_b16 v[64:65], v16 offset:4096
    v_mfma_f32_16x16x32_bf16 v[120:123], v[68:71], a[200:203], v[120:123]
    s_lshl_b32 s94, s94, 2
    ds_read_b64_tr_b16 v[66:67], v16 offset:5120
    v_mfma_f32_16x16x32_bf16 v[116:119], v[68:71], a[196:199], v[116:119]
    s_add_u32 s94, s94, s3
    s_mul_i32 s94, s94, 9216
    v_mfma_f32_16x16x32_bf16 v[112:115], v[68:71], a[192:195], v[112:115]
    s_waitcnt lgkmcnt(4)
    s_add_u32 s94, s94, s42
    v_mfma_f32_16x16x32_bf16 v[128:131], v[72:75], a[192:195], v[128:131]
    s_add_u32 s94, s94, 8192
    ds_read_b64_tr_b16 v[68:69], v17 offset:0
    v_mfma_f32_16x16x32_bf16 v[132:135], v[72:75], a[196:199], v[132:135]
    s_add_u32 m0, s81, 143360
    ds_read_b64_tr_b16 v[70:71], v17 offset:1024
    v_mfma_f32_16x16x32_bf16 v[136:139], v[72:75], a[200:203], v[136:139]
L_page6:
    s_cbranch_execz L_page10
    buffer_load_dwordx4 v1, s[8:11], s94 offen sc1 lds
    v_mfma_f32_16x16x32_bf16 v[140:143], v[72:75], a[204:207], v[140:143]
    s_waitcnt lgkmcnt(4)
    s_add_u32 s65, s45, 36864
    v_mfma_f32_16x16x32_bf16 v[156:159], v[76:79], a[204:207], v[156:159]
    s_add_u32 m0, s64, 73728
    ds_read_b64_tr_b16 v[72:73], v18 offset:14336
    v_mfma_f32_16x16x32_bf16 v[152:155], v[76:79], a[200:203], v[152:155]
    ds_read_b64_tr_b16 v[74:75], v18 offset:14848
    v_mfma_f32_16x16x32_bf16 v[148:151], v[76:79], a[196:199], v[148:151]
    buffer_load_dwordx4 v25, s[28:31], s65 offen lds
    v_mfma_f32_16x16x32_bf16 v[144:147], v[76:79], a[192:195], v[144:147]
    s_waitcnt lgkmcnt(4)
    v_mfma_f32_16x16x32_bf16 v[160:163], a[192:195], v[64:67], v[160:163]
    ds_read_b64_tr_b16 v[76:77], v18 offset:15360
    v_mfma_f32_16x16x32_bf16 v[164:167], a[196:199], v[64:67], v[164:167]
    ds_read_b64_tr_b16 v[78:79], v18 offset:15872
    v_mfma_f32_16x16x32_bf16 v[168:171], a[200:203], v[64:67], v[168:171]
    buffer_load_dwordx4 v25, s[32:35], s65 offen offset:1024 lds
    v_mfma_f32_16x16x32_bf16 v[172:175], a[204:207], v[64:67], v[172:175]
    s_waitcnt lgkmcnt(4)
    s_add_u32 s94, s3, 16
    v_mfma_f32_16x16x32_bf16 v[188:191], v[68:71], a[204:207], v[188:191]
    s_mul_i32 s94, s94, 9216
    ds_read_b64_tr_b16 v[64:65], v16 offset:8192
    v_mfma_f32_16x16x32_bf16 v[184:187], v[68:71], a[200:203], v[184:187]
    s_add_u32 s94, s94, s42
    ds_read_b64_tr_b16 v[66:67], v16 offset:9216
    v_mfma_f32_16x16x32_bf16 v[180:183], v[68:71], a[196:199], v[180:183]
    s_add_u32 s94, s94, 8192
    s_cmp_lt_u32 s3, 2
    s_cselect_b32 s94, s94, 1073741824
    v_mfma_f32_16x16x32_bf16 v[176:179], v[68:71], a[192:195], v[176:179]
    s_waitcnt lgkmcnt(4)
    s_add_u32 m0, s81, 147456
    v_mfma_f32_16x16x32_bf16 v[96:99], v[72:75], a[208:211], v[96:99]
    ds_read_b64_tr_b16 v[68:69], v16 offset:10240
    v_mfma_f32_16x16x32_bf16 v[100:103], v[72:75], a[212:215], v[100:103]
    ds_read_b64_tr_b16 v[70:71], v16 offset:11264
    v_mfma_f32_16x16x32_bf16 v[104:107], v[72:75], a[216:219], v[104:107]
    buffer_load_dwordx4 v1, s[8:11], s94 offen sc1 lds
    v_mfma_f32_16x16x32_bf16 v[108:111], v[72:75], a[220:223], v[108:111]
    s_waitcnt lgkmcnt(4)
    s_add_u32 s65, s48, 0
    v_mfma_f32_16x16x32_bf16 v[124:127], v[76:79], a[220:223], v[124:127]
    s_add_u32 m0, s64, 81920
    ds_read_b64_tr_b16 v[72:73], v16 offset:12288
    v_mfma_f32_16x16x32_bf16 v[120:123], v[76:79], a[216:219], v[120:123]
    ds_read_b64_tr_b16 v[74:75], v16 offset:13312
    v_mfma_f32_16x16x32_bf16 v[116:119], v[76:79], a[212:215], v[116:119]
    v_mfma_f32_16x16x32_bf16 v[112:115], v[76:79], a[208:211], v[112:115]
    s_waitcnt lgkmcnt(4)
    v_mfma_f32_16x16x32_bf16 v[128:131], v[64:67], a[208:211], v[128:131]
    ds_read_b64_tr_b16 v[76:77], v17 offset:8192
    v_mfma_f32_16x16x32_bf16 v[132:135], v[64:67], a[212:215], v[132:135]
    ds_read_b64_tr_b16 v[78:79], v17 offset:9216
    v_mfma_f32_16x16x32_bf16 v[136:139], v[64:67], a[216:219], v[136:139]
    buffer_load_dwordx4 v25, s[28:31], s65 offen lds
    v_mfma_f32_16x16x32_bf16 v[140:143], v[64:67], a[220:223], v[140:143]
    s_waitcnt lgkmcnt(4)
    v_mfma_f32_16x16x32_bf16 v[156:159], v[68:71], a[220:223], v[156:159]
    ds_read_b64_tr_b16 v[64:65], v18 offset:22528
    v_mfma_f32_16x16x32_bf16 v[152:155], v[68:71], a[216:219], v[152:155]
    ds_read_b64_tr_b16 v[66:67], v18 offset:23040
    v_mfma_f32_16x16x32_bf16 v[148:151], v[68:71], a[212:215], v[148:151]
    v_mfma_f32_16x16x32_bf16 v[144:147], v[68:71], a[208:211], v[144:147]
    s_waitcnt lgkmcnt(4)
    v_mfma_f32_16x16x32_bf16 v[160:163], a[208:211], v[72:75], v[160:163]
    ds_read_b64_tr_b16 v[68:69], v18 offset:23552
    v_mfma_f32_16x16x32_bf16 v[164:167], a[212:215], v[72:75], v[164:167]
    ds_read_b64_tr_b16 v[70:71], v18 offset:24064
    v_mfma_f32_16x16x32_bf16 v[168:171], a[216:219], v[72:75], v[168:171]
    buffer_load_dwordx4 v25, s[32:35], s65 offen offset:1024 lds
    v_mfma_f32_16x16x32_bf16 v[172:175], a[220:223], v[72:75], v[172:175]
    s_waitcnt lgkmcnt(4)
    v_mfma_f32_16x16x32_bf16 v[188:191], v[76:79], a[220:223], v[188:191]
    ds_read_b64_tr_b16 v[72:73], v16 offset:16384
    v_mfma_f32_16x16x32_bf16 v[184:187], v[76:79], a[216:219], v[184:187]
    ds_read_b64_tr_b16 v[74:75], v16 offset:17408
    v_mfma_f32_16x16x32_bf16 v[180:183], v[76:79], a[212:215], v[180:183]
    v_mfma_f32_16x16x32_bf16 v[176:179], v[76:79], a[208:211], v[176:179]
    s_waitcnt lgkmcnt(4)
    v_mfma_f32_16x16x32_bf16 v[96:99], v[64:67], a[224:227], v[96:99]
    ds_read_b64_tr_b16 v[76:77], v16 offset:18432
    v_mfma_f32_16x16x32_bf16 v[100:103], v[64:67], a[228:231], v[100:103]
    ds_read_b64_tr_b16 v[78:79], v16 offset:19456
    v_mfma_f32_16x16x32_bf16 v[104:107], v[64:67], a[232:235], v[104:107]
    v_mfma_f32_16x16x32_bf16 v[108:111], v[64:67], a[236:239], v[108:111]
    s_waitcnt lgkmcnt(4)
    v_mfma_f32_16x16x32_bf16 v[124:127], v[68:71], a[236:239], v[124:127]
    ds_read_b64_tr_b16 v[64:65], v16 offset:20480
    v_mfma_f32_16x16x32_bf16 v[120:123], v[68:71], a[232:235], v[120:123]
    ds_read_b64_tr_b16 v[66:67], v16 offset:21504
    v_mfma_f32_16x16x32_bf16 v[116:119], v[68:71], a[228:231], v[116:119]
    v_mfma_f32_16x16x32_bf16 v[112:115], v[68:71], a[224:227], v[112:115]
    s_waitcnt lgkmcnt(4)
    v_mfma_f32_16x16x32_bf16 v[128:131], v[72:75], a[224:227], v[128:131]
    ds_read_b64_tr_b16 v[68:69], v17 offset:16384
    v_mfma_f32_16x16x32_bf16 v[132:135], v[72:75], a[228:231], v[132:135]
    ds_read_b64_tr_b16 v[70:71], v17 offset:17408
    v_mfma_f32_16x16x32_bf16 v[136:139], v[72:75], a[232:235], v[136:139]
    v_mfma_f32_16x16x32_bf16 v[140:143], v[72:75], a[236:239], v[140:143]
    s_waitcnt lgkmcnt(4)
    s_barrier
    v_mfma_f32_16x16x32_bf16 v[156:159], v[76:79], a[236:239], v[156:159]
    ds_read_b64_tr_b16 v[72:73], v18 offset:30720
    v_mfma_f32_16x16x32_bf16 v[152:155], v[76:79], a[232:235], v[152:155]
    s_add_u32 s65, s48, 36864
    ds_read_b64_tr_b16 v[74:75], v18 offset:31232
    v_mfma_f32_16x16x32_bf16 v[148:151], v[76:79], a[228:231], v[148:151]
    s_add_u32 m0, s64, 90112
    v_mfma_f32_16x16x32_bf16 v[144:147], v[76:79], a[224:227], v[144:147]
    s_waitcnt lgkmcnt(4)
    buffer_load_dwordx4 v25, s[28:31], s65 offen lds
    v_mfma_f32_16x16x32_bf16 v[160:163], a[224:227], v[64:67], v[160:163]
    ds_read_b64_tr_b16 v[76:77], v18 offset:31744
    v_mfma_f32_16x16x32_bf16 v[164:167], a[228:231], v[64:67], v[164:167]
    ds_read_b64_tr_b16 v[78:79], v18 offset:32256
    v_mfma_f32_16x16x32_bf16 v[168:171], a[232:235], v[64:67], v[168:171]
    buffer_load_dwordx4 v25, s[32:35], s65 offen offset:1024 lds
    v_mfma_f32_16x16x32_bf16 v[172:175], a[236:239], v[64:67], v[172:175]
    s_waitcnt lgkmcnt(4)
    s_add_u32 s65, s49, 0
    v_mfma_f32_16x16x32_bf16 v[188:191], v[68:71], a[236:239], v[188:191]
    s_add_u32 m0, s64, 98304
    ds_read_b64_tr_b16 v[64:65], v16 offset:24576
    v_mfma_f32_16x16x32_bf16 v[184:187], v[68:71], a[232:235], v[184:187]
    ds_read_b64_tr_b16 v[66:67], v16 offset:25600
    v_mfma_f32_16x16x32_bf16 v[180:183], v[68:71], a[228:231], v[180:183]
    buffer_load_dwordx4 v25, s[28:31], s65 offen lds
    v_mfma_f32_16x16x32_bf16 v[176:179], v[68:71], a[224:227], v[176:179]
    s_waitcnt lgkmcnt(4)
    v_mfma_f32_16x16x32_bf16 v[96:99], v[72:75], a[240:243], v[96:99]
    ds_read_b64_tr_b16 v[68:69], v16 offset:26624
    v_mfma_f32_16x16x32_bf16 v[100:103], v[72:75], a[244:247], v[100:103]
    ds_read_b64_tr_b16 v[70:71], v16 offset:27648
    v_mfma_f32_16x16x32_bf16 v[104:107], v[72:75], a[248:251], v[104:107]
    buffer_load_dwordx4 v25, s[32:35], s65 offen offset:1024 lds
    v_mfma_f32_16x16x32_bf16 v[108:111], v[72:75], a[252:255], v[108:111]
    s_waitcnt lgkmcnt(4)
    s_add_u32 s65, s49, 36864
    v_mfma_f32_16x16x32_bf16 v[124:127], v[76:79], a[252:255], v[124:127]
    s_add_u32 m0, s64, 106496
    ds_read_b64_tr_b16 v[72:73], v16 offset:28672
    v_mfma_f32_16x16x32_bf16 v[120:123], v[76:79], a[248:251], v[120:123]
    ds_read_b64_tr_b16 v[74:75], v16 offset:29696
    v_mfma_f32_16x16x32_bf16 v[116:119], v[76:79], a[244:247], v[116:119]
    buffer_load_dwordx4 v25, s[28:31], s65 offen lds
    v_mfma_f32_16x16x32_bf16 v[112:115], v[76:79], a[240:243], v[112:115]
    s_waitcnt lgkmcnt(4)
    v_mfma_f32_16x16x32_bf16 v[128:131], v[64:67], a[240:243], v[128:131]
    ds_read_b64_tr_b16 v[76:77], v17 offset:24576
    v_mfma_f32_16x16x32_bf16 v[132:135], v[64:67], a[244:247], v[132:135]
    ds_read_b64_tr_b16 v[78:79], v17 offset:25600
    v_mfma_f32_16x16x32_bf16 v[136:139], v[64:67], a[248:251], v[136:139]
    buffer_load_dwordx4 v25, s[32:35], s65 offen offset:1024 lds
    v_mfma_f32_16x16x32_bf16 v[140:143], v[64:67], a[252:255], v[140:143]
    s_waitcnt lgkmcnt(4)
    s_add_u32 s83, s72, 0
    v_mfma_f32_16x16x32_bf16 v[156:159], v[68:71], a[252:255], v[156:159]
    ds_read_b64_tr_b16 v[64:65], v18 offset:38912
    v_mfma_f32_16x16x32_bf16 v[152:155], v[68:71], a[248:251], v[152:155]
    ds_read_b64_tr_b16 v[66:67], v18 offset:39424
    v_mfma_f32_16x16x32_bf16 v[148:151], v[68:71], a[244:247], v[148:151]
    buffer_load_dwordx4 a[0:3], v1, s[8:11], s83 offen offset:0 sc1
    v_mfma_f32_16x16x32_bf16 v[144:147], v[68:71], a[240:243], v[144:147]
    s_waitcnt lgkmcnt(4)
    v_mfma_f32_16x16x32_bf16 v[160:163], a[240:243], v[72:75], v[160:163]
    ds_read_b64_tr_b16 v[68:69], v18 offset:39936
    v_mfma_f32_16x16x32_bf16 v[164:167], a[244:247], v[72:75], v[164:167]
    ds_read_b64_tr_b16 v[70:71], v18 offset:40448
    v_mfma_f32_16x16x32_bf16 v[168:171], a[248:251], v[72:75], v[168:171]
    v_mfma_f32_16x16x32_bf16 v[172:175], a[252:255], v[72:75], v[172:175]
    s_waitcnt lgkmcnt(4)
    buffer_load_dwordx4 a[4:7], v1, s[8:11], s83 offen offset:1024 sc1
    v_mfma_f32_16x16x32_bf16 v[188:191], v[76:79], a[252:255], v[188:191]
    ds_read_b64_tr_b16 v[72:73], v18 offset:47104
    v_mfma_f32_16x16x32_bf16 v[184:187], v[76:79], a[248:251], v[184:187]
    ds_read_b64_tr_b16 v[74:75], v18 offset:47616
    v_mfma_f32_16x16x32_bf16 v[180:183], v[76:79], a[244:247], v[180:183]
    v_mfma_f32_16x16x32_bf16 v[176:179], v[76:79], a[240:243], v[176:179]
    s_waitcnt lgkmcnt(4)
    v_mfma_f32_16x16x32_bf16 v[96:99], v[64:67], v[224:227], v[96:99]
    ds_read_b64_tr_b16 v[76:77], v18 offset:48128
    v_mfma_f32_16x16x32_bf16 v[100:103], v[64:67], v[228:231], v[100:103]
    ds_read_b64_tr_b16 v[78:79], v18 offset:48640
    v_mfma_f32_16x16x32_bf16 v[104:107], v[64:67], v[232:235], v[104:107]
    buffer_load_dwordx4 a[8:11], v1, s[8:11], s83 offen offset:2048 sc1
    v_mfma_f32_16x16x32_bf16 v[108:111], v[64:67], v[236:239], v[108:111]
    s_waitcnt lgkmcnt(4)
    v_mfma_f32_16x16x32_bf16 v[124:127], v[68:71], v[236:239], v[124:127]
    ds_read_b64_tr_b16 v[64:65], v16 offset:32768
    v_mfma_f32_16x16x32_bf16 v[120:123], v[68:71], v[232:235], v[120:123]
    ds_read_b64_tr_b16 v[66:67], v16 offset:33792
    v_mfma_f32_16x16x32_bf16 v[116:119], v[68:71], v[228:231], v[116:119]
    buffer_load_dwordx4 a[12:15], v1, s[8:11], s83 offen offset:3072 sc1
    v_mfma_f32_16x16x32_bf16 v[112:115], v[68:71], v[224:227], v[112:115]
    s_waitcnt lgkmcnt(4)
    s_add_u32 s83, s72, 4096
    v_mfma_f32_16x16x32_bf16 v[96:99], v[72:75], v[240:243], v[96:99]
    ds_read_b64_tr_b16 v[68:69], v16 offset:34816
    v_mfma_f32_16x16x32_bf16 v[100:103], v[72:75], v[244:247], v[100:103]
    ds_read_b64_tr_b16 v[70:71], v16 offset:35840
    v_mfma_f32_16x16x32_bf16 v[104:107], v[72:75], v[248:251], v[104:107]
    buffer_load_dwordx4 a[16:19], v1, s[8:11], s83 offen offset:0 sc1
    v_mfma_f32_16x16x32_bf16 v[108:111], v[72:75], v[252:255], v[108:111]
    s_waitcnt lgkmcnt(4)
    v_mfma_f32_16x16x32_bf16 v[124:127], v[76:79], v[252:255], v[124:127]
    ds_read_b64_tr_b16 v[72:73], v16 offset:40960
    v_mfma_f32_16x16x32_bf16 v[120:123], v[76:79], v[248:251], v[120:123]
    ds_read_b64_tr_b16 v[74:75], v16 offset:41984
    v_mfma_f32_16x16x32_bf16 v[116:119], v[76:79], v[244:247], v[116:119]
    buffer_load_dwordx4 a[20:23], v1, s[8:11], s83 offen offset:1024 sc1
    v_mfma_f32_16x16x32_bf16 v[112:115], v[76:79], v[240:243], v[112:115]
    s_waitcnt lgkmcnt(4)
    v_mfma_f32_16x16x32_bf16 v[128:131], v[64:67], v[224:227], v[128:131]
    ds_read_b64_tr_b16 v[76:77], v16 offset:43008
    v_mfma_f32_16x16x32_bf16 v[132:135], v[64:67], v[228:231], v[132:135]
    ds_read_b64_tr_b16 v[78:79], v16 offset:44032
    v_mfma_f32_16x16x32_bf16 v[136:139], v[64:67], v[232:235], v[136:139]
    buffer_load_dwordx4 a[24:27], v1, s[8:11], s83 offen offset:2048 sc1
    v_mfma_f32_16x16x32_bf16 v[140:143], v[64:67], v[236:239], v[140:143]
    s_waitcnt lgkmcnt(4)
    v_mul_f32 v96, v96, v112
    v_mul_f32 v97, v97, v113
    v_mfma_f32_16x16x32_bf16 v[156:159], v[68:71], v[236:239], v[156:159]
    ds_read_b64_tr_b16 v[64:65], v16 offset:36864
    v_mul_f32 v98, v98, v114
    v_mfma_f32_16x16x32_bf16 v[152:155], v[68:71], v[232:235], v[152:155]
    ds_read_b64_tr_b16 v[66:67], v16 offset:37888
    v_mul_f32 v99, v99, v115
    v_mfma_f32_16x16x32_bf16 v[148:151], v[68:71], v[228:231], v[148:151]
    buffer_load_dwordx4 a[28:31], v1, s[8:11], s83 offen offset:3072 sc1
    v_mfma_f32_16x16x32_bf16 v[144:147], v[68:71], v[224:227], v[144:147]
    s_waitcnt lgkmcnt(4)
    s_add_u32 s83, s73, 0
    v_cvt_pk_bf16_f32 v32, v96, v97
    v_mfma_f32_16x16x32_bf16 v[128:131], v[72:75], v[240:243], v[128:131]
    ds_read_b64_tr_b16 v[68:69], v17 offset:32768
    v_cvt_pk_bf16_f32 v33, v98, v99
    v_mfma_f32_16x16x32_bf16 v[132:135], v[72:75], v[244:247], v[132:135]
    ds_read_b64_tr_b16 v[70:71], v17 offset:33792
    v_mul_f32 v100, v100, v116
    v_mfma_f32_16x16x32_bf16 v[136:139], v[72:75], v[248:251], v[136:139]
    buffer_load_dwordx4 a[32:35], v1, s[8:11], s83 offen offset:0 sc1
    v_mfma_f32_16x16x32_bf16 v[140:143], v[72:75], v[252:255], v[140:143]
    s_waitcnt lgkmcnt(4)
    v_mul_f32 v101, v101, v117
    v_mul_f32 v102, v102, v118
    v_mfma_f32_16x16x32_bf16 v[156:159], v[76:79], v[252:255], v[156:159]
    ds_read_b64_tr_b16 v[72:73], v16 offset:45056
    v_mul_f32 v103, v103, v119
    v_mfma_f32_16x16x32_bf16 v[152:155], v[76:79], v[248:251], v[152:155]
    ds_read_b64_tr_b16 v[74:75], v16 offset:46080
    v_cvt_pk_bf16_f32 v34, v100, v101
    v_mfma_f32_16x16x32_bf16 v[148:151], v[76:79], v[244:247], v[148:151]
    v_cvt_pk_bf16_f32 v35, v102, v103
    v_mul_f32 v104, v104, v120
    v_mfma_f32_16x16x32_bf16 v[144:147], v[76:79], v[240:243], v[144:147]
    s_waitcnt lgkmcnt(4)
    buffer_load_dwordx4 a[36:39], v1, s[8:11], s83 offen offset:1024 sc1
    v_mfma_f32_16x16x32_bf16 v[160:163], v[224:227], v[64:67], v[160:163]
    ds_read_b64_tr_b16 v[76:77], v17 offset:40960
    v_mul_f32 v105, v105, v121
    v_mfma_f32_16x16x32_bf16 v[164:167], v[228:231], v[64:67], v[164:167]
    ds_read_b64_tr_b16 v[78:79], v17 offset:41984
    v_mul_f32 v106, v106, v122
    v_mfma_f32_16x16x32_bf16 v[168:171], v[232:235], v[64:67], v[168:171]
    v_mul_f32 v107, v107, v123
    v_cvt_pk_bf16_f32 v36, v104, v105
    v_mfma_f32_16x16x32_bf16 v[172:175], v[236:239], v[64:67], v[172:175]
    s_waitcnt lgkmcnt(4)
    s_waitcnt vmcnt(16)
    s_barrier
    v_mfma_f32_16x16x32_bf16 v[188:191], v[68:71], v[236:239], v[188:191]
    ds_read_b64_tr_b16 v[64:65], v10 offset:50176
    v_cvt_pk_bf16_f32 v37, v106, v107
    v_mfma_f32_16x16x32_bf16 v[184:187], v[68:71], v[232:235], v[184:187]
    ds_read_b64_tr_b16 v[66:67], v10 offset:54272
    v_mul_f32 v108, v108, v124
    v_mfma_f32_16x16x32_bf16 v[180:183], v[68:71], v[228:231], v[180:183]
    buffer_load_dwordx4 a[40:43], v1, s[8:11], s83 offen offset:2048 sc1
    v_mfma_f32_16x16x32_bf16 v[176:179], v[68:71], v[224:227], v[176:179]
    s_waitcnt lgkmcnt(4)
    v_mul_f32 v109, v109, v125
    v_mul_f32 v110, v110, v126
    v_mfma_f32_16x16x32_bf16 v[160:163], v[240:243], v[72:75], v[160:163]
    ds_read_b64_tr_b16 v[68:69], v11 offset:50176
    v_mul_f32 v111, v111, v127
    v_mfma_f32_16x16x32_bf16 v[164:167], v[244:247], v[72:75], v[164:167]
    ds_read_b64_tr_b16 v[70:71], v11 offset:54272
    v_cvt_pk_bf16_f32 v38, v108, v109
    v_mfma_f32_16x16x32_bf16 v[168:171], v[248:251], v[72:75], v[168:171]
    buffer_load_dwordx4 a[44:47], v1, s[8:11], s83 offen offset:3072 sc1
    v_mfma_f32_16x16x32_bf16 v[172:175], v[252:255], v[72:75], v[172:175]
    s_waitcnt lgkmcnt(4)
    s_add_u32 s65, s44, 73728
    v_cvt_pk_bf16_f32 v39, v110, v111
    v_mfma_f32_16x16x32_bf16 v[188:191], v[76:79], v[252:255], v[188:191]
    s_add_u32 m0, s64, 114688
    ds_read_b64_tr_b16 v[72:73], v22 offset:0
    v_mul_f32 v128, s79, v128
    v_mfma_f32_16x16x32_bf16 v[184:187], v[76:79], v[248:251], v[184:187]
    ds_read_b64_tr_b16 v[74:75], v22 offset:512
    v_mul_f32 v129, s79, v129
    v_mfma_f32_16x16x32_bf16 v[180:183], v[76:79], v[244:247], v[180:183]
    buffer_load_dwordx4 v25, s[28:31], s65 offen lds
    v_mfma_f32_16x16x32_bf16 v[176:179], v[76:79], v[240:243], v[176:179]
    s_waitcnt vmcnt(9)
    s_waitcnt lgkmcnt(4)
    v_mul_f32 v130, s79, v130
    v_mfma_f32_16x16x32_bf16 v[192:195], v[64:67], a[0:3], 0
    ds_read_b64_tr_b16 v[76:77], v10 offset:58368
    v_mul_f32 v131, s79, v131
    v_mfma_f32_16x16x32_bf16 v[196:199], v[64:67], a[4:7], 0
    ds_read_b64_tr_b16 v[78:79], v10 offset:62464
    v_cvt_pk_bf16_f32 v80, v128, v129
    v_mfma_f32_16x16x32_bf16 v[200:203], v[64:67], a[8:11], 0
    buffer_load_dwordx4 v25, s[32:35], s65 offen offset:1024 lds
    v_mfma_f32_16x16x32_bf16 v[204:207], v[64:67], a[12:15], 0
    s_waitcnt lgkmcnt(4)
    s_add_u32 s65, s44, 110592
    v_cvt_pk_bf16_f32 v81, v130, v131
    v_mfma_f32_16x16x32_bf16 v[220:223], v[68:71], a[12:15], 0
    s_add_u32 m0, s64, 122880
    ds_read_b64_tr_b16 v[64:65], v11 offset:58368
    v_mul_f32 v132, s79, v132
    v_mfma_f32_16x16x32_bf16 v[216:219], v[68:71], a[8:11], 0
    ds_read_b64_tr_b16 v[66:67], v11 offset:62464
    v_mul_f32 v133, s79, v133
    v_mfma_f32_16x16x32_bf16 v[212:215], v[68:71], a[4:7], 0
    buffer_load_dwordx4 v25, s[28:31], s65 offen lds
    v_mfma_f32_16x16x32_bf16 v[208:211], v[68:71], a[0:3], 0
    s_waitcnt lgkmcnt(4)
    v_mul_f32 v134, s79, v134
    v_mul_f32 v135, s79, v135
    v_mfma_f32_16x16x32_bf16 v[224:227], v[72:75], a[0:3], 0
    ds_read_b64_tr_b16 v[68:69], v22 offset:1024
    v_cvt_pk_bf16_f32 v82, v132, v133
    v_mfma_f32_16x16x32_bf16 v[228:231], v[72:75], a[4:7], 0
    ds_read_b64_tr_b16 v[70:71], v22 offset:1536
    v_cvt_pk_bf16_f32 v83, v134, v135
    v_mfma_f32_16x16x32_bf16 v[232:235], v[72:75], a[8:11], 0
    buffer_load_dwordx4 v25, s[32:35], s65 offen offset:1024 lds
    v_mfma_f32_16x16x32_bf16 v[236:239], v[72:75], a[12:15], 0
    s_waitcnt vmcnt(8)
    s_waitcnt lgkmcnt(4)
    v_mul_f32 v136, s79, v136
    v_mfma_f32_16x16x32_bf16 v[204:207], v[76:79], a[28:31], v[204:207]
    s_add_u32 s65, s45, 73728
    ds_read_b64_tr_b16 v[72:73], v8 offset:49152
    v_mul_f32 v137, s79, v137
    v_mfma_f32_16x16x32_bf16 v[200:203], v[76:79], a[24:27], v[200:203]
    s_add_u32 m0, s64, 0
    ds_read_b64_tr_b16 v[74:75], v8 offset:53248
    v_mul_f32 v138, s79, v138
    v_mfma_f32_16x16x32_bf16 v[196:199], v[76:79], a[20:23], v[196:199]
    buffer_load_dwordx4 v25, s[28:31], s65 offen lds
    v_mfma_f32_16x16x32_bf16 v[192:195], v[76:79], a[16:19], v[192:195]
    s_waitcnt lgkmcnt(4)
    v_mul_f32 v139, s79, v139
    v_cvt_pk_bf16_f32 v84, v136, v137
    v_mfma_f32_16x16x32_bf16 v[208:211], v[64:67], a[16:19], v[208:211]
    ds_read_b64_tr_b16 v[76:77], v9 offset:49152
    v_cvt_pk_bf16_f32 v85, v138, v139
    v_mfma_f32_16x16x32_bf16 v[212:215], v[64:67], a[20:23], v[212:215]
    ds_read_b64_tr_b16 v[78:79], v9 offset:53248
    v_mul_f32 v140, s79, v140
    v_mfma_f32_16x16x32_bf16 v[216:219], v[64:67], a[24:27], v[216:219]
    buffer_load_dwordx4 v25, s[32:35], s65 offen offset:1024 lds
    v_mfma_f32_16x16x32_bf16 v[220:223], v[64:67], a[28:31], v[220:223]
    s_waitcnt lgkmcnt(4)
    s_add_u32 s83, s73, 4096
    v_mul_f32 v141, s79, v141
    v_mfma_f32_16x16x32_bf16 v[236:239], v[68:71], a[28:31], v[236:239]
    ds_read_b64_tr_b16 v[64:65], v8 offset:57344
    v_mul_f32 v142, s79, v142
    v_mfma_f32_16x16x32_bf16 v[232:235], v[68:71], a[24:27], v[232:235]
    ds_read_b64_tr_b16 v[66:67], v8 offset:61440
    v_mul_f32 v143, s79, v143
    v_mfma_f32_16x16x32_bf16 v[228:231], v[68:71], a[20:23], v[228:231]
    buffer_load_dwordx4 a[48:51], v1, s[8:11], s83 offen offset:0 sc1
    v_mfma_f32_16x16x32_bf16 v[224:227], v[68:71], a[16:19], v[224:227]
    s_waitcnt lgkmcnt(4)
    v_cvt_pk_bf16_f32 v86, v140, v141
    v_cvt_pk_bf16_f32 v87, v142, v143
    v_mfma_f32_16x16x32_bf16 v[96:99], v[72:75], a[0:3], 0
    ds_read_b64_tr_b16 v[68:69], v9 offset:57344
    v_mfma_f32_16x16x32_bf16 v[100:103], v[72:75], a[4:7], 0
    ds_read_b64_tr_b16 v[70:71], v9 offset:61440
    v_mfma_f32_16x16x32_bf16 v[104:107], v[72:75], a[8:11], 0
    buffer_load_dwordx4 a[52:55], v1, s[8:11], s83 offen offset:1024 sc1
    v_mfma_f32_16x16x32_bf16 v[108:111], v[72:75], a[12:15], 0
    s_waitcnt lgkmcnt(4)
    v_permlane16_swap_b32 v80, v82
    v_mfma_f32_16x16x32_bf16 v[124:127], v[76:79], a[12:15], 0
    ds_read_b64_tr_b16 v[72:73], v10 offset:49152
    v_mfma_f32_16x16x32_bf16 v[120:123], v[76:79], a[8:11], 0
    ds_read_b64_tr_b16 v[74:75], v10 offset:53248
    v_mfma_f32_16x16x32_bf16 v[116:119], v[76:79], a[4:7], 0
    buffer_load_dwordx4 a[56:59], v1, s[8:11], s83 offen offset:2048 sc1
    v_mfma_f32_16x16x32_bf16 v[112:115], v[76:79], a[0:3], 0
    s_waitcnt lgkmcnt(4)
    v_permlane16_swap_b32 v81, v83
    v_mfma_f32_16x16x32_bf16 v[96:99], v[64:67], a[16:19], v[96:99]
    ds_read_b64_tr_b16 v[76:77], v11 offset:49152
    v_mfma_f32_16x16x32_bf16 v[100:103], v[64:67], a[20:23], v[100:103]
    ds_read_b64_tr_b16 v[78:79], v11 offset:53248
    v_mfma_f32_16x16x32_bf16 v[104:107], v[64:67], a[24:27], v[104:107]
    buffer_load_dwordx4 a[60:63], v1, s[8:11], s83 offen offset:3072 sc1
    v_mfma_f32_16x16x32_bf16 v[108:111], v[64:67], a[28:31], v[108:111]
    s_waitcnt lgkmcnt(4)
    v_permlane16_swap_b32 v84, v86
    v_mfma_f32_16x16x32_bf16 v[124:127], v[68:71], a[28:31], v[124:127]
    ds_read_b64_tr_b16 v[64:65], v10 offset:57344
    v_mfma_f32_16x16x32_bf16 v[120:123], v[68:71], a[24:27], v[120:123]
    ds_read_b64_tr_b16 v[66:67], v10 offset:61440
    v_mfma_f32_16x16x32_bf16 v[116:119], v[68:71], a[20:23], v[116:119]
    buffer_load_dword v6, v4, s[8:11], s88 offen sc1
    v_mfma_f32_16x16x32_bf16 v[112:115], v[68:71], a[16:19], v[112:115]
    s_waitcnt lgkmcnt(4)
    s_add_u32 s83, s74, 0
    v_mfma_f32_16x16x32_bf16 v[128:131], v[72:75], a[0:3], 0
    ds_read_b64_tr_b16 v[68:69], v11 offset:57344
    v_mfma_f32_16x16x32_bf16 v[132:135], v[72:75], a[4:7], 0
    ds_read_b64_tr_b16 v[70:71], v11 offset:61440
    v_mfma_f32_16x16x32_bf16 v[136:139], v[72:75], a[8:11], 0
    buffer_load_dwordx4 a[64:67], v1, s[8:11], s83 offen offset:0 sc1
    v_mfma_f32_16x16x32_bf16 v[140:143], v[72:75], a[12:15], 0
    s_waitcnt lgkmcnt(4)
    v_permlane16_swap_b32 v85, v87
    v_cvt_pk_bf16_f32 v40, v144, v145
    v_cvt_pk_bf16_f32 v41, v146, v147
    v_cvt_pk_bf16_f32 v42, v148, v149
    v_cvt_pk_bf16_f32 v43, v150, v151
    v_cvt_pk_bf16_f32 v44, v152, v153
    v_cvt_pk_bf16_f32 v45, v154, v155
    v_cvt_pk_bf16_f32 v46, v156, v157
    v_cvt_pk_bf16_f32 v47, v158, v159
    v_mfma_f32_16x16x32_bf16 v[156:159], v[76:79], a[12:15], 0
    ds_read_b64_tr_b16 v[72:73], v8 offset:50176
    v_mfma_f32_16x16x32_bf16 v[152:155], v[76:79], a[8:11], 0
    ds_read_b64_tr_b16 v[74:75], v8 offset:54272
    v_mfma_f32_16x16x32_bf16 v[148:151], v[76:79], a[4:7], 0
    v_permlane16_swap_b32 v40, v42
    v_mfma_f32_16x16x32_bf16 v[144:147], v[76:79], a[0:3], 0
    s_waitcnt lgkmcnt(4)
    buffer_load_dwordx4 a[68:71], v1, s[8:11], s83 offen offset:1024 sc1
    v_mfma_f32_16x16x32_bf16 v[128:131], v[64:67], a[16:19], v[128:131]
    ds_read_b64_tr_b16 v[76:77], v9 offset:50176
    v_mfma_f32_16x16x32_bf16 v[132:135], v[64:67], a[20:23], v[132:135]
    ds_read_b64_tr_b16 v[78:79], v9 offset:54272
    v_mfma_f32_16x16x32_bf16 v[136:139], v[64:67], a[24:27], v[136:139]
    v_permlane16_swap_b32 v41, v43
    v_mfma_f32_16x16x32_bf16 v[140:143], v[64:67], a[28:31], v[140:143]
    s_waitcnt lgkmcnt(4)
    v_permlane16_swap_b32 v44, v46
    v_mfma_f32_16x16x32_bf16 v[156:159], v[68:71], a[28:31], v[156:159]
    ds_read_b64_tr_b16 v[64:65], v8 offset:58368
    v_mfma_f32_16x16x32_bf16 v[152:155], v[68:71], a[24:27], v[152:155]
    ds_read_b64_tr_b16 v[66:67], v8 offset:62464
    v_mfma_f32_16x16x32_bf16 v[148:151], v[68:71], a[20:23], v[148:151]
    v_permlane16_swap_b32 v45, v47
    v_mfma_f32_16x16x32_bf16 v[144:147], v[68:71], a[16:19], v[144:147]
    s_waitcnt lgkmcnt(4)
    buffer_load_dwordx4 a[72:75], v1, s[8:11], s83 offen offset:2048 sc1
    v_cvt_pk_bf16_f32 v48, v160, v161
    v_cvt_pk_bf16_f32 v49, v162, v163
    v_cvt_pk_bf16_f32 v50, v164, v165
    v_cvt_pk_bf16_f32 v51, v166, v167
    v_cvt_pk_bf16_f32 v52, v168, v169
    v_cvt_pk_bf16_f32 v53, v170, v171
    v_cvt_pk_bf16_f32 v54, v172, v173
    v_cvt_pk_bf16_f32 v55, v174, v175
    v_mfma_f32_16x16x32_bf16 v[160:163], v[72:75], a[0:3], 0
    ds_read_b64_tr_b16 v[68:69], v9 offset:58368
    v_mfma_f32_16x16x32_bf16 v[164:167], v[72:75], a[4:7], 0
    ds_read_b64_tr_b16 v[70:71], v9 offset:62464
    v_mfma_f32_16x16x32_bf16 v[168:171], v[72:75], a[8:11], 0
    v_permlane16_swap_b32 v48, v50
    v_mfma_f32_16x16x32_bf16 v[172:175], v[72:75], a[12:15], 0
    s_waitcnt lgkmcnt(4)
    v_permlane16_swap_b32 v49, v51
    v_permlane16_swap_b32 v52, v54
    v_permlane16_swap_b32 v53, v55
    ds_write_b128 v30, v[48:51] offset:0
    ds_write_b128 v30, v[52:55] offset:1216
    v_mov_b32 v60, 0x3f803f80
    v_mul_f32 v178, v31, v178
    v_mul_f32 v179, v31, v179
    v_cvt_pk_bf16_f32 v56, v178, v179
    v_cndmask_b32 v56, v56, v60, s[92:93]
    v_mul_f32 v182, v31, v182
    v_mul_f32 v183, v31, v183
    v_cvt_pk_bf16_f32 v58, v182, v183
    v_cndmask_b32 v58, v58, v60, s[92:93]
    v_mul_f32 v186, v31, v186
    v_mul_f32 v187, v31, v187
    v_cvt_pk_bf16_f32 v57, v186, v187
    v_cndmask_b32 v57, v57, v60, s[92:93]
    v_mul_f32 v190, v31, v190
    v_mul_f32 v191, v31, v191
    v_cvt_pk_bf16_f32 v59, v190, v191
    v_cndmask_b32 v59, v59, v60, s[92:93]
    v_mfma_f32_16x16x32_bf16 v[188:191], v[76:79], a[12:15], 0
    ds_read_b64_tr_b16 v[72:73], v12 offset:0
    ds_write_b16 v28, v56 offset:0
    v_mfma_f32_16x16x32_bf16 v[184:187], v[76:79], a[8:11], 0
    ds_read_b64_tr_b16 v[74:75], v12 offset:4096
    ds_write_b16_d16_hi v29, v56 offset:0
    v_mfma_f32_16x16x32_bf16 v[180:183], v[76:79], a[4:7], 0
    ds_write_b16 v28, v58 offset:608
    v_mfma_f32_16x16x32_bf16 v[176:179], v[76:79], a[0:3], 0
    s_waitcnt lgkmcnt(9)
    buffer_load_dwordx4 a[76:79], v1, s[8:11], s83 offen offset:3072 sc1
    v_mfma_f32_16x16x32_bf16 v[160:163], v[64:67], a[16:19], v[160:163]
    ds_read_b64_tr_b16 v[76:77], v13 offset:0
    ds_write_b16_d16_hi v29, v58 offset:608
    v_mfma_f32_16x16x32_bf16 v[164:167], v[64:67], a[20:23], v[164:167]
    ds_read_b64_tr_b16 v[78:79], v13 offset:4096
    ds_write_b16 v28, v57 offset:1216
    v_mfma_f32_16x16x32_bf16 v[168:171], v[64:67], a[24:27], v[168:171]
    ds_write_b16_d16_hi v29, v57 offset:1216
    v_mfma_f32_16x16x32_bf16 v[172:175], v[64:67], a[28:31], v[172:175]
    s_waitcnt lgkmcnt(12)
    ds_write_b16 v28, v59 offset:1824
    v_mfma_f32_16x16x32_bf16 v[188:191], v[68:71], a[28:31], v[188:191]
    ds_read_b64_tr_b16 v[64:65], v14 offset:0
    ds_write_b16_d16_hi v29, v59 offset:1824
    v_mfma_f32_16x16x32_bf16 v[184:187], v[68:71], a[24:27], v[184:187]
    ds_read_b64_tr_b16 v[66:67], v14 offset:4096
    v_add_u32 v30, s47, v1
    v_mfma_f32_16x16x32_bf16 v[180:183], v[68:71], a[20:23], v[180:183]
    v_mov_b32 v28, 1073741824
    v_mov_b32 v60, 384
    v_mfma_f32_16x16x32_bf16 v[176:179], v[68:71], a[16:19], v[176:179]
    s_waitcnt vmcnt(15)
    s_waitcnt lgkmcnt(11)
    v_cmp_gt_u32 s[100:101], v60, v1
    v_mfma_f32_16x16x32_bf16 v[96:99], v[72:75], a[32:35], v[96:99]
    ds_read_b64_tr_b16 v[68:69], v15 offset:0
    v_cndmask_b32 v28, v28, v1, s[100:101]
    v_mfma_f32_16x16x32_bf16 v[100:103], v[72:75], a[36:39], v[100:103]
    ds_read_b64_tr_b16 v[70:71], v15 offset:4096
    s_waitcnt vmcnt(4)
    v_cmp_eq_u32 vcc, s40, v6
    s_nop 0
    s_and_b32 vcc_lo, vcc_lo, 240
    s_cmp_eq_u32 vcc_lo, 240
    s_cbranch_scc0 L_spin3
L_back3:
    v_mfma_f32_16x16x32_bf16 v[104:107], v[72:75], a[40:43], v[104:107]
    ds_read_b128 v[48:51], v30 offset:0
    v_mfma_f32_16x16x32_bf16 v[108:111], v[72:75], a[44:47], v[108:111]
    s_waitcnt lgkmcnt(9)
    ds_read_b128 v[52:55], v30 offset:1024
    v_mfma_f32_16x16x32_bf16 v[124:127], v[76:79], a[44:47], v[124:127]
    ds_read_b64_tr_b16 v[72:73], v12 offset:1024
    ds_read_b128 v[244:247], v30 offset:2048
    v_mfma_f32_16x16x32_bf16 v[120:123], v[76:79], a[40:43], v[120:123]
    ds_read_b64_tr_b16 v[74:75], v12 offset:5120
    v_mov_b32 v60, 256
    v_mfma_f32_16x16x32_bf16 v[116:119], v[76:79], a[36:39], v[116:119]
    v_cmp_gt_u32 s[100:101], v60, v2
    v_mov_b32 v88, v56
    v_mfma_f32_16x16x32_bf16 v[112:115], v[76:79], a[32:35], v[112:115]
    s_waitcnt lgkmcnt(7)
    v_mov_b32 v89, v58
    v_mov_b32 v90, 0
    v_mfma_f32_16x16x32_bf16 v[128:131], v[64:67], a[32:35], v[128:131]
    ds_read_b64_tr_b16 v[76:77], v13 offset:1024
    v_mfma_f32_16x16x32_bf16 v[132:135], v[64:67], a[36:39], v[132:135]
    ds_read_b64_tr_b16 v[78:79], v13 offset:5120
    v_mfma_f32_16x16x32_bf16 v[136:139], v[64:67], a[40:43], v[136:139]
    v_permlane16_swap_b32 v88, v89
    v_mfma_f32_16x16x32_bf16 v[140:143], v[64:67], a[44:47], v[140:143]
    s_waitcnt lgkmcnt(7)
    v_cndmask_b32 v88, 0, v88, s[100:101]
    v_mov_b32 v89, 0
L_page7:
    s_cbranch_execz L_page11
    v_mfma_f32_16x16x32_bf16 v[156:159], v[68:71], a[44:47], v[156:159]
    ds_read_b64_tr_b16 v[64:65], v14 offset:1024
    v_mov_b32 v91, v88
    v_mfma_f32_16x16x32_bf16 v[152:155], v[68:71], a[40:43], v[152:155]
    ds_read_b64_tr_b16 v[66:67], v14 offset:5120
    v_mov_b32 v92, v57
    v_mfma_f32_16x16x32_bf16 v[148:151], v[68:71], a[36:39], v[148:151]
    v_mov_b32 v93, v59
    v_mov_b32 v94, 0
    v_mfma_f32_16x16x32_bf16 v[144:147], v[68:71], a[32:35], v[144:147]
    s_waitcnt lgkmcnt(4)
    v_permlane16_swap_b32 v92, v93
    v_mfma_f32_16x16x32_bf16 v[160:163], v[72:75], a[32:35], v[160:163]
    ds_read_b64_tr_b16 v[68:69], v15 offset:1024
    v_cndmask_b32 v92, 0, v92, s[100:101]
    v_mfma_f32_16x16x32_bf16 v[164:167], v[72:75], a[36:39], v[164:167]
    ds_read_b64_tr_b16 v[70:71], v15 offset:5120
    v_mov_b32 v93, 0
    v_mfma_f32_16x16x32_bf16 v[168:171], v[72:75], a[40:43], v[168:171]
    v_mov_b32 v95, v92
    v_mfma_f32_16x16x32_bf16 v[172:175], v[72:75], a[44:47], v[172:175]
    s_waitcnt lgkmcnt(4)
    buffer_store_dwordx2 v[32:33], v2, s[8:11], s77 offen offset:0 sc1
    v_mfma_f32_16x16x32_bf16 v[188:191], v[76:79], a[44:47], v[188:191]
    ds_read_b64_tr_b16 v[72:73], v22 offset:4096
    v_mfma_f32_16x16x32_bf16 v[184:187], v[76:79], a[40:43], v[184:187]
    ds_read_b64_tr_b16 v[74:75], v22 offset:4608
    v_mfma_f32_16x16x32_bf16 v[180:183], v[76:79], a[36:39], v[180:183]
    buffer_store_dwordx2 v[34:35], v2, s[8:11], s77 offen offset:1024 sc1
    v_mfma_f32_16x16x32_bf16 v[176:179], v[76:79], a[32:35], v[176:179]
    s_waitcnt lgkmcnt(4)
    s_barrier
    v_mfma_f32_16x16x32_bf16 v[192:195], v[64:67], a[32:35], v[192:195]
    ds_read_b64_tr_b16 v[76:77], v12 offset:8192
    v_mfma_f32_16x16x32_bf16 v[196:199], v[64:67], a[36:39], v[196:199]
    ds_read_b64_tr_b16 v[78:79], v12 offset:12288
    v_mfma_f32_16x16x32_bf16 v[200:203], v[64:67], a[40:43], v[200:203]
    buffer_store_dwordx2 v[36:37], v2, s[8:11], s77 offen offset:2048 sc1
    v_mfma_f32_16x16x32_bf16 v[204:207], v[64:67], a[44:47], v[204:207]
    s_waitcnt lgkmcnt(4)
    v_mfma_f32_16x16x32_bf16 v[220:223], v[68:71], a[44:47], v[220:223]
    ds_read_b64_tr_b16 v[64:65], v13 offset:8192
    v_mfma_f32_16x16x32_bf16 v[216:219], v[68:71], a[40:43], v[216:219]
    ds_read_b64_tr_b16 v[66:67], v13 offset:12288
    v_mfma_f32_16x16x32_bf16 v[212:215], v[68:71], a[36:39], v[212:215]
    buffer_store_dwordx2 v[38:39], v2, s[8:11], s77 offen offset:3072 sc1
    v_mfma_f32_16x16x32_bf16 v[208:211], v[68:71], a[32:35], v[208:211]
    s_waitcnt lgkmcnt(4)
    v_mfma_f32_16x16x32_bf16 v[224:227], v[72:75], a[32:35], v[224:227]
    ds_read_b64_tr_b16 v[68:69], v14 offset:8192
    v_mfma_f32_16x16x32_bf16 v[228:231], v[72:75], a[36:39], v[228:231]
    ds_read_b64_tr_b16 v[70:71], v14 offset:12288
    v_mfma_f32_16x16x32_bf16 v[232:235], v[72:75], a[40:43], v[232:235]
    buffer_store_dwordx4 v[40:43], v1, s[8:11], s78 offen offset:0 sc1
    v_mfma_f32_16x16x32_bf16 v[236:239], v[72:75], a[44:47], v[236:239]
    s_waitcnt lgkmcnt(4)
    v_mfma_f32_16x16x32_bf16 v[108:111], v[76:79], a[60:63], v[108:111]
    ds_read_b64_tr_b16 v[72:73], v15 offset:8192
    v_mfma_f32_16x16x32_bf16 v[104:107], v[76:79], a[56:59], v[104:107]
    ds_read_b64_tr_b16 v[74:75], v15 offset:12288
    v_mfma_f32_16x16x32_bf16 v[100:103], v[76:79], a[52:55], v[100:103]
    buffer_store_dwordx4 v[44:47], v1, s[8:11], s78 offen offset:1024 sc1
    v_mfma_f32_16x16x32_bf16 v[96:99], v[76:79], a[48:51], v[96:99]
    s_waitcnt lgkmcnt(4)
    s_add_u32 s83, s74, 4096
    v_mfma_f32_16x16x32_bf16 v[112:115], v[64:67], a[48:51], v[112:115]
    ds_read_b64_tr_b16 v[76:77], v12 offset:9216
    v_mfma_f32_16x16x32_bf16 v[116:119], v[64:67], a[52:55], v[116:119]
    ds_read_b64_tr_b16 v[78:79], v12 offset:13312
    v_mfma_f32_16x16x32_bf16 v[120:123], v[64:67], a[56:59], v[120:123]
    buffer_load_dwordx4 a[80:83], v1, s[8:11], s83 offen offset:0 sc1
    v_mfma_f32_16x16x32_bf16 v[124:127], v[64:67], a[60:63], v[124:127]
    s_waitcnt lgkmcnt(4)
    v_mfma_f32_16x16x32_bf16 v[140:143], v[68:71], a[60:63], v[140:143]
    ds_read_b64_tr_b16 v[64:65], v13 offset:9216
    v_mfma_f32_16x16x32_bf16 v[136:139], v[68:71], a[56:59], v[136:139]
    ds_read_b64_tr_b16 v[66:67], v13 offset:13312
    v_mfma_f32_16x16x32_bf16 v[132:135], v[68:71], a[52:55], v[132:135]
    buffer_load_dwordx4 a[84:87], v1, s[8:11], s83 offen offset:1024 sc1
    v_mfma_f32_16x16x32_bf16 v[128:131], v[68:71], a[48:51], v[128:131]
    s_waitcnt lgkmcnt(4)
    v_mfma_f32_16x16x32_bf16 v[144:147], v[72:75], a[48:51], v[144:147]
    ds_read_b64_tr_b16 v[68:69], v14 offset:9216
    v_mfma_f32_16x16x32_bf16 v[148:151], v[72:75], a[52:55], v[148:151]
    ds_read_b64_tr_b16 v[70:71], v14 offset:13312
    v_mfma_f32_16x16x32_bf16 v[152:155], v[72:75], a[56:59], v[152:155]
    buffer_load_dwordx4 a[88:91], v1, s[8:11], s83 offen offset:2048 sc1
    v_mfma_f32_16x16x32_bf16 v[156:159], v[72:75], a[60:63], v[156:159]
    s_waitcnt lgkmcnt(4)
    v_mfma_f32_16x16x32_bf16 v[172:175], v[76:79], a[60:63], v[172:175]
    ds_read_b64_tr_b16 v[72:73], v15 offset:9216
    v_mfma_f32_16x16x32_bf16 v[168:171], v[76:79], a[56:59], v[168:171]
    ds_read_b64_tr_b16 v[74:75], v15 offset:13312
    v_mfma_f32_16x16x32_bf16 v[164:167], v[76:79], a[52:55], v[164:167]
    buffer_load_dwordx4 a[92:95], v1, s[8:11], s83 offen offset:3072 sc1
    v_mfma_f32_16x16x32_bf16 v[160:163], v[76:79], a[48:51], v[160:163]
    s_waitcnt lgkmcnt(4)
    s_add_u32 s65, s45, 110592
    v_mfma_f32_16x16x32_bf16 v[176:179], v[64:67], a[48:51], v[176:179]
    s_add_u32 m0, s64, 8192
    ds_read_b64_tr_b16 v[76:77], v22 offset:5120
    v_mfma_f32_16x16x32_bf16 v[180:183], v[64:67], a[52:55], v[180:183]
    ds_read_b64_tr_b16 v[78:79], v22 offset:5632
    v_mfma_f32_16x16x32_bf16 v[184:187], v[64:67], a[56:59], v[184:187]
    buffer_load_dwordx4 v25, s[28:31], s65 offen lds
    v_mfma_f32_16x16x32_bf16 v[188:191], v[64:67], a[60:63], v[188:191]
    s_waitcnt lgkmcnt(4)
    v_mfma_f32_16x16x32_bf16 v[204:207], v[68:71], a[60:63], v[204:207]
    ds_read_b64_tr_b16 v[64:65], v12 offset:16384
    v_mfma_f32_16x16x32_bf16 v[200:203], v[68:71], a[56:59], v[200:203]
    ds_read_b64_tr_b16 v[66:67], v12 offset:20480
    v_mfma_f32_16x16x32_bf16 v[196:199], v[68:71], a[52:55], v[196:199]
    buffer_load_dwordx4 v25, s[32:35], s65 offen offset:1024 lds
    v_mfma_f32_16x16x32_bf16 v[192:195], v[68:71], a[48:51], v[192:195]
    s_waitcnt lgkmcnt(4)
    s_add_u32 s65, s48, 73728
    v_mfma_f32_16x16x32_bf16 v[208:211], v[72:75], a[48:51], v[208:211]
    s_add_u32 m0, s64, 16384
    ds_read_b64_tr_b16 v[68:69], v13 offset:16384
    v_mfma_f32_16x16x32_bf16 v[212:215], v[72:75], a[52:55], v[212:215]
    ds_read_b64_tr_b16 v[70:71], v13 offset:20480
    v_mfma_f32_16x16x32_bf16 v[216:219], v[72:75], a[56:59], v[216:219]
    buffer_load_dwordx4 v25, s[28:31], s65 offen lds
    v_mfma_f32_16x16x32_bf16 v[220:223], v[72:75], a[60:63], v[220:223]
    s_waitcnt lgkmcnt(4)
    v_mfma_f32_16x16x32_bf16 v[236:239], v[76:79], a[60:63], v[236:239]
    ds_read_b64_tr_b16 v[72:73], v14 offset:16384
    v_mfma_f32_16x16x32_bf16 v[232:235], v[76:79], a[56:59], v[232:235]
    ds_read_b64_tr_b16 v[74:75], v14 offset:20480
    v_mfma_f32_16x16x32_bf16 v[228:231], v[76:79], a[52:55], v[228:231]
    buffer_load_dwordx4 v25, s[32:35], s65 offen offset:1024 lds
    v_mfma_f32_16x16x32_bf16 v[224:227], v[76:79], a[48:51], v[224:227]
    s_waitcnt vmcnt(14)
    s_waitcnt lgkmcnt(4)
    v_mfma_f32_16x16x32_bf16 v[96:99], v[64:67], a[64:67], v[96:99]
    s_add_u32 s65, s48, 110592
    ds_read_b64_tr_b16 v[76:77], v15 offset:16384
    v_mfma_f32_16x16x32_bf16 v[100:103], v[64:67], a[68:71], v[100:103]
    s_add_u32 m0, s64, 24576
    ds_read_b64_tr_b16 v[78:79], v15 offset:20480
    v_mfma_f32_16x16x32_bf16 v[104:107], v[64:67], a[72:75], v[104:107]
    buffer_load_dwordx4 v25, s[28:31], s65 offen lds
    v_mfma_f32_16x16x32_bf16 v[108:111], v[64:67], a[76:79], v[108:111]
    s_waitcnt lgkmcnt(4)
    v_mfma_f32_16x16x32_bf16 v[124:127], v[68:71], a[76:79], v[124:127]
    ds_read_b64_tr_b16 v[64:65], v12 offset:17408
    v_mfma_f32_16x16x32_bf16 v[120:123], v[68:71], a[72:75], v[120:123]
    ds_read_b64_tr_b16 v[66:67], v12 offset:21504
    v_mfma_f32_16x16x32_bf16 v[116:119], v[68:71], a[68:71], v[116:119]
    buffer_load_dwordx4 v25, s[32:35], s65 offen offset:1024 lds
    v_mfma_f32_16x16x32_bf16 v[112:115], v[68:71], a[64:67], v[112:115]
    s_waitcnt lgkmcnt(4)
    v_mfma_f32_16x16x32_bf16 v[128:131], v[72:75], a[64:67], v[128:131]
    ds_read_b64_tr_b16 v[68:69], v13 offset:17408
    v_mfma_f32_16x16x32_bf16 v[132:135], v[72:75], a[68:71], v[132:135]
    ds_read_b64_tr_b16 v[70:71], v13 offset:21504
    v_mfma_f32_16x16x32_bf16 v[136:139], v[72:75], a[72:75], v[136:139]
    buffer_store_dwordx2 v[56:57], v27, s[8:11], 0 offen offset:0 sc1
    v_mfma_f32_16x16x32_bf16 v[140:143], v[72:75], a[76:79], v[140:143]
    s_waitcnt lgkmcnt(4)
    v_mfma_f32_16x16x32_bf16 v[156:159], v[76:79], a[76:79], v[156:159]
    ds_read_b64_tr_b16 v[72:73], v14 offset:17408
    v_mfma_f32_16x16x32_bf16 v[152:155], v[76:79], a[72:75], v[152:155]
    ds_read_b64_tr_b16 v[74:75], v14 offset:21504
    v_mfma_f32_16x16x32_bf16 v[148:151], v[76:79], a[68:71], v[148:151]
    buffer_store_dwordx2 v[58:59], v27, s[8:11], 0 offen offset:128 sc1
    v_mfma_f32_16x16x32_bf16 v[144:147], v[76:79], a[64:67], v[144:147]
    s_waitcnt lgkmcnt(4)
    v_mfma_f32_16x16x32_bf16 v[160:163], v[64:67], a[64:67], v[160:163]
    ds_read_b64_tr_b16 v[76:77], v15 offset:17408
    v_mfma_f32_16x16x32_bf16 v[164:167], v[64:67], a[68:71], v[164:167]
    ds_read_b64_tr_b16 v[78:79], v15 offset:21504
    v_mfma_f32_16x16x32_bf16 v[168:171], v[64:67], a[72:75], v[168:171]
    buffer_store_dwordx4 v[48:51], v1, s[8:11], s46 offen offset:0 sc1
    v_mfma_f32_16x16x32_bf16 v[172:175], v[64:67], a[76:79], v[172:175]
    s_waitcnt lgkmcnt(4)
    v_mfma_f32_16x16x32_bf16 v[188:191], v[68:71], a[76:79], v[188:191]
    ds_read_b64_tr_b16 v[64:65], v22 offset:8192
    v_mfma_f32_16x16x32_bf16 v[184:187], v[68:71], a[72:75], v[184:187]
    ds_read_b64_tr_b16 v[66:67], v22 offset:8704
    v_mfma_f32_16x16x32_bf16 v[180:183], v[68:71], a[68:71], v[180:183]
    buffer_store_dwordx4 v[52:55], v1, s[8:11], s46 offen offset:1024 sc1
    v_mfma_f32_16x16x32_bf16 v[176:179], v[68:71], a[64:67], v[176:179]
    s_waitcnt lgkmcnt(4)
    v_mfma_f32_16x16x32_bf16 v[192:195], v[72:75], a[64:67], v[192:195]
    ds_read_b64_tr_b16 v[68:69], v12 offset:24576
    v_mfma_f32_16x16x32_bf16 v[196:199], v[72:75], a[68:71], v[196:199]
    ds_read_b64_tr_b16 v[70:71], v12 offset:28672
    v_mfma_f32_16x16x32_bf16 v[200:203], v[72:75], a[72:75], v[200:203]
    buffer_store_dwordx4 v[244:247], v28, s[8:11], s46 offen offset:2048 sc1
    v_mfma_f32_16x16x32_bf16 v[204:207], v[72:75], a[76:79], v[204:207]
    s_waitcnt lgkmcnt(4)
    s_add_u32 s83, s66, 0
    v_mfma_f32_16x16x32_bf16 v[220:223], v[76:79], a[76:79], v[220:223]
    ds_read_b64_tr_b16 v[72:73], v13 offset:24576
    v_mfma_f32_16x16x32_bf16 v[216:219], v[76:79], a[72:75], v[216:219]
    ds_read_b64_tr_b16 v[74:75], v13 offset:28672
    v_mfma_f32_16x16x32_bf16 v[212:215], v[76:79], a[68:71], v[212:215]
    buffer_load_dwordx4 a[96:99], v1, s[8:11], s83 offen offset:0 sc1
    v_mfma_f32_16x16x32_bf16 v[208:211], v[76:79], a[64:67], v[208:211]
    s_waitcnt lgkmcnt(4)
    v_mfma_f32_16x16x32_bf16 v[224:227], v[64:67], a[64:67], v[224:227]
    ds_read_b64_tr_b16 v[76:77], v14 offset:24576
    v_mfma_f32_16x16x32_bf16 v[228:231], v[64:67], a[68:71], v[228:231]
    ds_read_b64_tr_b16 v[78:79], v14 offset:28672
    v_mfma_f32_16x16x32_bf16 v[232:235], v[64:67], a[72:75], v[232:235]
    buffer_load_dwordx4 a[100:103], v1, s[8:11], s83 offen offset:1024 sc1
    v_mfma_f32_16x16x32_bf16 v[236:239], v[64:67], a[76:79], v[236:239]
    s_waitcnt vmcnt(13)
    s_waitcnt lgkmcnt(4)
    v_mfma_f32_16x16x32_bf16 v[108:111], v[68:71], a[92:95], v[108:111]
    ds_read_b64_tr_b16 v[64:65], v15 offset:24576
    v_mfma_f32_16x16x32_bf16 v[104:107], v[68:71], a[88:91], v[104:107]
    ds_read_b64_tr_b16 v[66:67], v15 offset:28672
    v_mfma_f32_16x16x32_bf16 v[100:103], v[68:71], a[84:87], v[100:103]
    buffer_load_dwordx4 a[104:107], v1, s[8:11], s83 offen offset:2048 sc1
    v_mfma_f32_16x16x32_bf16 v[96:99], v[68:71], a[80:83], v[96:99]
    s_waitcnt lgkmcnt(4)
    v_mfma_f32_16x16x32_bf16 v[112:115], v[72:75], a[80:83], v[112:115]
    ds_read_b64_tr_b16 v[68:69], v12 offset:25600
    v_mfma_f32_16x16x32_bf16 v[116:119], v[72:75], a[84:87], v[116:119]
    ds_read_b64_tr_b16 v[70:71], v12 offset:29696
    v_mfma_f32_16x16x32_bf16 v[120:123], v[72:75], a[88:91], v[120:123]
    buffer_load_dwordx4 a[108:111], v1, s[8:11], s83 offen offset:3072 sc1
    v_mfma_f32_16x16x32_bf16 v[124:127], v[72:75], a[92:95], v[124:127]
    s_waitcnt lgkmcnt(4)
    s_add_u32 s83, s66, 4096
    v_mfma_f32_16x16x32_bf16 v[140:143], v[76:79], a[92:95], v[140:143]
    ds_read_b64_tr_b16 v[72:73], v13 offset:25600
    v_mfma_f32_16x16x32_bf16 v[136:139], v[76:79], a[88:91], v[136:139]
    ds_read_b64_tr_b16 v[74:75], v13 offset:29696
    v_mfma_f32_16x16x32_bf16 v[132:135], v[76:79], a[84:87], v[132:135]
    buffer_load_dwordx4 a[112:115], v1, s[8:11], s83 offen offset:0 sc1
    v_mfma_f32_16x16x32_bf16 v[128:131], v[76:79], a[80:83], v[128:131]
    s_waitcnt lgkmcnt(4)
    v_mfma_f32_16x16x32_bf16 v[144:147], v[64:67], a[80:83], v[144:147]
    ds_read_b64_tr_b16 v[76:77], v14 offset:25600
    v_mfma_f32_16x16x32_bf16 v[148:151], v[64:67], a[84:87], v[148:151]
    ds_read_b64_tr_b16 v[78:79], v14 offset:29696
    v_mfma_f32_16x16x32_bf16 v[152:155], v[64:67], a[88:91], v[152:155]
    buffer_load_dwordx4 a[116:119], v1, s[8:11], s83 offen offset:1024 sc1
    v_mfma_f32_16x16x32_bf16 v[156:159], v[64:67], a[92:95], v[156:159]
    s_waitcnt lgkmcnt(4)
    v_mfma_f32_16x16x32_bf16 v[172:175], v[68:71], a[92:95], v[172:175]
    ds_read_b64_tr_b16 v[64:65], v15 offset:25600
    v_mfma_f32_16x16x32_bf16 v[168:171], v[68:71], a[88:91], v[168:171]
    ds_read_b64_tr_b16 v[66:67], v15 offset:29696
    v_mfma_f32_16x16x32_bf16 v[164:167], v[68:71], a[84:87], v[164:167]
    buffer_load_dwordx4 a[120:123], v1, s[8:11], s83 offen offset:2048 sc1
    v_mfma_f32_16x16x32_bf16 v[160:163], v[68:71], a[80:83], v[160:163]
    s_waitcnt lgkmcnt(4)
    v_mfma_f32_16x16x32_bf16 v[176:179], v[72:75], a[80:83], v[176:179]
    ds_read_b64_tr_b16 v[68:69], v22 offset:9216
    v_mfma_f32_16x16x32_bf16 v[180:183], v[72:75], a[84:87], v[180:183]
    ds_read_b64_tr_b16 v[70:71], v22 offset:9728
    v_mfma_f32_16x16x32_bf16 v[184:187], v[72:75], a[88:91], v[184:187]
    buffer_load_dwordx4 a[124:127], v1, s[8:11], s83 offen offset:3072 sc1
    v_mfma_f32_16x16x32_bf16 v[188:191], v[72:75], a[92:95], v[188:191]
    s_waitcnt lgkmcnt(4)
    s_barrier
    v_mfma_f32_16x16x32_bf16 v[204:207], v[76:79], a[92:95], v[204:207]
    s_add_u32 s83, s72, 8192
    ds_read_b64_tr_b16 v[72:73], v12 offset:32768
    v_mfma_f32_16x16x32_bf16 v[200:203], v[76:79], a[88:91], v[200:203]
    ds_read_b64_tr_b16 v[74:75], v12 offset:36864
    v_mfma_f32_16x16x32_bf16 v[196:199], v[76:79], a[84:87], v[196:199]
    buffer_load_dwordx4 a[128:131], v1, s[8:11], s83 offen offset:0 sc1
    v_mfma_f32_16x16x32_bf16 v[192:195], v[76:79], a[80:83], v[192:195]
    s_waitcnt lgkmcnt(4)
    v_mfma_f32_16x16x32_bf16 v[208:211], v[64:67], a[80:83], v[208:211]
    ds_read_b64_tr_b16 v[76:77], v13 offset:32768
    v_mfma_f32_16x16x32_bf16 v[212:215], v[64:67], a[84:87], v[212:215]
    ds_read_b64_tr_b16 v[78:79], v13 offset:36864
    v_mfma_f32_16x16x32_bf16 v[216:219], v[64:67], a[88:91], v[216:219]
    buffer_load_dwordx4 a[132:135], v1, s[8:11], s83 offen offset:1024 sc1
    v_mfma_f32_16x16x32_bf16 v[220:223], v[64:67], a[92:95], v[220:223]
    s_waitcnt lgkmcnt(4)
    v_mfma_f32_16x16x32_bf16 v[236:239], v[68:71], a[92:95], v[236:239]
    ds_read_b64_tr_b16 v[64:65], v14 offset:32768
    v_mfma_f32_16x16x32_bf16 v[232:235], v[68:71], a[88:91], v[232:235]
    ds_read_b64_tr_b16 v[66:67], v14 offset:36864
    v_mfma_f32_16x16x32_bf16 v[228:231], v[68:71], a[84:87], v[228:231]
    buffer_load_dwordx4 a[136:139], v1, s[8:11], s83 offen offset:2048 sc1
    v_mfma_f32_16x16x32_bf16 v[224:227], v[68:71], a[80:83], v[224:227]
    s_waitcnt vmcnt(7)
    s_waitcnt lgkmcnt(4)
    v_mfma_f32_16x16x32_bf16 v[96:99], v[72:75], a[96:99], v[96:99]
    ds_read_b64_tr_b16 v[68:69], v15 offset:32768
    v_mfma_f32_16x16x32_bf16 v[100:103], v[72:75], a[100:103], v[100:103]
    ds_read_b64_tr_b16 v[70:71], v15 offset:36864
    v_mfma_f32_16x16x32_bf16 v[104:107], v[72:75], a[104:107], v[104:107]
    buffer_load_dwordx4 a[140:143], v1, s[8:11], s83 offen offset:3072 sc1
    v_mfma_f32_16x16x32_bf16 v[108:111], v[72:75], a[108:111], v[108:111]
    s_waitcnt lgkmcnt(4)
    s_add_u32 s65, s49, 73728
    v_mfma_f32_16x16x32_bf16 v[124:127], v[76:79], a[108:111], v[124:127]
    s_add_u32 m0, s64, 32768
    ds_read_b64_tr_b16 v[72:73], v12 offset:33792
    v_mfma_f32_16x16x32_bf16 v[120:123], v[76:79], a[104:107], v[120:123]
    ds_read_b64_tr_b16 v[74:75], v12 offset:37888
    v_mfma_f32_16x16x32_bf16 v[116:119], v[76:79], a[100:103], v[116:119]
    buffer_load_dwordx4 v25, s[28:31], s65 offen lds
    v_mfma_f32_16x16x32_bf16 v[112:115], v[76:79], a[96:99], v[112:115]
    s_waitcnt lgkmcnt(4)
    v_mfma_f32_16x16x32_bf16 v[128:131], v[64:67], a[96:99], v[128:131]
    ds_read_b64_tr_b16 v[76:77], v13 offset:33792
    v_mfma_f32_16x16x32_bf16 v[132:135], v[64:67], a[100:103], v[132:135]
    ds_read_b64_tr_b16 v[78:79], v13 offset:37888
    v_mfma_f32_16x16x32_bf16 v[136:139], v[64:67], a[104:107], v[136:139]
    buffer_load_dwordx4 v25, s[32:35], s65 offen offset:1024 lds
    v_mfma_f32_16x16x32_bf16 v[140:143], v[64:67], a[108:111], v[140:143]
    s_waitcnt lgkmcnt(4)
    s_add_u32 s65, s49, 110592
    v_mfma_f32_16x16x32_bf16 v[156:159], v[68:71], a[108:111], v[156:159]
    s_add_u32 m0, s64, 40960
    ds_read_b64_tr_b16 v[64:65], v14 offset:33792
    v_mfma_f32_16x16x32_bf16 v[152:155], v[68:71], a[104:107], v[152:155]
    ds_read_b64_tr_b16 v[66:67], v14 offset:37888
    v_mfma_f32_16x16x32_bf16 v[148:151], v[68:71], a[100:103], v[148:151]
    buffer_load_dwordx4 v25, s[28:31], s65 offen lds
    v_mfma_f32_16x16x32_bf16 v[144:147], v[68:71], a[96:99], v[144:147]
    s_waitcnt lgkmcnt(4)
    v_mfma_f32_16x16x32_bf16 v[160:163], v[72:75], a[96:99], v[160:163]
    ds_read_b64_tr_b16 v[68:69], v15 offset:33792
    v_mfma_f32_16x16x32_bf16 v[164:167], v[72:75], a[100:103], v[164:167]
    ds_read_b64_tr_b16 v[70:71], v15 offset:37888
    v_mfma_f32_16x16x32_bf16 v[168:171], v[72:75], a[104:107], v[168:171]
    buffer_load_dwordx4 v25, s[32:35], s65 offen offset:1024 lds
    v_mfma_f32_16x16x32_bf16 v[172:175], v[72:75], a[108:111], v[172:175]
    s_waitcnt lgkmcnt(4)
    s_add_u32 s65, s80, 589824
    v_mfma_f32_16x16x32_bf16 v[188:191], v[76:79], a[108:111], v[188:191]
    s_add_u32 m0, s64, 49152
    ds_read_b64_tr_b16 v[72:73], v22 offset:12288
    v_mfma_f32_16x16x32_bf16 v[184:187], v[76:79], a[104:107], v[184:187]
    ds_read_b64_tr_b16 v[74:75], v22 offset:12800
    v_mfma_f32_16x16x32_bf16 v[180:183], v[76:79], a[100:103], v[180:183]
    buffer_load_dwordx4 v25, s[28:31], s65 offen lds
    v_mfma_f32_16x16x32_bf16 v[176:179], v[76:79], a[96:99], v[176:179]
    s_waitcnt lgkmcnt(4)
    v_mfma_f32_16x16x32_bf16 v[192:195], v[64:67], a[96:99], v[192:195]
    ds_read_b64_tr_b16 v[76:77], v12 offset:40960
    v_mfma_f32_16x16x32_bf16 v[196:199], v[64:67], a[100:103], v[196:199]
    ds_read_b64_tr_b16 v[78:79], v12 offset:45056
    v_mfma_f32_16x16x32_bf16 v[200:203], v[64:67], a[104:107], v[200:203]
    buffer_load_dwordx4 v25, s[32:35], s65 offen offset:1024 lds
    v_mfma_f32_16x16x32_bf16 v[204:207], v[64:67], a[108:111], v[204:207]
    s_waitcnt lgkmcnt(4)
    v_mfma_f32_16x16x32_bf16 v[220:223], v[68:71], a[108:111], v[220:223]
    ds_read_b64_tr_b16 v[64:65], v13 offset:40960
    v_mov_b32 v240, s40
    v_mfma_f32_16x16x32_bf16 v[216:219], v[68:71], a[104:107], v[216:219]
    ds_read_b64_tr_b16 v[66:67], v13 offset:45056
    v_mfma_f32_16x16x32_bf16 v[212:215], v[68:71], a[100:103], v[212:215]
    buffer_store_dword v240, v5, s[8:11], s84 offen offset:32 sc1
    v_mfma_f32_16x16x32_bf16 v[208:211], v[68:71], a[96:99], v[208:211]
    s_waitcnt lgkmcnt(4)
    v_mov_b32 v240, s40
    v_mfma_f32_16x16x32_bf16 v[224:227], v[72:75], a[96:99], v[224:227]
    ds_read_b64_tr_b16 v[68:69], v14 offset:40960
    v_mfma_f32_16x16x32_bf16 v[228:231], v[72:75], a[100:103], v[228:231]
    ds_read_b64_tr_b16 v[70:71], v14 offset:45056
    v_mfma_f32_16x16x32_bf16 v[232:235], v[72:75], a[104:107], v[232:235]
    buffer_store_dword v240, v5, s[8:11], s85 offen offset:0 sc1
    v_mfma_f32_16x16x32_bf16 v[236:239], v[72:75], a[108:111], v[236:239]
    s_waitcnt vmcnt(12)
    s_waitcnt lgkmcnt(4)
    v_mfma_f32_16x16x32_bf16 v[108:111], v[76:79], a[124:127], v[108:111]
    s_add_u32 s83, s72, 12288
    ds_read_b64_tr_b16 v[72:73], v15 offset:40960
    v_mfma_f32_16x16x32_bf16 v[104:107], v[76:79], a[120:123], v[104:107]
    ds_read_b64_tr_b16 v[74:75], v15 offset:45056
    v_mfma_f32_16x16x32_bf16 v[100:103], v[76:79], a[116:119], v[100:103]
    buffer_load_dwordx4 a[144:147], v1, s[8:11], s83 offen offset:0 sc1
    v_mfma_f32_16x16x32_bf16 v[96:99], v[76:79], a[112:115], v[96:99]
    s_waitcnt lgkmcnt(4)
    v_mfma_f32_16x16x32_bf16 v[112:115], v[64:67], a[112:115], v[112:115]
    ds_read_b64_tr_b16 v[76:77], v12 offset:41984
    v_mfma_f32_16x16x32_bf16 v[116:119], v[64:67], a[116:119], v[116:119]
    ds_read_b64_tr_b16 v[78:79], v12 offset:46080
    v_mfma_f32_16x16x32_bf16 v[120:123], v[64:67], a[120:123], v[120:123]
    buffer_load_dwordx4 a[148:151], v1, s[8:11], s83 offen offset:1024 sc1
    v_mfma_f32_16x16x32_bf16 v[124:127], v[64:67], a[124:127], v[124:127]
    s_waitcnt lgkmcnt(4)
    v_mfma_f32_16x16x32_bf16 v[140:143], v[68:71], a[124:127], v[140:143]
    ds_read_b64_tr_b16 v[64:65], v13 offset:41984
    v_mfma_f32_16x16x32_bf16 v[136:139], v[68:71], a[120:123], v[136:139]
    ds_read_b64_tr_b16 v[66:67], v13 offset:46080
    v_mfma_f32_16x16x32_bf16 v[132:135], v[68:71], a[116:119], v[132:135]
    buffer_load_dwordx4 a[152:155], v1, s[8:11], s83 offen offset:2048 sc1
    v_mfma_f32_16x16x32_bf16 v[128:131], v[68:71], a[112:115], v[128:131]
    s_waitcnt lgkmcnt(4)
    v_mfma_f32_16x16x32_bf16 v[144:147], v[72:75], a[112:115], v[144:147]
    ds_read_b64_tr_b16 v[68:69], v14 offset:41984
    v_mfma_f32_16x16x32_bf16 v[148:151], v[72:75], a[116:119], v[148:151]
    ds_read_b64_tr_b16 v[70:71], v14 offset:46080
    v_mfma_f32_16x16x32_bf16 v[152:155], v[72:75], a[120:123], v[152:155]
    buffer_load_dwordx4 a[156:159], v1, s[8:11], s83 offen offset:3072 sc1
    v_mfma_f32_16x16x32_bf16 v[156:159], v[72:75], a[124:127], v[156:159]
    s_waitcnt lgkmcnt(4)
    s_add_u32 s83, s73, 8192
    v_mfma_f32_16x16x32_bf16 v[172:175], v[76:79], a[124:127], v[172:175]
    ds_read_b64_tr_b16 v[72:73], v15 offset:41984
    v_mfma_f32_16x16x32_bf16 v[168:171], v[76:79], a[120:123], v[168:171]
    ds_read_b64_tr_b16 v[74:75], v15 offset:46080
    v_mfma_f32_16x16x32_bf16 v[164:167], v[76:79], a[116:119], v[164:167]
    buffer_load_dwordx4 a[160:163], v1, s[8:11], s83 offen offset:0 sc1
    v_mfma_f32_16x16x32_bf16 v[160:163], v[76:79], a[112:115], v[160:163]
    s_waitcnt lgkmcnt(4)
    v_mfma_f32_16x16x32_bf16 v[176:179], v[64:67], a[112:115], v[176:179]
    ds_read_b64_tr_b16 v[76:77], v22 offset:13312
    v_mfma_f32_16x16x32_bf16 v[180:183], v[64:67], a[116:119], v[180:183]
    ds_read_b64_tr_b16 v[78:79], v22 offset:13824
    v_mfma_f32_16x16x32_bf16 v[184:187], v[64:67], a[120:123], v[184:187]
    v_mfma_f32_16x16x32_bf16 v[188:191], v[64:67], a[124:127], v[188:191]
    s_waitcnt lgkmcnt(4)
    buffer_load_dwordx4 a[164:167], v1, s[8:11], s83 offen offset:1024 sc1
    v_mfma_f32_16x16x32_bf16 v[204:207], v[68:71], a[124:127], v[204:207]
    ds_read_b64_tr_b16 v[64:65], v12 offset:49152
    v_mfma_f32_16x16x32_bf16 v[200:203], v[68:71], a[120:123], v[200:203]
    ds_read_b64_tr_b16 v[66:67], v12 offset:53248
    v_mfma_f32_16x16x32_bf16 v[196:199], v[68:71], a[116:119], v[196:199]
    v_mfma_f32_16x16x32_bf16 v[192:195], v[68:71], a[112:115], v[192:195]
    s_waitcnt lgkmcnt(4)
    v_mfma_f32_16x16x32_bf16 v[208:211], v[72:75], a[112:115], v[208:211]
    ds_read_b64_tr_b16 v[68:69], v13 offset:49152
    v_mfma_f32_16x16x32_bf16 v[212:215], v[72:75], a[116:119], v[212:215]
    ds_read_b64_tr_b16 v[70:71], v13 offset:53248
    v_mfma_f32_16x16x32_bf16 v[216:219], v[72:75], a[120:123], v[216:219]
    v_mfma_f32_16x16x32_bf16 v[220:223], v[72:75], a[124:127], v[220:223]
    s_waitcnt lgkmcnt(4)
    buffer_load_dwordx4 a[168:171], v1, s[8:11], s83 offen offset:2048 sc1
    v_mfma_f32_16x16x32_bf16 v[236:239], v[76:79], a[124:127], v[236:239]
    ds_read_b64_tr_b16 v[72:73], v14 offset:49152
    v_mfma_f32_16x16x32_bf16 v[232:235], v[76:79], a[120:123], v[232:235]
    ds_read_b64_tr_b16 v[74:75], v14 offset:53248
    v_mfma_f32_16x16x32_bf16 v[228:231], v[76:79], a[116:119], v[228:231]
    v_mfma_f32_16x16x32_bf16 v[224:227], v[76:79], a[112:115], v[224:227]
    s_waitcnt vmcnt(15)
    s_waitcnt lgkmcnt(4)
    v_mfma_f32_16x16x32_bf16 v[96:99], v[64:67], a[128:131], v[96:99]
    ds_read_b64_tr_b16 v[76:77], v15 offset:49152
    v_mfma_f32_16x16x32_bf16 v[100:103], v[64:67], a[132:135], v[100:103]
    ds_read_b64_tr_b16 v[78:79], v15 offset:53248
    v_mfma_f32_16x16x32_bf16 v[104:107], v[64:67], a[136:139], v[104:107]
    buffer_load_dwordx4 a[172:175], v1, s[8:11], s83 offen offset:3072 sc1
    v_mfma_f32_16x16x32_bf16 v[108:111], v[64:67], a[140:143], v[108:111]
    s_waitcnt lgkmcnt(4)
    s_add_u32 s83, s73, 12288
    v_mfma_f32_16x16x32_bf16 v[124:127], v[68:71], a[140:143], v[124:127]
    ds_read_b64_tr_b16 v[64:65], v12 offset:50176
    v_mfma_f32_16x16x32_bf16 v[120:123], v[68:71], a[136:139], v[120:123]
    ds_read_b64_tr_b16 v[66:67], v12 offset:54272
    v_mfma_f32_16x16x32_bf16 v[116:119], v[68:71], a[132:135], v[116:119]
    buffer_load_dwordx4 a[176:179], v1, s[8:11], s83 offen offset:0 sc1
    v_mfma_f32_16x16x32_bf16 v[112:115], v[68:71], a[128:131], v[112:115]
    s_waitcnt lgkmcnt(4)
    v_mfma_f32_16x16x32_bf16 v[128:131], v[72:75], a[128:131], v[128:131]
    ds_read_b64_tr_b16 v[68:69], v13 offset:50176
    v_mfma_f32_16x16x32_bf16 v[132:135], v[72:75], a[132:135], v[132:135]
    ds_read_b64_tr_b16 v[70:71], v13 offset:54272
    v_mfma_f32_16x16x32_bf16 v[136:139], v[72:75], a[136:139], v[136:139]
    v_mfma_f32_16x16x32_bf16 v[140:143], v[72:75], a[140:143], v[140:143]
    s_waitcnt lgkmcnt(4)
    buffer_load_dwordx4 a[180:183], v1, s[8:11], s83 offen offset:1024 sc1
    v_mfma_f32_16x16x32_bf16 v[156:159], v[76:79], a[140:143], v[156:159]
    ds_read_b64_tr_b16 v[72:73], v14 offset:50176
    v_mfma_f32_16x16x32_bf16 v[152:155], v[76:79], a[136:139], v[152:155]
    ds_read_b64_tr_b16 v[74:75], v14 offset:54272
    v_mfma_f32_16x16x32_bf16 v[148:151], v[76:79], a[132:135], v[148:151]
    v_mfma_f32_16x16x32_bf16 v[144:147], v[76:79], a[128:131], v[144:147]
    s_waitcnt lgkmcnt(4)
    v_mfma_f32_16x16x32_bf16 v[160:163], v[64:67], a[128:131], v[160:163]
    ds_read_b64_tr_b16 v[76:77], v15 offset:50176
    v_mfma_f32_16x16x32_bf16 v[164:167], v[64:67], a[132:135], v[164:167]
    ds_read_b64_tr_b16 v[78:79], v15 offset:54272
    v_mfma_f32_16x16x32_bf16 v[168:171], v[64:67], a[136:139], v[168:171]
    v_mfma_f32_16x16x32_bf16 v[172:175], v[64:67], a[140:143], v[172:175]
    s_waitcnt lgkmcnt(4)
    buffer_load_dwordx4 a[184:187], v1, s[8:11], s83 offen offset:2048 sc1
    v_mfma_f32_16x16x32_bf16 v[188:191], v[68:71], a[140:143], v[188:191]
    ds_read_b64_tr_b16 v[64:65], v22 offset:2048
    v_mfma_f32_16x16x32_bf16 v[184:187], v[68:71], a[136:139], v[184:187]
    ds_read_b64_tr_b16 v[66:67], v22 offset:2560
    v_mfma_f32_16x16x32_bf16 v[180:183], v[68:71], a[132:135], v[180:183]
    v_mfma_f32_16x16x32_bf16 v[176:179], v[68:71], a[128:131], v[176:179]
    s_waitcnt lgkmcnt(4)
    s_barrier
    v_mfma_f32_16x16x32_bf16 v[192:195], v[72:75], a[128:131], v[192:195]
    ds_read_b64_tr_b16 v[68:69], v12 offset:57344
    v_mfma_f32_16x16x32_bf16 v[196:199], v[72:75], a[132:135], v[196:199]
    ds_read_b64_tr_b16 v[70:71], v12 offset:61440
    v_mfma_f32_16x16x32_bf16 v[200:203], v[72:75], a[136:139], v[200:203]
    buffer_load_dwordx4 a[188:191], v1, s[8:11], s83 offen offset:3072 sc1
    v_mfma_f32_16x16x32_bf16 v[204:207], v[72:75], a[140:143], v[204:207]
    s_waitcnt lgkmcnt(4)
    s_add_u32 s65, s80, 626688
    v_mfma_f32_16x16x32_bf16 v[220:223], v[76:79], a[140:143], v[220:223]
    s_add_u32 m0, s64, 57344
    ds_read_b64_tr_b16 v[72:73], v13 offset:57344
    v_mfma_f32_16x16x32_bf16 v[216:219], v[76:79], a[136:139], v[216:219]
    ds_read_b64_tr_b16 v[74:75], v13 offset:61440
    v_mfma_f32_16x16x32_bf16 v[212:215], v[76:79], a[132:135], v[212:215]
    v_mfma_f32_16x16x32_bf16 v[208:211], v[76:79], a[128:131], v[208:211]
    s_waitcnt lgkmcnt(4)
    v_mfma_f32_16x16x32_bf16 v[224:227], v[64:67], a[128:131], v[224:227]
    ds_read_b64_tr_b16 v[76:77], v14 offset:57344
    v_mfma_f32_16x16x32_bf16 v[228:231], v[64:67], a[132:135], v[228:231]
    ds_read_b64_tr_b16 v[78:79], v14 offset:61440
    v_mfma_f32_16x16x32_bf16 v[232:235], v[64:67], a[136:139], v[232:235]
    buffer_load_dwordx4 v25, s[28:31], s65 offen lds
    v_mfma_f32_16x16x32_bf16 v[236:239], v[64:67], a[140:143], v[236:239]
    s_waitcnt vmcnt(9)
    s_waitcnt lgkmcnt(4)
    v_mfma_f32_16x16x32_bf16 v[108:111], v[68:71], a[156:159], v[108:111]
    ds_read_b64_tr_b16 v[64:65], v15 offset:57344
    v_mfma_f32_16x16x32_bf16 v[104:107], v[68:71], a[152:155], v[104:107]
    ds_read_b64_tr_b16 v[66:67], v15 offset:61440
    v_and_b32 v249, 63, v0
    v_mfma_f32_16x16x32_bf16 v[100:103], v[68:71], a[148:151], v[100:103]
    buffer_load_dwordx4 v25, s[32:35], s65 offen offset:1024 lds
    v_mfma_f32_16x16x32_bf16 v[96:99], v[68:71], a[144:147], v[96:99]
    s_waitcnt lgkmcnt(4)
    v_and_b32 v250, 31, v0
    v_add_u32 v241, 86016, v1
    v_mfma_f32_16x16x32_bf16 v[112:115], v[72:75], a[144:147], v[112:115]
    ds_read_b64_tr_b16 v[68:69], v12 offset:58368
    v_lshlrev_b32 v243, 3, v250
    v_mfma_f32_16x16x32_bf16 v[116:119], v[72:75], a[148:151], v[116:119]
    ds_read_b64_tr_b16 v[70:71], v12 offset:62464
    v_add_u32 v243, 86016, v243
    v_mfma_f32_16x16x32_bf16 v[120:123], v[72:75], a[152:155], v[120:123]
    buffer_load_dword v6, v4, s[8:11], s88 offen sc1
    v_mfma_f32_16x16x32_bf16 v[124:127], v[72:75], a[156:159], v[124:127]
    s_waitcnt lgkmcnt(4)
    s_add_u32 s83, s74, 8192
    v_lshrrev_b32 v251, 5, v249
    v_mfma_f32_16x16x32_bf16 v[140:143], v[76:79], a[156:159], v[140:143]
    ds_read_b64_tr_b16 v[72:73], v13 offset:58368
    v_mul_u32_u24 v251, 304, v251
    v_mfma_f32_16x16x32_bf16 v[136:139], v[76:79], a[152:155], v[136:139]
    ds_read_b64_tr_b16 v[74:75], v13 offset:62464
    v_min_u32 v248, 18, v250
    v_mfma_f32_16x16x32_bf16 v[132:135], v[76:79], a[148:151], v[132:135]
    buffer_load_dwordx4 a[192:195], v1, s[8:11], s83 offen offset:0 sc1
    v_mfma_f32_16x16x32_bf16 v[128:131], v[76:79], a[144:147], v[128:131]
    s_waitcnt lgkmcnt(4)
    v_lshl_add_u32 v248, v248, 4, v251
    v_mov_b32 v251, 1073741824
    v_mfma_f32_16x16x32_bf16 v[144:147], v[64:67], a[144:147], v[144:147]
    ds_read_b64_tr_b16 v[76:77], v14 offset:58368
    v_cmp_gt_u32 s[100:101], 19, v250
    v_mfma_f32_16x16x32_bf16 v[148:151], v[64:67], a[148:151], v[148:151]
    ds_read_b64_tr_b16 v[78:79], v14 offset:62464
    v_cndmask_b32 v245, v251, v248, s[100:101]
    v_mfma_f32_16x16x32_bf16 v[152:155], v[64:67], a[152:155], v[152:155]
L_page8:
    s_cbranch_execz L_page12
    v_cmp_eq_u32 s[100:101], 22, v250
    s_nop 1
    v_cndmask_b32 v248, v245, v248, s[100:101]
    v_mfma_f32_16x16x32_bf16 v[156:159], v[64:67], a[156:159], v[156:159]
    s_waitcnt lgkmcnt(4)
    buffer_load_dwordx4 a[196:199], v1, s[8:11], s83 offen offset:1024 sc1
    v_mfma_f32_16x16x32_bf16 v[172:175], v[68:71], a[156:159], v[172:175]
    ds_read_b64_tr_b16 v[64:65], v15 offset:58368
    v_add_u32 v245, 86016, v248
    v_mfma_f32_16x16x32_bf16 v[168:171], v[68:71], a[152:155], v[168:171]
    ds_read_b64_tr_b16 v[66:67], v15 offset:62464
    v_add_u32 v242, 37888, v241
    v_mfma_f32_16x16x32_bf16 v[164:167], v[68:71], a[148:151], v[164:167]
    v_add_u32 v244, 37888, v243
    v_add_u32 v246, 37888, v245
    v_mfma_f32_16x16x32_bf16 v[160:163], v[68:71], a[144:147], v[160:163]
    s_waitcnt lgkmcnt(4)
    v_cmp_gt_u32 s[100:101], 32, v249
    s_nop 1
    v_cndmask_b32 v247, v251, v4, s[100:101]
    v_mfma_f32_16x16x32_bf16 v[176:179], v[72:75], a[144:147], v[176:179]
    ds_read_b64_tr_b16 v[68:69], v22 offset:3072
    v_mov_b32 v253, 0xdddd
    v_mfma_f32_16x16x32_bf16 v[180:183], v[72:75], a[148:151], v[180:183]
    ds_read_b64_tr_b16 v[70:71], v22 offset:3584
    v_mov_b32 v32, 0
    v_mfma_f32_16x16x32_bf16 v[184:187], v[72:75], a[152:155], v[184:187]
    v_mov_b32 v33, 0
    v_mov_b32 v34, 0
    v_mfma_f32_16x16x32_bf16 v[188:191], v[72:75], a[156:159], v[188:191]
    s_waitcnt lgkmcnt(4)
    buffer_load_dwordx4 a[200:203], v1, s[8:11], s83 offen offset:2048 sc1
    v_mfma_f32_16x16x32_bf16 v[204:207], v[76:79], a[156:159], v[204:207]
    ds_read_b64_tr_b16 v[72:73], v8 offset:0
    v_mov_b32 v35, 0
    v_mfma_f32_16x16x32_bf16 v[200:203], v[76:79], a[152:155], v[200:203]
    ds_read_b64_tr_b16 v[74:75], v8 offset:4096
    v_mov_b32 v36, 0
    v_mfma_f32_16x16x32_bf16 v[196:199], v[76:79], a[148:151], v[196:199]
    v_mov_b32 v37, 0
    v_mov_b32 v38, 0
    v_mfma_f32_16x16x32_bf16 v[192:195], v[76:79], a[144:147], v[192:195]
    s_waitcnt lgkmcnt(4)
    v_mov_b32 v39, 0
    v_mov_b32 v40, 0
    v_mfma_f32_16x16x32_bf16 v[208:211], v[64:67], a[144:147], v[208:211]
    ds_read_b64_tr_b16 v[76:77], v9 offset:0
    v_mov_b32 v41, 0
    v_mfma_f32_16x16x32_bf16 v[212:215], v[64:67], a[148:151], v[212:215]
    ds_read_b64_tr_b16 v[78:79], v9 offset:4096
    v_mov_b32 v42, 0
    v_mfma_f32_16x16x32_bf16 v[216:219], v[64:67], a[152:155], v[216:219]
    v_mov_b32 v43, 0
    v_mov_b32 v44, 0
    v_mfma_f32_16x16x32_bf16 v[220:223], v[64:67], a[156:159], v[220:223]
    s_waitcnt lgkmcnt(4)
    buffer_load_dwordx4 a[204:207], v1, s[8:11], s83 offen offset:3072 sc1
    v_mfma_f32_16x16x32_bf16 v[236:239], v[68:71], a[156:159], v[236:239]
    ds_read_b64_tr_b16 v[64:65], v10 offset:0
    v_mov_b32 v45, 0
    v_mfma_f32_16x16x32_bf16 v[232:235], v[68:71], a[152:155], v[232:235]
    ds_read_b64_tr_b16 v[66:67], v10 offset:4096
    v_mov_b32 v46, 0
    v_mfma_f32_16x16x32_bf16 v[228:231], v[68:71], a[148:151], v[228:231]
    v_mov_b32 v47, 0
    v_mov_b32 v48, 0
    v_mfma_f32_16x16x32_bf16 v[224:227], v[68:71], a[144:147], v[224:227]
    s_waitcnt vmcnt(11)
    s_waitcnt lgkmcnt(4)
    v_mov_b32 v49, 0
    v_mfma_f32_16x16x32_bf16 v[96:99], v[72:75], a[160:163], v[96:99]
    ds_read_b64_tr_b16 v[68:69], v11 offset:0
    v_mov_b32 v50, 0
    v_mfma_f32_16x16x32_bf16 v[100:103], v[72:75], a[164:167], v[100:103]
    ds_read_b64_tr_b16 v[70:71], v11 offset:4096
    s_waitcnt vmcnt(4)
    v_cmp_eq_u32 vcc, s40, v6
    s_nop 0
    s_and_b32 vcc_lo, vcc_lo, 3840
    s_cmp_eq_u32 vcc_lo, 3840
    s_cbranch_scc0 L_spin4
L_back4:
    v_mfma_f32_16x16x32_bf16 v[104:107], v[72:75], a[168:171], v[104:107]
    s_add_u32 s83, s74, 12288
    buffer_load_dwordx4 a[208:211], v1, s[8:11], s83 offen offset:0 sc1
    v_mfma_f32_16x16x32_bf16 v[108:111], v[72:75], a[172:175], v[108:111]
    s_waitcnt lgkmcnt(4)
    v_mov_b32 v51, 0
    v_mov_b32 v52, 0
    v_mfma_f32_16x16x32_bf16 v[124:127], v[76:79], a[172:175], v[124:127]
    ds_read_b64_tr_b16 v[72:73], v8 offset:1024
    v_mov_b32 v53, 0
    v_mfma_f32_16x16x32_bf16 v[120:123], v[76:79], a[168:171], v[120:123]
    ds_read_b64_tr_b16 v[74:75], v8 offset:5120
    v_mov_b32 v54, 0
    v_mfma_f32_16x16x32_bf16 v[116:119], v[76:79], a[164:167], v[116:119]
    buffer_load_dwordx4 a[212:215], v1, s[8:11], s83 offen offset:1024 sc1
    v_mfma_f32_16x16x32_bf16 v[112:115], v[76:79], a[160:163], v[112:115]
    s_waitcnt lgkmcnt(4)
    v_mov_b32 v55, 0
    v_mov_b32 v56, 0
    v_mfma_f32_16x16x32_bf16 v[128:131], v[64:67], a[160:163], v[128:131]
    ds_read_b64_tr_b16 v[76:77], v9 offset:1024
    v_mov_b32 v57, 0
    v_mfma_f32_16x16x32_bf16 v[132:135], v[64:67], a[164:167], v[132:135]
    ds_read_b64_tr_b16 v[78:79], v9 offset:5120
    v_mov_b32 v58, 0
    v_mfma_f32_16x16x32_bf16 v[136:139], v[64:67], a[168:171], v[136:139]
    buffer_load_dwordx4 a[216:219], v1, s[8:11], s83 offen offset:2048 sc1
    v_mfma_f32_16x16x32_bf16 v[140:143], v[64:67], a[172:175], v[140:143]
    s_waitcnt lgkmcnt(4)
    v_mov_b32 v59, 0
    v_mov_b32 v60, 0
    v_mfma_f32_16x16x32_bf16 v[156:159], v[68:71], a[172:175], v[156:159]
    ds_read_b64_tr_b16 v[64:65], v10 offset:1024
    v_mov_b32 v61, 0
    v_mfma_f32_16x16x32_bf16 v[152:155], v[68:71], a[168:171], v[152:155]
    ds_read_b64_tr_b16 v[66:67], v10 offset:5120
    v_mov_b32 v62, 0
    v_mfma_f32_16x16x32_bf16 v[148:151], v[68:71], a[164:167], v[148:151]
    buffer_load_dwordx4 a[220:223], v1, s[8:11], s83 offen offset:3072 sc1
    v_mfma_f32_16x16x32_bf16 v[144:147], v[68:71], a[160:163], v[144:147]
    s_waitcnt lgkmcnt(4)
    s_add_u32 s83, s82, 65536
    v_mov_b32 v63, 0
    v_mfma_f32_16x16x32_bf16 v[160:163], v[72:75], a[160:163], v[160:163]
    ds_read_b64_tr_b16 v[68:69], v11 offset:1024
    s_mov_b32 s20, s52
    v_mfma_f32_16x16x32_bf16 v[164:167], v[72:75], a[164:167], v[164:167]
    ds_read_b64_tr_b16 v[70:71], v11 offset:5120
    s_mov_b32 s21, s53
    v_mfma_f32_16x16x32_bf16 v[168:171], v[72:75], a[168:171], v[168:171]
    buffer_load_dwordx2 a[0:1], v2, s[8:11], s83 offen offset:0 sc1
    v_mfma_f32_16x16x32_bf16 v[172:175], v[72:75], a[172:175], v[172:175]
    s_waitcnt lgkmcnt(4)
    s_mov_b32 s22, 663552
    s_mov_b32 s23, 0x20000
    v_mfma_f32_16x16x32_bf16 v[188:191], v[76:79], a[172:175], v[188:191]
    ds_read_b64_tr_b16 v[72:73], v22 offset:6144
    s_mov_b32 s24, s62
    v_mfma_f32_16x16x32_bf16 v[184:187], v[76:79], a[168:171], v[184:187]
    ds_read_b64_tr_b16 v[74:75], v22 offset:6656
    s_mov_b32 s25, s63
    v_mfma_f32_16x16x32_bf16 v[180:183], v[76:79], a[164:167], v[180:183]
    buffer_load_dwordx2 a[2:3], v2, s[8:11], s83 offen offset:512 sc1
    v_mfma_f32_16x16x32_bf16 v[176:179], v[76:79], a[160:163], v[176:179]
    s_waitcnt lgkmcnt(4)
    s_mov_b32 s26, 2359296
    s_mov_b32 s27, 0x20000
    v_mfma_f32_16x16x32_bf16 v[192:195], v[64:67], a[160:163], v[192:195]
    ds_read_b64_tr_b16 v[76:77], v8 offset:8192
    v_lshrrev_b32 v249, 3, v0
    v_mfma_f32_16x16x32_bf16 v[196:199], v[64:67], a[164:167], v[196:199]
    ds_read_b64_tr_b16 v[78:79], v8 offset:12288
    v_bfe_u32 v251, v249, 3, 1
    v_mfma_f32_16x16x32_bf16 v[200:203], v[64:67], a[168:171], v[200:203]
    buffer_load_dwordx2 a[4:5], v2, s[8:11], s83 offen offset:1024 sc1
    v_mfma_f32_16x16x32_bf16 v[204:207], v[64:67], a[172:175], v[204:207]
    s_waitcnt lgkmcnt(4)
    v_mul_u32_u24 v16, 18, v251
    v_lshrrev_b32 v251, 4, v249
    v_mfma_f32_16x16x32_bf16 v[220:223], v[68:71], a[172:175], v[220:223]
    ds_read_b64_tr_b16 v[64:65], v9 offset:8192
    v_lshl_add_u32 v16, v251, 3, v16
    v_mfma_f32_16x16x32_bf16 v[216:219], v[68:71], a[168:171], v[216:219]
    ds_read_b64_tr_b16 v[66:67], v9 offset:12288
    v_and_b32 v252, 7, v249
    v_mfma_f32_16x16x32_bf16 v[212:215], v[68:71], a[164:167], v[212:215]
    buffer_load_dwordx2 a[6:7], v2, s[8:11], s83 offen offset:1536 sc1
    v_mfma_f32_16x16x32_bf16 v[208:211], v[68:71], a[160:163], v[208:211]
    s_waitcnt lgkmcnt(4)
    v_add_u32 v16, v16, v252
    v_bfe_u32 v252, v249, 2, 2
    v_mfma_f32_16x16x32_bf16 v[224:227], v[72:75], a[160:163], v[224:227]
    ds_read_b64_tr_b16 v[68:69], v10 offset:8192
    v_lshlrev_b32 v252, 2, v252
    v_mfma_f32_16x16x32_bf16 v[228:231], v[72:75], a[164:167], v[228:231]
    ds_read_b64_tr_b16 v[70:71], v10 offset:12288
    v_lshl_add_u32 v252, v251, 1, v252
    v_mfma_f32_16x16x32_bf16 v[232:235], v[72:75], a[168:171], v[232:235]
    buffer_load_dwordx2 a[8:9], v2, s[8:11], s83 offen offset:2048 sc1
    v_mfma_f32_16x16x32_bf16 v[236:239], v[72:75], a[172:175], v[236:239]
    s_waitcnt lgkmcnt(4)
    v_bfe_u32 v251, v249, 1, 1
    v_add_u32 v252, v252, v251
    v_mfma_f32_16x16x32_bf16 v[108:111], v[76:79], a[188:191], v[108:111]
    ds_read_b64_tr_b16 v[72:73], v11 offset:8192
    v_mul_u32_u24 v17, 18, v252
    v_mfma_f32_16x16x32_bf16 v[104:107], v[76:79], a[184:187], v[104:107]
    ds_read_b64_tr_b16 v[74:75], v11 offset:12288
    v_and_b32 v251, 1, v249
    v_mfma_f32_16x16x32_bf16 v[100:103], v[76:79], a[180:183], v[100:103]
    buffer_load_dwordx2 a[10:11], v2, s[8:11], s83 offen offset:2560 sc1
    v_mfma_f32_16x16x32_bf16 v[96:99], v[76:79], a[176:179], v[96:99]
    s_waitcnt lgkmcnt(4)
    v_add3_u32 v17, v17, v251, 16
    v_and_b32 v251, 6, v249
    v_mfma_f32_16x16x32_bf16 v[112:115], v[64:67], a[176:179], v[112:115]
    ds_read_b64_tr_b16 v[76:77], v8 offset:9216
    v_and_b32 v252, 7, v0
    v_mfma_f32_16x16x32_bf16 v[116:119], v[64:67], a[180:183], v[116:119]
    ds_read_b64_tr_b16 v[78:79], v8 offset:13312
    v_xor_b32 v250, v251, v252
    v_mfma_f32_16x16x32_bf16 v[120:123], v[64:67], a[184:187], v[120:123]
    buffer_load_dwordx2 a[12:13], v2, s[8:11], s83 offen offset:3072 sc1
    v_mfma_f32_16x16x32_bf16 v[124:127], v[64:67], a[188:191], v[124:127]
    s_waitcnt lgkmcnt(4)
    v_lshlrev_b32 v250, 4, v250
    v_mul_u32_u24 v16, 1152, v16
    v_mfma_f32_16x16x32_bf16 v[140:143], v[68:71], a[188:191], v[140:143]
    ds_read_b64_tr_b16 v[64:65], v9 offset:9216
    v_add_u32 v16, v16, v250
    v_mfma_f32_16x16x32_bf16 v[136:139], v[68:71], a[184:187], v[136:139]
    ds_read_b64_tr_b16 v[66:67], v9 offset:13312
    v_mul_u32_u24 v17, 1152, v17
    v_mfma_f32_16x16x32_bf16 v[132:135], v[68:71], a[180:183], v[132:135]
    buffer_load_dwordx2 a[14:15], v2, s[8:11], s83 offen offset:3584 sc1
    v_mfma_f32_16x16x32_bf16 v[128:131], v[68:71], a[176:179], v[128:131]
    s_waitcnt lgkmcnt(4)
    s_add_u32 s83, s82, 69632
    v_add_u32 v17, v17, v250
    v_mfma_f32_16x16x32_bf16 v[144:147], v[72:75], a[176:179], v[144:147]
    ds_read_b64_tr_b16 v[68:69], v10 offset:9216
    s_lshl_b32 s100, s3, 3
    v_mfma_f32_16x16x32_bf16 v[148:151], v[72:75], a[180:183], v[148:151]
    ds_read_b64_tr_b16 v[70:71], v10 offset:13312
    v_and_b32 v249, 7, v0
    v_mfma_f32_16x16x32_bf16 v[152:155], v[72:75], a[184:187], v[152:155]
    buffer_load_dwordx2 a[16:17], v2, s[8:11], s83 offen offset:0 sc1
    v_mfma_f32_16x16x32_bf16 v[156:159], v[72:75], a[188:191], v[156:159]
    s_waitcnt lgkmcnt(4)
    v_add_u32 v249, s100, v249
    v_bfe_u32 v251, v249, 3, 1
    v_mfma_f32_16x16x32_bf16 v[172:175], v[76:79], a[188:191], v[172:175]
    ds_read_b64_tr_b16 v[72:73], v11 offset:9216
    v_mul_u32_u24 v18, 18, v251
    v_mfma_f32_16x16x32_bf16 v[168:171], v[76:79], a[184:187], v[168:171]
    ds_read_b64_tr_b16 v[74:75], v11 offset:13312
    v_lshrrev_b32 v251, 4, v249
    v_mfma_f32_16x16x32_bf16 v[164:167], v[76:79], a[180:183], v[164:167]
    buffer_load_dwordx2 a[18:19], v2, s[8:11], s83 offen offset:512 sc1
    v_mfma_f32_16x16x32_bf16 v[160:163], v[76:79], a[176:179], v[160:163]
    s_waitcnt lgkmcnt(4)
    v_lshl_add_u32 v18, v251, 3, v18
    v_and_b32 v252, 7, v249
    v_mfma_f32_16x16x32_bf16 v[176:179], v[64:67], a[176:179], v[176:179]
    ds_read_b64_tr_b16 v[76:77], v22 offset:7168
    v_add_u32 v18, v18, v252
    v_mfma_f32_16x16x32_bf16 v[180:183], v[64:67], a[180:183], v[180:183]
    ds_read_b64_tr_b16 v[78:79], v22 offset:7680
    v_bfe_u32 v252, v249, 2, 2
    v_mfma_f32_16x16x32_bf16 v[184:187], v[64:67], a[184:187], v[184:187]
    buffer_load_dwordx2 a[20:21], v2, s[8:11], s83 offen offset:1024 sc1
    v_mfma_f32_16x16x32_bf16 v[188:191], v[64:67], a[188:191], v[188:191]
    s_waitcnt lgkmcnt(4)
    s_barrier
    v_lshlrev_b32 v252, 2, v252
    v_mfma_f32_16x16x32_bf16 v[204:207], v[68:71], a[188:191], v[204:207]
    ds_read_b64_tr_b16 v[64:65], v8 offset:16384
    v_lshl_add_u32 v252, v251, 1, v252
    v_mfma_f32_16x16x32_bf16 v[200:203], v[68:71], a[184:187], v[200:203]
    ds_read_b64_tr_b16 v[66:67], v8 offset:20480
    v_bfe_u32 v251, v249, 1, 1
    v_mfma_f32_16x16x32_bf16 v[196:199], v[68:71], a[180:183], v[196:199]
    buffer_load_dwordx2 a[22:23], v2, s[8:11], s83 offen offset:1536 sc1
    v_mfma_f32_16x16x32_bf16 v[192:195], v[68:71], a[176:179], v[192:195]
    s_waitcnt lgkmcnt(4)
    v_add_u32 v252, v252, v251
    v_mul_u32_u24 v20, 18, v252
    v_mfma_f32_16x16x32_bf16 v[208:211], v[72:75], a[176:179], v[208:211]
    ds_read_b64_tr_b16 v[68:69], v9 offset:16384
    v_and_b32 v251, 1, v249
    v_mfma_f32_16x16x32_bf16 v[212:215], v[72:75], a[180:183], v[212:215]
    ds_read_b64_tr_b16 v[70:71], v9 offset:20480
    v_add3_u32 v20, v20, v251, 16
    v_mfma_f32_16x16x32_bf16 v[216:219], v[72:75], a[184:187], v[216:219]
    buffer_load_dwordx2 a[24:25], v2, s[8:11], s83 offen offset:2048 sc1
    v_mfma_f32_16x16x32_bf16 v[220:223], v[72:75], a[188:191], v[220:223]
    s_waitcnt lgkmcnt(4)
    v_bfe_u32 v250, v0, 3, 3
    v_mul_u32_u24 v251, 288, v250
    v_mfma_f32_16x16x32_bf16 v[236:239], v[76:79], a[188:191], v[236:239]
    ds_read_b64_tr_b16 v[72:73], v10 offset:16384
    v_add_u32 v20, v20, v251
    v_mfma_f32_16x16x32_bf16 v[232:235], v[76:79], a[184:187], v[232:235]
    ds_read_b64_tr_b16 v[74:75], v10 offset:20480
    v_mul_u32_u24 v20, 1152, v20
    v_mfma_f32_16x16x32_bf16 v[228:231], v[76:79], a[180:183], v[228:231]
    buffer_load_dwordx2 a[26:27], v2, s[8:11], s83 offen offset:2560 sc1
    v_mfma_f32_16x16x32_bf16 v[224:227], v[76:79], a[176:179], v[224:227]
    s_waitcnt vmcnt(18)
    s_waitcnt lgkmcnt(4)
    s_lshl_b32 s100, s4, 1
    v_mfma_f32_16x16x32_bf16 v[96:99], v[64:67], a[192:195], v[96:99]
    ds_read_b64_tr_b16 v[76:77], v11 offset:16384
    v_add_u32 v250, s100, v250
    v_mfma_f32_16x16x32_bf16 v[100:103], v[64:67], a[196:199], v[100:103]
    ds_read_b64_tr_b16 v[78:79], v11 offset:20480
    v_add_u32 v251, 8, v250
    v_mfma_f32_16x16x32_bf16 v[104:107], v[64:67], a[200:203], v[104:107]
    buffer_load_dwordx2 a[28:29], v2, s[8:11], s83 offen offset:3072 sc1
    v_mfma_f32_16x16x32_bf16 v[108:111], v[64:67], a[204:207], v[108:111]
    s_waitcnt lgkmcnt(4)
    v_and_b32 v251, 15, v251
    v_mul_u32_u24 v251, 36, v251
    v_mfma_f32_16x16x32_bf16 v[124:127], v[68:71], a[204:207], v[124:127]
    ds_read_b64_tr_b16 v[64:65], v8 offset:17408
    v_add_u32 v19, v18, v251
    v_mfma_f32_16x16x32_bf16 v[120:123], v[68:71], a[200:203], v[120:123]
    ds_read_b64_tr_b16 v[66:67], v8 offset:21504
    v_mul_u32_u24 v19, 1152, v19
    v_mfma_f32_16x16x32_bf16 v[116:119], v[68:71], a[196:199], v[116:119]
    buffer_load_dwordx2 a[30:31], v2, s[8:11], s83 offen offset:3584 sc1
    v_mfma_f32_16x16x32_bf16 v[112:115], v[68:71], a[192:195], v[112:115]
    s_waitcnt lgkmcnt(4)
    v_and_b32 v251, 15, v250
    v_mul_u32_u24 v251, 36, v251
    v_mfma_f32_16x16x32_bf16 v[128:131], v[72:75], a[192:195], v[128:131]
    ds_read_b64_tr_b16 v[68:69], v9 offset:17408
    v_add_u32 v18, v18, v251
    v_mfma_f32_16x16x32_bf16 v[132:135], v[72:75], a[196:199], v[132:135]
    ds_read_b64_tr_b16 v[70:71], v9 offset:21504
    v_mul_u32_u24 v18, 1152, v18
    v_mfma_f32_16x16x32_bf16 v[136:139], v[72:75], a[200:203], v[136:139]
    buffer_load_dword v254, v4, s[8:11], s89 offen sc1
    v_mfma_f32_16x16x32_bf16 v[140:143], v[72:75], a[204:207], v[140:143]
    s_waitcnt lgkmcnt(4)
    s_add_u32 s83, s66, 8192
    v_bfe_u32 v249, v0, 2, 4
    v_mfma_f32_16x16x32_bf16 v[156:159], v[76:79], a[204:207], v[156:159]
    ds_read_b64_tr_b16 v[72:73], v10 offset:17408
    v_lshrrev_b32 v250, 3, v249
    v_mfma_f32_16x16x32_bf16 v[152:155], v[76:79], a[200:203], v[152:155]
    ds_read_b64_tr_b16 v[74:75], v10 offset:21504
    v_mul_u32_u24 v250, 3072, v250
    v_mfma_f32_16x16x32_bf16 v[148:151], v[76:79], a[196:199], v[148:151]
    buffer_load_dwordx4 a[224:227], v1, s[8:11], s83 offen offset:0 sc1
    v_mfma_f32_16x16x32_bf16 v[144:147], v[76:79], a[192:195], v[144:147]
    s_waitcnt lgkmcnt(4)
    v_and_b32 v249, 7, v249
    v_lshl_add_u32 v250, v249, 4, v250
    v_mfma_f32_16x16x32_bf16 v[160:163], v[64:67], a[192:195], v[160:163]
    ds_read_b64_tr_b16 v[76:77], v11 offset:17408
    v_and_b32 v249, 1, v0
    v_mfma_f32_16x16x32_bf16 v[164:167], v[64:67], a[196:199], v[164:167]
    ds_read_b64_tr_b16 v[78:79], v11 offset:21504
    v_lshl_add_u32 v250, v249, 3, v250
    v_mfma_f32_16x16x32_bf16 v[168:171], v[64:67], a[200:203], v[168:171]
    buffer_load_dwordx4 a[228:231], v1, s[8:11], s83 offen offset:1024 sc1
    v_mfma_f32_16x16x32_bf16 v[172:175], v[64:67], a[204:207], v[172:175]
    s_waitcnt lgkmcnt(4)
    v_add_u32 v21, 73728, v250
    v_bfe_u32 v249, v0, 4, 2
    v_mfma_f32_16x16x32_bf16 v[188:191], v[68:71], a[204:207], v[188:191]
    ds_read_b64_tr_b16 v[64:65], v22 offset:10240
    v_and_b32 v250, 15, v0
    v_mfma_f32_16x16x32_bf16 v[184:187], v[68:71], a[200:203], v[184:187]
    ds_read_b64_tr_b16 v[66:67], v22 offset:10752
    v_lshrrev_b32 v251, 1, v249
    v_mfma_f32_16x16x32_bf16 v[180:183], v[68:71], a[196:199], v[180:183]
    buffer_load_dwordx4 a[232:235], v1, s[8:11], s83 offen offset:2048 sc1
    v_mfma_f32_16x16x32_bf16 v[176:179], v[68:71], a[192:195], v[176:179]
    s_waitcnt lgkmcnt(4)
    v_lshlrev_b32 v251, 16, v251
    v_and_b32 v252, 1, v249
    v_mfma_f32_16x16x32_bf16 v[192:195], v[72:75], a[192:195], v[192:195]
    ds_read_b64_tr_b16 v[68:69], v8 offset:24576
    v_lshl_add_u32 v251, v252, 9, v251
    v_mfma_f32_16x16x32_bf16 v[196:199], v[72:75], a[196:199], v[196:199]
    ds_read_b64_tr_b16 v[70:71], v8 offset:28672
    v_lshl_add_u32 v24, v250, 4, v251
    v_mfma_f32_16x16x32_bf16 v[200:203], v[72:75], a[200:203], v[200:203]
    buffer_load_dwordx4 a[236:239], v1, s[8:11], s83 offen offset:3072 sc1
    v_mfma_f32_16x16x32_bf16 v[204:207], v[72:75], a[204:207], v[204:207]
    s_waitcnt lgkmcnt(4)
    s_waitcnt vmcnt(4)
    v_cmp_eq_u32 vcc, s40, v254
    s_nop 0
    s_cmp_eq_u32 vcc_lo, -1
    s_cbranch_scc0 L_spin5
L_back5:
    v_lshlrev_b32 v251, 15, v249
    v_mfma_f32_16x16x32_bf16 v[220:223], v[76:79], a[204:207], v[220:223]
    s_add_u32 s83, s66, 12288
    ds_read_b64_tr_b16 v[72:73], v9 offset:24576
    v_lshl_add_u32 v27, v250, 2, v251
    v_mfma_f32_16x16x32_bf16 v[216:219], v[76:79], a[200:203], v[216:219]
    ds_read_b64_tr_b16 v[74:75], v9 offset:28672
    s_lshl_b32 s58, s5, 2
    v_mfma_f32_16x16x32_bf16 v[212:215], v[76:79], a[196:199], v[212:215]
    buffer_load_dwordx4 a[240:243], v1, s[8:11], s83 offen offset:0 sc1
    v_mfma_f32_16x16x32_bf16 v[208:211], v[76:79], a[192:195], v[208:211]
    s_waitcnt lgkmcnt(4)
    s_add_u32 s58, s58, s3
    s_lshl_b32 s100, s58, 4
    v_mfma_f32_16x16x32_bf16 v[224:227], v[64:67], a[192:195], v[224:227]
    ds_read_b64_tr_b16 v[76:77], v10 offset:24576
    v_add_u32 v251, s100, v250
    v_mfma_f32_16x16x32_bf16 v[228:231], v[64:67], a[196:199], v[228:231]
    ds_read_b64_tr_b16 v[78:79], v10 offset:28672
    v_mul_u32_u24 v251, 1152, v251
    v_mfma_f32_16x16x32_bf16 v[232:235], v[64:67], a[200:203], v[232:235]
    v_lshl_add_u32 v251, v249, 3, v251
    s_lshl_b32 s75, s4, 7
    v_mfma_f32_16x16x32_bf16 v[236:239], v[64:67], a[204:207], v[236:239]
    s_waitcnt lgkmcnt(4)
    buffer_load_dwordx4 a[244:247], v1, s[8:11], s83 offen offset:1024 sc1
    v_mfma_f32_16x16x32_bf16 v[108:111], v[68:71], a[220:223], v[108:111]
    ds_read_b64_tr_b16 v[64:65], v11 offset:24576
    v_add_u32 v28, s75, v251
    v_mfma_f32_16x16x32_bf16 v[104:107], v[68:71], a[216:219], v[104:107]
    ds_read_b64_tr_b16 v[66:67], v11 offset:28672
    s_lshl_b32 s76, s4, 4
    v_mfma_f32_16x16x32_bf16 v[100:103], v[68:71], a[212:215], v[100:103]
    s_add_u32 s76, s76, 1024
    v_add_u32 v251, s76, v251
    s_and_b32 s78, s4, 1
    v_mfma_f32_16x16x32_bf16 v[96:99], v[68:71], a[208:211], v[96:99]
    s_waitcnt lgkmcnt(4)
    s_lshl_b32 s101, s78, 11
    v_add_u32 v30, s101, v1
    v_mfma_f32_16x16x32_bf16 v[112:115], v[72:75], a[208:211], v[112:115]
    ds_read_b64_tr_b16 v[68:69], v8 offset:25600
    s_lshl_b32 s101, s78, 8
    v_mfma_f32_16x16x32_bf16 v[116:119], v[72:75], a[212:215], v[116:119]
    ds_read_b64_tr_b16 v[70:71], v8 offset:29696
    v_add_u32 v250, s101, v3
    v_mfma_f32_16x16x32_bf16 v[120:123], v[72:75], a[216:219], v[120:123]
    v_mov_b32 v252, 1073741824
    v_cmp_gt_u32 s[100:101], 2, v249
    v_mfma_f32_16x16x32_bf16 v[124:127], v[72:75], a[220:223], v[124:127]
    s_waitcnt lgkmcnt(4)
    buffer_load_dwordx4 a[248:251], v1, s[8:11], s83 offen offset:2048 sc1
    v_mfma_f32_16x16x32_bf16 v[140:143], v[76:79], a[220:223], v[140:143]
    ds_read_b64_tr_b16 v[72:73], v9 offset:25600
    v_cndmask_b32 v29, v252, v251, s[100:101]
    v_mfma_f32_16x16x32_bf16 v[136:139], v[76:79], a[216:219], v[136:139]
    ds_read_b64_tr_b16 v[74:75], v9 offset:29696
    v_cndmask_b32 v31, v252, v250, s[100:101]
    v_mfma_f32_16x16x32_bf16 v[132:135], v[76:79], a[212:215], v[132:135]
    s_lshr_b32 s100, s4, 1
    s_lshl_b32 s101, s58, 2
    s_add_u32 s100, s100, s101
    v_mfma_f32_16x16x32_bf16 v[128:131], v[76:79], a[208:211], v[128:131]
    s_waitcnt lgkmcnt(4)
    s_mul_i32 s78, s100, 4608
    s_add_u32 s78, s78, 30801920
    v_mfma_f32_16x16x32_bf16 v[144:147], v[64:67], a[208:211], v[144:147]
    ds_read_b64_tr_b16 v[76:77], v10 offset:25600
    s_lshr_b32 s100, s58, 1
    v_mfma_f32_16x16x32_bf16 v[148:151], v[64:67], a[212:215], v[148:151]
    ds_read_b64_tr_b16 v[78:79], v10 offset:29696
    s_lshl_b32 s100, s100, 10
    v_mfma_f32_16x16x32_bf16 v[152:155], v[64:67], a[216:219], v[152:155]
    s_and_b32 s101, s58, 1
    s_lshl_b32 s101, s101, 8
    s_add_u32 s100, s100, s101
    v_mfma_f32_16x16x32_bf16 v[156:159], v[64:67], a[220:223], v[156:159]
    s_waitcnt lgkmcnt(4)
    buffer_load_dwordx4 a[252:255], v1, s[8:11], s83 offen offset:3072 sc1
    v_mfma_f32_16x16x32_bf16 v[172:175], v[68:71], a[220:223], v[172:175]
    ds_read_b64_tr_b16 v[64:65], v11 offset:25600
    s_add_u32 s56, s100, 28442624
    v_mfma_f32_16x16x32_bf16 v[168:171], v[68:71], a[216:219], v[168:171]
    ds_read_b64_tr_b16 v[66:67], v11 offset:29696
    s_add_u32 s57, s56, 2097152
    v_mfma_f32_16x16x32_bf16 v[164:167], v[68:71], a[212:215], v[164:167]
    s_lshl_b32 s100, s4, 18
    s_add_u32 s79, s56, s100
    s_lshl_b32 s58, s58, 6
    v_mfma_f32_16x16x32_bf16 v[160:163], v[68:71], a[208:211], v[160:163]
    s_waitcnt lgkmcnt(4)
    s_add_u32 s58, s58, 30539776
    s_mul_i32 s77, s3, 3072
    v_mfma_f32_16x16x32_bf16 v[176:179], v[72:75], a[208:211], v[176:179]
    ds_read_b64_tr_b16 v[68:69], v22 offset:11264
    s_add_u32 s77, s77, 73728
    v_mfma_f32_16x16x32_bf16 v[180:183], v[72:75], a[212:215], v[180:183]
    ds_read_b64_tr_b16 v[70:71], v22 offset:11776
    s_add_u32 s12, s52, 40448
    s_addc_u32 s13, s53, 0
    v_mfma_f32_16x16x32_bf16 v[184:187], v[72:75], a[216:219], v[184:187]
    s_mov_b32 s14, 623104
    s_mov_b32 s15, 0x20000
    s_add_u32 s100, s4, 0
    v_mfma_f32_16x16x32_bf16 v[188:191], v[72:75], a[220:223], v[188:191]
    s_waitcnt lgkmcnt(4)
    s_and_b32 s100, s100, 7
    s_mul_i32 s100, s100, 82944
    v_mfma_f32_16x16x32_bf16 v[204:207], v[76:79], a[220:223], v[204:207]
    ds_read_b64_tr_b16 v[72:73], v8 offset:32768
    s_add_u32 s16, s100, s75
    v_mfma_f32_16x16x32_bf16 v[200:203], v[76:79], a[216:219], v[200:203]
    ds_read_b64_tr_b16 v[74:75], v8 offset:36864
    s_add_u32 s100, s4, 1
    v_mfma_f32_16x16x32_bf16 v[196:199], v[76:79], a[212:215], v[196:199]
    s_and_b32 s100, s100, 7
    s_mul_i32 s100, s100, 82944
    s_add_u32 s17, s100, s75
    v_mfma_f32_16x16x32_bf16 v[192:195], v[76:79], a[208:211], v[192:195]
    s_waitcnt lgkmcnt(4)
    s_add_u32 s100, s4, 2
    s_and_b32 s100, s100, 7
    v_mfma_f32_16x16x32_bf16 v[208:211], v[64:67], a[208:211], v[208:211]
    ds_read_b64_tr_b16 v[76:77], v9 offset:32768
    s_mul_i32 s100, s100, 82944
    v_mfma_f32_16x16x32_bf16 v[212:215], v[64:67], a[212:215], v[212:215]
    ds_read_b64_tr_b16 v[78:79], v9 offset:36864
    s_add_u32 s18, s100, s75
    v_mfma_f32_16x16x32_bf16 v[216:219], v[64:67], a[216:219], v[216:219]
    s_add_u32 s100, s4, 3
    s_and_b32 s100, s100, 7
    s_mul_i32 s100, s100, 82944
    v_mfma_f32_16x16x32_bf16 v[220:223], v[64:67], a[220:223], v[220:223]
    s_waitcnt lgkmcnt(4)
    s_add_u32 s19, s100, s75
    s_add_u32 s100, s4, 4
    v_mfma_f32_16x16x32_bf16 v[236:239], v[68:71], a[220:223], v[236:239]
    ds_read_b64_tr_b16 v[64:65], v10 offset:32768
    s_and_b32 s100, s100, 7
    v_mfma_f32_16x16x32_bf16 v[232:235], v[68:71], a[216:219], v[232:235]
    ds_read_b64_tr_b16 v[66:67], v10 offset:36864
    s_mul_i32 s100, s100, 82944
    v_mfma_f32_16x16x32_bf16 v[228:231], v[68:71], a[212:215], v[228:231]
    s_add_u32 s42, s100, s75
    s_add_u32 s100, s4, 5
    s_and_b32 s100, s100, 7
    v_mfma_f32_16x16x32_bf16 v[224:227], v[68:71], a[208:211], v[224:227]
    s_waitcnt vmcnt(4)
    s_waitcnt lgkmcnt(4)
    s_mul_i32 s100, s100, 82944
    v_mfma_f32_16x16x32_bf16 v[96:99], v[72:75], a[224:227], v[96:99]
    ds_read_b64_tr_b16 v[68:69], v11 offset:32768
    s_add_u32 s43, s100, s75
    v_mfma_f32_16x16x32_bf16 v[100:103], v[72:75], a[228:231], v[100:103]
    ds_read_b64_tr_b16 v[70:71], v11 offset:36864
    s_add_u32 s100, s4, 6
    v_mfma_f32_16x16x32_bf16 v[104:107], v[72:75], a[232:235], v[104:107]
    s_and_b32 s100, s100, 7
    s_mul_i32 s100, s100, 82944
    s_add_u32 s50, s100, s75
    v_mfma_f32_16x16x32_bf16 v[108:111], v[72:75], a[236:239], v[108:111]
    s_waitcnt lgkmcnt(4)
    s_add_u32 s100, s4, 7
    s_and_b32 s100, s100, 7
    v_mfma_f32_16x16x32_bf16 v[124:127], v[76:79], a[236:239], v[124:127]
    ds_read_b64_tr_b16 v[72:73], v8 offset:33792
    s_mul_i32 s100, s100, 82944
    v_mfma_f32_16x16x32_bf16 v[120:123], v[76:79], a[232:235], v[120:123]
    ds_read_b64_tr_b16 v[74:75], v8 offset:37888
    s_add_u32 s51, s100, s75
    v_mfma_f32_16x16x32_bf16 v[116:119], v[76:79], a[228:231], v[116:119]
    v_mfma_f32_16x16x32_bf16 v[112:115], v[76:79], a[224:227], v[112:115]
    s_waitcnt lgkmcnt(4)
    v_mfma_f32_16x16x32_bf16 v[128:131], v[64:67], a[224:227], v[128:131]
    ds_read_b64_tr_b16 v[76:77], v9 offset:33792
    v_mfma_f32_16x16x32_bf16 v[132:135], v[64:67], a[228:231], v[132:135]
    ds_read_b64_tr_b16 v[78:79], v9 offset:37888
    v_mfma_f32_16x16x32_bf16 v[136:139], v[64:67], a[232:235], v[136:139]
    v_mfma_f32_16x16x32_bf16 v[140:143], v[64:67], a[236:239], v[140:143]
    s_waitcnt lgkmcnt(4)
    v_mfma_f32_16x16x32_bf16 v[156:159], v[68:71], a[236:239], v[156:159]
    ds_read_b64_tr_b16 v[64:65], v10 offset:33792
    v_mfma_f32_16x16x32_bf16 v[152:155], v[68:71], a[232:235], v[152:155]
    ds_read_b64_tr_b16 v[66:67], v10 offset:37888
    v_mfma_f32_16x16x32_bf16 v[148:151], v[68:71], a[228:231], v[148:151]
    v_mfma_f32_16x16x32_bf16 v[144:147], v[68:71], a[224:227], v[144:147]
    s_waitcnt lgkmcnt(4)
    v_mfma_f32_16x16x32_bf16 v[160:163], v[72:75], a[224:227], v[160:163]
    ds_read_b64_tr_b16 v[68:69], v11 offset:33792
    v_mfma_f32_16x16x32_bf16 v[164:167], v[72:75], a[228:231], v[164:167]
    ds_read_b64_tr_b16 v[70:71], v11 offset:37888
    v_mfma_f32_16x16x32_bf16 v[168:171], v[72:75], a[232:235], v[168:171]
    v_mfma_f32_16x16x32_bf16 v[172:175], v[72:75], a[236:239], v[172:175]
    s_waitcnt lgkmcnt(4)
    v_mfma_f32_16x16x32_bf16 v[188:191], v[76:79], a[236:239], v[188:191]
    ds_read_b64_tr_b16 v[72:73], v22 offset:14336
    v_mfma_f32_16x16x32_bf16 v[184:187], v[76:79], a[232:235], v[184:187]
    ds_read_b64_tr_b16 v[74:75], v22 offset:14848
    v_mfma_f32_16x16x32_bf16 v[180:183], v[76:79], a[228:231], v[180:183]
    v_mfma_f32_16x16x32_bf16 v[176:179], v[76:79], a[224:227], v[176:179]
    s_waitcnt lgkmcnt(4)
    s_barrier
    v_mfma_f32_16x16x32_bf16 v[192:195], v[64:67], a[224:227], v[192:195]
    ds_read_b64_tr_b16 v[76:77], v8 offset:40960
    v_mfma_f32_16x16x32_bf16 v[196:199], v[64:67], a[228:231], v[196:199]
    s_add_u32 s95, s54, 0
    ds_read_b64_tr_b16 v[78:79], v8 offset:45056
    v_mfma_f32_16x16x32_bf16 v[200:203], v[64:67], a[232:235], v[200:203]
    s_add_u32 m0, s67, 86016
    v_mfma_f32_16x16x32_bf16 v[204:207], v[64:67], a[236:239], v[204:207]
    s_waitcnt lgkmcnt(4)
    buffer_load_dwordx4 v1, s[8:11], s95 offen offset:0 sc1 lds
    v_mfma_f32_16x16x32_bf16 v[220:223], v[68:71], a[236:239], v[220:223]
    ds_read_b64_tr_b16 v[64:65], v9 offset:40960
    v_mfma_f32_16x16x32_bf16 v[216:219], v[68:71], a[232:235], v[216:219]
    ds_read_b64_tr_b16 v[66:67], v9 offset:45056
    v_mfma_f32_16x16x32_bf16 v[212:215], v[68:71], a[228:231], v[212:215]
    buffer_load_dwordx4 v1, s[8:11], s95 offen offset:1024 sc1 lds
    v_mfma_f32_16x16x32_bf16 v[208:211], v[68:71], a[224:227], v[208:211]
    s_waitcnt lgkmcnt(4)
    v_mfma_f32_16x16x32_bf16 v[224:227], v[72:75], a[224:227], v[224:227]
    ds_read_b64_tr_b16 v[68:69], v10 offset:40960
    v_mfma_f32_16x16x32_bf16 v[228:231], v[72:75], a[228:231], v[228:231]
    ds_read_b64_tr_b16 v[70:71], v10 offset:45056
    v_mfma_f32_16x16x32_bf16 v[232:235], v[72:75], a[232:235], v[232:235]
    buffer_load_dwordx4 v1, s[8:11], s95 offen offset:2048 sc1 lds
    v_mfma_f32_16x16x32_bf16 v[236:239], v[72:75], a[236:239], v[236:239]
    s_waitcnt vmcnt(3)
    s_waitcnt lgkmcnt(4)
    v_mfma_f32_16x16x32_bf16 v[108:111], v[76:79], a[252:255], v[108:111]
    ds_read_b64_tr_b16 v[72:73], v11 offset:40960
    v_mfma_f32_16x16x32_bf16 v[104:107], v[76:79], a[248:251], v[104:107]
L_page9:
    s_cbranch_execz L_page13
    ds_read_b64_tr_b16 v[74:75], v11 offset:45056
    v_mfma_f32_16x16x32_bf16 v[100:103], v[76:79], a[244:247], v[100:103]
    buffer_load_dwordx4 v1, s[8:11], s95 offen offset:3072 sc1 lds
    v_mfma_f32_16x16x32_bf16 v[96:99], v[76:79], a[240:243], v[96:99]
    s_waitcnt lgkmcnt(4)
    s_add_u32 s95, s54, 4096
    v_mfma_f32_16x16x32_bf16 v[112:115], v[64:67], a[240:243], v[112:115]
    s_add_u32 m0, s67, 90112
    ds_read_b64_tr_b16 v[76:77], v8 offset:41984
    v_mfma_f32_16x16x32_bf16 v[116:119], v[64:67], a[244:247], v[116:119]
    ds_read_b64_tr_b16 v[78:79], v8 offset:46080
    v_mfma_f32_16x16x32_bf16 v[120:123], v[64:67], a[248:251], v[120:123]
    buffer_load_dwordx4 v1, s[8:11], s95 offen offset:0 sc1 lds
    v_mfma_f32_16x16x32_bf16 v[124:127], v[64:67], a[252:255], v[124:127]
    s_waitcnt lgkmcnt(4)
    v_mfma_f32_16x16x32_bf16 v[140:143], v[68:71], a[252:255], v[140:143]
    ds_read_b64_tr_b16 v[64:65], v9 offset:41984
    v_mfma_f32_16x16x32_bf16 v[136:139], v[68:71], a[248:251], v[136:139]
    ds_read_b64_tr_b16 v[66:67], v9 offset:46080
    v_mfma_f32_16x16x32_bf16 v[132:135], v[68:71], a[244:247], v[132:135]
    buffer_load_dwordx4 v1, s[8:11], s95 offen offset:1024 sc1 lds
    v_mfma_f32_16x16x32_bf16 v[128:131], v[68:71], a[240:243], v[128:131]
    s_waitcnt lgkmcnt(4)
    v_mfma_f32_16x16x32_bf16 v[144:147], v[72:75], a[240:243], v[144:147]
    ds_read_b64_tr_b16 v[68:69], v10 offset:41984
    v_mfma_f32_16x16x32_bf16 v[148:151], v[72:75], a[244:247], v[148:151]
    ds_read_b64_tr_b16 v[70:71], v10 offset:46080
    v_mfma_f32_16x16x32_bf16 v[152:155], v[72:75], a[248:251], v[152:155]
    buffer_load_dwordx4 v1, s[8:11], s95 offen offset:2048 sc1 lds
    v_mfma_f32_16x16x32_bf16 v[156:159], v[72:75], a[252:255], v[156:159]
    s_waitcnt lgkmcnt(4)
    v_mfma_f32_16x16x32_bf16 v[172:175], v[76:79], a[252:255], v[172:175]
    ds_read_b64_tr_b16 v[72:73], v11 offset:41984
    v_mfma_f32_16x16x32_bf16 v[168:171], v[76:79], a[248:251], v[168:171]
    ds_read_b64_tr_b16 v[74:75], v11 offset:46080
    v_mfma_f32_16x16x32_bf16 v[164:167], v[76:79], a[244:247], v[164:167]
    v_mfma_f32_16x16x32_bf16 v[160:163], v[76:79], a[240:243], v[160:163]
    s_waitcnt lgkmcnt(4)
    buffer_load_dwordx4 v1, s[8:11], s95 offen offset:3072 sc1 lds
    v_mfma_f32_16x16x32_bf16 v[176:179], v[64:67], a[240:243], v[176:179]
    s_add_u32 s95, s54, 8192
    ds_read_b64_tr_b16 v[76:77], v22 offset:15360
    v_mfma_f32_16x16x32_bf16 v[180:183], v[64:67], a[244:247], v[180:183]
    s_add_u32 m0, s67, 94208
    ds_read_b64_tr_b16 v[78:79], v22 offset:15872
    v_mfma_f32_16x16x32_bf16 v[184:187], v[64:67], a[248:251], v[184:187]
    v_mfma_f32_16x16x32_bf16 v[188:191], v[64:67], a[252:255], v[188:191]
    s_waitcnt lgkmcnt(4)
    v_mfma_f32_16x16x32_bf16 v[204:207], v[68:71], a[252:255], v[204:207]
    ds_read_b64_tr_b16 v[64:65], v22 offset:16384
    v_mfma_f32_16x16x32_bf16 v[200:203], v[68:71], a[248:251], v[200:203]
    ds_read_b64_tr_b16 v[66:67], v22 offset:16896
    v_mfma_f32_16x16x32_bf16 v[196:199], v[68:71], a[244:247], v[196:199]
    v_mfma_f32_16x16x32_bf16 v[192:195], v[68:71], a[240:243], v[192:195]
    s_waitcnt lgkmcnt(4)
    buffer_load_dwordx4 v1, s[8:11], s95 offen offset:0 sc1 lds
    v_mfma_f32_16x16x32_bf16 v[208:211], v[72:75], a[240:243], v[208:211]
    s_add_u32 s95, s54, 36864
    ds_read_b64_tr_b16 v[68:69], v22 offset:17408
    v_mfma_f32_16x16x32_bf16 v[212:215], v[72:75], a[244:247], v[212:215]
    s_cmp_eq_u32 s3, 0
    s_cselect_b32 s95, s95, 1073741824
    s_cselect_b32 s94, 122880, s55
    ds_read_b64_tr_b16 v[70:71], v22 offset:17920
    v_mfma_f32_16x16x32_bf16 v[216:219], v[72:75], a[248:251], v[216:219]
    s_mov_b32 m0, s94
    v_mfma_f32_16x16x32_bf16 v[220:223], v[72:75], a[252:255], v[220:223]
    s_waitcnt lgkmcnt(4)
    v_mfma_f32_16x16x32_bf16 v[236:239], v[76:79], a[252:255], v[236:239]
    ds_read_b64_tr_b16 v[72:73], v8 offset:49152
    v_mfma_f32_16x16x32_bf16 v[232:235], v[76:79], a[248:251], v[232:235]
    ds_read_b64_tr_b16 v[74:75], v8 offset:53248
    v_mfma_f32_16x16x32_bf16 v[228:231], v[76:79], a[244:247], v[228:231]
    v_mfma_f32_16x16x32_bf16 v[224:227], v[76:79], a[240:243], v[224:227]
    s_waitcnt lgkmcnt(4)
    buffer_load_dwordx4 v1, s[8:11], s95 offen sc1 lds
    v_mfma_f32_16x16x32_bf16 v[224:227], v[64:67], a[0:3], v[224:227]
    ds_read_b64_tr_b16 v[76:77], v9 offset:49152
    v_mfma_f32_16x16x32_bf16 v[228:231], v[64:67], a[4:7], v[228:231]
    ds_read_b64_tr_b16 v[78:79], v9 offset:53248
    v_mfma_f32_16x16x32_bf16 v[232:235], v[64:67], a[8:11], v[232:235]
    v_mfma_f32_16x16x32_bf16 v[236:239], v[64:67], a[12:15], v[236:239]
    s_waitcnt lgkmcnt(4)
    v_mfma_f32_16x16x32_bf16 v[236:239], v[68:71], a[28:31], v[236:239]
    ds_read_b64_tr_b16 v[64:65], v8 offset:57344
    v_mfma_f32_16x16x32_bf16 v[232:235], v[68:71], a[24:27], v[232:235]
    ds_read_b64_tr_b16 v[66:67], v8 offset:61440
    v_mfma_f32_16x16x32_bf16 v[228:231], v[68:71], a[20:23], v[228:231]
    v_mfma_f32_16x16x32_bf16 v[224:227], v[68:71], a[16:19], v[224:227]
    s_waitcnt lgkmcnt(4)
    v_mfma_f32_16x16x32_bf16 v[96:99], v[72:75], a[0:3], v[96:99]
    ds_read_b64_tr_b16 v[68:69], v9 offset:57344
    v_mfma_f32_16x16x32_bf16 v[100:103], v[72:75], a[4:7], v[100:103]
    ds_read_b64_tr_b16 v[70:71], v9 offset:61440
    v_mfma_f32_16x16x32_bf16 v[104:107], v[72:75], a[8:11], v[104:107]
    s_nop 1
    v_cvt_pk_bf16_f32 v224, v224, v225
    v_cvt_pk_bf16_f32 v225, v226, v227
    v_mfma_f32_16x16x32_bf16 v[108:111], v[72:75], a[12:15], v[108:111]
    s_waitcnt lgkmcnt(4)
    v_cvt_pk_bf16_f32 v228, v228, v229
    v_cvt_pk_bf16_f32 v229, v230, v231
    v_mfma_f32_16x16x32_bf16 v[124:127], v[76:79], a[12:15], v[124:127]
    ds_read_b64_tr_b16 v[72:73], v10 offset:49152
    v_cvt_pk_bf16_f32 v232, v232, v233
    v_mfma_f32_16x16x32_bf16 v[120:123], v[76:79], a[8:11], v[120:123]
    ds_read_b64_tr_b16 v[74:75], v10 offset:53248
    v_cvt_pk_bf16_f32 v233, v234, v235
    v_mfma_f32_16x16x32_bf16 v[116:119], v[76:79], a[4:7], v[116:119]
    v_cvt_pk_bf16_f32 v236, v236, v237
    v_cvt_pk_bf16_f32 v237, v238, v239
    v_mfma_f32_16x16x32_bf16 v[112:115], v[76:79], a[0:3], v[112:115]
    s_waitcnt lgkmcnt(4)
    v_mfma_f32_16x16x32_bf16 v[96:99], v[64:67], a[16:19], v[96:99]
    ds_read_b64_tr_b16 v[76:77], v11 offset:49152
    v_mfma_f32_16x16x32_bf16 v[100:103], v[64:67], a[20:23], v[100:103]
    ds_read_b64_tr_b16 v[78:79], v11 offset:53248
    v_mfma_f32_16x16x32_bf16 v[104:107], v[64:67], a[24:27], v[104:107]
    v_mfma_f32_16x16x32_bf16 v[108:111], v[64:67], a[28:31], v[108:111]
    s_waitcnt lgkmcnt(4)
    v_mfma_f32_16x16x32_bf16 v[124:127], v[68:71], a[28:31], v[124:127]
    ds_read_b64_tr_b16 v[64:65], v10 offset:57344
    v_mfma_f32_16x16x32_bf16 v[120:123], v[68:71], a[24:27], v[120:123]
    ds_read_b64_tr_b16 v[66:67], v10 offset:61440
    v_mfma_f32_16x16x32_bf16 v[116:119], v[68:71], a[20:23], v[116:119]
    v_mfma_f32_16x16x32_bf16 v[112:115], v[68:71], a[16:19], v[112:115]
    s_waitcnt lgkmcnt(4)
    v_mfma_f32_16x16x32_bf16 v[128:131], v[72:75], a[0:3], v[128:131]
    ds_read_b64_tr_b16 v[68:69], v11 offset:57344
    v_mfma_f32_16x16x32_bf16 v[132:135], v[72:75], a[4:7], v[132:135]
    ds_read_b64_tr_b16 v[70:71], v11 offset:61440
    v_mfma_f32_16x16x32_bf16 v[136:139], v[72:75], a[8:11], v[136:139]
    v_cvt_pk_bf16_f32 v96, v96, v97
    v_cvt_pk_bf16_f32 v97, v98, v99
    v_mfma_f32_16x16x32_bf16 v[140:143], v[72:75], a[12:15], v[140:143]
    s_waitcnt lgkmcnt(4)
    v_cvt_pk_bf16_f32 v98, v112, v113
    v_cvt_pk_bf16_f32 v99, v114, v115
    v_mfma_f32_16x16x32_bf16 v[156:159], v[76:79], a[12:15], v[156:159]
    ds_read_b64_tr_b16 v[72:73], v8 offset:50176
    v_cvt_pk_bf16_f32 v100, v100, v101
    v_mfma_f32_16x16x32_bf16 v[152:155], v[76:79], a[8:11], v[152:155]
    ds_read_b64_tr_b16 v[74:75], v8 offset:54272
    v_cvt_pk_bf16_f32 v101, v102, v103
    v_mfma_f32_16x16x32_bf16 v[148:151], v[76:79], a[4:7], v[148:151]
    v_cvt_pk_bf16_f32 v102, v116, v117
    v_cvt_pk_bf16_f32 v103, v118, v119
    v_mfma_f32_16x16x32_bf16 v[144:147], v[76:79], a[0:3], v[144:147]
    s_waitcnt lgkmcnt(4)
    v_cvt_pk_bf16_f32 v104, v104, v105
    v_cvt_pk_bf16_f32 v105, v106, v107
    v_mfma_f32_16x16x32_bf16 v[128:131], v[64:67], a[16:19], v[128:131]
    ds_read_b64_tr_b16 v[76:77], v9 offset:50176
    v_cvt_pk_bf16_f32 v106, v120, v121
    v_mfma_f32_16x16x32_bf16 v[132:135], v[64:67], a[20:23], v[132:135]
    ds_read_b64_tr_b16 v[78:79], v9 offset:54272
    v_cvt_pk_bf16_f32 v107, v122, v123
    v_mfma_f32_16x16x32_bf16 v[136:139], v[64:67], a[24:27], v[136:139]
    v_cvt_pk_bf16_f32 v108, v108, v109
    v_cvt_pk_bf16_f32 v109, v110, v111
    v_mfma_f32_16x16x32_bf16 v[140:143], v[64:67], a[28:31], v[140:143]
    s_waitcnt lgkmcnt(4)
    v_cvt_pk_bf16_f32 v110, v124, v125
    v_cvt_pk_bf16_f32 v111, v126, v127
    v_mfma_f32_16x16x32_bf16 v[156:159], v[68:71], a[28:31], v[156:159]
    ds_read_b64_tr_b16 v[64:65], v8 offset:58368
    v_mfma_f32_16x16x32_bf16 v[152:155], v[68:71], a[24:27], v[152:155]
    ds_read_b64_tr_b16 v[66:67], v8 offset:62464
    v_mfma_f32_16x16x32_bf16 v[148:151], v[68:71], a[20:23], v[148:151]
    v_mfma_f32_16x16x32_bf16 v[144:147], v[68:71], a[16:19], v[144:147]
    s_waitcnt lgkmcnt(4)
    v_mfma_f32_16x16x32_bf16 v[160:163], v[72:75], a[0:3], v[160:163]
    ds_read_b64_tr_b16 v[68:69], v9 offset:58368
    v_mfma_f32_16x16x32_bf16 v[164:167], v[72:75], a[4:7], v[164:167]
    ds_read_b64_tr_b16 v[70:71], v9 offset:62464
    v_mfma_f32_16x16x32_bf16 v[168:171], v[72:75], a[8:11], v[168:171]
    v_cvt_pk_bf16_f32 v128, v128, v129
    v_cvt_pk_bf16_f32 v129, v130, v131
    v_mfma_f32_16x16x32_bf16 v[172:175], v[72:75], a[12:15], v[172:175]
    s_waitcnt lgkmcnt(4)
    v_cvt_pk_bf16_f32 v130, v144, v145
    v_cvt_pk_bf16_f32 v131, v146, v147
    v_mfma_f32_16x16x32_bf16 v[188:191], v[76:79], a[12:15], v[188:191]
    ds_read_b64_tr_b16 v[72:73], v10 offset:50176
    v_cvt_pk_bf16_f32 v132, v132, v133
    v_mfma_f32_16x16x32_bf16 v[184:187], v[76:79], a[8:11], v[184:187]
    ds_read_b64_tr_b16 v[74:75], v10 offset:54272
    v_cvt_pk_bf16_f32 v133, v134, v135
    v_mfma_f32_16x16x32_bf16 v[180:183], v[76:79], a[4:7], v[180:183]
    v_cvt_pk_bf16_f32 v134, v148, v149
    v_cvt_pk_bf16_f32 v135, v150, v151
    v_mfma_f32_16x16x32_bf16 v[176:179], v[76:79], a[0:3], v[176:179]
    s_waitcnt lgkmcnt(4)
    v_cvt_pk_bf16_f32 v136, v136, v137
    v_cvt_pk_bf16_f32 v137, v138, v139
    v_mfma_f32_16x16x32_bf16 v[160:163], v[64:67], a[16:19], v[160:163]
    ds_read_b64_tr_b16 v[76:77], v11 offset:50176
    v_cvt_pk_bf16_f32 v138, v152, v153
    v_mfma_f32_16x16x32_bf16 v[164:167], v[64:67], a[20:23], v[164:167]
    ds_read_b64_tr_b16 v[78:79], v11 offset:54272
    v_cvt_pk_bf16_f32 v139, v154, v155
    v_mfma_f32_16x16x32_bf16 v[168:171], v[64:67], a[24:27], v[168:171]
    v_cvt_pk_bf16_f32 v140, v140, v141
    v_cvt_pk_bf16_f32 v141, v142, v143
    v_mfma_f32_16x16x32_bf16 v[172:175], v[64:67], a[28:31], v[172:175]
    s_waitcnt lgkmcnt(4)
    v_cvt_pk_bf16_f32 v142, v156, v157
    v_cvt_pk_bf16_f32 v143, v158, v159
    v_mfma_f32_16x16x32_bf16 v[188:191], v[68:71], a[28:31], v[188:191]
    ds_read_b64_tr_b16 v[64:65], v10 offset:58368
    v_mfma_f32_16x16x32_bf16 v[184:187], v[68:71], a[24:27], v[184:187]
    ds_read_b64_tr_b16 v[66:67], v10 offset:62464
    v_mfma_f32_16x16x32_bf16 v[180:183], v[68:71], a[20:23], v[180:183]
    v_mfma_f32_16x16x32_bf16 v[176:179], v[68:71], a[16:19], v[176:179]
    s_waitcnt lgkmcnt(4)
    v_mfma_f32_16x16x32_bf16 v[192:195], v[72:75], a[0:3], v[192:195]
    ds_read_b64_tr_b16 v[68:69], v11 offset:58368
    v_mfma_f32_16x16x32_bf16 v[196:199], v[72:75], a[4:7], v[196:199]
    ds_read_b64_tr_b16 v[70:71], v11 offset:62464
    v_mfma_f32_16x16x32_bf16 v[200:203], v[72:75], a[8:11], v[200:203]
    v_cvt_pk_bf16_f32 v160, v160, v161
    v_cvt_pk_bf16_f32 v161, v162, v163
    v_mfma_f32_16x16x32_bf16 v[204:207], v[72:75], a[12:15], v[204:207]
    s_waitcnt lgkmcnt(4)
    v_cvt_pk_bf16_f32 v162, v176, v177
    v_cvt_pk_bf16_f32 v163, v178, v179
    v_mfma_f32_16x16x32_bf16 v[220:223], v[76:79], a[12:15], v[220:223]
    v_cvt_pk_bf16_f32 v164, v164, v165
    v_cvt_pk_bf16_f32 v165, v166, v167
    v_mfma_f32_16x16x32_bf16 v[216:219], v[76:79], a[8:11], v[216:219]
    v_cvt_pk_bf16_f32 v166, v180, v181
    v_cvt_pk_bf16_f32 v167, v182, v183
    v_mfma_f32_16x16x32_bf16 v[212:215], v[76:79], a[4:7], v[212:215]
    v_cvt_pk_bf16_f32 v168, v168, v169
    v_cvt_pk_bf16_f32 v169, v170, v171
    v_mfma_f32_16x16x32_bf16 v[208:211], v[76:79], a[0:3], v[208:211]
    s_waitcnt lgkmcnt(2)
    v_cvt_pk_bf16_f32 v170, v184, v185
    v_cvt_pk_bf16_f32 v171, v186, v187
    v_mfma_f32_16x16x32_bf16 v[192:195], v[64:67], a[16:19], v[192:195]
    v_cvt_pk_bf16_f32 v172, v172, v173
    v_cvt_pk_bf16_f32 v173, v174, v175
    v_mfma_f32_16x16x32_bf16 v[196:199], v[64:67], a[20:23], v[196:199]
    v_cvt_pk_bf16_f32 v174, v188, v189
    v_cvt_pk_bf16_f32 v175, v190, v191
    v_mfma_f32_16x16x32_bf16 v[200:203], v[64:67], a[24:27], v[200:203]
    v_mfma_f32_16x16x32_bf16 v[204:207], v[64:67], a[28:31], v[204:207]
    s_waitcnt lgkmcnt(0)
    v_mfma_f32_16x16x32_bf16 v[220:223], v[68:71], a[28:31], v[220:223]
    v_mfma_f32_16x16x32_bf16 v[216:219], v[68:71], a[24:27], v[216:219]
    v_mfma_f32_16x16x32_bf16 v[212:215], v[68:71], a[20:23], v[212:215]
    v_mfma_f32_16x16x32_bf16 v[208:211], v[68:71], a[16:19], v[208:211]
    v_cvt_pk_bf16_f32 v192, v192, v193
    v_cvt_pk_bf16_f32 v193, v194, v195
    s_nop 5
    v_cvt_pk_bf16_f32 v194, v208, v209
    v_cvt_pk_bf16_f32 v195, v210, v211
    v_cvt_pk_bf16_f32 v196, v196, v197
    v_cvt_pk_bf16_f32 v197, v198, v199
    v_cvt_pk_bf16_f32 v198, v212, v213
    v_cvt_pk_bf16_f32 v199, v214, v215
    v_cvt_pk_bf16_f32 v200, v200, v201
    v_cvt_pk_bf16_f32 v201, v202, v203
    v_cvt_pk_bf16_f32 v202, v216, v217
    v_cvt_pk_bf16_f32 v203, v218, v219
    v_cvt_pk_bf16_f32 v204, v204, v205
    v_cvt_pk_bf16_f32 v205, v206, v207
    v_cvt_pk_bf16_f32 v206, v220, v221
    v_cvt_pk_bf16_f32 v207, v222, v223
    s_waitcnt vmcnt(0)
    s_barrier
    ds_read_b128 v[64:67], v241 offset:0
    ds_read_b64 v[76:77], v243 offset:16384
    ds_read_b128 v[68:71], v245 offset:18432
    s_waitcnt lgkmcnt(1)
    v_mfma_f32_32x32x16_bf16 v[112:127], v[64:67], v[80:83], 0
    v_mfma_f32_32x32x16_bf16 v[144:159], v[64:67], v[84:87], 0
    ds_read_b128 v[64:67], v241 offset:1024
    v_mfma_f32_32x32x8bf16_1k v[112:127], v[76:77], v[88:89], v[112:127]
    v_mfma_f32_32x32x8bf16_1k v[144:159], v[76:77], v[92:93], v[144:159]
    s_nop 10
    v_exp_f32 v112, v112
    v_exp_f32 v113, v113
    s_add_u32 s95, s0, 0
    buffer_store_dwordx2 v[224:225], v3, s[8:11], s68 offen sc1
    v_exp_f32 v114, v114
    v_exp_f32 v115, v115
    v_exp_f32 v116, v116
    v_exp_f32 v117, v117
    s_waitcnt lgkmcnt(0)
    ds_read_b128 v[72:75], v245 offset:19040
    v_exp_f32 v118, v118
    v_exp_f32 v119, v119
    v_exp_f32 v144, v144
    v_exp_f32 v145, v145
    v_mfma_f32_32x32x16_bf16 v[176:191], v[64:67], v[80:83], 0
    s_add_u32 m0, s67, 123904
    v_exp_f32 v146, v146
    v_exp_f32 v147, v147
    v_exp_f32 v148, v148
    v_exp_f32 v149, v149
    v_mfma_f32_32x32x16_bf16 v[208:223], v[64:67], v[84:87], 0
    ds_read_b128 v[64:67], v241 offset:2048
    v_exp_f32 v150, v150
    v_exp_f32 v151, v151
    v_exp_f32 v120, v120
    v_exp_f32 v121, v121
    v_mfma_f32_32x32x8bf16_1k v[176:191], v[76:77], v[90:91], v[176:191]
    v_exp_f32 v122, v122
    v_exp_f32 v123, v123
    v_exp_f32 v124, v124
    v_exp_f32 v125, v125
    v_mfma_f32_32x32x8bf16_1k v[208:223], v[76:77], v[94:95], v[208:223]
    v_exp_f32 v126, v126
    v_exp_f32 v127, v127
    v_exp_f32 v152, v152
    v_exp_f32 v153, v153
    v_smfmac_f32_32x32x32_bf16 v[32:47], v[68:71], v[112:119], v253
    buffer_load_dwordx4 v1, s[8:11], s95 offen offset:0 sc1 lds
    ds_read_b64 v[76:77], v243 offset:16640
    v_exp_f32 v154, v154
    v_exp_f32 v155, v155
    v_exp_f32 v156, v156
    v_exp_f32 v157, v157
    v_smfmac_f32_32x32x32_bf16 v[48:63], v[68:71], v[144:151], v253
    s_waitcnt lgkmcnt(2)
    ds_read_b128 v[68:71], v245 offset:19648
    v_exp_f32 v158, v158
    v_exp_f32 v159, v159
    v_exp_f32 v176, v176
    v_exp_f32 v177, v177
    v_smfmac_f32_32x32x32_bf16 v[32:47], v[72:75], v[120:127], v253
    buffer_store_dwordx2 v[228:229], v3, s[8:11], s69 offen sc1
    v_exp_f32 v178, v178
    v_exp_f32 v179, v179
    v_exp_f32 v180, v180
    v_exp_f32 v181, v181
    v_smfmac_f32_32x32x32_bf16 v[48:63], v[72:75], v[152:159], v253
    s_waitcnt lgkmcnt(0)
    ds_read_b128 v[72:75], v245 offset:20256
    v_exp_f32 v182, v182
    v_exp_f32 v183, v183
    v_exp_f32 v208, v208
    v_exp_f32 v209, v209
    v_mfma_f32_32x32x16_bf16 v[112:127], v[64:67], v[80:83], 0
    v_exp_f32 v210, v210
    v_exp_f32 v211, v211
    v_exp_f32 v212, v212
    v_exp_f32 v213, v213
    v_mfma_f32_32x32x16_bf16 v[144:159], v[64:67], v[84:87], 0
    ds_read_b128 v[64:67], v241 offset:3072
    v_exp_f32 v214, v214
    v_exp_f32 v215, v215
    v_exp_f32 v184, v184
    v_exp_f32 v185, v185
    v_mfma_f32_32x32x8bf16_1k v[112:127], v[76:77], v[88:89], v[112:127]
    v_exp_f32 v186, v186
    v_exp_f32 v187, v187
    v_exp_f32 v188, v188
    v_exp_f32 v189, v189
    v_mfma_f32_32x32x8bf16_1k v[144:159], v[76:77], v[92:93], v[144:159]
    v_exp_f32 v190, v190
    v_exp_f32 v191, v191
    v_exp_f32 v216, v216
    v_exp_f32 v217, v217
    v_smfmac_f32_32x32x32_bf16 v[32:47], v[68:71], v[176:183], v253
    buffer_load_dwordx4 v1, s[8:11], s95 offen offset:1024 sc1 lds
    v_exp_f32 v218, v218
    v_exp_f32 v219, v219
    v_exp_f32 v220, v220
    v_exp_f32 v221, v221
    v_smfmac_f32_32x32x32_bf16 v[48:63], v[68:71], v[208:215], v253
    s_waitcnt lgkmcnt(1)
    ds_read_b128 v[68:71], v245 offset:20864
    v_exp_f32 v222, v222
    v_exp_f32 v223, v223
    v_exp_f32 v112, v112
    v_exp_f32 v113, v113
    v_smfmac_f32_32x32x32_bf16 v[32:47], v[72:75], v[184:191], v253
    buffer_store_dwordx2 v[232:233], v3, s[8:11], s70 offen sc1
    v_exp_f32 v114, v114
    v_exp_f32 v115, v115
    v_exp_f32 v116, v116
    v_exp_f32 v117, v117
    v_smfmac_f32_32x32x32_bf16 v[48:63], v[72:75], v[216:223], v253
    s_waitcnt lgkmcnt(0)
    ds_read_b128 v[72:75], v245 offset:21472
    v_exp_f32 v118, v118
    v_exp_f32 v119, v119
    v_exp_f32 v144, v144
    v_exp_f32 v145, v145
    v_mfma_f32_32x32x16_bf16 v[176:191], v[64:67], v[80:83], 0
    v_exp_f32 v146, v146
    v_exp_f32 v147, v147
    v_exp_f32 v148, v148
    v_exp_f32 v149, v149
    v_mfma_f32_32x32x16_bf16 v[208:223], v[64:67], v[84:87], 0
    ds_read_b128 v[64:67], v241 offset:4096
    v_exp_f32 v150, v150
    v_exp_f32 v151, v151
    v_exp_f32 v120, v120
    v_exp_f32 v121, v121
    v_mfma_f32_32x32x8bf16_1k v[176:191], v[76:77], v[90:91], v[176:191]
    v_exp_f32 v122, v122
    v_exp_f32 v123, v123
    v_exp_f32 v124, v124
    v_exp_f32 v125, v125
    v_mfma_f32_32x32x8bf16_1k v[208:223], v[76:77], v[94:95], v[208:223]
    v_exp_f32 v126, v126
    v_exp_f32 v127, v127
    v_exp_f32 v152, v152
    v_exp_f32 v153, v153
    v_smfmac_f32_32x32x32_bf16 v[32:47], v[68:71], v[112:119], v253
    buffer_load_dwordx4 v1, s[8:11], s95 offen offset:2048 sc1 lds
    ds_read_b64 v[76:77], v243 offset:16896
    v_exp_f32 v154, v154
    v_exp_f32 v155, v155
    v_exp_f32 v156, v156
    v_exp_f32 v157, v157
    v_smfmac_f32_32x32x32_bf16 v[48:63], v[68:71], v[144:151], v253
    s_waitcnt lgkmcnt(2)
    ds_read_b128 v[68:71], v245 offset:22080
    v_exp_f32 v158, v158
    v_exp_f32 v159, v159
    v_exp_f32 v176, v176
    v_exp_f32 v177, v177
    v_smfmac_f32_32x32x32_bf16 v[32:47], v[72:75], v[120:127], v253
    buffer_store_dwordx2 v[236:237], v3, s[8:11], s71 offen sc1
    v_exp_f32 v178, v178
    v_exp_f32 v179, v179
    v_exp_f32 v180, v180
    v_exp_f32 v181, v181
    v_smfmac_f32_32x32x32_bf16 v[48:63], v[72:75], v[152:159], v253
    s_waitcnt lgkmcnt(0)
    ds_read_b128 v[72:75], v245 offset:22688
    v_exp_f32 v182, v182
    v_exp_f32 v183, v183
    v_exp_f32 v208, v208
    v_exp_f32 v209, v209
    v_mfma_f32_32x32x16_bf16 v[112:127], v[64:67], v[80:83], 0
    v_exp_f32 v210, v210
    v_exp_f32 v211, v211
    v_exp_f32 v212, v212
    v_exp_f32 v213, v213
    v_mfma_f32_32x32x16_bf16 v[144:159], v[64:67], v[84:87], 0
    ds_read_b128 v[64:67], v241 offset:5120
    v_exp_f32 v214, v214
    v_exp_f32 v215, v215
    v_exp_f32 v184, v184
    v_exp_f32 v185, v185
    v_mfma_f32_32x32x8bf16_1k v[112:127], v[76:77], v[88:89], v[112:127]
    v_exp_f32 v186, v186
    v_exp_f32 v187, v187
    v_exp_f32 v188, v188
    v_exp_f32 v189, v189
    v_mfma_f32_32x32x8bf16_1k v[144:159], v[76:77], v[92:93], v[144:159]
    v_exp_f32 v190, v190
    v_exp_f32 v191, v191
    v_exp_f32 v216, v216
    v_exp_f32 v217, v217
    v_smfmac_f32_32x32x32_bf16 v[32:47], v[68:71], v[176:183], v253
    buffer_load_dwordx4 v1, s[8:11], s95 offen offset:3072 sc1 lds
    v_exp_f32 v218, v218
    v_exp_f32 v219, v219
    v_exp_f32 v220, v220
    v_exp_f32 v221, v221
    v_smfmac_f32_32x32x32_bf16 v[48:63], v[68:71], v[208:215], v253
    s_waitcnt lgkmcnt(1)
    ds_read_b128 v[68:71], v245 offset:23296
    v_exp_f32 v222, v222
    v_exp_f32 v223, v223
    v_exp_f32 v112, v112
    v_exp_f32 v113, v113
    v_smfmac_f32_32x32x32_bf16 v[32:47], v[72:75], v[184:191], v253
    s_add_u32 s95, s0, 4096
    buffer_store_dwordx4 v[96:99], v1, s[8:11], s68 offen offset:0 sc1
    v_exp_f32 v114, v114
    v_exp_f32 v115, v115
    v_exp_f32 v116, v116
    v_exp_f32 v117, v117
    v_smfmac_f32_32x32x32_bf16 v[48:63], v[72:75], v[216:223], v253
    s_waitcnt lgkmcnt(0)
    ds_read_b128 v[72:75], v245 offset:23904
    v_exp_f32 v118, v118
    v_exp_f32 v119, v119
    v_exp_f32 v144, v144
    v_exp_f32 v145, v145
    v_mfma_f32_32x32x16_bf16 v[176:191], v[64:67], v[80:83], 0
    s_add_u32 m0, s67, 128000
    v_exp_f32 v146, v146
    v_exp_f32 v147, v147
    v_exp_f32 v148, v148
    v_exp_f32 v149, v149
    v_mfma_f32_32x32x16_bf16 v[208:223], v[64:67], v[84:87], 0
    ds_read_b128 v[64:67], v241 offset:6144
    v_exp_f32 v150, v150
    v_exp_f32 v151, v151
    v_exp_f32 v120, v120
    v_exp_f32 v121, v121
    v_mfma_f32_32x32x8bf16_1k v[176:191], v[76:77], v[90:91], v[176:191]
    v_exp_f32 v122, v122
    v_exp_f32 v123, v123
    v_exp_f32 v124, v124
    v_exp_f32 v125, v125
    v_mfma_f32_32x32x8bf16_1k v[208:223], v[76:77], v[94:95], v[208:223]
    v_exp_f32 v126, v126
    v_exp_f32 v127, v127
    v_exp_f32 v152, v152
    v_exp_f32 v153, v153
    v_smfmac_f32_32x32x32_bf16 v[32:47], v[68:71], v[112:119], v253
    buffer_load_dwordx4 v1, s[8:11], s95 offen offset:0 sc1 lds
    ds_read_b64 v[76:77], v243 offset:17152
    v_exp_f32 v154, v154
    v_exp_f32 v155, v155
    v_exp_f32 v156, v156
    v_exp_f32 v157, v157
    v_smfmac_f32_32x32x32_bf16 v[48:63], v[68:71], v[144:151], v253
    s_waitcnt lgkmcnt(2)
    ds_read_b128 v[68:71], v245 offset:24512
    v_exp_f32 v158, v158
    v_exp_f32 v159, v159
    v_exp_f32 v176, v176
    v_exp_f32 v177, v177
    v_smfmac_f32_32x32x32_bf16 v[32:47], v[72:75], v[120:127], v253
    buffer_store_dwordx4 v[100:103], v1, s[8:11], s69 offen offset:0 sc1
    v_exp_f32 v178, v178
    v_exp_f32 v179, v179
    v_exp_f32 v180, v180
    v_exp_f32 v181, v181
    v_smfmac_f32_32x32x32_bf16 v[48:63], v[72:75], v[152:159], v253
    s_waitcnt lgkmcnt(0)
    ds_read_b128 v[72:75], v245 offset:25120
    v_exp_f32 v182, v182
    v_exp_f32 v183, v183
    v_exp_f32 v208, v208
    v_exp_f32 v209, v209
    v_mfma_f32_32x32x16_bf16 v[112:127], v[64:67], v[80:83], 0
    v_exp_f32 v210, v210
    v_exp_f32 v211, v211
    v_exp_f32 v212, v212
    v_exp_f32 v213, v213
    v_mfma_f32_32x32x16_bf16 v[144:159], v[64:67], v[84:87], 0
    ds_read_b128 v[64:67], v241 offset:7168
    v_exp_f32 v214, v214
    v_exp_f32 v215, v215
    v_exp_f32 v184, v184
    v_exp_f32 v185, v185
    v_mfma_f32_32x32x8bf16_1k v[112:127], v[76:77], v[88:89], v[112:127]
    v_exp_f32 v186, v186
    v_exp_f32 v187, v187
    v_exp_f32 v188, v188
    v_exp_f32 v189, v189
    v_mfma_f32_32x32x8bf16_1k v[144:159], v[76:77], v[92:93], v[144:159]
    v_exp_f32 v190, v190
    v_exp_f32 v191, v191
    v_exp_f32 v216, v216
    v_exp_f32 v217, v217
    v_smfmac_f32_32x32x32_bf16 v[32:47], v[68:71], v[176:183], v253
    buffer_load_dwordx4 v1, s[8:11], s95 offen offset:1024 sc1 lds
    v_exp_f32 v218, v218
    v_exp_f32 v219, v219
    v_exp_f32 v220, v220
    v_exp_f32 v221, v221
    v_smfmac_f32_32x32x32_bf16 v[48:63], v[68:71], v[208:215], v253
    s_waitcnt lgkmcnt(1)
    ds_read_b128 v[68:71], v245 offset:25728
    v_exp_f32 v222, v222
    v_exp_f32 v223, v223
    v_exp_f32 v112, v112
    v_exp_f32 v113, v113
    v_smfmac_f32_32x32x32_bf16 v[32:47], v[72:75], v[184:191], v253
    buffer_store_dwordx4 v[104:107], v1, s[8:11], s70 offen offset:0 sc1
    v_exp_f32 v114, v114
    v_exp_f32 v115, v115
    v_exp_f32 v116, v116
    v_exp_f32 v117, v117
    v_smfmac_f32_32x32x32_bf16 v[48:63], v[72:75], v[216:223], v253
    s_waitcnt lgkmcnt(0)
    ds_read_b128 v[72:75], v245 offset:26336
    v_exp_f32 v118, v118
    v_exp_f32 v119, v119
    v_exp_f32 v144, v144
    v_exp_f32 v145, v145
    v_mfma_f32_32x32x16_bf16 v[176:191], v[64:67], v[80:83], 0
    v_exp_f32 v146, v146
    v_exp_f32 v147, v147
    v_exp_f32 v148, v148
    v_exp_f32 v149, v149
    v_mfma_f32_32x32x16_bf16 v[208:223], v[64:67], v[84:87], 0
    ds_read_b128 v[64:67], v241 offset:8192
    v_exp_f32 v150, v150
    v_exp_f32 v151, v151
    v_exp_f32 v120, v120
    v_exp_f32 v121, v121
    v_mfma_f32_32x32x8bf16_1k v[176:191], v[76:77], v[90:91], v[176:191]
    v_exp_f32 v122, v122
    v_exp_f32 v123, v123
    v_exp_f32 v124, v124
    v_exp_f32 v125, v125
    v_mfma_f32_32x32x8bf16_1k v[208:223], v[76:77], v[94:95], v[208:223]
    v_exp_f32 v126, v126
    v_exp_f32 v127, v127
    v_exp_f32 v152, v152
    v_exp_f32 v153, v153
    v_smfmac_f32_32x32x32_bf16 v[32:47], v[68:71], v[112:119], v253
    buffer_load_dwordx4 v1, s[8:11], s95 offen offset:2048 sc1 lds
    ds_read_b64 v[76:77], v243 offset:17408
    v_exp_f32 v154, v154
    v_exp_f32 v155, v155
    v_exp_f32 v156, v156
    v_exp_f32 v157, v157
    v_smfmac_f32_32x32x32_bf16 v[48:63], v[68:71], v[144:151], v253
    s_waitcnt lgkmcnt(2)
    ds_read_b128 v[68:71], v245 offset:26944
    v_exp_f32 v158, v158
    v_exp_f32 v159, v159
    v_exp_f32 v176, v176
    v_exp_f32 v177, v177
    v_smfmac_f32_32x32x32_bf16 v[32:47], v[72:75], v[120:127], v253
    buffer_store_dwordx4 v[108:111], v1, s[8:11], s71 offen offset:0 sc1
    v_exp_f32 v178, v178
    v_exp_f32 v179, v179
    v_exp_f32 v180, v180
    v_exp_f32 v181, v181
    v_smfmac_f32_32x32x32_bf16 v[48:63], v[72:75], v[152:159], v253
    s_waitcnt lgkmcnt(0)
    ds_read_b128 v[72:75], v245 offset:27552
    v_exp_f32 v182, v182
    v_exp_f32 v183, v183
    v_exp_f32 v208, v208
    v_exp_f32 v209, v209
    v_mfma_f32_32x32x16_bf16 v[112:127], v[64:67], v[80:83], 0
    v_exp_f32 v210, v210
    v_exp_f32 v211, v211
    v_exp_f32 v212, v212
    v_exp_f32 v213, v213
    v_mfma_f32_32x32x16_bf16 v[144:159], v[64:67], v[84:87], 0
    ds_read_b128 v[64:67], v241 offset:9216
    v_exp_f32 v214, v214
    v_exp_f32 v215, v215
    v_exp_f32 v184, v184
    v_exp_f32 v185, v185
    v_mfma_f32_32x32x8bf16_1k v[112:127], v[76:77], v[88:89], v[112:127]
    v_exp_f32 v186, v186
    v_exp_f32 v187, v187
    v_exp_f32 v188, v188
    v_exp_f32 v189, v189
    v_mfma_f32_32x32x8bf16_1k v[144:159], v[76:77], v[92:93], v[144:159]
    v_exp_f32 v190, v190
    v_exp_f32 v191, v191
    v_exp_f32 v216, v216
    v_exp_f32 v217, v217
    v_smfmac_f32_32x32x32_bf16 v[32:47], v[68:71], v[176:183], v253
    buffer_load_dwordx4 v1, s[8:11], s95 offen offset:3072 sc1 lds
    v_exp_f32 v218, v218
    v_exp_f32 v219, v219
    v_exp_f32 v220, v220
    v_exp_f32 v221, v221
    v_smfmac_f32_32x32x32_bf16 v[48:63], v[68:71], v[208:215], v253
    s_waitcnt lgkmcnt(1)
    ds_read_b128 v[68:71], v245 offset:28160
    v_exp_f32 v222, v222
    v_exp_f32 v223, v223
    v_exp_f32 v112, v112
    v_exp_f32 v113, v113
    v_smfmac_f32_32x32x32_bf16 v[32:47], v[72:75], v[184:191], v253
L_page10:
    s_cbranch_execz L_page14
    s_add_u32 s95, s0, 8192
    buffer_store_dwordx4 v[128:131], v1, s[8:11], s68 offen offset:1024 sc1
    v_exp_f32 v114, v114
    v_exp_f32 v115, v115
    v_exp_f32 v116, v116
    v_exp_f32 v117, v117
    v_smfmac_f32_32x32x32_bf16 v[48:63], v[72:75], v[216:223], v253
    s_waitcnt lgkmcnt(0)
    ds_read_b128 v[72:75], v245 offset:28768
    v_exp_f32 v118, v118
    v_exp_f32 v119, v119
    v_exp_f32 v144, v144
    v_exp_f32 v145, v145
    v_mfma_f32_32x32x16_bf16 v[176:191], v[64:67], v[80:83], 0
    s_add_u32 m0, s67, 132096
    v_exp_f32 v146, v146
    v_exp_f32 v147, v147
    v_exp_f32 v148, v148
    v_exp_f32 v149, v149
    v_mfma_f32_32x32x16_bf16 v[208:223], v[64:67], v[84:87], 0
    ds_read_b128 v[64:67], v241 offset:10240
    v_exp_f32 v150, v150
    v_exp_f32 v151, v151
    v_exp_f32 v120, v120
    v_exp_f32 v121, v121
    v_mfma_f32_32x32x8bf16_1k v[176:191], v[76:77], v[90:91], v[176:191]
    v_exp_f32 v122, v122
    v_exp_f32 v123, v123
    v_exp_f32 v124, v124
    v_exp_f32 v125, v125
    v_mfma_f32_32x32x8bf16_1k v[208:223], v[76:77], v[94:95], v[208:223]
    v_exp_f32 v126, v126
    v_exp_f32 v127, v127
    v_exp_f32 v152, v152
    v_exp_f32 v153, v153
    v_smfmac_f32_32x32x32_bf16 v[32:47], v[68:71], v[112:119], v253
    buffer_load_dwordx4 v1, s[8:11], s95 offen offset:0 sc1 lds
    ds_read_b64 v[76:77], v243 offset:17664
    v_exp_f32 v154, v154
    v_exp_f32 v155, v155
    v_exp_f32 v156, v156
    v_exp_f32 v157, v157
    v_smfmac_f32_32x32x32_bf16 v[48:63], v[68:71], v[144:151], v253
    s_waitcnt lgkmcnt(2)
    ds_read_b128 v[68:71], v245 offset:29376
    v_exp_f32 v158, v158
    v_exp_f32 v159, v159
    v_exp_f32 v176, v176
    v_exp_f32 v177, v177
    v_smfmac_f32_32x32x32_bf16 v[32:47], v[72:75], v[120:127], v253
    s_add_u32 s95, s0, 36864
    buffer_store_dwordx4 v[132:135], v1, s[8:11], s69 offen offset:1024 sc1
    v_exp_f32 v178, v178
    v_exp_f32 v179, v179
    v_exp_f32 v180, v180
    v_exp_f32 v181, v181
    v_smfmac_f32_32x32x32_bf16 v[48:63], v[72:75], v[152:159], v253
    s_waitcnt lgkmcnt(0)
    ds_read_b128 v[72:75], v245 offset:29984
    v_exp_f32 v182, v182
    v_exp_f32 v183, v183
    v_exp_f32 v208, v208
    v_exp_f32 v209, v209
    v_mfma_f32_32x32x16_bf16 v[112:127], v[64:67], v[80:83], 0
    s_cmp_eq_u32 s3, 0
    s_cselect_b32 s95, s95, 1073741824
    s_cselect_b32 s94, 160768, s55
    v_exp_f32 v210, v210
    v_exp_f32 v211, v211
    v_exp_f32 v212, v212
    v_exp_f32 v213, v213
    v_mfma_f32_32x32x16_bf16 v[144:159], v[64:67], v[84:87], 0
    ds_read_b128 v[64:67], v241 offset:11264
    v_exp_f32 v214, v214
    v_exp_f32 v215, v215
    v_exp_f32 v184, v184
    v_exp_f32 v185, v185
    v_mfma_f32_32x32x8bf16_1k v[112:127], v[76:77], v[88:89], v[112:127]
    v_exp_f32 v186, v186
    v_exp_f32 v187, v187
    v_exp_f32 v188, v188
    v_exp_f32 v189, v189
    v_mfma_f32_32x32x8bf16_1k v[144:159], v[76:77], v[92:93], v[144:159]
    v_exp_f32 v190, v190
    v_exp_f32 v191, v191
    v_exp_f32 v216, v216
    v_exp_f32 v217, v217
    v_smfmac_f32_32x32x32_bf16 v[32:47], v[68:71], v[176:183], v253
    s_mov_b32 m0, s94
    v_exp_f32 v218, v218
    v_exp_f32 v219, v219
    v_exp_f32 v220, v220
    v_exp_f32 v221, v221
    v_smfmac_f32_32x32x32_bf16 v[48:63], v[68:71], v[208:215], v253
    s_waitcnt lgkmcnt(1)
    ds_read_b128 v[68:71], v245 offset:30592
    v_exp_f32 v222, v222
    v_exp_f32 v223, v223
    v_exp_f32 v112, v112
    v_exp_f32 v113, v113
    v_smfmac_f32_32x32x32_bf16 v[32:47], v[72:75], v[184:191], v253
    buffer_store_dwordx4 v[136:139], v1, s[8:11], s70 offen offset:1024 sc1
    v_exp_f32 v114, v114
    v_exp_f32 v115, v115
    v_exp_f32 v116, v116
    v_exp_f32 v117, v117
    v_smfmac_f32_32x32x32_bf16 v[48:63], v[72:75], v[216:223], v253
    s_waitcnt lgkmcnt(0)
    ds_read_b128 v[72:75], v245 offset:31200
    v_exp_f32 v118, v118
    v_exp_f32 v119, v119
    v_exp_f32 v144, v144
    v_exp_f32 v145, v145
    v_mfma_f32_32x32x16_bf16 v[176:191], v[64:67], v[80:83], 0
    v_exp_f32 v146, v146
    v_exp_f32 v147, v147
    v_exp_f32 v148, v148
    v_exp_f32 v149, v149
    v_mfma_f32_32x32x16_bf16 v[208:223], v[64:67], v[84:87], 0
    ds_read_b128 v[64:67], v241 offset:12288
    v_exp_f32 v150, v150
    v_exp_f32 v151, v151
    v_exp_f32 v120, v120
    v_exp_f32 v121, v121
    v_mfma_f32_32x32x8bf16_1k v[176:191], v[76:77], v[90:91], v[176:191]
    v_exp_f32 v122, v122
    v_exp_f32 v123, v123
    v_exp_f32 v124, v124
    v_exp_f32 v125, v125
    v_mfma_f32_32x32x8bf16_1k v[208:223], v[76:77], v[94:95], v[208:223]
    v_exp_f32 v126, v126
    v_exp_f32 v127, v127
    v_exp_f32 v152, v152
    v_exp_f32 v153, v153
    v_smfmac_f32_32x32x32_bf16 v[32:47], v[68:71], v[112:119], v253
    buffer_load_dwordx4 v1, s[8:11], s95 offen sc1 lds
    ds_read_b64 v[76:77], v243 offset:17920
    v_exp_f32 v154, v154
    v_exp_f32 v155, v155
    v_exp_f32 v156, v156
    v_exp_f32 v157, v157
    v_smfmac_f32_32x32x32_bf16 v[48:63], v[68:71], v[144:151], v253
    s_waitcnt lgkmcnt(2)
    ds_read_b128 v[68:71], v245 offset:31808
    v_exp_f32 v158, v158
    v_exp_f32 v159, v159
    v_exp_f32 v176, v176
    v_exp_f32 v177, v177
    v_smfmac_f32_32x32x32_bf16 v[32:47], v[72:75], v[120:127], v253
    buffer_store_dwordx4 v[140:143], v1, s[8:11], s71 offen offset:1024 sc1
    v_exp_f32 v178, v178
    v_exp_f32 v179, v179
    v_exp_f32 v180, v180
    v_exp_f32 v181, v181
    v_smfmac_f32_32x32x32_bf16 v[48:63], v[72:75], v[152:159], v253
    s_waitcnt lgkmcnt(0)
    ds_read_b128 v[72:75], v245 offset:32416
    v_exp_f32 v182, v182
    v_exp_f32 v183, v183
    v_exp_f32 v208, v208
    v_exp_f32 v209, v209
    v_mfma_f32_32x32x16_bf16 v[112:127], v[64:67], v[80:83], 0
    v_exp_f32 v210, v210
    v_exp_f32 v211, v211
    v_exp_f32 v212, v212
    v_exp_f32 v213, v213
    v_mfma_f32_32x32x16_bf16 v[144:159], v[64:67], v[84:87], 0
    ds_read_b128 v[64:67], v241 offset:13312
    v_exp_f32 v214, v214
    v_exp_f32 v215, v215
    v_exp_f32 v184, v184
    v_exp_f32 v185, v185
    v_mfma_f32_32x32x8bf16_1k v[112:127], v[76:77], v[88:89], v[112:127]
    v_exp_f32 v186, v186
    v_exp_f32 v187, v187
    v_exp_f32 v188, v188
    v_exp_f32 v189, v189
    v_mfma_f32_32x32x8bf16_1k v[144:159], v[76:77], v[92:93], v[144:159]
    v_exp_f32 v190, v190
    v_exp_f32 v191, v191
    v_exp_f32 v216, v216
    v_exp_f32 v217, v217
    v_smfmac_f32_32x32x32_bf16 v[32:47], v[68:71], v[176:183], v253
    v_exp_f32 v218, v218
    v_exp_f32 v219, v219
    v_exp_f32 v220, v220
    v_exp_f32 v221, v221
    v_smfmac_f32_32x32x32_bf16 v[48:63], v[68:71], v[208:215], v253
    s_waitcnt lgkmcnt(1)
    ds_read_b128 v[68:71], v245 offset:33024
    v_exp_f32 v222, v222
    v_exp_f32 v223, v223
    v_exp_f32 v112, v112
    v_exp_f32 v113, v113
    v_smfmac_f32_32x32x32_bf16 v[32:47], v[72:75], v[184:191], v253
    buffer_store_dwordx4 v[160:163], v1, s[8:11], s68 offen offset:2048 sc1
    v_exp_f32 v114, v114
    v_exp_f32 v115, v115
    v_exp_f32 v116, v116
    v_exp_f32 v117, v117
    v_smfmac_f32_32x32x32_bf16 v[48:63], v[72:75], v[216:223], v253
    s_waitcnt lgkmcnt(0)
    ds_read_b128 v[72:75], v245 offset:33632
    v_exp_f32 v118, v118
    v_exp_f32 v119, v119
    v_exp_f32 v144, v144
    v_exp_f32 v145, v145
    v_mfma_f32_32x32x16_bf16 v[176:191], v[64:67], v[80:83], 0
    v_exp_f32 v146, v146
    v_exp_f32 v147, v147
    v_exp_f32 v148, v148
    v_exp_f32 v149, v149
    v_mfma_f32_32x32x16_bf16 v[208:223], v[64:67], v[84:87], 0
    ds_read_b128 v[64:67], v241 offset:14336
    v_exp_f32 v150, v150
    v_exp_f32 v151, v151
    v_exp_f32 v120, v120
    v_exp_f32 v121, v121
    v_mfma_f32_32x32x8bf16_1k v[176:191], v[76:77], v[90:91], v[176:191]
    v_exp_f32 v122, v122
    v_exp_f32 v123, v123
    v_exp_f32 v124, v124
    v_exp_f32 v125, v125
    v_mfma_f32_32x32x8bf16_1k v[208:223], v[76:77], v[94:95], v[208:223]
    v_exp_f32 v126, v126
    v_exp_f32 v127, v127
    v_exp_f32 v152, v152
    v_exp_f32 v153, v153
    v_smfmac_f32_32x32x32_bf16 v[32:47], v[68:71], v[112:119], v253
    ds_read_b64 v[76:77], v243 offset:18176
    v_exp_f32 v154, v154
    v_exp_f32 v155, v155
    v_exp_f32 v156, v156
    v_exp_f32 v157, v157
    v_smfmac_f32_32x32x32_bf16 v[48:63], v[68:71], v[144:151], v253
    s_waitcnt lgkmcnt(2)
    ds_read_b128 v[68:71], v245 offset:34240
    v_exp_f32 v158, v158
    v_exp_f32 v159, v159
    v_exp_f32 v176, v176
    v_exp_f32 v177, v177
    v_smfmac_f32_32x32x32_bf16 v[32:47], v[72:75], v[120:127], v253
    buffer_store_dwordx4 v[164:167], v1, s[8:11], s69 offen offset:2048 sc1
    v_exp_f32 v178, v178
    v_exp_f32 v179, v179
    v_exp_f32 v180, v180
    v_exp_f32 v181, v181
    v_smfmac_f32_32x32x32_bf16 v[48:63], v[72:75], v[152:159], v253
    s_waitcnt lgkmcnt(0)
    ds_read_b128 v[72:75], v245 offset:34848
    v_exp_f32 v182, v182
    v_exp_f32 v183, v183
    v_exp_f32 v208, v208
    v_exp_f32 v209, v209
    v_mfma_f32_32x32x16_bf16 v[112:127], v[64:67], v[80:83], 0
    v_exp_f32 v210, v210
    v_exp_f32 v211, v211
    v_exp_f32 v212, v212
    v_exp_f32 v213, v213
    v_mfma_f32_32x32x16_bf16 v[144:159], v[64:67], v[84:87], 0
    ds_read_b128 v[64:67], v241 offset:15360
    v_exp_f32 v214, v214
    v_exp_f32 v215, v215
    v_exp_f32 v184, v184
    v_exp_f32 v185, v185
    v_mfma_f32_32x32x8bf16_1k v[112:127], v[76:77], v[88:89], v[112:127]
    v_exp_f32 v186, v186
    v_exp_f32 v187, v187
    v_exp_f32 v188, v188
    v_exp_f32 v189, v189
    v_mfma_f32_32x32x8bf16_1k v[144:159], v[76:77], v[92:93], v[144:159]
    v_exp_f32 v190, v190
    v_exp_f32 v191, v191
    v_exp_f32 v216, v216
    v_exp_f32 v217, v217
    v_smfmac_f32_32x32x32_bf16 v[32:47], v[68:71], v[176:183], v253
    v_exp_f32 v218, v218
    v_exp_f32 v219, v219
    v_exp_f32 v220, v220
    v_exp_f32 v221, v221
    v_smfmac_f32_32x32x32_bf16 v[48:63], v[68:71], v[208:215], v253
    s_waitcnt lgkmcnt(1)
    ds_read_b128 v[68:71], v245 offset:35456
    v_exp_f32 v222, v222
    v_exp_f32 v223, v223
    v_exp_f32 v112, v112
    v_exp_f32 v113, v113
    v_smfmac_f32_32x32x32_bf16 v[32:47], v[72:75], v[184:191], v253
    buffer_store_dwordx4 v[168:171], v1, s[8:11], s70 offen offset:2048 sc1
    v_exp_f32 v114, v114
    v_exp_f32 v115, v115
    v_exp_f32 v116, v116
    v_exp_f32 v117, v117
    v_smfmac_f32_32x32x32_bf16 v[48:63], v[72:75], v[216:223], v253
    s_waitcnt lgkmcnt(0)
    ds_read_b128 v[72:75], v245 offset:36064
    v_exp_f32 v118, v118
    v_exp_f32 v119, v119
    v_exp_f32 v144, v144
    v_exp_f32 v145, v145
    v_mfma_f32_32x32x16_bf16 v[176:191], v[64:67], v[80:83], 0
    s_waitcnt vmcnt(4)
    s_barrier
    v_exp_f32 v146, v146
    v_exp_f32 v147, v147
    v_exp_f32 v148, v148
    v_exp_f32 v149, v149
    v_mfma_f32_32x32x16_bf16 v[208:223], v[64:67], v[84:87], 0
    ds_read_b128 v[64:67], v242 offset:0
    v_exp_f32 v150, v150
    v_exp_f32 v151, v151
    v_exp_f32 v120, v120
    v_exp_f32 v121, v121
    v_mfma_f32_32x32x8bf16_1k v[176:191], v[76:77], v[90:91], v[176:191]
    v_exp_f32 v122, v122
    v_exp_f32 v123, v123
    v_exp_f32 v124, v124
    v_exp_f32 v125, v125
    v_mfma_f32_32x32x8bf16_1k v[208:223], v[76:77], v[94:95], v[208:223]
    v_exp_f32 v126, v126
    v_exp_f32 v127, v127
    v_exp_f32 v152, v152
    v_exp_f32 v153, v153
    v_smfmac_f32_32x32x32_bf16 v[32:47], v[68:71], v[112:119], v253
    ds_read_b64 v[76:77], v244 offset:16384
    v_exp_f32 v154, v154
    v_exp_f32 v155, v155
    v_exp_f32 v156, v156
    v_exp_f32 v157, v157
    v_smfmac_f32_32x32x32_bf16 v[48:63], v[68:71], v[144:151], v253
    s_waitcnt lgkmcnt(2)
    ds_read_b128 v[68:71], v245 offset:36672
    v_exp_f32 v158, v158
    v_exp_f32 v159, v159
    v_exp_f32 v176, v176
    v_exp_f32 v177, v177
    v_smfmac_f32_32x32x32_bf16 v[32:47], v[72:75], v[120:127], v253
    buffer_store_dwordx4 v[172:175], v1, s[8:11], s71 offen offset:2048 sc1
    v_exp_f32 v178, v178
    v_exp_f32 v179, v179
    v_exp_f32 v180, v180
    v_exp_f32 v181, v181
    v_smfmac_f32_32x32x32_bf16 v[48:63], v[72:75], v[152:159], v253
    s_waitcnt lgkmcnt(0)
    ds_read_b128 v[72:75], v245 offset:37280
    v_exp_f32 v182, v182
    v_exp_f32 v183, v183
    v_exp_f32 v208, v208
    v_exp_f32 v209, v209
    v_mfma_f32_32x32x16_bf16 v[112:127], v[64:67], v[80:83], 0
    v_exp_f32 v210, v210
    v_exp_f32 v211, v211
    v_exp_f32 v212, v212
    v_exp_f32 v213, v213
    v_mfma_f32_32x32x16_bf16 v[144:159], v[64:67], v[84:87], 0
    ds_read_b128 v[64:67], v242 offset:1024
    v_exp_f32 v214, v214
    v_exp_f32 v215, v215
    v_exp_f32 v184, v184
    v_exp_f32 v185, v185
    v_mfma_f32_32x32x8bf16_1k v[112:127], v[76:77], v[88:89], v[112:127]
    v_exp_f32 v186, v186
    v_exp_f32 v187, v187
    v_exp_f32 v188, v188
    v_exp_f32 v189, v189
    v_mfma_f32_32x32x8bf16_1k v[144:159], v[76:77], v[92:93], v[144:159]
    v_exp_f32 v190, v190
    v_exp_f32 v191, v191
    v_exp_f32 v216, v216
    v_exp_f32 v217, v217
    v_smfmac_f32_32x32x32_bf16 v[32:47], v[68:71], v[176:183], v253
    v_exp_f32 v218, v218
    v_exp_f32 v219, v219
    v_exp_f32 v220, v220
    v_exp_f32 v221, v221
    v_smfmac_f32_32x32x32_bf16 v[48:63], v[68:71], v[208:215], v253
    s_waitcnt lgkmcnt(1)
    ds_read_b128 v[68:71], v246 offset:18432
    v_exp_f32 v222, v222
    v_exp_f32 v223, v223
    v_exp_f32 v112, v112
    v_exp_f32 v113, v113
    v_smfmac_f32_32x32x32_bf16 v[32:47], v[72:75], v[184:191], v253
    s_barrier
    v_exp_f32 v114, v114
    v_exp_f32 v115, v115
    v_exp_f32 v116, v116
    v_exp_f32 v117, v117
    v_smfmac_f32_32x32x32_bf16 v[48:63], v[72:75], v[216:223], v253
    s_waitcnt lgkmcnt(0)
    ds_read_b128 v[72:75], v246 offset:19040
    v_exp_f32 v118, v118
    v_exp_f32 v119, v119
    v_exp_f32 v144, v144
    v_exp_f32 v145, v145
    v_mfma_f32_32x32x16_bf16 v[176:191], v[64:67], v[80:83], 0
    s_add_u32 s95, s1, 0
    v_exp_f32 v146, v146
    v_exp_f32 v147, v147
    v_exp_f32 v148, v148
    v_exp_f32 v149, v149
    v_mfma_f32_32x32x16_bf16 v[208:223], v[64:67], v[84:87], 0
    ds_read_b128 v[64:67], v242 offset:2048
    v_exp_f32 v150, v150
    v_exp_f32 v151, v151
    v_exp_f32 v120, v120
    v_exp_f32 v121, v121
    v_mfma_f32_32x32x8bf16_1k v[176:191], v[76:77], v[90:91], v[176:191]
    v_exp_f32 v122, v122
    v_exp_f32 v123, v123
    v_exp_f32 v124, v124
    v_exp_f32 v125, v125
    v_mfma_f32_32x32x8bf16_1k v[208:223], v[76:77], v[94:95], v[208:223]
    v_exp_f32 v126, v126
    v_exp_f32 v127, v127
    v_exp_f32 v152, v152
    v_exp_f32 v153, v153
    v_smfmac_f32_32x32x32_bf16 v[32:47], v[68:71], v[112:119], v253
    s_add_u32 m0, s67, 86016
    ds_read_b64 v[76:77], v244 offset:16640
    v_exp_f32 v154, v154
    v_exp_f32 v155, v155
    v_exp_f32 v156, v156
    v_exp_f32 v157, v157
    v_smfmac_f32_32x32x32_bf16 v[48:63], v[68:71], v[144:151], v253
    s_waitcnt lgkmcnt(2)
    ds_read_b128 v[68:71], v246 offset:19648
    v_exp_f32 v158, v158
    v_exp_f32 v159, v159
    v_exp_f32 v176, v176
    v_exp_f32 v177, v177
    v_smfmac_f32_32x32x32_bf16 v[32:47], v[72:75], v[120:127], v253
    buffer_store_dwordx4 v[192:195], v1, s[8:11], s68 offen offset:3072 sc1
    v_exp_f32 v178, v178
    v_exp_f32 v179, v179
    v_exp_f32 v180, v180
    v_exp_f32 v181, v181
    v_smfmac_f32_32x32x32_bf16 v[48:63], v[72:75], v[152:159], v253
    s_waitcnt lgkmcnt(0)
    ds_read_b128 v[72:75], v246 offset:20256
    v_exp_f32 v182, v182
    v_exp_f32 v183, v183
    v_exp_f32 v208, v208
    v_exp_f32 v209, v209
    v_mfma_f32_32x32x16_bf16 v[112:127], v[64:67], v[80:83], 0
    v_exp_f32 v210, v210
    v_exp_f32 v211, v211
    v_exp_f32 v212, v212
    v_exp_f32 v213, v213
    v_mfma_f32_32x32x16_bf16 v[144:159], v[64:67], v[84:87], 0
    ds_read_b128 v[64:67], v242 offset:3072
    v_exp_f32 v214, v214
    v_exp_f32 v215, v215
    v_exp_f32 v184, v184
    v_exp_f32 v185, v185
    v_mfma_f32_32x32x8bf16_1k v[112:127], v[76:77], v[88:89], v[112:127]
    v_exp_f32 v186, v186
    v_exp_f32 v187, v187
    v_exp_f32 v188, v188
    v_exp_f32 v189, v189
    v_mfma_f32_32x32x8bf16_1k v[144:159], v[76:77], v[92:93], v[144:159]
    v_exp_f32 v190, v190
    v_exp_f32 v191, v191
    v_exp_f32 v216, v216
    v_exp_f32 v217, v217
    v_smfmac_f32_32x32x32_bf16 v[32:47], v[68:71], v[176:183], v253
    buffer_load_dwordx4 v1, s[8:11], s95 offen offset:0 sc1 lds
    v_exp_f32 v218, v218
    v_exp_f32 v219, v219
    v_exp_f32 v220, v220
    v_exp_f32 v221, v221
    v_smfmac_f32_32x32x32_bf16 v[48:63], v[68:71], v[208:215], v253
    s_waitcnt lgkmcnt(1)
    ds_read_b128 v[68:71], v246 offset:20864
    v_exp_f32 v222, v222
    v_exp_f32 v223, v223
    v_exp_f32 v112, v112
    v_exp_f32 v113, v113
    v_smfmac_f32_32x32x32_bf16 v[32:47], v[72:75], v[184:191], v253
    buffer_store_dwordx4 v[196:199], v1, s[8:11], s69 offen offset:3072 sc1
    v_exp_f32 v114, v114
    v_exp_f32 v115, v115
    v_exp_f32 v116, v116
    v_exp_f32 v117, v117
    v_smfmac_f32_32x32x32_bf16 v[48:63], v[72:75], v[216:223], v253
    s_waitcnt lgkmcnt(0)
    ds_read_b128 v[72:75], v246 offset:21472
    v_exp_f32 v118, v118
    v_exp_f32 v119, v119
    v_exp_f32 v144, v144
    v_exp_f32 v145, v145
    v_mfma_f32_32x32x16_bf16 v[176:191], v[64:67], v[80:83], 0
    v_exp_f32 v146, v146
    v_exp_f32 v147, v147
    v_exp_f32 v148, v148
    v_exp_f32 v149, v149
    v_mfma_f32_32x32x16_bf16 v[208:223], v[64:67], v[84:87], 0
    ds_read_b128 v[64:67], v242 offset:4096
    v_exp_f32 v150, v150
    v_exp_f32 v151, v151
    v_exp_f32 v120, v120
    v_exp_f32 v121, v121
    v_mfma_f32_32x32x8bf16_1k v[176:191], v[76:77], v[90:91], v[176:191]
    v_exp_f32 v122, v122
    v_exp_f32 v123, v123
    v_exp_f32 v124, v124
    v_exp_f32 v125, v125
    v_mfma_f32_32x32x8bf16_1k v[208:223], v[76:77], v[94:95], v[208:223]
    v_exp_f32 v126, v126
    v_exp_f32 v127, v127
    v_exp_f32 v152, v152
    v_exp_f32 v153, v153
    v_smfmac_f32_32x32x32_bf16 v[32:47], v[68:71], v[112:119], v253
    buffer_load_dwordx4 v1, s[8:11], s95 offen offset:1024 sc1 lds
    ds_read_b64 v[76:77], v244 offset:16896
    v_exp_f32 v154, v154
    v_exp_f32 v155, v155
    v_exp_f32 v156, v156
    v_exp_f32 v157, v157
    v_smfmac_f32_32x32x32_bf16 v[48:63], v[68:71], v[144:151], v253
    s_waitcnt lgkmcnt(2)
    ds_read_b128 v[68:71], v246 offset:22080
    v_exp_f32 v158, v158
    v_exp_f32 v159, v159
    v_exp_f32 v176, v176
    v_exp_f32 v177, v177
    v_smfmac_f32_32x32x32_bf16 v[32:47], v[72:75], v[120:127], v253
    buffer_store_dwordx4 v[200:203], v1, s[8:11], s70 offen offset:3072 sc1
    v_exp_f32 v178, v178
    v_exp_f32 v179, v179
    v_exp_f32 v180, v180
    v_exp_f32 v181, v181
    v_smfmac_f32_32x32x32_bf16 v[48:63], v[72:75], v[152:159], v253
    s_waitcnt lgkmcnt(0)
    ds_read_b128 v[72:75], v246 offset:22688
    v_exp_f32 v182, v182
    v_exp_f32 v183, v183
    v_exp_f32 v208, v208
    v_exp_f32 v209, v209
    v_mfma_f32_32x32x16_bf16 v[112:127], v[64:67], v[80:83], 0
    v_exp_f32 v210, v210
    v_exp_f32 v211, v211
    v_exp_f32 v212, v212
    v_exp_f32 v213, v213
    v_mfma_f32_32x32x16_bf16 v[144:159], v[64:67], v[84:87], 0
    ds_read_b128 v[64:67], v242 offset:5120
    v_exp_f32 v214, v214
    v_exp_f32 v215, v215
    v_exp_f32 v184, v184
    v_exp_f32 v185, v185
    v_mfma_f32_32x32x8bf16_1k v[112:127], v[76:77], v[88:89], v[112:127]
    v_exp_f32 v186, v186
    v_exp_f32 v187, v187
    v_exp_f32 v188, v188
    v_exp_f32 v189, v189
    v_mfma_f32_32x32x8bf16_1k v[144:159], v[76:77], v[92:93], v[144:159]
    v_exp_f32 v190, v190
    v_exp_f32 v191, v191
    v_exp_f32 v216, v216
    v_exp_f32 v217, v217
    v_smfmac_f32_32x32x32_bf16 v[32:47], v[68:71], v[176:183], v253
    buffer_load_dwordx4 v1, s[8:11], s95 offen offset:2048 sc1 lds
    v_exp_f32 v218, v218
    v_exp_f32 v219, v219
    v_exp_f32 v220, v220
    v_exp_f32 v221, v221
    v_smfmac_f32_32x32x32_bf16 v[48:63], v[68:71], v[208:215], v253
    s_waitcnt lgkmcnt(1)
    ds_read_b128 v[68:71], v246 offset:23296
    v_exp_f32 v222, v222
    v_exp_f32 v223, v223
    v_exp_f32 v112, v112
    v_exp_f32 v113, v113
    v_smfmac_f32_32x32x32_bf16 v[32:47], v[72:75], v[184:191], v253
    buffer_store_dwordx4 v[204:207], v1, s[8:11], s71 offen offset:3072 sc1
    v_exp_f32 v114, v114
    v_exp_f32 v115, v115
    v_exp_f32 v116, v116
    v_exp_f32 v117, v117
    v_smfmac_f32_32x32x32_bf16 v[48:63], v[72:75], v[216:223], v253
    s_waitcnt lgkmcnt(0)
    ds_read_b128 v[72:75], v246 offset:23904
    v_exp_f32 v118, v118
    v_exp_f32 v119, v119
    v_exp_f32 v144, v144
    v_exp_f32 v145, v145
    v_mfma_f32_32x32x16_bf16 v[176:191], v[64:67], v[80:83], 0
    v_exp_f32 v146, v146
    v_exp_f32 v147, v147
    v_exp_f32 v148, v148
    v_exp_f32 v149, v149
    v_mfma_f32_32x32x16_bf16 v[208:223], v[64:67], v[84:87], 0
    ds_read_b128 v[64:67], v242 offset:6144
    v_exp_f32 v150, v150
    v_exp_f32 v151, v151
    v_exp_f32 v120, v120
    v_exp_f32 v121, v121
    v_mfma_f32_32x32x8bf16_1k v[176:191], v[76:77], v[90:91], v[176:191]
    v_exp_f32 v122, v122
    v_exp_f32 v123, v123
    v_exp_f32 v124, v124
    v_exp_f32 v125, v125
    v_mfma_f32_32x32x8bf16_1k v[208:223], v[76:77], v[94:95], v[208:223]
    v_exp_f32 v126, v126
    v_exp_f32 v127, v127
    v_exp_f32 v152, v152
    v_exp_f32 v153, v153
    v_smfmac_f32_32x32x32_bf16 v[32:47], v[68:71], v[112:119], v253
    buffer_load_dwordx4 v1, s[8:11], s95 offen offset:3072 sc1 lds
    ds_read_b64 v[76:77], v244 offset:17152
    v_exp_f32 v154, v154
    v_exp_f32 v155, v155
    v_exp_f32 v156, v156
    v_exp_f32 v157, v157
    v_smfmac_f32_32x32x32_bf16 v[48:63], v[68:71], v[144:151], v253
    s_waitcnt lgkmcnt(2)
    ds_read_b128 v[68:71], v246 offset:24512
    v_exp_f32 v158, v158
    v_exp_f32 v159, v159
    v_exp_f32 v176, v176
    v_exp_f32 v177, v177
    v_smfmac_f32_32x32x32_bf16 v[32:47], v[72:75], v[120:127], v253
    s_add_u32 s95, s1, 4096
    v_exp_f32 v178, v178
    v_exp_f32 v179, v179
    v_exp_f32 v180, v180
    v_exp_f32 v181, v181
    v_smfmac_f32_32x32x32_bf16 v[48:63], v[72:75], v[152:159], v253
    s_waitcnt lgkmcnt(0)
    ds_read_b128 v[72:75], v246 offset:25120
    v_exp_f32 v182, v182
    v_exp_f32 v183, v183
    v_exp_f32 v208, v208
    v_exp_f32 v209, v209
    v_mfma_f32_32x32x16_bf16 v[112:127], v[64:67], v[80:83], 0
    s_add_u32 m0, s67, 90112
    v_exp_f32 v210, v210
    v_exp_f32 v211, v211
    v_exp_f32 v212, v212
    v_exp_f32 v213, v213
    v_mfma_f32_32x32x16_bf16 v[144:159], v[64:67], v[84:87], 0
    ds_read_b128 v[64:67], v242 offset:7168
    v_exp_f32 v214, v214
    v_exp_f32 v215, v215
    v_exp_f32 v184, v184
    v_exp_f32 v185, v185
    v_mfma_f32_32x32x8bf16_1k v[112:127], v[76:77], v[88:89], v[112:127]
    v_exp_f32 v186, v186
    v_exp_f32 v187, v187
    v_exp_f32 v188, v188
    v_exp_f32 v189, v189
    v_mfma_f32_32x32x8bf16_1k v[144:159], v[76:77], v[92:93], v[144:159]
    v_exp_f32 v190, v190
    v_exp_f32 v191, v191
    v_exp_f32 v216, v216
    v_exp_f32 v217, v217
    v_smfmac_f32_32x32x32_bf16 v[32:47], v[68:71], v[176:183], v253
    buffer_load_dwordx4 v1, s[8:11], s95 offen offset:0 sc1 lds
    v_exp_f32 v218, v218
    v_exp_f32 v219, v219
    v_exp_f32 v220, v220
    v_exp_f32 v221, v221
    v_smfmac_f32_32x32x32_bf16 v[48:63], v[68:71], v[208:215], v253
    s_waitcnt lgkmcnt(1)
    ds_read_b128 v[68:71], v246 offset:25728
    v_exp_f32 v222, v222
    v_exp_f32 v223, v223
    v_exp_f32 v112, v112
    v_exp_f32 v113, v113
    v_smfmac_f32_32x32x32_bf16 v[32:47], v[72:75], v[184:191], v253
    v_exp_f32 v114, v114
    v_exp_f32 v115, v115
    v_exp_f32 v116, v116
    v_exp_f32 v117, v117
    v_smfmac_f32_32x32x32_bf16 v[48:63], v[72:75], v[216:223], v253
    s_waitcnt lgkmcnt(0)
    ds_read_b128 v[72:75], v246 offset:26336
    v_exp_f32 v118, v118
    v_exp_f32 v119, v119
    v_exp_f32 v144, v144
    v_exp_f32 v145, v145
    v_mfma_f32_32x32x16_bf16 v[176:191], v[64:67], v[80:83], 0
    v_exp_f32 v146, v146
    v_exp_f32 v147, v147
    v_exp_f32 v148, v148
    v_exp_f32 v149, v149
    v_mfma_f32_32x32x16_bf16 v[208:223], v[64:67], v[84:87], 0
    ds_read_b128 v[64:67], v242 offset:8192
    v_exp_f32 v150, v150
    v_exp_f32 v151, v151
    v_exp_f32 v120, v120
    v_exp_f32 v121, v121
    v_mfma_f32_32x32x8bf16_1k v[176:191], v[76:77], v[90:91], v[176:191]
    v_exp_f32 v122, v122
    v_exp_f32 v123, v123
    v_exp_f32 v124, v124
    v_exp_f32 v125, v125
    v_mfma_f32_32x32x8bf16_1k v[208:223], v[76:77], v[94:95], v[208:223]
    v_exp_f32 v126, v126
    v_exp_f32 v127, v127
    v_exp_f32 v152, v152
    v_exp_f32 v153, v153
    v_smfmac_f32_32x32x32_bf16 v[32:47], v[68:71], v[112:119], v253
    buffer_load_dwordx4 v1, s[8:11], s95 offen offset:1024 sc1 lds
    ds_read_b64 v[76:77], v244 offset:17408
    v_exp_f32 v154, v154
    v_exp_f32 v155, v155
    v_exp_f32 v156, v156
    v_exp_f32 v157, v157
    v_smfmac_f32_32x32x32_bf16 v[48:63], v[68:71], v[144:151], v253
    s_waitcnt lgkmcnt(2)
    ds_read_b128 v[68:71], v246 offset:26944
    v_exp_f32 v158, v158
    v_exp_f32 v159, v159
    v_exp_f32 v176, v176
    v_exp_f32 v177, v177
    v_smfmac_f32_32x32x32_bf16 v[32:47], v[72:75], v[120:127], v253
    v_exp_f32 v178, v178
    v_exp_f32 v179, v179
    v_exp_f32 v180, v180
    v_exp_f32 v181, v181
    v_smfmac_f32_32x32x32_bf16 v[48:63], v[72:75], v[152:159], v253
    s_waitcnt lgkmcnt(0)
    ds_read_b128 v[72:75], v246 offset:27552
    v_exp_f32 v182, v182
    v_exp_f32 v183, v183
    v_exp_f32 v208, v208
    v_exp_f32 v209, v209
    v_mfma_f32_32x32x16_bf16 v[112:127], v[64:67], v[80:83], 0
    s_waitcnt vmcnt(3)
    v_exp_f32 v210, v210
    v_exp_f32 v211, v211
    v_exp_f32 v212, v212
    v_exp_f32 v213, v213
    v_mfma_f32_32x32x16_bf16 v[144:159], v[64:67], v[84:87], 0
    ds_read_b128 v[64:67], v242 offset:9216
    v_exp_f32 v214, v214
    v_exp_f32 v215, v215
    v_exp_f32 v184, v184
    v_exp_f32 v185, v185
    v_mfma_f32_32x32x8bf16_1k v[112:127], v[76:77], v[88:89], v[112:127]
    v_exp_f32 v186, v186
    v_exp_f32 v187, v187
    v_exp_f32 v188, v188
    v_exp_f32 v189, v189
    v_mfma_f32_32x32x8bf16_1k v[144:159], v[76:77], v[92:93], v[144:159]
    v_exp_f32 v190, v190
    v_exp_f32 v191, v191
    v_exp_f32 v216, v216
    v_exp_f32 v217, v217
    v_smfmac_f32_32x32x32_bf16 v[32:47], v[68:71], v[176:183], v253
    buffer_load_dwordx4 v1, s[8:11], s95 offen offset:2048 sc1 lds
    v_exp_f32 v218, v218
    v_exp_f32 v219, v219
    v_exp_f32 v220, v220
    v_exp_f32 v221, v221
    v_smfmac_f32_32x32x32_bf16 v[48:63], v[68:71], v[208:215], v253
    s_waitcnt lgkmcnt(1)
    ds_read_b128 v[68:71], v246 offset:28160
    v_exp_f32 v222, v222
    v_exp_f32 v223, v223
    v_exp_f32 v112, v112
    v_exp_f32 v113, v113
    v_smfmac_f32_32x32x32_bf16 v[32:47], v[72:75], v[184:191], v253
    v_exp_f32 v114, v114
    v_exp_f32 v115, v115
    v_exp_f32 v116, v116
    v_exp_f32 v117, v117
    v_smfmac_f32_32x32x32_bf16 v[48:63], v[72:75], v[216:223], v253
    s_waitcnt lgkmcnt(0)
    ds_read_b128 v[72:75], v246 offset:28768
    v_exp_f32 v118, v118
    v_exp_f32 v119, v119
    v_exp_f32 v144, v144
    v_exp_f32 v145, v145
    v_mfma_f32_32x32x16_bf16 v[176:191], v[64:67], v[80:83], 0
    v_mov_b32 v240, s40
    v_exp_f32 v146, v146
    v_exp_f32 v147, v147
    v_exp_f32 v148, v148
    v_exp_f32 v149, v149
    v_mfma_f32_32x32x16_bf16 v[208:223], v[64:67], v[84:87], 0
    ds_read_b128 v[64:67], v242 offset:10240
    v_exp_f32 v150, v150
    v_exp_f32 v151, v151
    v_exp_f32 v120, v120
    v_exp_f32 v121, v121
    v_mfma_f32_32x32x8bf16_1k v[176:191], v[76:77], v[90:91], v[176:191]
    v_exp_f32 v122, v122
    v_exp_f32 v123, v123
    v_exp_f32 v124, v124
    v_exp_f32 v125, v125
    v_mfma_f32_32x32x8bf16_1k v[208:223], v[76:77], v[94:95], v[208:223]
    v_exp_f32 v126, v126
    v_exp_f32 v127, v127
    v_exp_f32 v152, v152
    v_exp_f32 v153, v153
    v_smfmac_f32_32x32x32_bf16 v[32:47], v[68:71], v[112:119], v253
    buffer_load_dwordx4 v1, s[8:11], s95 offen offset:3072 sc1 lds
    ds_read_b64 v[76:77], v244 offset:17664
    v_exp_f32 v154, v154
L_page11:
    s_cbranch_execz L_pagedone
    v_exp_f32 v155, v155
    v_exp_f32 v156, v156
    v_exp_f32 v157, v157
    v_smfmac_f32_32x32x32_bf16 v[48:63], v[68:71], v[144:151], v253
    s_waitcnt lgkmcnt(2)
    ds_read_b128 v[68:71], v246 offset:29376
    v_exp_f32 v158, v158
    v_exp_f32 v159, v159
    v_exp_f32 v176, v176
    v_exp_f32 v177, v177
    v_smfmac_f32_32x32x32_bf16 v[32:47], v[72:75], v[120:127], v253
    s_add_u32 s95, s1, 8192
    buffer_store_dword v240, v5, s[8:11], s86 offen offset:0 sc1
    v_exp_f32 v178, v178
    v_exp_f32 v179, v179
    v_exp_f32 v180, v180
    v_exp_f32 v181, v181
    v_smfmac_f32_32x32x32_bf16 v[48:63], v[72:75], v[152:159], v253
    s_waitcnt lgkmcnt(0)
    ds_read_b128 v[72:75], v246 offset:29984
    v_exp_f32 v182, v182
    v_exp_f32 v183, v183
    v_exp_f32 v208, v208
    v_exp_f32 v209, v209
    v_mfma_f32_32x32x16_bf16 v[112:127], v[64:67], v[80:83], 0
    s_add_u32 m0, s67, 94208
    v_exp_f32 v210, v210
    v_exp_f32 v211, v211
    v_exp_f32 v212, v212
    v_exp_f32 v213, v213
    v_mfma_f32_32x32x16_bf16 v[144:159], v[64:67], v[84:87], 0
    ds_read_b128 v[64:67], v242 offset:11264
    v_exp_f32 v214, v214
    v_exp_f32 v215, v215
    v_exp_f32 v184, v184
    v_exp_f32 v185, v185
    v_mfma_f32_32x32x8bf16_1k v[112:127], v[76:77], v[88:89], v[112:127]
    v_exp_f32 v186, v186
    v_exp_f32 v187, v187
    v_exp_f32 v188, v188
    v_exp_f32 v189, v189
    v_mfma_f32_32x32x8bf16_1k v[144:159], v[76:77], v[92:93], v[144:159]
    v_exp_f32 v190, v190
    v_exp_f32 v191, v191
    v_exp_f32 v216, v216
    v_exp_f32 v217, v217
    v_smfmac_f32_32x32x32_bf16 v[32:47], v[68:71], v[176:183], v253
    buffer_load_dwordx4 v1, s[8:11], s95 offen offset:0 sc1 lds
    v_exp_f32 v218, v218
    v_exp_f32 v219, v219
    v_exp_f32 v220, v220
    v_exp_f32 v221, v221
    v_smfmac_f32_32x32x32_bf16 v[48:63], v[68:71], v[208:215], v253
    s_waitcnt lgkmcnt(1)
    ds_read_b128 v[68:71], v246 offset:30592
    v_exp_f32 v222, v222
    v_exp_f32 v223, v223
    v_exp_f32 v112, v112
    v_exp_f32 v113, v113
    v_smfmac_f32_32x32x32_bf16 v[32:47], v[72:75], v[184:191], v253
    s_add_u32 s95, s1, 36864
    buffer_load_dwordx2 a[80:81], v28, s[36:39], 0 offen offset:0
    v_exp_f32 v114, v114
    v_exp_f32 v115, v115
    v_exp_f32 v116, v116
    v_exp_f32 v117, v117
    v_smfmac_f32_32x32x32_bf16 v[48:63], v[72:75], v[216:223], v253
    s_waitcnt lgkmcnt(0)
    ds_read_b128 v[72:75], v246 offset:31200
    v_exp_f32 v118, v118
    v_exp_f32 v119, v119
    v_exp_f32 v144, v144
    v_exp_f32 v145, v145
    v_mfma_f32_32x32x16_bf16 v[176:191], v[64:67], v[80:83], 0
    s_cmp_eq_u32 s3, 0
    s_cselect_b32 s95, s95, 1073741824
    s_cselect_b32 s94, 122880, s55
    v_exp_f32 v146, v146
    v_exp_f32 v147, v147
    v_exp_f32 v148, v148
    v_exp_f32 v149, v149
    v_mfma_f32_32x32x16_bf16 v[208:223], v[64:67], v[84:87], 0
    ds_read_b128 v[64:67], v242 offset:12288
    v_exp_f32 v150, v150
    v_exp_f32 v151, v151
    v_exp_f32 v120, v120
    v_exp_f32 v121, v121
    v_mfma_f32_32x32x8bf16_1k v[176:191], v[76:77], v[90:91], v[176:191]
    v_exp_f32 v122, v122
    v_exp_f32 v123, v123
    v_exp_f32 v124, v124
    v_exp_f32 v125, v125
    v_mfma_f32_32x32x8bf16_1k v[208:223], v[76:77], v[94:95], v[208:223]
    v_exp_f32 v126, v126
    v_exp_f32 v127, v127
    v_exp_f32 v152, v152
    v_exp_f32 v153, v153
    v_smfmac_f32_32x32x32_bf16 v[32:47], v[68:71], v[112:119], v253
    s_mov_b32 m0, s94
    ds_read_b64 v[76:77], v244 offset:17920
    v_exp_f32 v154, v154
    v_exp_f32 v155, v155
    v_exp_f32 v156, v156
    v_exp_f32 v157, v157
    v_smfmac_f32_32x32x32_bf16 v[48:63], v[68:71], v[144:151], v253
    s_waitcnt lgkmcnt(2)
    ds_read_b128 v[68:71], v246 offset:31808
    v_exp_f32 v158, v158
    v_exp_f32 v159, v159
    v_exp_f32 v176, v176
    v_exp_f32 v177, v177
    v_smfmac_f32_32x32x32_bf16 v[32:47], v[72:75], v[120:127], v253
    buffer_load_dwordx2 a[82:83], v28, s[36:39], 0 offen offset:32
    v_exp_f32 v178, v178
    v_exp_f32 v179, v179
    v_exp_f32 v180, v180
    v_exp_f32 v181, v181
    v_smfmac_f32_32x32x32_bf16 v[48:63], v[72:75], v[152:159], v253
    s_waitcnt lgkmcnt(0)
    ds_read_b128 v[72:75], v246 offset:32416
    v_exp_f32 v182, v182
    v_exp_f32 v183, v183
    v_exp_f32 v208, v208
    v_exp_f32 v209, v209
    v_mfma_f32_32x32x16_bf16 v[112:127], v[64:67], v[80:83], 0
    v_exp_f32 v210, v210
    v_exp_f32 v211, v211
    v_exp_f32 v212, v212
    v_exp_f32 v213, v213
    v_mfma_f32_32x32x16_bf16 v[144:159], v[64:67], v[84:87], 0
    ds_read_b128 v[64:67], v242 offset:13312
    v_exp_f32 v214, v214
    v_exp_f32 v215, v215
    v_exp_f32 v184, v184
    v_exp_f32 v185, v185
    v_mfma_f32_32x32x8bf16_1k v[112:127], v[76:77], v[88:89], v[112:127]
    v_exp_f32 v186, v186
    v_exp_f32 v187, v187
    v_exp_f32 v188, v188
    v_exp_f32 v189, v189
    v_mfma_f32_32x32x8bf16_1k v[144:159], v[76:77], v[92:93], v[144:159]
    v_exp_f32 v190, v190
    v_exp_f32 v191, v191
    v_exp_f32 v216, v216
    v_exp_f32 v217, v217
    v_smfmac_f32_32x32x32_bf16 v[32:47], v[68:71], v[176:183], v253
    buffer_load_dwordx4 v1, s[8:11], s95 offen sc1 lds
    v_exp_f32 v218, v218
    v_exp_f32 v219, v219
    v_exp_f32 v220, v220
    v_exp_f32 v221, v221
    v_smfmac_f32_32x32x32_bf16 v[48:63], v[68:71], v[208:215], v253
    s_waitcnt lgkmcnt(1)
    ds_read_b128 v[68:71], v246 offset:33024
    v_exp_f32 v222, v222
    v_exp_f32 v223, v223
    v_exp_f32 v112, v112
    v_exp_f32 v113, v113
    v_smfmac_f32_32x32x32_bf16 v[32:47], v[72:75], v[184:191], v253
    s_add_u32 m0, s64, 0
    buffer_load_dwordx2 a[84:85], v28, s[36:39], 0 offen offset:64
    v_exp_f32 v114, v114
    v_exp_f32 v115, v115
    v_exp_f32 v116, v116
    v_exp_f32 v117, v117
    v_smfmac_f32_32x32x32_bf16 v[48:63], v[72:75], v[216:223], v253
    s_waitcnt lgkmcnt(0)
    ds_read_b128 v[72:75], v246 offset:33632
    v_exp_f32 v118, v118
    v_exp_f32 v119, v119
    v_exp_f32 v144, v144
    v_exp_f32 v145, v145
    v_mfma_f32_32x32x16_bf16 v[176:191], v[64:67], v[80:83], 0
    v_exp_f32 v146, v146
    v_exp_f32 v147, v147
    v_exp_f32 v148, v148
    v_exp_f32 v149, v149
    v_mfma_f32_32x32x16_bf16 v[208:223], v[64:67], v[84:87], 0
    ds_read_b128 v[64:67], v242 offset:14336
    v_exp_f32 v150, v150
    v_exp_f32 v151, v151
    v_exp_f32 v120, v120
    v_exp_f32 v121, v121
    v_mfma_f32_32x32x8bf16_1k v[176:191], v[76:77], v[90:91], v[176:191]
    v_exp_f32 v122, v122
    v_exp_f32 v123, v123
    v_exp_f32 v124, v124
    v_exp_f32 v125, v125
    v_mfma_f32_32x32x8bf16_1k v[208:223], v[76:77], v[94:95], v[208:223]
    v_exp_f32 v126, v126
    v_exp_f32 v127, v127
    v_exp_f32 v152, v152
    v_exp_f32 v153, v153
    v_smfmac_f32_32x32x32_bf16 v[32:47], v[68:71], v[112:119], v253
    buffer_load_dwordx4 v16, s[20:23], s16 offen lds
    ds_read_b64 v[76:77], v244 offset:18176
    v_exp_f32 v154, v154
    v_exp_f32 v155, v155
    v_exp_f32 v156, v156
    v_exp_f32 v157, v157
    v_smfmac_f32_32x32x32_bf16 v[48:63], v[68:71], v[144:151], v253
    s_waitcnt lgkmcnt(2)
    ds_read_b128 v[68:71], v246 offset:34240
    v_exp_f32 v158, v158
    v_exp_f32 v159, v159
    v_exp_f32 v176, v176
    v_exp_f32 v177, v177
    v_smfmac_f32_32x32x32_bf16 v[32:47], v[72:75], v[120:127], v253
    buffer_load_dwordx2 a[86:87], v28, s[36:39], 0 offen offset:96
    v_exp_f32 v178, v178
    v_exp_f32 v179, v179
    v_exp_f32 v180, v180
    v_exp_f32 v181, v181
    v_smfmac_f32_32x32x32_bf16 v[48:63], v[72:75], v[152:159], v253
    s_waitcnt lgkmcnt(0)
    ds_read_b128 v[72:75], v246 offset:34848
    v_exp_f32 v182, v182
    v_exp_f32 v183, v183
    v_exp_f32 v208, v208
    v_exp_f32 v209, v209
    v_mfma_f32_32x32x16_bf16 v[112:127], v[64:67], v[80:83], 0
    v_exp_f32 v210, v210
    v_exp_f32 v211, v211
    v_exp_f32 v212, v212
    v_exp_f32 v213, v213
    v_mfma_f32_32x32x16_bf16 v[144:159], v[64:67], v[84:87], 0
    ds_read_b128 v[64:67], v242 offset:15360
    v_exp_f32 v214, v214
    v_exp_f32 v215, v215
    v_exp_f32 v184, v184
    v_exp_f32 v185, v185
    v_mfma_f32_32x32x8bf16_1k v[112:127], v[76:77], v[88:89], v[112:127]
    v_exp_f32 v186, v186
    v_exp_f32 v187, v187
    v_exp_f32 v188, v188
    v_exp_f32 v189, v189
    v_mfma_f32_32x32x8bf16_1k v[144:159], v[76:77], v[92:93], v[144:159]
    v_exp_f32 v190, v190
    v_exp_f32 v191, v191
    v_exp_f32 v216, v216
    v_exp_f32 v217, v217
    v_smfmac_f32_32x32x32_bf16 v[32:47], v[68:71], v[176:183], v253
    buffer_load_dwordx4 v16, s[12:15], s16 offen offset:1024 lds
    v_exp_f32 v218, v218
    v_exp_f32 v219, v219
    v_exp_f32 v220, v220
    v_exp_f32 v221, v221
    v_smfmac_f32_32x32x32_bf16 v[48:63], v[68:71], v[208:215], v253
    s_waitcnt lgkmcnt(1)
    ds_read_b128 v[68:71], v246 offset:35456
    v_exp_f32 v222, v222
    v_exp_f32 v223, v223
    v_exp_f32 v112, v112
    v_exp_f32 v113, v113
    v_smfmac_f32_32x32x32_bf16 v[32:47], v[72:75], v[184:191], v253
    buffer_load_dwordx2 a[88:89], v29, s[36:39], 0 offen
    v_exp_f32 v114, v114
    v_exp_f32 v115, v115
    v_exp_f32 v116, v116
    v_exp_f32 v117, v117
    v_smfmac_f32_32x32x32_bf16 v[48:63], v[72:75], v[216:223], v253
    s_waitcnt lgkmcnt(0)
    ds_read_b128 v[72:75], v246 offset:36064
    v_exp_f32 v118, v118
    v_exp_f32 v119, v119
    v_exp_f32 v144, v144
    v_exp_f32 v145, v145
    v_mfma_f32_32x32x16_bf16 v[176:191], v[64:67], v[80:83], 0
    s_waitcnt vmcnt(5)
    s_barrier
    v_exp_f32 v146, v146
    v_exp_f32 v147, v147
    v_exp_f32 v148, v148
    v_exp_f32 v149, v149
    v_mfma_f32_32x32x16_bf16 v[208:223], v[64:67], v[84:87], 0
    ds_read_b128 v[64:67], v241 offset:0
    v_exp_f32 v150, v150
    v_exp_f32 v151, v151
    v_exp_f32 v120, v120
    v_exp_f32 v121, v121
    v_mfma_f32_32x32x8bf16_1k v[176:191], v[76:77], v[90:91], v[176:191]
    v_exp_f32 v122, v122
    v_exp_f32 v123, v123
    v_exp_f32 v124, v124
    v_exp_f32 v125, v125
    v_mfma_f32_32x32x8bf16_1k v[208:223], v[76:77], v[94:95], v[208:223]
    v_exp_f32 v126, v126
    v_exp_f32 v127, v127
    v_exp_f32 v152, v152
    v_exp_f32 v153, v153
    v_smfmac_f32_32x32x32_bf16 v[32:47], v[68:71], v[112:119], v253
    ds_read_b64 v[76:77], v243 offset:16384
    v_exp_f32 v154, v154
    v_exp_f32 v155, v155
    v_exp_f32 v156, v156
    v_exp_f32 v157, v157
    v_smfmac_f32_32x32x32_bf16 v[48:63], v[68:71], v[144:151], v253
    s_waitcnt lgkmcnt(2)
    ds_read_b128 v[68:71], v246 offset:36672
    v_exp_f32 v158, v158
    v_exp_f32 v159, v159
    v_exp_f32 v176, v176
    v_exp_f32 v177, v177
    v_smfmac_f32_32x32x32_bf16 v[32:47], v[72:75], v[120:127], v253
    v_exp_f32 v178, v178
    v_exp_f32 v179, v179
    v_exp_f32 v180, v180
    v_exp_f32 v181, v181
    v_smfmac_f32_32x32x32_bf16 v[48:63], v[72:75], v[152:159], v253
    s_waitcnt lgkmcnt(0)
    ds_read_b128 v[72:75], v246 offset:37280
    v_exp_f32 v182, v182
    v_exp_f32 v183, v183
    v_exp_f32 v208, v208
    v_exp_f32 v209, v209
    v_mfma_f32_32x32x16_bf16 v[112:127], v[64:67], v[80:83], 0
    v_accvgpr_write_b32 a90, 0
    v_exp_f32 v210, v210
    v_exp_f32 v211, v211
    v_exp_f32 v212, v212
    v_exp_f32 v213, v213
    v_mfma_f32_32x32x16_bf16 v[144:159], v[64:67], v[84:87], 0
    ds_read_b128 v[64:67], v241 offset:1024
    v_exp_f32 v214, v214
    v_exp_f32 v215, v215
    v_exp_f32 v184, v184
    v_exp_f32 v185, v185
    v_mfma_f32_32x32x8bf16_1k v[112:127], v[76:77], v[88:89], v[112:127]
    v_exp_f32 v186, v186
    v_exp_f32 v187, v187
    v_exp_f32 v188, v188
    v_exp_f32 v189, v189
    v_mfma_f32_32x32x8bf16_1k v[144:159], v[76:77], v[92:93], v[144:159]
    v_exp_f32 v190, v190
    v_exp_f32 v191, v191
    v_exp_f32 v216, v216
    v_exp_f32 v217, v217
    v_smfmac_f32_32x32x32_bf16 v[32:47], v[68:71], v[176:183], v253
    v_exp_f32 v218, v218
    v_exp_f32 v219, v219
    v_exp_f32 v220, v220
    v_exp_f32 v221, v221
    v_smfmac_f32_32x32x32_bf16 v[48:63], v[68:71], v[208:215], v253
    s_waitcnt lgkmcnt(1)
    ds_read_b128 v[68:71], v245 offset:18432
    v_exp_f32 v222, v222
    v_exp_f32 v223, v223
    v_exp_f32 v112, v112
    v_exp_f32 v113, v113
    v_smfmac_f32_32x32x32_bf16 v[32:47], v[72:75], v[184:191], v253
    s_barrier
    v_exp_f32 v114, v114
    v_exp_f32 v115, v115
    v_exp_f32 v116, v116
    v_exp_f32 v117, v117
    v_smfmac_f32_32x32x32_bf16 v[48:63], v[72:75], v[216:223], v253
    s_waitcnt lgkmcnt(0)
    ds_read_b128 v[72:75], v245 offset:19040
    v_exp_f32 v118, v118
    v_exp_f32 v119, v119
    v_exp_f32 v144, v144
    v_exp_f32 v145, v145
    v_mfma_f32_32x32x16_bf16 v[176:191], v[64:67], v[80:83], 0
    s_add_u32 s95, s97, 0
    v_exp_f32 v146, v146
    v_exp_f32 v147, v147
    v_exp_f32 v148, v148
    v_exp_f32 v149, v149
    v_mfma_f32_32x32x16_bf16 v[208:223], v[64:67], v[84:87], 0
    ds_read_b128 v[64:67], v241 offset:2048
    v_exp_f32 v150, v150
    v_exp_f32 v151, v151
    v_exp_f32 v120, v120
    v_exp_f32 v121, v121
    v_mfma_f32_32x32x8bf16_1k v[176:191], v[76:77], v[90:91], v[176:191]
    v_exp_f32 v122, v122
    v_exp_f32 v123, v123
    v_exp_f32 v124, v124
    v_exp_f32 v125, v125
    v_mfma_f32_32x32x8bf16_1k v[208:223], v[76:77], v[94:95], v[208:223]
    v_exp_f32 v126, v126
    v_exp_f32 v127, v127
    v_exp_f32 v152, v152
    v_exp_f32 v153, v153
    v_smfmac_f32_32x32x32_bf16 v[32:47], v[68:71], v[112:119], v253
    s_add_u32 m0, s67, 123904
    ds_read_b64 v[76:77], v243 offset:16640
    v_exp_f32 v154, v154
    v_exp_f32 v155, v155
    v_exp_f32 v156, v156
    v_exp_f32 v157, v157
    v_smfmac_f32_32x32x32_bf16 v[48:63], v[68:71], v[144:151], v253
    s_waitcnt lgkmcnt(2)
    ds_read_b128 v[68:71], v245 offset:19648
    v_exp_f32 v158, v158
    v_exp_f32 v159, v159
    v_exp_f32 v176, v176
    v_exp_f32 v177, v177
    v_smfmac_f32_32x32x32_bf16 v[32:47], v[72:75], v[120:127], v253
    v_exp_f32 v178, v178
    v_exp_f32 v179, v179
    v_exp_f32 v180, v180
    v_exp_f32 v181, v181
    v_smfmac_f32_32x32x32_bf16 v[48:63], v[72:75], v[152:159], v253
    s_waitcnt lgkmcnt(0)
    ds_read_b128 v[72:75], v245 offset:20256
    v_exp_f32 v182, v182
    v_exp_f32 v183, v183
    v_exp_f32 v208, v208
    v_exp_f32 v209, v209
    v_mfma_f32_32x32x16_bf16 v[112:127], v[64:67], v[80:83], 0
    v_accvgpr_write_b32 a91, 0
    v_exp_f32 v210, v210
    v_exp_f32 v211, v211
    v_exp_f32 v212, v212
    v_exp_f32 v213, v213
    v_mfma_f32_32x32x16_bf16 v[144:159], v[64:67], v[84:87], 0
    ds_read_b128 v[64:67], v241 offset:3072
    v_exp_f32 v214, v214
    v_exp_f32 v215, v215
    v_exp_f32 v184, v184
    v_exp_f32 v185, v185
    v_mfma_f32_32x32x8bf16_1k v[112:127], v[76:77], v[88:89], v[112:127]
    v_exp_f32 v186, v186
    v_exp_f32 v187, v187
    v_exp_f32 v188, v188
    v_exp_f32 v189, v189
    v_mfma_f32_32x32x8bf16_1k v[144:159], v[76:77], v[92:93], v[144:159]
    v_exp_f32 v190, v190
    v_exp_f32 v191, v191
    v_exp_f32 v216, v216
    v_exp_f32 v217, v217
    v_smfmac_f32_32x32x32_bf16 v[32:47], v[68:71], v[176:183], v253
    buffer_load_dwordx4 v1, s[8:11], s95 offen offset:0 sc1 lds
    v_exp_f32 v218, v218
    v_exp_f32 v219, v219
    v_exp_f32 v220, v220
    v_exp_f32 v221, v221
    v_smfmac_f32_32x32x32_bf16 v[48:63], v[68:71], v[208:215], v253
    s_waitcnt lgkmcnt(1)
    ds_read_b128 v[68:71], v245 offset:20864
    v_exp_f32 v222, v222
    v_exp_f32 v223, v223
    v_exp_f32 v112, v112
    v_exp_f32 v113, v113
    v_smfmac_f32_32x32x32_bf16 v[32:47], v[72:75], v[184:191], v253
    v_exp_f32 v114, v114
    v_exp_f32 v115, v115
    v_exp_f32 v116, v116
    v_exp_f32 v117, v117
    v_smfmac_f32_32x32x32_bf16 v[48:63], v[72:75], v[216:223], v253
    s_waitcnt lgkmcnt(0)
    ds_read_b128 v[72:75], v245 offset:21472
    v_exp_f32 v118, v118
    v_exp_f32 v119, v119
    v_exp_f32 v144, v144
    v_exp_f32 v145, v145
    v_mfma_f32_32x32x16_bf16 v[176:191], v[64:67], v[80:83], 0
    v_exp_f32 v146, v146
    v_exp_f32 v147, v147
    v_exp_f32 v148, v148
    v_exp_f32 v149, v149
    v_mfma_f32_32x32x16_bf16 v[208:223], v[64:67], v[84:87], 0
    ds_read_b128 v[64:67], v241 offset:4096
    v_exp_f32 v150, v150
    v_exp_f32 v151, v151
    v_exp_f32 v120, v120
    v_exp_f32 v121, v121
    v_mfma_f32_32x32x8bf16_1k v[176:191], v[76:77], v[90:91], v[176:191]
    v_exp_f32 v122, v122
    v_exp_f32 v123, v123
    v_exp_f32 v124, v124
    v_exp_f32 v125, v125
    v_mfma_f32_32x32x8bf16_1k v[208:223], v[76:77], v[94:95], v[208:223]
    v_exp_f32 v126, v126
    v_exp_f32 v127, v127
    v_exp_f32 v152, v152
    v_exp_f32 v153, v153
    v_smfmac_f32_32x32x32_bf16 v[32:47], v[68:71], v[112:119], v253
    buffer_load_dwordx4 v1, s[8:11], s95 offen offset:1024 sc1 lds
    ds_read_b64 v[76:77], v243 offset:16896
    v_exp_f32 v154, v154
    v_exp_f32 v155, v155
    v_exp_f32 v156, v156
    v_exp_f32 v157, v157
    v_smfmac_f32_32x32x32_bf16 v[48:63], v[68:71], v[144:151], v253
    s_waitcnt lgkmcnt(2)
    ds_read_b128 v[68:71], v245 offset:22080
    v_exp_f32 v158, v158
    v_exp_f32 v159, v159
    v_exp_f32 v176, v176
    v_exp_f32 v177, v177
    v_smfmac_f32_32x32x32_bf16 v[32:47], v[72:75], v[120:127], v253
    v_exp_f32 v178, v178
    v_exp_f32 v179, v179
    v_exp_f32 v180, v180
    v_exp_f32 v181, v181
    v_smfmac_f32_32x32x32_bf16 v[48:63], v[72:75], v[152:159], v253
    s_waitcnt lgkmcnt(0)
    ds_read_b128 v[72:75], v245 offset:22688
    v_exp_f32 v182, v182
    v_exp_f32 v183, v183
    v_exp_f32 v208, v208
    v_exp_f32 v209, v209
    v_mfma_f32_32x32x16_bf16 v[112:127], v[64:67], v[80:83], 0
    v_exp_f32 v210, v210
    v_exp_f32 v211, v211
    v_exp_f32 v212, v212
    v_exp_f32 v213, v213
    v_mfma_f32_32x32x16_bf16 v[144:159], v[64:67], v[84:87], 0
    ds_read_b128 v[64:67], v241 offset:5120
    v_exp_f32 v214, v214
    v_exp_f32 v215, v215
    v_exp_f32 v184, v184
    v_exp_f32 v185, v185
    v_mfma_f32_32x32x8bf16_1k v[112:127], v[76:77], v[88:89], v[112:127]
    v_exp_f32 v186, v186
    v_exp_f32 v187, v187
    v_exp_f32 v188, v188
    v_exp_f32 v189, v189
    v_mfma_f32_32x32x8bf16_1k v[144:159], v[76:77], v[92:93], v[144:159]
    v_exp_f32 v190, v190
    v_exp_f32 v191, v191
    v_exp_f32 v216, v216
    v_exp_f32 v217, v217
    v_smfmac_f32_32x32x32_bf16 v[32:47], v[68:71], v[176:183], v253
    buffer_load_dwordx4 v1, s[8:11], s95 offen offset:2048 sc1 lds
    v_exp_f32 v218, v218
    v_exp_f32 v219, v219
    v_exp_f32 v220, v220
    v_exp_f32 v221, v221
    v_smfmac_f32_32x32x32_bf16 v[48:63], v[68:71], v[208:215], v253
    s_waitcnt lgkmcnt(1)
    ds_read_b128 v[68:71], v245 offset:23296
    v_exp_f32 v222, v222
    v_exp_f32 v223, v223
    v_exp_f32 v112, v112
    v_exp_f32 v113, v113
    v_smfmac_f32_32x32x32_bf16 v[32:47], v[72:75], v[184:191], v253
    buffer_load_dword v6, v4, s[8:11], s90 offen sc1
    v_exp_f32 v114, v114
    v_exp_f32 v115, v115
    v_exp_f32 v116, v116
    v_exp_f32 v117, v117
    v_smfmac_f32_32x32x32_bf16 v[48:63], v[72:75], v[216:223], v253
    s_waitcnt lgkmcnt(0)
    ds_read_b128 v[72:75], v245 offset:23904
    v_exp_f32 v118, v118
    v_exp_f32 v119, v119
    v_exp_f32 v144, v144
    v_exp_f32 v145, v145
    v_mfma_f32_32x32x16_bf16 v[176:191], v[64:67], v[80:83], 0
    v_exp_f32 v146, v146
    v_exp_f32 v147, v147
    v_exp_f32 v148, v148
    v_exp_f32 v149, v149
    v_mfma_f32_32x32x16_bf16 v[208:223], v[64:67], v[84:87], 0
    ds_read_b128 v[64:67], v241 offset:6144
    v_exp_f32 v150, v150
    v_exp_f32 v151, v151
    v_exp_f32 v120, v120
    v_exp_f32 v121, v121
    v_mfma_f32_32x32x8bf16_1k v[176:191], v[76:77], v[90:91], v[176:191]
    v_exp_f32 v122, v122
    v_exp_f32 v123, v123
    v_exp_f32 v124, v124
    v_exp_f32 v125, v125
    v_mfma_f32_32x32x8bf16_1k v[208:223], v[76:77], v[94:95], v[208:223]
    v_exp_f32 v126, v126
    v_exp_f32 v127, v127
    v_exp_f32 v152, v152
    v_exp_f32 v153, v153
    v_smfmac_f32_32x32x32_bf16 v[32:47], v[68:71], v[112:119], v253
    buffer_load_dwordx4 v1, s[8:11], s95 offen offset:3072 sc1 lds
    ds_read_b64 v[76:77], v243 offset:17152
    v_exp_f32 v154, v154
    v_exp_f32 v155, v155
    v_exp_f32 v156, v156
    v_exp_f32 v157, v157
    v_smfmac_f32_32x32x32_bf16 v[48:63], v[68:71], v[144:151], v253
    s_waitcnt lgkmcnt(2)
    ds_read_b128 v[68:71], v245 offset:24512
    v_exp_f32 v158, v158
    v_exp_f32 v159, v159
    v_exp_f32 v176, v176
    v_exp_f32 v177, v177
    v_smfmac_f32_32x32x32_bf16 v[32:47], v[72:75], v[120:127], v253
    s_add_u32 s95, s97, 4096
    v_exp_f32 v178, v178
    v_exp_f32 v179, v179
    v_exp_f32 v180, v180
    v_exp_f32 v181, v181
    v_smfmac_f32_32x32x32_bf16 v[48:63], v[72:75], v[152:159], v253
    s_waitcnt lgkmcnt(0)
    ds_read_b128 v[72:75], v245 offset:25120
    v_exp_f32 v182, v182
    v_exp_f32 v183, v183
    v_exp_f32 v208, v208
    v_exp_f32 v209, v209
    v_mfma_f32_32x32x16_bf16 v[112:127], v[64:67], v[80:83], 0
    s_add_u32 m0, s67, 128000
    v_exp_f32 v210, v210
    v_exp_f32 v211, v211
    v_exp_f32 v212, v212
    v_exp_f32 v213, v213
    v_mfma_f32_32x32x16_bf16 v[144:159], v[64:67], v[84:87], 0
    ds_read_b128 v[64:67], v241 offset:7168
    v_exp_f32 v214, v214
    v_exp_f32 v215, v215
    v_exp_f32 v184, v184
    v_exp_f32 v185, v185
    v_mfma_f32_32x32x8bf16_1k v[112:127], v[76:77], v[88:89], v[112:127]
    v_exp_f32 v186, v186
    v_exp_f32 v187, v187
    v_exp_f32 v188, v188
    v_exp_f32 v189, v189
    v_mfma_f32_32x32x8bf16_1k v[144:159], v[76:77], v[92:93], v[144:159]
    v_exp_f32 v190, v190
    v_exp_f32 v191, v191
    v_exp_f32 v216, v216
    v_exp_f32 v217, v217
    v_smfmac_f32_32x32x32_bf16 v[32:47], v[68:71], v[176:183], v253
    buffer_load_dwordx4 v1, s[8:11], s95 offen offset:0 sc1 lds
    v_exp_f32 v218, v218
    v_exp_f32 v219, v219
    v_exp_f32 v220, v220
    v_exp_f32 v221, v221
    v_smfmac_f32_32x32x32_bf16 v[48:63], v[68:71], v[208:215], v253
    s_waitcnt lgkmcnt(1)
    ds_read_b128 v[68:71], v245 offset:25728
    v_exp_f32 v222, v222
    v_exp_f32 v223, v223
    v_exp_f32 v112, v112
    v_exp_f32 v113, v113
    v_smfmac_f32_32x32x32_bf16 v[32:47], v[72:75], v[184:191], v253
    v_exp_f32 v114, v114
    v_exp_f32 v115, v115
    v_exp_f32 v116, v116
    v_exp_f32 v117, v117
    v_smfmac_f32_32x32x32_bf16 v[48:63], v[72:75], v[216:223], v253
    s_waitcnt lgkmcnt(0)
    ds_read_b128 v[72:75], v245 offset:26336
    v_exp_f32 v118, v118
    v_exp_f32 v119, v119
    v_exp_f32 v144, v144
    v_exp_f32 v145, v145
    v_mfma_f32_32x32x16_bf16 v[176:191], v[64:67], v[80:83], 0
    v_exp_f32 v146, v146
    v_exp_f32 v147, v147
    v_exp_f32 v148, v148
    v_exp_f32 v149, v149
    v_mfma_f32_32x32x16_bf16 v[208:223], v[64:67], v[84:87], 0
    ds_read_b128 v[64:67], v241 offset:8192
    v_exp_f32 v150, v150
    v_exp_f32 v151, v151
    v_exp_f32 v120, v120
    v_exp_f32 v121, v121
    v_mfma_f32_32x32x8bf16_1k v[176:191], v[76:77], v[90:91], v[176:191]
    v_exp_f32 v122, v122
    v_exp_f32 v123, v123
    v_exp_f32 v124, v124
    v_exp_f32 v125, v125
    v_mfma_f32_32x32x8bf16_1k v[208:223], v[76:77], v[94:95], v[208:223]
    v_exp_f32 v126, v126
    v_exp_f32 v127, v127
    v_exp_f32 v152, v152
    v_exp_f32 v153, v153
    v_smfmac_f32_32x32x32_bf16 v[32:47], v[68:71], v[112:119], v253
    buffer_load_dwordx4 v1, s[8:11], s95 offen offset:1024 sc1 lds
    ds_read_b64 v[76:77], v243 offset:17408
    v_exp_f32 v154, v154
    v_exp_f32 v155, v155
    v_exp_f32 v156, v156
    v_exp_f32 v157, v157
    v_smfmac_f32_32x32x32_bf16 v[48:63], v[68:71], v[144:151], v253
    s_waitcnt lgkmcnt(2)
    ds_read_b128 v[68:71], v245 offset:26944
    v_exp_f32 v158, v158
    v_exp_f32 v159, v159
    v_exp_f32 v176, v176
    v_exp_f32 v177, v177
    v_smfmac_f32_32x32x32_bf16 v[32:47], v[72:75], v[120:127], v253
    v_exp_f32 v178, v178
    v_exp_f32 v179, v179
    v_exp_f32 v180, v180
    v_exp_f32 v181, v181
    v_smfmac_f32_32x32x32_bf16 v[48:63], v[72:75], v[152:159], v253
    s_waitcnt lgkmcnt(0)
    ds_read_b128 v[72:75], v245 offset:27552
    v_exp_f32 v182, v182
    v_exp_f32 v183, v183
    v_exp_f32 v208, v208
    v_exp_f32 v209, v209
    v_mfma_f32_32x32x16_bf16 v[112:127], v[64:67], v[80:83], 0
    s_waitcnt vmcnt(3)
    v_cmp_eq_u32 vcc, s40, v6
    s_nop 0
    s_and_b32 vcc_lo, vcc_lo, 255
    s_cmp_eq_u32 vcc_lo, 255
    s_cbranch_scc0 L_spin6
L_back6:
    v_exp_f32 v210, v210
    v_exp_f32 v211, v211
    v_exp_f32 v212, v212
    v_exp_f32 v213, v213
    v_mfma_f32_32x32x16_bf16 v[144:159], v[64:67], v[84:87], 0
    ds_read_b128 v[64:67], v241 offset:9216
    v_exp_f32 v214, v214
    v_exp_f32 v215, v215
    v_exp_f32 v184, v184
    v_exp_f32 v185, v185
    v_mfma_f32_32x32x8bf16_1k v[112:127], v[76:77], v[88:89], v[112:127]
    v_exp_f32 v186, v186
    v_exp_f32 v187, v187
    v_exp_f32 v188, v188
    v_exp_f32 v189, v189
    v_mfma_f32_32x32x8bf16_1k v[144:159], v[76:77], v[92:93], v[144:159]
    v_exp_f32 v190, v190
    v_exp_f32 v191, v191
    v_exp_f32 v216, v216
    v_exp_f32 v217, v217
    v_smfmac_f32_32x32x32_bf16 v[32:47], v[68:71], v[176:183], v253
    buffer_load_dwordx4 v1, s[8:11], s95 offen offset:2048 sc1 lds
    v_exp_f32 v218, v218
    v_exp_f32 v219, v219
    v_exp_f32 v220, v220
    v_exp_f32 v221, v221
    v_smfmac_f32_32x32x32_bf16 v[48:63], v[68:71], v[208:215], v253
    s_waitcnt lgkmcnt(1)
    ds_read_b128 v[68:71], v245 offset:28160
    v_exp_f32 v222, v222
    v_exp_f32 v223, v223
    v_exp_f32 v112, v112
    v_exp_f32 v113, v113
    v_smfmac_f32_32x32x32_bf16 v[32:47], v[72:75], v[184:191], v253
    buffer_load_dwordx4 a[0:3], v30, s[8:11], s78 offen offset:0 sc1
    v_exp_f32 v114, v114
    v_exp_f32 v115, v115
    v_exp_f32 v116, v116
    v_exp_f32 v117, v117
    v_smfmac_f32_32x32x32_bf16 v[48:63], v[72:75], v[216:223], v253
    s_waitcnt lgkmcnt(0)
    ds_read_b128 v[72:75], v245 offset:28768
    v_exp_f32 v118, v118
    v_exp_f32 v119, v119
    v_exp_f32 v144, v144
    v_exp_f32 v145, v145
    v_mfma_f32_32x32x16_bf16 v[176:191], v[64:67], v[80:83], 0
    v_exp_f32 v146, v146
    v_exp_f32 v147, v147
    v_exp_f32 v148, v148
    v_exp_f32 v149, v149
    v_mfma_f32_32x32x16_bf16 v[208:223], v[64:67], v[84:87], 0
    ds_read_b128 v[64:67], v241 offset:10240
    v_exp_f32 v150, v150
    v_exp_f32 v151, v151
    v_exp_f32 v120, v120
    v_exp_f32 v121, v121
    v_mfma_f32_32x32x8bf16_1k v[176:191], v[76:77], v[90:91], v[176:191]
    v_exp_f32 v122, v122
    v_exp_f32 v123, v123
    v_exp_f32 v124, v124
    v_exp_f32 v125, v125
    v_mfma_f32_32x32x8bf16_1k v[208:223], v[76:77], v[94:95], v[208:223]
    v_exp_f32 v126, v126
    v_exp_f32 v127, v127
    v_exp_f32 v152, v152
    v_exp_f32 v153, v153
    v_smfmac_f32_32x32x32_bf16 v[32:47], v[68:71], v[112:119], v253
    buffer_load_dwordx4 v1, s[8:11], s95 offen offset:3072 sc1 lds
    ds_read_b64 v[76:77], v243 offset:17664
    v_exp_f32 v154, v154
    v_exp_f32 v155, v155
    v_exp_f32 v156, v156
    v_exp_f32 v157, v157
    v_smfmac_f32_32x32x32_bf16 v[48:63], v[68:71], v[144:151], v253
    s_waitcnt lgkmcnt(2)
    ds_read_b128 v[68:71], v245 offset:29376
    v_exp_f32 v158, v158
    v_exp_f32 v159, v159
    v_exp_f32 v176, v176
    v_exp_f32 v177, v177
    v_smfmac_f32_32x32x32_bf16 v[32:47], v[72:75], v[120:127], v253
    s_add_u32 s95, s97, 8192
    buffer_load_dwordx4 a[4:7], v30, s[8:11], s78 offen offset:1024 sc1
    v_exp_f32 v178, v178
    v_exp_f32 v179, v179
    v_exp_f32 v180, v180
    v_exp_f32 v181, v181
    v_smfmac_f32_32x32x32_bf16 v[48:63], v[72:75], v[152:159], v253
    s_waitcnt lgkmcnt(0)
    ds_read_b128 v[72:75], v245 offset:29984
    v_exp_f32 v182, v182
    v_exp_f32 v183, v183
    v_exp_f32 v208, v208
    v_exp_f32 v209, v209
    v_mfma_f32_32x32x16_bf16 v[112:127], v[64:67], v[80:83], 0
    s_add_u32 m0, s67, 132096
    v_exp_f32 v210, v210
    v_exp_f32 v211, v211
L_page12:
    s_cbranch_execz L_pagedone
    v_exp_f32 v212, v212
    v_exp_f32 v213, v213
    v_mfma_f32_32x32x16_bf16 v[144:159], v[64:67], v[84:87], 0
    ds_read_b128 v[64:67], v241 offset:11264
    v_exp_f32 v214, v214
    v_exp_f32 v215, v215
    v_exp_f32 v184, v184
    v_exp_f32 v185, v185
    v_mfma_f32_32x32x8bf16_1k v[112:127], v[76:77], v[88:89], v[112:127]
    v_exp_f32 v186, v186
    v_exp_f32 v187, v187
    v_exp_f32 v188, v188
    v_exp_f32 v189, v189
    v_mfma_f32_32x32x8bf16_1k v[144:159], v[76:77], v[92:93], v[144:159]
    v_exp_f32 v190, v190
    v_exp_f32 v191, v191
    v_exp_f32 v216, v216
    v_exp_f32 v217, v217
    v_smfmac_f32_32x32x32_bf16 v[32:47], v[68:71], v[176:183], v253
    buffer_load_dwordx4 v1, s[8:11], s95 offen offset:0 sc1 lds
    v_exp_f32 v218, v218
    v_exp_f32 v219, v219
    v_exp_f32 v220, v220
    v_exp_f32 v221, v221
    v_smfmac_f32_32x32x32_bf16 v[48:63], v[68:71], v[208:215], v253
    s_waitcnt lgkmcnt(1)
    ds_read_b128 v[68:71], v245 offset:30592
    v_exp_f32 v222, v222
    v_exp_f32 v223, v223
    v_exp_f32 v112, v112
    v_exp_f32 v113, v113
    v_smfmac_f32_32x32x32_bf16 v[32:47], v[72:75], v[184:191], v253
    s_add_u32 s95, s97, 36864
    buffer_load_dwordx2 a[64:65], v31, s[8:11], s78 offen sc1
    v_exp_f32 v114, v114
    v_exp_f32 v115, v115
    v_exp_f32 v116, v116
    v_exp_f32 v117, v117
    v_smfmac_f32_32x32x32_bf16 v[48:63], v[72:75], v[216:223], v253
    s_waitcnt lgkmcnt(0)
    ds_read_b128 v[72:75], v245 offset:31200
    v_exp_f32 v118, v118
    v_exp_f32 v119, v119
    v_exp_f32 v144, v144
    v_exp_f32 v145, v145
    v_mfma_f32_32x32x16_bf16 v[176:191], v[64:67], v[80:83], 0
    s_cmp_eq_u32 s3, 0
    s_cselect_b32 s95, s95, 1073741824
    s_cselect_b32 s94, 160768, s55
    v_exp_f32 v146, v146
    v_exp_f32 v147, v147
    v_exp_f32 v148, v148
    v_exp_f32 v149, v149
    v_mfma_f32_32x32x16_bf16 v[208:223], v[64:67], v[84:87], 0
    ds_read_b128 v[64:67], v241 offset:12288
    v_exp_f32 v150, v150
    v_exp_f32 v151, v151
    v_exp_f32 v120, v120
    v_exp_f32 v121, v121
    v_mfma_f32_32x32x8bf16_1k v[176:191], v[76:77], v[90:91], v[176:191]
    v_exp_f32 v122, v122
    v_exp_f32 v123, v123
    v_exp_f32 v124, v124
    v_exp_f32 v125, v125
    v_mfma_f32_32x32x8bf16_1k v[208:223], v[76:77], v[94:95], v[208:223]
    v_exp_f32 v126, v126
    v_exp_f32 v127, v127
    v_exp_f32 v152, v152
    v_exp_f32 v153, v153
    v_smfmac_f32_32x32x32_bf16 v[32:47], v[68:71], v[112:119], v253
    s_mov_b32 m0, s94
    ds_read_b64 v[76:77], v243 offset:17920
    v_exp_f32 v154, v154
    v_exp_f32 v155, v155
    v_exp_f32 v156, v156
    v_exp_f32 v157, v157
    v_smfmac_f32_32x32x32_bf16 v[48:63], v[68:71], v[144:151], v253
    s_waitcnt lgkmcnt(2)
    ds_read_b128 v[68:71], v245 offset:31808
    v_exp_f32 v158, v158
    v_exp_f32 v159, v159
    v_exp_f32 v176, v176
    v_exp_f32 v177, v177
    v_smfmac_f32_32x32x32_bf16 v[32:47], v[72:75], v[120:127], v253
    v_exp_f32 v178, v178
    v_exp_f32 v179, v179
    v_exp_f32 v180, v180
    v_exp_f32 v181, v181
    v_smfmac_f32_32x32x32_bf16 v[48:63], v[72:75], v[152:159], v253
    s_waitcnt lgkmcnt(0)
    ds_read_b128 v[72:75], v245 offset:32416
    v_exp_f32 v182, v182
    v_exp_f32 v183, v183
    v_exp_f32 v208, v208
    v_exp_f32 v209, v209
    v_mfma_f32_32x32x16_bf16 v[112:127], v[64:67], v[80:83], 0
    s_add_u32 s78, s78, 2359296
    v_exp_f32 v210, v210
    v_exp_f32 v211, v211
    v_exp_f32 v212, v212
    v_exp_f32 v213, v213
    v_mfma_f32_32x32x16_bf16 v[144:159], v[64:67], v[84:87], 0
    ds_read_b128 v[64:67], v241 offset:13312
    v_exp_f32 v214, v214
    v_exp_f32 v215, v215
    v_exp_f32 v184, v184
    v_exp_f32 v185, v185
    v_mfma_f32_32x32x8bf16_1k v[112:127], v[76:77], v[88:89], v[112:127]
    v_exp_f32 v186, v186
    v_exp_f32 v187, v187
    v_exp_f32 v188, v188
    v_exp_f32 v189, v189
    v_mfma_f32_32x32x8bf16_1k v[144:159], v[76:77], v[92:93], v[144:159]
    v_exp_f32 v190, v190
    v_exp_f32 v191, v191
    v_exp_f32 v216, v216
    v_exp_f32 v217, v217
    v_smfmac_f32_32x32x32_bf16 v[32:47], v[68:71], v[176:183], v253
    buffer_load_dwordx4 v1, s[8:11], s95 offen sc1 lds
    v_exp_f32 v218, v218
    v_exp_f32 v219, v219
    v_exp_f32 v220, v220
    v_exp_f32 v221, v221
    v_smfmac_f32_32x32x32_bf16 v[48:63], v[68:71], v[208:215], v253
    s_waitcnt lgkmcnt(1)
    ds_read_b128 v[68:71], v245 offset:33024
    v_exp_f32 v222, v222
    v_exp_f32 v223, v223
    v_exp_f32 v112, v112
    v_exp_f32 v113, v113
    v_smfmac_f32_32x32x32_bf16 v[32:47], v[72:75], v[184:191], v253
    s_add_u32 m0, s64, 8192
    buffer_load_dwordx4 a[8:11], v30, s[8:11], s78 offen offset:0 sc1
    v_exp_f32 v114, v114
    v_exp_f32 v115, v115
    v_exp_f32 v116, v116
    v_exp_f32 v117, v117
    v_smfmac_f32_32x32x32_bf16 v[48:63], v[72:75], v[216:223], v253
    s_waitcnt lgkmcnt(0)
    ds_read_b128 v[72:75], v245 offset:33632
    v_exp_f32 v118, v118
    v_exp_f32 v119, v119
    v_exp_f32 v144, v144
    v_exp_f32 v145, v145
    v_mfma_f32_32x32x16_bf16 v[176:191], v[64:67], v[80:83], 0
    v_exp_f32 v146, v146
    v_exp_f32 v147, v147
    v_exp_f32 v148, v148
    v_exp_f32 v149, v149
    v_mfma_f32_32x32x16_bf16 v[208:223], v[64:67], v[84:87], 0
    ds_read_b128 v[64:67], v241 offset:14336
    v_exp_f32 v150, v150
    v_exp_f32 v151, v151
    v_exp_f32 v120, v120
    v_exp_f32 v121, v121
    v_mfma_f32_32x32x8bf16_1k v[176:191], v[76:77], v[90:91], v[176:191]
    v_exp_f32 v122, v122
    v_exp_f32 v123, v123
    v_exp_f32 v124, v124
    v_exp_f32 v125, v125
    v_mfma_f32_32x32x8bf16_1k v[208:223], v[76:77], v[94:95], v[208:223]
    v_exp_f32 v126, v126
    v_exp_f32 v127, v127
    v_exp_f32 v152, v152
    v_exp_f32 v153, v153
    v_smfmac_f32_32x32x32_bf16 v[32:47], v[68:71], v[112:119], v253
    buffer_load_dwordx4 v16, s[20:23], s17 offen lds
    ds_read_b64 v[76:77], v243 offset:18176
    v_exp_f32 v154, v154
    v_exp_f32 v155, v155
    v_exp_f32 v156, v156
    v_exp_f32 v157, v157
    v_smfmac_f32_32x32x32_bf16 v[48:63], v[68:71], v[144:151], v253
    s_waitcnt lgkmcnt(2)
    ds_read_b128 v[68:71], v245 offset:34240
    v_exp_f32 v158, v158
    v_exp_f32 v159, v159
    v_exp_f32 v176, v176
    v_exp_f32 v177, v177
    v_smfmac_f32_32x32x32_bf16 v[32:47], v[72:75], v[120:127], v253
    buffer_load_dwordx4 a[12:15], v30, s[8:11], s78 offen offset:1024 sc1
    v_exp_f32 v178, v178
    v_exp_f32 v179, v179
    v_exp_f32 v180, v180
    v_exp_f32 v181, v181
    v_smfmac_f32_32x32x32_bf16 v[48:63], v[72:75], v[152:159], v253
    s_waitcnt lgkmcnt(0)
    ds_read_b128 v[72:75], v245 offset:34848
    v_exp_f32 v182, v182
    v_exp_f32 v183, v183
    v_exp_f32 v208, v208
    v_exp_f32 v209, v209
    v_mfma_f32_32x32x16_bf16 v[112:127], v[64:67], v[80:83], 0
    v_exp_f32 v210, v210
    v_exp_f32 v211, v211
    v_exp_f32 v212, v212
    v_exp_f32 v213, v213
    v_mfma_f32_32x32x16_bf16 v[144:159], v[64:67], v[84:87], 0
    ds_read_b128 v[64:67], v241 offset:15360
    v_exp_f32 v214, v214
    v_exp_f32 v215, v215
    v_exp_f32 v184, v184
    v_exp_f32 v185, v185
    v_mfma_f32_32x32x8bf16_1k v[112:127], v[76:77], v[88:89], v[112:127]
    v_exp_f32 v186, v186
    v_exp_f32 v187, v187
    v_exp_f32 v188, v188
    v_exp_f32 v189, v189
    v_mfma_f32_32x32x8bf16_1k v[144:159], v[76:77], v[92:93], v[144:159]
    v_exp_f32 v190, v190
    v_exp_f32 v191, v191
    v_exp_f32 v216, v216
    v_exp_f32 v217, v217
    v_smfmac_f32_32x32x32_bf16 v[32:47], v[68:71], v[176:183], v253
    buffer_load_dwordx4 v16, s[12:15], s17 offen offset:1024 lds
    v_exp_f32 v218, v218
    v_exp_f32 v219, v219
    v_exp_f32 v220, v220
    v_exp_f32 v221, v221
    v_smfmac_f32_32x32x32_bf16 v[48:63], v[68:71], v[208:215], v253
    s_waitcnt lgkmcnt(1)
    ds_read_b128 v[68:71], v245 offset:35456
    v_exp_f32 v222, v222
    v_exp_f32 v223, v223
    v_exp_f32 v112, v112
    v_exp_f32 v113, v113
    v_smfmac_f32_32x32x32_bf16 v[32:47], v[72:75], v[184:191], v253
    s_add_u32 m0, s64, 16384
    buffer_load_dwordx2 a[66:67], v31, s[8:11], s78 offen sc1
    v_exp_f32 v114, v114
    v_exp_f32 v115, v115
    v_exp_f32 v116, v116
    v_exp_f32 v117, v117
    v_smfmac_f32_32x32x32_bf16 v[48:63], v[72:75], v[216:223], v253
    s_waitcnt lgkmcnt(0)
    ds_read_b128 v[72:75], v245 offset:36064
    v_exp_f32 v118, v118
    v_exp_f32 v119, v119
    v_exp_f32 v144, v144
    v_exp_f32 v145, v145
    v_mfma_f32_32x32x16_bf16 v[176:191], v[64:67], v[80:83], 0
    s_waitcnt vmcnt(5)
    s_barrier
    v_exp_f32 v146, v146
    v_exp_f32 v147, v147
    v_exp_f32 v148, v148
    v_exp_f32 v149, v149
    v_mfma_f32_32x32x16_bf16 v[208:223], v[64:67], v[84:87], 0
    ds_read_b128 v[64:67], v242 offset:0
    v_exp_f32 v150, v150
    v_exp_f32 v151, v151
    v_exp_f32 v120, v120
    v_exp_f32 v121, v121
    v_mfma_f32_32x32x8bf16_1k v[176:191], v[76:77], v[90:91], v[176:191]
    v_exp_f32 v122, v122
    v_exp_f32 v123, v123
    v_exp_f32 v124, v124
    v_exp_f32 v125, v125
    v_mfma_f32_32x32x8bf16_1k v[208:223], v[76:77], v[94:95], v[208:223]
    v_exp_f32 v126, v126
    v_exp_f32 v127, v127
    v_exp_f32 v152, v152
    v_exp_f32 v153, v153
    v_smfmac_f32_32x32x32_bf16 v[32:47], v[68:71], v[112:119], v253
    buffer_load_dwordx4 v16, s[20:23], s18 offen lds
    ds_read_b64 v[76:77], v244 offset:16384
    v_exp_f32 v154, v154
    v_exp_f32 v155, v155
    v_exp_f32 v156, v156
    v_exp_f32 v157, v157
    v_smfmac_f32_32x32x32_bf16 v[48:63], v[68:71], v[144:151], v253
    s_waitcnt lgkmcnt(2)
    buffer_load_dwordx4 v16, s[12:15], s18 offen offset:1024 lds
    ds_read_b128 v[68:71], v245 offset:36672
    v_exp_f32 v158, v158
    v_exp_f32 v159, v159
    v_exp_f32 v176, v176
    v_exp_f32 v177, v177
    v_smfmac_f32_32x32x32_bf16 v[32:47], v[72:75], v[120:127], v253
    s_add_u32 m0, s64, 24576
    v_exp_f32 v178, v178
    v_exp_f32 v179, v179
    v_exp_f32 v180, v180
    v_exp_f32 v181, v181
    v_smfmac_f32_32x32x32_bf16 v[48:63], v[72:75], v[152:159], v253
    s_waitcnt lgkmcnt(0)
    ds_read_b128 v[72:75], v245 offset:37280
    v_exp_f32 v182, v182
    v_exp_f32 v183, v183
    v_exp_f32 v208, v208
    v_exp_f32 v209, v209
    v_mfma_f32_32x32x16_bf16 v[112:127], v[64:67], v[80:83], 0
    s_add_u32 s78, s78, 2359296
    v_exp_f32 v210, v210
    v_exp_f32 v211, v211
    v_exp_f32 v212, v212
    v_exp_f32 v213, v213
    v_mfma_f32_32x32x16_bf16 v[144:159], v[64:67], v[84:87], 0
    ds_read_b128 v[64:67], v242 offset:1024
    v_exp_f32 v214, v214
    v_exp_f32 v215, v215
    v_exp_f32 v184, v184
    v_exp_f32 v185, v185
    v_mfma_f32_32x32x8bf16_1k v[112:127], v[76:77], v[88:89], v[112:127]
    v_exp_f32 v186, v186
    v_exp_f32 v187, v187
    v_exp_f32 v188, v188
    v_exp_f32 v189, v189
    v_mfma_f32_32x32x8bf16_1k v[144:159], v[76:77], v[92:93], v[144:159]
    v_exp_f32 v190, v190
    v_exp_f32 v191, v191
    v_exp_f32 v216, v216
    v_exp_f32 v217, v217
    v_smfmac_f32_32x32x32_bf16 v[32:47], v[68:71], v[176:183], v253
    buffer_load_dwordx4 v16, s[20:23], s19 offen lds
    v_exp_f32 v218, v218
    v_exp_f32 v219, v219
    v_exp_f32 v220, v220
    v_exp_f32 v221, v221
    v_smfmac_f32_32x32x32_bf16 v[48:63], v[68:71], v[208:215], v253
    s_waitcnt lgkmcnt(1)
    buffer_load_dwordx4 v16, s[12:15], s19 offen offset:1024 lds
    ds_read_b128 v[68:71], v246 offset:18432
    v_exp_f32 v222, v222
    v_exp_f32 v223, v223
    v_exp_f32 v112, v112
    v_exp_f32 v113, v113
    v_smfmac_f32_32x32x32_bf16 v[32:47], v[72:75], v[184:191], v253
    s_add_u32 m0, s64, 32768
    buffer_load_dwordx4 a[16:19], v30, s[8:11], s78 offen offset:0 sc1
    v_exp_f32 v114, v114
    v_exp_f32 v115, v115
    v_exp_f32 v116, v116
    v_exp_f32 v117, v117
    v_smfmac_f32_32x32x32_bf16 v[48:63], v[72:75], v[216:223], v253
    s_waitcnt lgkmcnt(0)
    ds_read_b128 v[72:75], v246 offset:19040
    v_exp_f32 v118, v118
    v_exp_f32 v119, v119
    v_exp_f32 v144, v144
    v_exp_f32 v145, v145
    v_mfma_f32_32x32x16_bf16 v[176:191], v[64:67], v[80:83], 0
    v_exp_f32 v146, v146
    v_exp_f32 v147, v147
    v_exp_f32 v148, v148
    v_exp_f32 v149, v149
    v_mfma_f32_32x32x16_bf16 v[208:223], v[64:67], v[84:87], 0
    ds_read_b128 v[64:67], v242 offset:2048
    v_exp_f32 v150, v150
    v_exp_f32 v151, v151
    v_exp_f32 v120, v120
    v_exp_f32 v121, v121
    v_mfma_f32_32x32x8bf16_1k v[176:191], v[76:77], v[90:91], v[176:191]
    v_exp_f32 v122, v122
    v_exp_f32 v123, v123
    v_exp_f32 v124, v124
    v_exp_f32 v125, v125
    v_mfma_f32_32x32x8bf16_1k v[208:223], v[76:77], v[94:95], v[208:223]
    v_exp_f32 v126, v126
    v_exp_f32 v127, v127
    v_exp_f32 v152, v152
    v_exp_f32 v153, v153
    v_smfmac_f32_32x32x32_bf16 v[32:47], v[68:71], v[112:119], v253
    buffer_load_dwordx4 v16, s[20:23], s42 offen lds
    ds_read_b64 v[76:77], v244 offset:16640
    v_exp_f32 v154, v154
    v_exp_f32 v155, v155
    v_exp_f32 v156, v156
    v_exp_f32 v157, v157
    v_smfmac_f32_32x32x32_bf16 v[48:63], v[68:71], v[144:151], v253
    s_waitcnt lgkmcnt(2)
    buffer_load_dwordx4 v16, s[12:15], s42 offen offset:1024 lds
    ds_read_b128 v[68:71], v246 offset:19648
    v_exp_f32 v158, v158
    v_exp_f32 v159, v159
    v_exp_f32 v176, v176
    v_exp_f32 v177, v177
    v_smfmac_f32_32x32x32_bf16 v[32:47], v[72:75], v[120:127], v253
    s_add_u32 m0, s64, 40960
    buffer_load_dwordx4 a[20:23], v30, s[8:11], s78 offen offset:1024 sc1
    v_exp_f32 v178, v178
    v_exp_f32 v179, v179
    v_exp_f32 v180, v180
    v_exp_f32 v181, v181
    v_smfmac_f32_32x32x32_bf16 v[48:63], v[72:75], v[152:159], v253
    s_waitcnt lgkmcnt(0)
    ds_read_b128 v[72:75], v246 offset:20256
    v_exp_f32 v182, v182
    v_exp_f32 v183, v183
    v_exp_f32 v208, v208
    v_exp_f32 v209, v209
    v_mfma_f32_32x32x16_bf16 v[112:127], v[64:67], v[80:83], 0
    v_exp_f32 v210, v210
    v_exp_f32 v211, v211
    v_exp_f32 v212, v212
    v_exp_f32 v213, v213
    v_mfma_f32_32x32x16_bf16 v[144:159], v[64:67], v[84:87], 0
    ds_read_b128 v[64:67], v242 offset:3072
    v_exp_f32 v214, v214
    v_exp_f32 v215, v215
    v_exp_f32 v184, v184
    v_exp_f32 v185, v185
    v_mfma_f32_32x32x8bf16_1k v[112:127], v[76:77], v[88:89], v[112:127]
    v_exp_f32 v186, v186
    v_exp_f32 v187, v187
    v_exp_f32 v188, v188
    v_exp_f32 v189, v189
    v_mfma_f32_32x32x8bf16_1k v[144:159], v[76:77], v[92:93], v[144:159]
    v_exp_f32 v190, v190
    v_exp_f32 v191, v191
    v_exp_f32 v216, v216
    v_exp_f32 v217, v217
    v_smfmac_f32_32x32x32_bf16 v[32:47], v[68:71], v[176:183], v253
    buffer_load_dwordx4 v16, s[20:23], s43 offen lds
    v_exp_f32 v218, v218
    v_exp_f32 v219, v219
    v_exp_f32 v220, v220
    v_exp_f32 v221, v221
    v_smfmac_f32_32x32x32_bf16 v[48:63], v[68:71], v[208:215], v253
    s_waitcnt lgkmcnt(1)
    buffer_load_dwordx4 v16, s[12:15], s43 offen offset:1024 lds
    ds_read_b128 v[68:71], v246 offset:20864
    v_exp_f32 v222, v222
    v_exp_f32 v223, v223
    v_exp_f32 v112, v112
    v_exp_f32 v113, v113
    v_smfmac_f32_32x32x32_bf16 v[32:47], v[72:75], v[184:191], v253
    s_add_u32 m0, s64, 49152
    buffer_load_dwordx2 a[68:69], v31, s[8:11], s78 offen sc1
    v_exp_f32 v114, v114
    v_exp_f32 v115, v115
    v_exp_f32 v116, v116
    v_exp_f32 v117, v117
    v_smfmac_f32_32x32x32_bf16 v[48:63], v[72:75], v[216:223], v253
    s_waitcnt lgkmcnt(0)
    ds_read_b128 v[72:75], v246 offset:21472
    v_exp_f32 v118, v118
    v_exp_f32 v119, v119
    v_exp_f32 v144, v144
    v_exp_f32 v145, v145
    v_mfma_f32_32x32x16_bf16 v[176:191], v[64:67], v[80:83], 0
    s_add_u32 s78, s78, 2359296
    v_exp_f32 v146, v146
    v_exp_f32 v147, v147
    v_exp_f32 v148, v148
    v_exp_f32 v149, v149
    v_mfma_f32_32x32x16_bf16 v[208:223], v[64:67], v[84:87], 0
    ds_read_b128 v[64:67], v242 offset:4096
    v_exp_f32 v150, v150
    v_exp_f32 v151, v151
    v_exp_f32 v120, v120
    v_exp_f32 v121, v121
    v_mfma_f32_32x32x8bf16_1k v[176:191], v[76:77], v[90:91], v[176:191]
    v_exp_f32 v122, v122
    v_exp_f32 v123, v123
    v_exp_f32 v124, v124
    v_exp_f32 v125, v125
    v_mfma_f32_32x32x8bf16_1k v[208:223], v[76:77], v[94:95], v[208:223]
    v_exp_f32 v126, v126
    v_exp_f32 v127, v127
    v_exp_f32 v152, v152
    v_exp_f32 v153, v153
    v_smfmac_f32_32x32x32_bf16 v[32:47], v[68:71], v[112:119], v253
    buffer_load_dwordx4 v16, s[20:23], s50 offen lds
    ds_read_b64 v[76:77], v244 offset:16896
    v_exp_f32 v154, v154
    v_exp_f32 v155, v155
    v_exp_f32 v156, v156
    v_exp_f32 v157, v157
    v_smfmac_f32_32x32x32_bf16 v[48:63], v[68:71], v[144:151], v253
    s_waitcnt lgkmcnt(2)
    buffer_load_dwordx4 v16, s[12:15], s50 offen offset:1024 lds
    ds_read_b128 v[68:71], v246 offset:22080
    v_exp_f32 v158, v158
    v_exp_f32 v159, v159
    v_exp_f32 v176, v176
    v_exp_f32 v177, v177
    v_smfmac_f32_32x32x32_bf16 v[32:47], v[72:75], v[120:127], v253
    s_add_u32 m0, s64, 57344
    buffer_load_dwordx4 a[24:27], v30, s[8:11], s78 offen offset:0 sc1
    v_exp_f32 v178, v178
    v_exp_f32 v179, v179
    v_exp_f32 v180, v180
    v_exp_f32 v181, v181
    v_smfmac_f32_32x32x32_bf16 v[48:63], v[72:75], v[152:159], v253
    s_waitcnt lgkmcnt(0)
    ds_read_b128 v[72:75], v246 offset:22688
    v_exp_f32 v182, v182
    v_exp_f32 v183, v183
    v_exp_f32 v208, v208
    v_exp_f32 v209, v209
    v_mfma_f32_32x32x16_bf16 v[112:127], v[64:67], v[80:83], 0
    v_exp_f32 v210, v210
    v_exp_f32 v211, v211
    v_exp_f32 v212, v212
    v_exp_f32 v213, v213
    v_mfma_f32_32x32x16_bf16 v[144:159], v[64:67], v[84:87], 0
    ds_read_b128 v[64:67], v242 offset:5120
    v_exp_f32 v214, v214
    v_exp_f32 v215, v215
    v_exp_f32 v184, v184
    v_exp_f32 v185, v185
    v_mfma_f32_32x32x8bf16_1k v[112:127], v[76:77], v[88:89], v[112:127]
    v_exp_f32 v186, v186
    v_exp_f32 v187, v187
    v_exp_f32 v188, v188
    v_exp_f32 v189, v189
    v_mfma_f32_32x32x8bf16_1k v[144:159], v[76:77], v[92:93], v[144:159]
    v_exp_f32 v190, v190
    v_exp_f32 v191, v191
    v_exp_f32 v216, v216
    v_exp_f32 v217, v217
    v_smfmac_f32_32x32x32_bf16 v[32:47], v[68:71], v[176:183], v253
    buffer_load_dwordx4 v16, s[20:23], s51 offen lds
    v_exp_f32 v218, v218
    v_exp_f32 v219, v219
    v_exp_f32 v220, v220
    v_exp_f32 v221, v221
    v_smfmac_f32_32x32x32_bf16 v[48:63], v[68:71], v[208:215], v253
    s_waitcnt lgkmcnt(1)
    buffer_load_dwordx4 v16, s[12:15], s51 offen offset:1024 lds
    ds_read_b128 v[68:71], v246 offset:23296
    v_exp_f32 v222, v222
    v_exp_f32 v223, v223
    v_exp_f32 v112, v112
    v_exp_f32 v113, v113
    v_smfmac_f32_32x32x32_bf16 v[32:47], v[72:75], v[184:191], v253
    s_add_u32 m0, s64, 65536
    buffer_load_dwordx4 a[28:31], v30, s[8:11], s78 offen offset:1024 sc1
    v_exp_f32 v114, v114
    v_exp_f32 v115, v115
    v_exp_f32 v116, v116
    v_exp_f32 v117, v117
    v_smfmac_f32_32x32x32_bf16 v[48:63], v[72:75], v[216:223], v253
    s_waitcnt lgkmcnt(0)
    ds_read_b128 v[72:75], v246 offset:23904
    v_exp_f32 v118, v118
    v_exp_f32 v119, v119
    v_exp_f32 v144, v144
    v_exp_f32 v145, v145
    v_mfma_f32_32x32x16_bf16 v[176:191], v[64:67], v[80:83], 0
    v_exp_f32 v146, v146
    v_exp_f32 v147, v147
    v_exp_f32 v148, v148
    v_exp_f32 v149, v149
    v_mfma_f32_32x32x16_bf16 v[208:223], v[64:67], v[84:87], 0
    ds_read_b128 v[64:67], v242 offset:6144
    v_exp_f32 v150, v150
    v_exp_f32 v151, v151
    v_exp_f32 v120, v120
    v_exp_f32 v121, v121
    v_mfma_f32_32x32x8bf16_1k v[176:191], v[76:77], v[90:91], v[176:191]
    v_exp_f32 v122, v122
    v_exp_f32 v123, v123
    v_exp_f32 v124, v124
    v_exp_f32 v125, v125
    v_mfma_f32_32x32x8bf16_1k v[208:223], v[76:77], v[94:95], v[208:223]
    v_exp_f32 v126, v126
    v_exp_f32 v127, v127
    v_exp_f32 v152, v152
    v_exp_f32 v153, v153
    v_smfmac_f32_32x32x32_bf16 v[32:47], v[68:71], v[112:119], v253
    buffer_load_dwordx4 v17, s[20:23], s75 offen lds
    ds_read_b64 v[76:77], v244 offset:17152
    v_exp_f32 v154, v154
    v_exp_f32 v155, v155
    v_exp_f32 v156, v156
    v_exp_f32 v157, v157
    v_smfmac_f32_32x32x32_bf16 v[48:63], v[68:71], v[144:151], v253
    s_waitcnt lgkmcnt(2)
    ds_read_b128 v[68:71], v246 offset:24512
    v_exp_f32 v158, v158
    v_exp_f32 v159, v159
    v_exp_f32 v176, v176
    v_exp_f32 v177, v177
    v_smfmac_f32_32x32x32_bf16 v[32:47], v[72:75], v[120:127], v253
    s_add_u32 s95, s75, 330752
    buffer_load_dwordx2 a[70:71], v31, s[8:11], s78 offen sc1
    v_exp_f32 v178, v178
    v_exp_f32 v179, v179
    v_exp_f32 v180, v180
    v_exp_f32 v181, v181
    v_smfmac_f32_32x32x32_bf16 v[48:63], v[72:75], v[152:159], v253
    s_waitcnt lgkmcnt(0)
    ds_read_b128 v[72:75], v246 offset:25120
    v_exp_f32 v182, v182
    v_exp_f32 v183, v183
    v_exp_f32 v208, v208
    v_exp_f32 v209, v209
    v_mfma_f32_32x32x16_bf16 v[112:127], v[64:67], v[80:83], 0
    s_add_u32 s78, s78, 2359296
    v_exp_f32 v210, v210
    v_exp_f32 v211, v211
    v_exp_f32 v212, v212
    v_exp_f32 v213, v213
    v_mfma_f32_32x32x16_bf16 v[144:159], v[64:67], v[84:87], 0
    ds_read_b128 v[64:67], v242 offset:7168
    v_exp_f32 v214, v214
    v_exp_f32 v215, v215
    v_exp_f32 v184, v184
    v_exp_f32 v185, v185
    v_mfma_f32_32x32x8bf16_1k v[112:127], v[76:77], v[88:89], v[112:127]
    v_exp_f32 v186, v186
    v_exp_f32 v187, v187
    v_exp_f32 v188, v188
    v_exp_f32 v189, v189
    v_mfma_f32_32x32x8bf16_1k v[144:159], v[76:77], v[92:93], v[144:159]
    v_exp_f32 v190, v190
    v_exp_f32 v191, v191
    v_exp_f32 v216, v216
    v_exp_f32 v217, v217
    v_smfmac_f32_32x32x32_bf16 v[32:47], v[68:71], v[176:183], v253
    buffer_load_dwordx4 v17, s[20:23], s95 offen offset:1024 lds
    v_exp_f32 v218, v218
    v_exp_f32 v219, v219
    v_exp_f32 v220, v220
    v_exp_f32 v221, v221
    v_smfmac_f32_32x32x32_bf16 v[48:63], v[68:71], v[208:215], v253
    s_waitcnt lgkmcnt(1)
    ds_read_b128 v[68:71], v246 offset:25728
    v_exp_f32 v222, v222
    v_exp_f32 v223, v223
    v_exp_f32 v112, v112
    v_exp_f32 v113, v113
    v_smfmac_f32_32x32x32_bf16 v[32:47], v[72:75], v[184:191], v253
    s_add_u32 m0, s77, 0
    buffer_load_dwordx4 a[32:35], v30, s[8:11], s78 offen offset:0 sc1
    v_exp_f32 v114, v114
    v_exp_f32 v115, v115
    v_exp_f32 v116, v116
    v_exp_f32 v117, v117
    v_smfmac_f32_32x32x32_bf16 v[48:63], v[72:75], v[216:223], v253
    s_waitcnt lgkmcnt(0)
    ds_read_b128 v[72:75], v246 offset:26336
    v_exp_f32 v118, v118
    v_exp_f32 v119, v119
    v_exp_f32 v144, v144
    v_exp_f32 v145, v145
    v_mfma_f32_32x32x16_bf16 v[176:191], v[64:67], v[80:83], 0
    v_exp_f32 v146, v146
    v_exp_f32 v147, v147
    v_exp_f32 v148, v148
    v_exp_f32 v149, v149
    v_mfma_f32_32x32x16_bf16 v[208:223], v[64:67], v[84:87], 0
    ds_read_b128 v[64:67], v242 offset:8192
    v_exp_f32 v150, v150
    v_exp_f32 v151, v151
    v_exp_f32 v120, v120
    v_exp_f32 v121, v121
    v_mfma_f32_32x32x8bf16_1k v[176:191], v[76:77], v[90:91], v[176:191]
    v_exp_f32 v122, v122
    v_exp_f32 v123, v123
    v_exp_f32 v124, v124
    v_exp_f32 v125, v125
    v_mfma_f32_32x32x8bf16_1k v[208:223], v[76:77], v[94:95], v[208:223]
    v_exp_f32 v126, v126
    v_exp_f32 v127, v127
    v_exp_f32 v152, v152
    v_exp_f32 v153, v153
    v_smfmac_f32_32x32x32_bf16 v[32:47], v[68:71], v[112:119], v253
    buffer_load_dwordx4 v18, s[20:23], s76 offen lds
    ds_read_b64 v[76:77], v244 offset:17408
    v_exp_f32 v154, v154
    v_exp_f32 v155, v155
    v_exp_f32 v156, v156
    v_exp_f32 v157, v157
    v_smfmac_f32_32x32x32_bf16 v[48:63], v[68:71], v[144:151], v253
    s_waitcnt lgkmcnt(2)
    ds_read_b128 v[68:71], v246 offset:26944
    v_exp_f32 v158, v158
    v_exp_f32 v159, v159
    v_exp_f32 v176, v176
    v_exp_f32 v177, v177
    v_smfmac_f32_32x32x32_bf16 v[32:47], v[72:75], v[120:127], v253
    s_add_u32 m0, s77, 1024
    buffer_load_dwordx4 a[36:39], v30, s[8:11], s78 offen offset:1024 sc1
    v_exp_f32 v178, v178
    v_exp_f32 v179, v179
    v_exp_f32 v180, v180
    v_exp_f32 v181, v181
    v_smfmac_f32_32x32x32_bf16 v[48:63], v[72:75], v[152:159], v253
    s_waitcnt lgkmcnt(0)
    ds_read_b128 v[72:75], v246 offset:27552
    v_exp_f32 v182, v182
    v_exp_f32 v183, v183
    v_exp_f32 v208, v208
    v_exp_f32 v209, v209
    v_mfma_f32_32x32x16_bf16 v[112:127], v[64:67], v[80:83], 0
    v_exp_f32 v210, v210
    v_exp_f32 v211, v211
    v_exp_f32 v212, v212
    v_exp_f32 v213, v213
    v_mfma_f32_32x32x16_bf16 v[144:159], v[64:67], v[84:87], 0
    ds_read_b128 v[64:67], v242 offset:9216
    v_exp_f32 v214, v214
    v_exp_f32 v215, v215
    v_exp_f32 v184, v184
    v_exp_f32 v185, v185
    v_mfma_f32_32x32x8bf16_1k v[112:127], v[76:77], v[88:89], v[112:127]
    v_exp_f32 v186, v186
    v_exp_f32 v187, v187
    v_exp_f32 v188, v188
    v_exp_f32 v189, v189
    v_mfma_f32_32x32x8bf16_1k v[144:159], v[76:77], v[92:93], v[144:159]
    v_exp_f32 v190, v190
    v_exp_f32 v191, v191
    v_exp_f32 v216, v216
    v_exp_f32 v217, v217
    v_smfmac_f32_32x32x32_bf16 v[32:47], v[68:71], v[176:183], v253
    buffer_load_dwordx4 v19, s[20:23], s76 offen lds
    v_exp_f32 v218, v218
    v_exp_f32 v219, v219
    v_exp_f32 v220, v220
    v_exp_f32 v221, v221
    v_smfmac_f32_32x32x32_bf16 v[48:63], v[68:71], v[208:215], v253
    s_waitcnt lgkmcnt(1)
    ds_read_b128 v[68:71], v246 offset:28160
    v_exp_f32 v222, v222
    v_exp_f32 v223, v223
    v_exp_f32 v112, v112
    v_exp_f32 v113, v113
    v_smfmac_f32_32x32x32_bf16 v[32:47], v[72:75], v[184:191], v253
    s_add_u32 m0, s77, 2048
    buffer_load_dwordx2 a[72:73], v31, s[8:11], s78 offen sc1
    v_exp_f32 v114, v114
    v_exp_f32 v115, v115
    v_exp_f32 v116, v116
    v_exp_f32 v117, v117
    v_smfmac_f32_32x32x32_bf16 v[48:63], v[72:75], v[216:223], v253
    s_waitcnt lgkmcnt(0)
    ds_read_b128 v[72:75], v246 offset:28768
    v_exp_f32 v118, v118
    v_exp_f32 v119, v119
    v_exp_f32 v144, v144
    v_exp_f32 v145, v145
    v_mfma_f32_32x32x16_bf16 v[176:191], v[64:67], v[80:83], 0
    s_add_u32 s78, s78, 2359296
    v_exp_f32 v146, v146
    v_exp_f32 v147, v147
    v_exp_f32 v148, v148
    v_exp_f32 v149, v149
    v_mfma_f32_32x32x16_bf16 v[208:223], v[64:67], v[84:87], 0
    ds_read_b128 v[64:67], v242 offset:10240
    v_exp_f32 v150, v150
    v_exp_f32 v151, v151
    v_exp_f32 v120, v120
    v_exp_f32 v121, v121
    v_mfma_f32_32x32x8bf16_1k v[176:191], v[76:77], v[90:91], v[176:191]
    v_exp_f32 v122, v122
    v_exp_f32 v123, v123
    v_exp_f32 v124, v124
    v_exp_f32 v125, v125
    v_mfma_f32_32x32x8bf16_1k v[208:223], v[76:77], v[94:95], v[208:223]
    v_exp_f32 v126, v126
    v_exp_f32 v127, v127
    v_exp_f32 v152, v152
    v_exp_f32 v153, v153
    v_smfmac_f32_32x32x32_bf16 v[32:47], v[68:71], v[112:119], v253
    buffer_load_dwordx4 v20, s[20:23], s76 offen lds
    ds_read_b64 v[76:77], v244 offset:17664
    v_exp_f32 v154, v154
    v_exp_f32 v155, v155
    v_exp_f32 v156, v156
    v_exp_f32 v157, v157
    v_smfmac_f32_32x32x32_bf16 v[48:63], v[68:71], v[144:151], v253
    s_waitcnt lgkmcnt(2)
    ds_read_b128 v[68:71], v246 offset:29376
    v_exp_f32 v158, v158
    v_exp_f32 v159, v159
    v_exp_f32 v176, v176
    v_exp_f32 v177, v177
    v_smfmac_f32_32x32x32_bf16 v[32:47], v[72:75], v[120:127], v253
    buffer_load_dwordx4 a[40:43], v30, s[8:11], s78 offen offset:0 sc1
    v_exp_f32 v178, v178
    v_exp_f32 v179, v179
    v_exp_f32 v180, v180
    v_exp_f32 v181, v181
    v_smfmac_f32_32x32x32_bf16 v[48:63], v[72:75], v[152:159], v253
    s_waitcnt lgkmcnt(0)
    ds_read_b128 v[72:75], v246 offset:29984
    v_exp_f32 v182, v182
    v_exp_f32 v183, v183
    v_exp_f32 v208, v208
    v_exp_f32 v209, v209
    v_mfma_f32_32x32x16_bf16 v[112:127], v[64:67], v[80:83], 0
    v_exp_f32 v210, v210
L_page13:
    s_cbranch_execz L_pagedone
    v_exp_f32 v211, v211
    v_exp_f32 v212, v212
    v_exp_f32 v213, v213
    v_mfma_f32_32x32x16_bf16 v[144:159], v[64:67], v[84:87], 0
    ds_read_b128 v[64:67], v242 offset:11264
    v_exp_f32 v214, v214
    v_exp_f32 v215, v215
    v_exp_f32 v184, v184
    v_exp_f32 v185, v185
    v_mfma_f32_32x32x8bf16_1k v[112:127], v[76:77], v[88:89], v[112:127]
    v_exp_f32 v186, v186
    v_exp_f32 v187, v187
    v_exp_f32 v188, v188
    v_exp_f32 v189, v189
    v_mfma_f32_32x32x8bf16_1k v[144:159], v[76:77], v[92:93], v[144:159]
    v_exp_f32 v190, v190
    v_exp_f32 v191, v191
    v_exp_f32 v216, v216
    v_exp_f32 v217, v217
    v_smfmac_f32_32x32x32_bf16 v[32:47], v[68:71], v[176:183], v253
    buffer_load_dwordx4 a[44:47], v30, s[8:11], s78 offen offset:1024 sc1
    v_exp_f32 v218, v218
    v_exp_f32 v219, v219
    v_exp_f32 v220, v220
    v_exp_f32 v221, v221
    v_smfmac_f32_32x32x32_bf16 v[48:63], v[68:71], v[208:215], v253
    s_waitcnt lgkmcnt(1)
    ds_read_b128 v[68:71], v246 offset:30592
    v_exp_f32 v222, v222
    v_exp_f32 v223, v223
    v_exp_f32 v112, v112
    v_exp_f32 v113, v113
    v_smfmac_f32_32x32x32_bf16 v[32:47], v[72:75], v[184:191], v253
    buffer_load_dwordx2 a[74:75], v31, s[8:11], s78 offen sc1
    v_exp_f32 v114, v114
    v_exp_f32 v115, v115
    v_exp_f32 v116, v116
    v_exp_f32 v117, v117
    v_smfmac_f32_32x32x32_bf16 v[48:63], v[72:75], v[216:223], v253
    s_waitcnt lgkmcnt(0)
    ds_read_b128 v[72:75], v246 offset:31200
    v_exp_f32 v118, v118
    v_exp_f32 v119, v119
    v_exp_f32 v144, v144
    v_exp_f32 v145, v145
    v_mfma_f32_32x32x16_bf16 v[176:191], v[64:67], v[80:83], 0
    s_add_u32 s78, s78, 2359296
    v_exp_f32 v146, v146
    v_exp_f32 v147, v147
    v_exp_f32 v148, v148
    v_exp_f32 v149, v149
    v_mfma_f32_32x32x16_bf16 v[208:223], v[64:67], v[84:87], 0
    ds_read_b128 v[64:67], v242 offset:12288
    v_exp_f32 v150, v150
    v_exp_f32 v151, v151
    v_exp_f32 v120, v120
    v_exp_f32 v121, v121
    v_mfma_f32_32x32x8bf16_1k v[176:191], v[76:77], v[90:91], v[176:191]
    v_exp_f32 v122, v122
    v_exp_f32 v123, v123
    v_exp_f32 v124, v124
    v_exp_f32 v125, v125
    v_mfma_f32_32x32x8bf16_1k v[208:223], v[76:77], v[94:95], v[208:223]
    v_exp_f32 v126, v126
    v_exp_f32 v127, v127
    v_exp_f32 v152, v152
    v_exp_f32 v153, v153
    v_smfmac_f32_32x32x32_bf16 v[32:47], v[68:71], v[112:119], v253
    buffer_load_dwordx4 a[48:51], v30, s[8:11], s78 offen offset:0 sc1
    ds_read_b64 v[76:77], v244 offset:17920
    v_exp_f32 v154, v154
    v_exp_f32 v155, v155
    v_exp_f32 v156, v156
    v_exp_f32 v157, v157
    v_smfmac_f32_32x32x32_bf16 v[48:63], v[68:71], v[144:151], v253
    s_waitcnt lgkmcnt(2)
    ds_read_b128 v[68:71], v246 offset:31808
    v_exp_f32 v158, v158
    v_exp_f32 v159, v159
    v_exp_f32 v176, v176
    v_exp_f32 v177, v177
    v_smfmac_f32_32x32x32_bf16 v[32:47], v[72:75], v[120:127], v253
    buffer_load_dwordx4 a[52:55], v30, s[8:11], s78 offen offset:1024 sc1
    v_exp_f32 v178, v178
    v_exp_f32 v179, v179
    v_exp_f32 v180, v180
    v_exp_f32 v181, v181
    v_smfmac_f32_32x32x32_bf16 v[48:63], v[72:75], v[152:159], v253
    s_waitcnt lgkmcnt(0)
    ds_read_b128 v[72:75], v246 offset:32416
    v_exp_f32 v182, v182
    v_exp_f32 v183, v183
    v_exp_f32 v208, v208
    v_exp_f32 v209, v209
    v_mfma_f32_32x32x16_bf16 v[112:127], v[64:67], v[80:83], 0
    v_exp_f32 v210, v210
    v_exp_f32 v211, v211
    v_exp_f32 v212, v212
    v_exp_f32 v213, v213
    v_mfma_f32_32x32x16_bf16 v[144:159], v[64:67], v[84:87], 0
    ds_read_b128 v[64:67], v242 offset:13312
    v_exp_f32 v214, v214
    v_exp_f32 v215, v215
    v_exp_f32 v184, v184
    v_exp_f32 v185, v185
    v_mfma_f32_32x32x8bf16_1k v[112:127], v[76:77], v[88:89], v[112:127]
    v_exp_f32 v186, v186
    v_exp_f32 v187, v187
    v_exp_f32 v188, v188
    v_exp_f32 v189, v189
    v_mfma_f32_32x32x8bf16_1k v[144:159], v[76:77], v[92:93], v[144:159]
    v_exp_f32 v190, v190
    v_exp_f32 v191, v191
    v_exp_f32 v216, v216
    v_exp_f32 v217, v217
    v_smfmac_f32_32x32x32_bf16 v[32:47], v[68:71], v[176:183], v253
    buffer_load_dwordx2 a[76:77], v31, s[8:11], s78 offen sc1
    v_exp_f32 v218, v218
    v_exp_f32 v219, v219
    v_exp_f32 v220, v220
    v_exp_f32 v221, v221
    v_smfmac_f32_32x32x32_bf16 v[48:63], v[68:71], v[208:215], v253
    s_waitcnt lgkmcnt(1)
    ds_read_b128 v[68:71], v246 offset:33024
    v_exp_f32 v222, v222
    v_exp_f32 v223, v223
    v_exp_f32 v112, v112
    v_exp_f32 v113, v113
    v_smfmac_f32_32x32x32_bf16 v[32:47], v[72:75], v[184:191], v253
    v_exp_f32 v114, v114
    v_exp_f32 v115, v115
    v_exp_f32 v116, v116
    v_exp_f32 v117, v117
    v_smfmac_f32_32x32x32_bf16 v[48:63], v[72:75], v[216:223], v253
    s_waitcnt lgkmcnt(0)
    ds_read_b128 v[72:75], v246 offset:33632
    v_exp_f32 v118, v118
    v_exp_f32 v119, v119
    v_exp_f32 v144, v144
    v_exp_f32 v145, v145
    v_mfma_f32_32x32x16_bf16 v[176:191], v[64:67], v[80:83], 0
    s_add_u32 s78, s78, 2359296
    v_exp_f32 v146, v146
    v_exp_f32 v147, v147
    v_exp_f32 v148, v148
    v_exp_f32 v149, v149
    v_mfma_f32_32x32x16_bf16 v[208:223], v[64:67], v[84:87], 0
    ds_read_b128 v[64:67], v242 offset:14336
    v_exp_f32 v150, v150
    v_exp_f32 v151, v151
    v_exp_f32 v120, v120
    v_exp_f32 v121, v121
    v_mfma_f32_32x32x8bf16_1k v[176:191], v[76:77], v[90:91], v[176:191]
    v_exp_f32 v122, v122
    v_exp_f32 v123, v123
    v_exp_f32 v124, v124
    v_exp_f32 v125, v125
    v_mfma_f32_32x32x8bf16_1k v[208:223], v[76:77], v[94:95], v[208:223]
    v_exp_f32 v126, v126
    v_exp_f32 v127, v127
    v_exp_f32 v152, v152
    v_exp_f32 v153, v153
    v_smfmac_f32_32x32x32_bf16 v[32:47], v[68:71], v[112:119], v253
    buffer_load_dwordx4 a[56:59], v30, s[8:11], s78 offen offset:0 sc1
    ds_read_b64 v[76:77], v244 offset:18176
    v_exp_f32 v154, v154
    v_exp_f32 v155, v155
    v_exp_f32 v156, v156
    v_exp_f32 v157, v157
    v_smfmac_f32_32x32x32_bf16 v[48:63], v[68:71], v[144:151], v253
    s_waitcnt lgkmcnt(2)
    ds_read_b128 v[68:71], v246 offset:34240
    v_exp_f32 v158, v158
    v_exp_f32 v159, v159
    v_exp_f32 v176, v176
    v_exp_f32 v177, v177
    v_smfmac_f32_32x32x32_bf16 v[32:47], v[72:75], v[120:127], v253
    buffer_load_dwordx4 a[60:63], v30, s[8:11], s78 offen offset:1024 sc1
    v_exp_f32 v178, v178
    v_exp_f32 v179, v179
    v_exp_f32 v180, v180
    v_exp_f32 v181, v181
    v_smfmac_f32_32x32x32_bf16 v[48:63], v[72:75], v[152:159], v253
    s_waitcnt lgkmcnt(0)
    ds_read_b128 v[72:75], v246 offset:34848
    v_exp_f32 v182, v182
    v_exp_f32 v183, v183
    v_exp_f32 v208, v208
    v_exp_f32 v209, v209
    v_mfma_f32_32x32x16_bf16 v[112:127], v[64:67], v[80:83], 0
    v_exp_f32 v210, v210
    v_exp_f32 v211, v211
    v_exp_f32 v212, v212
    v_exp_f32 v213, v213
    v_mfma_f32_32x32x16_bf16 v[144:159], v[64:67], v[84:87], 0
    ds_read_b128 v[64:67], v242 offset:15360
    v_exp_f32 v214, v214
    v_exp_f32 v215, v215
    v_exp_f32 v184, v184
    v_exp_f32 v185, v185
    v_mfma_f32_32x32x8bf16_1k v[112:127], v[76:77], v[88:89], v[112:127]
    v_exp_f32 v186, v186
    v_exp_f32 v187, v187
    v_exp_f32 v188, v188
    v_exp_f32 v189, v189
    v_mfma_f32_32x32x8bf16_1k v[144:159], v[76:77], v[92:93], v[144:159]
    v_exp_f32 v190, v190
    v_exp_f32 v191, v191
    v_exp_f32 v216, v216
    v_exp_f32 v217, v217
    v_smfmac_f32_32x32x32_bf16 v[32:47], v[68:71], v[176:183], v253
    buffer_load_dwordx2 a[78:79], v31, s[8:11], s78 offen sc1
    v_exp_f32 v218, v218
    v_exp_f32 v219, v219
    v_exp_f32 v220, v220
    v_exp_f32 v221, v221
    v_smfmac_f32_32x32x32_bf16 v[48:63], v[68:71], v[208:215], v253
    s_waitcnt lgkmcnt(1)
    ds_read_b128 v[68:71], v246 offset:35456
    v_exp_f32 v222, v222
    v_exp_f32 v223, v223
    v_exp_f32 v112, v112
    v_exp_f32 v113, v113
    v_smfmac_f32_32x32x32_bf16 v[32:47], v[72:75], v[184:191], v253
    v_exp_f32 v114, v114
    v_exp_f32 v115, v115
    v_exp_f32 v116, v116
    v_exp_f32 v117, v117
    v_smfmac_f32_32x32x32_bf16 v[48:63], v[72:75], v[216:223], v253
    s_waitcnt lgkmcnt(0)
    ds_read_b128 v[72:75], v246 offset:36064
    v_exp_f32 v118, v118
    v_exp_f32 v119, v119
    v_exp_f32 v144, v144
    v_exp_f32 v145, v145
    v_mfma_f32_32x32x16_bf16 v[176:191], v[64:67], v[80:83], 0
    s_waitcnt vmcnt(9)
    s_barrier
    v_exp_f32 v146, v146
    v_exp_f32 v147, v147
    v_exp_f32 v148, v148
    v_exp_f32 v149, v149
    v_mfma_f32_32x32x16_bf16 v[208:223], v[64:67], v[84:87], 0
    v_exp_f32 v150, v150
    v_exp_f32 v151, v151
    v_exp_f32 v120, v120
    v_exp_f32 v121, v121
    v_mfma_f32_32x32x8bf16_1k v[176:191], v[76:77], v[90:91], v[176:191]
    v_exp_f32 v122, v122
    v_exp_f32 v123, v123
    v_exp_f32 v124, v124
    v_exp_f32 v125, v125
    v_mfma_f32_32x32x8bf16_1k v[208:223], v[76:77], v[94:95], v[208:223]
    v_exp_f32 v126, v126
    v_exp_f32 v127, v127
    v_exp_f32 v152, v152
    v_exp_f32 v153, v153
    v_smfmac_f32_32x32x32_bf16 v[32:47], v[68:71], v[112:119], v253
    v_exp_f32 v154, v154
    v_exp_f32 v155, v155
    v_exp_f32 v156, v156
    v_exp_f32 v157, v157
    v_smfmac_f32_32x32x32_bf16 v[48:63], v[68:71], v[144:151], v253
    s_waitcnt lgkmcnt(0)
    ds_read_b128 v[68:71], v246 offset:36672
    v_exp_f32 v158, v158
    v_exp_f32 v159, v159
    v_exp_f32 v176, v176
    v_exp_f32 v177, v177
    v_smfmac_f32_32x32x32_bf16 v[32:47], v[72:75], v[120:127], v253
    v_exp_f32 v178, v178
    v_exp_f32 v179, v179
    v_exp_f32 v180, v180
    v_exp_f32 v181, v181
    v_smfmac_f32_32x32x32_bf16 v[48:63], v[72:75], v[152:159], v253
    s_waitcnt lgkmcnt(0)
    ds_read_b128 v[72:75], v246 offset:37280
    v_exp_f32 v182, v182
    v_exp_f32 v183, v183
    v_exp_f32 v208, v208
    v_exp_f32 v209, v209
    v_exp_f32 v210, v210
    v_exp_f32 v211, v211
    v_exp_f32 v212, v212
    v_exp_f32 v213, v213
    v_exp_f32 v214, v214
    v_exp_f32 v215, v215
    v_exp_f32 v184, v184
    v_exp_f32 v185, v185
    v_exp_f32 v186, v186
    v_exp_f32 v187, v187
    v_exp_f32 v188, v188
    v_exp_f32 v189, v189
    v_exp_f32 v190, v190
    v_exp_f32 v191, v191
    v_exp_f32 v216, v216
    v_exp_f32 v217, v217
    v_smfmac_f32_32x32x32_bf16 v[32:47], v[68:71], v[176:183], v253
    v_exp_f32 v218, v218
    v_exp_f32 v219, v219
    v_exp_f32 v220, v220
    v_exp_f32 v221, v221
    v_smfmac_f32_32x32x32_bf16 v[48:63], v[68:71], v[208:215], v253
    s_waitcnt lgkmcnt(0)
    v_exp_f32 v222, v222
    v_exp_f32 v223, v223
    v_smfmac_f32_32x32x32_bf16 v[32:47], v[72:75], v[184:191], v253
    s_nop 0
    v_smfmac_f32_32x32x32_bf16 v[48:63], v[72:75], v[216:223], v253
    s_mov_b32 s94, 0x1f800000
    s_mov_b32 s95, 0x5f800000
    s_mov_b32 s97, 0x7b800000
    s_mov_b64 s[100:101], exec
    s_nop 5
    v_max3_f32 v249, |v32|, |v33|, |v34|
    v_max3_f32 v249, v249, |v35|, |v36|
    v_max3_f32 v249, v249, |v37|, |v38|
    v_max3_f32 v249, v249, |v39|, |v40|
    v_max_f32 v249, v249, |v41|
    v_cmp_le_f32 vcc, s94, v42
    s_nop 0
    s_and_b64 s[100:101], s[100:101], vcc
    v_cmp_ge_f32 vcc, s95, v42
    s_nop 0
    s_and_b64 s[100:101], s[100:101], vcc
    v_cmp_ge_f32 vcc, s97, v249
    s_nop 0
    s_and_b64 s[100:101], s[100:101], vcc
    v_max3_f32 v249, |v48|, |v49|, |v50|
    v_max3_f32 v249, v249, |v51|, |v52|
    v_max3_f32 v249, v249, |v53|, |v54|
    v_max3_f32 v249, v249, |v55|, |v56|
    v_max_f32 v249, v249, |v57|
    v_cmp_le_f32 vcc, s94, v58
    s_nop 0
    s_and_b64 s[100:101], s[100:101], vcc
    v_cmp_ge_f32 vcc, s95, v58
    s_nop 0
    s_and_b64 s[100:101], s[100:101], vcc
    v_cmp_ge_f32 vcc, s97, v249
    s_nop 0
    s_and_b64 s[100:101], s[100:101], vcc
    s_cmp_eq_u64 s[100:101], exec
    s_cbranch_scc0 L_slow
    s_nop 1
L_fin:
    s_lshl_b32 s94, s5, 3
    s_add_u32 s94, s94, s4
    s_lshl_b32 s94, s94, 2
    s_add_u32 s94, s94, s3
    s_lshl_b32 s95, s94, 8
    s_add_u32 s95, s95, 30539776
    s_lshl_b32 s94, s94, 11
    s_add_u32 s94, s94, 28442624
    v_rcp_f32 v42, v42
    s_nop 0
    v_mul_f32 v32, v32, v42
    v_mul_f32 v33, v33, v42
    v_mul_f32 v34, v34, v42
    v_mul_f32 v35, v35, v42
    v_mul_f32 v36, v36, v42
    v_mul_f32 v37, v37, v42
    v_mul_f32 v38, v38, v42
    v_mul_f32 v39, v39, v42
    v_mul_f32 v40, v40, v42
    v_mul_f32 v41, v41, v42
    v_cvt_pk_bf16_f32 v64, v32, v33
    v_cvt_pk_bf16_f32 v65, v34, v35
    v_cvt_pk_bf16_f32 v66, v36, v37
    v_cvt_pk_bf16_f32 v67, v38, v39
    v_cvt_pk_bf16_f32 v68, v40, v41
    buffer_store_dwordx4 v[64:67], v1, s[8:11], s94 offen offset:0 sc1
    buffer_store_dword v68, v247, s[8:11], s95 offen offset:0 sc1
    v_rcp_f32 v58, v58
    s_nop 0
    v_mul_f32 v48, v48, v58
    v_mul_f32 v49, v49, v58
    v_mul_f32 v50, v50, v58
    v_mul_f32 v51, v51, v58
    v_mul_f32 v52, v52, v58
    v_mul_f32 v53, v53, v58
    v_mul_f32 v54, v54, v58
    v_mul_f32 v55, v55, v58
    v_mul_f32 v56, v56, v58
    v_mul_f32 v57, v57, v58
    v_cvt_pk_bf16_f32 v70, v48, v49
    v_cvt_pk_bf16_f32 v71, v50, v51
    v_cvt_pk_bf16_f32 v72, v52, v53
    v_cvt_pk_bf16_f32 v73, v54, v55
    v_cvt_pk_bf16_f32 v74, v56, v57
    buffer_store_dwordx4 v[70:73], v1, s[8:11], s94 offen offset:1024 sc1
    buffer_store_dword v74, v247, s[8:11], s95 offen offset:128 sc1
    v_bfe_u32 v170, v0, 4, 2
    v_lshlrev_b32 v170, 2, v170
    v_and_b32 v171, 15, v0
    v_sub_u32 v170, v171, v170
    v_mov_b32 v171, 0x3f80
    v_mov_b32 v172, 0x3f800000
    v_cmp_eq_u32 vcc, 0, v170
    s_nop 1
    v_cndmask_b32 v168, 0, v171, vcc
    v_cmp_eq_u32 vcc, 1, v170
    s_nop 1
    v_cndmask_b32 v168, v168, v172, vcc
    v_cmp_eq_u32 vcc, 2, v170
    s_nop 1
    v_cndmask_b32 v169, 0, v171, vcc
    v_cmp_eq_u32 vcc, 3, v170
    s_nop 1
    v_cndmask_b32 v169, v169, v172, vcc
    v_mov_b32 v170, 0
    v_mov_b32 v172, 0
    v_mov_b32 v174, v168
    v_mov_b32 v176, v168
    v_mov_b32 v178, v168
    v_mov_b32 v171, 0
    v_mov_b32 v173, 0
    v_mov_b32 v175, v169
    v_mov_b32 v177, v169
    v_mov_b32 v179, v169
    ds_read_b64_tr_b16 a[96:97], v8 offset:0
    ds_read_b64_tr_b16 a[98:99], v8 offset:4096
    ds_read_b64_tr_b16 a[100:101], v9 offset:0
    ds_read_b64_tr_b16 a[102:103], v9 offset:4096
    ds_read_b64_tr_b16 a[104:105], v10 offset:0
    ds_read_b64_tr_b16 a[106:107], v10 offset:4096
    ds_read_b64_tr_b16 a[108:109], v11 offset:0
    ds_read_b64_tr_b16 a[110:111], v11 offset:4096
    ds_read_b64_tr_b16 a[112:113], v21 offset:0
    ds_read_b64_tr_b16 a[114:115], v21 offset:6144
    ds_read_b64_tr_b16 a[116:117], v8 offset:1024
    ds_read_b64_tr_b16 a[118:119], v8 offset:5120
    s_waitcnt lgkmcnt(8)
    ds_read_b64_tr_b16 a[120:121], v9 offset:1024
    ds_read_b64_tr_b16 a[122:123], v9 offset:5120
    ds_read_b64_tr_b16 a[124:125], v10 offset:1024
    ds_read_b64_tr_b16 a[126:127], v10 offset:5120
    s_waitcnt lgkmcnt(8)
    ds_read_b64_tr_b16 a[128:129], v11 offset:1024
    ds_read_b64_tr_b16 a[130:131], v11 offset:5120
    ds_read_b64_tr_b16 a[132:133], v21 offset:128
    ds_read_b64_tr_b16 a[134:135], v21 offset:6272
    s_waitcnt lgkmcnt(8)
    ds_read_b64_tr_b16 a[136:137], v8 offset:8192
    ds_read_b64_tr_b16 a[138:139], v8 offset:12288
    ds_read_b64_tr_b16 a[140:141], v9 offset:8192
    ds_read_b64_tr_b16 a[142:143], v9 offset:12288
    s_waitcnt lgkmcnt(8)
    ds_read_b64_tr_b16 a[144:145], v10 offset:8192
    ds_read_b64_tr_b16 a[146:147], v10 offset:12288
    ds_read_b64_tr_b16 a[148:149], v11 offset:8192
    ds_read_b64_tr_b16 a[150:151], v11 offset:12288
    s_waitcnt lgkmcnt(8)
    ds_read_b64_tr_b16 a[152:153], v21 offset:256
    ds_read_b64_tr_b16 a[154:155], v21 offset:6400
    ds_read_b64_tr_b16 a[156:157], v8 offset:9216
    ds_read_b64_tr_b16 a[158:159], v8 offset:13312
    s_waitcnt lgkmcnt(8)
    ds_read_b64_tr_b16 a[160:161], v9 offset:9216
    ds_read_b64_tr_b16 a[162:163], v9 offset:13312
    ds_read_b64_tr_b16 a[164:165], v10 offset:9216
    ds_read_b64_tr_b16 a[166:167], v10 offset:13312
    s_waitcnt lgkmcnt(8)
    ds_read_b64_tr_b16 a[168:169], v11 offset:9216
    ds_read_b64_tr_b16 a[170:171], v11 offset:13312
    ds_read_b64_tr_b16 a[172:173], v21 offset:384
    ds_read_b64_tr_b16 a[174:175], v21 offset:6528
    s_waitcnt lgkmcnt(8)
    ds_read_b64_tr_b16 a[176:177], v8 offset:16384
    ds_read_b64_tr_b16 a[178:179], v8 offset:20480
    ds_read_b64_tr_b16 a[180:181], v9 offset:16384
    ds_read_b64_tr_b16 a[182:183], v9 offset:20480
    s_waitcnt lgkmcnt(8)
    ds_read_b64_tr_b16 a[184:185], v10 offset:16384
    ds_read_b64_tr_b16 a[186:187], v10 offset:20480
    ds_read_b64_tr_b16 a[188:189], v11 offset:16384
    ds_read_b64_tr_b16 a[190:191], v11 offset:20480
    s_waitcnt vmcnt(0)
    v_mov_b32 v240, s40
    buffer_store_dword v240, v5, s[8:11], s87 offen offset:0 sc1
    s_mov_b32 s12, s79
    s_add_u32 s13, s12, 131072
    s_cmp_eq_u32 s13, s57
    s_cselect_b32 s13, s56, s13
    s_waitcnt lgkmcnt(8)
    ds_read_b64_tr_b16 a[192:193], v21 offset:512
    ds_read_b64_tr_b16 a[194:195], v21 offset:6656
    s_add_u32 s14, s13, 131072
    s_cmp_eq_u32 s14, s57
    s_cselect_b32 s14, s56, s14
    s_add_u32 s15, s14, 131072
    s_cmp_eq_u32 s15, s57
    s_cselect_b32 s15, s56, s15
    ds_read_b64_tr_b16 a[196:197], v8 offset:17408
    ds_read_b64_tr_b16 a[198:199], v8 offset:21504
    s_add_u32 s16, s15, 131072
    s_cmp_eq_u32 s16, s57
    s_cselect_b32 s16, s56, s16
    s_add_u32 s17, s16, 131072
    s_cmp_eq_u32 s17, s57
    s_cselect_b32 s17, s56, s17
    s_waitcnt lgkmcnt(8)
    ds_read_b64_tr_b16 a[200:201], v9 offset:17408
    ds_read_b64_tr_b16 a[202:203], v9 offset:21504
    s_add_u32 s18, s17, 131072
    s_cmp_eq_u32 s18, s57
    s_cselect_b32 s18, s56, s18
    s_add_u32 s19, s18, 131072
    s_cmp_eq_u32 s19, s57
    s_cselect_b32 s19, s56, s19
    ds_read_b64_tr_b16 a[204:205], v10 offset:17408
    ds_read_b64_tr_b16 a[206:207], v10 offset:21504
    s_add_u32 s28, s19, 131072
    s_cmp_eq_u32 s28, s57
    s_cselect_b32 s28, s56, s28
    s_add_u32 s29, s28, 131072
    s_cmp_eq_u32 s29, s57
    s_cselect_b32 s29, s56, s29
    s_waitcnt lgkmcnt(8)
    ds_read_b64_tr_b16 a[208:209], v11 offset:17408
    ds_read_b64_tr_b16 a[210:211], v11 offset:21504
    s_add_u32 s30, s29, 131072
    s_cmp_eq_u32 s30, s57
    s_cselect_b32 s30, s56, s30
    s_add_u32 s31, s30, 131072
    s_cmp_eq_u32 s31, s57
    s_cselect_b32 s31, s56, s31
    ds_read_b64_tr_b16 a[212:213], v21 offset:640
    ds_read_b64_tr_b16 a[214:215], v21 offset:6784
    s_add_u32 s32, s31, 131072
    s_cmp_eq_u32 s32, s57
    s_cselect_b32 s32, s56, s32
    s_add_u32 s33, s32, 131072
    s_cmp_eq_u32 s33, s57
    s_cselect_b32 s33, s56, s33
    s_waitcnt lgkmcnt(8)
    ds_read_b64_tr_b16 a[216:217], v8 offset:24576
    ds_read_b64_tr_b16 a[218:219], v8 offset:28672
    s_add_u32 s34, s33, 131072
    s_cmp_eq_u32 s34, s57
    s_cselect_b32 s34, s56, s34
    s_add_u32 s35, s34, 131072
    s_cmp_eq_u32 s35, s57
    s_cselect_b32 s35, s56, s35
    ds_read_b64_tr_b16 a[220:221], v9 offset:24576
    ds_read_b64_tr_b16 a[222:223], v9 offset:28672
    s_add_u32 s64, s58, 0
    s_add_u32 s65, s58, 8192
    s_add_u32 s66, s58, 16384
    s_add_u32 s67, s58, 24576
    s_add_u32 s68, s58, 131072
    s_add_u32 s69, s58, 139264
    s_add_u32 s70, s58, 147456
    s_add_u32 s71, s58, 155648
    buffer_load_dword v6, v4, s[8:11], s91 offen sc1
    v_mfma_f32_16x16x32_bf16 v[76:79], v[168:171], a[0:3], 0
    s_waitcnt lgkmcnt(8)
    ds_read_b64_tr_b16 a[224:225], v10 offset:24576
    ds_read_b64_tr_b16 a[226:227], v10 offset:28672
    v_mfma_f32_16x16x32_bf16 v[80:83], v[172:175], a[0:3], 0
    ds_read_b64_tr_b16 a[228:229], v11 offset:24576
    ds_read_b64_tr_b16 a[230:231], v11 offset:28672
    v_mfma_f32_16x16x32_bf16 v[84:87], v[168:171], a[4:7], 0
    s_waitcnt lgkmcnt(8)
    ds_read_b64_tr_b16 a[232:233], v21 offset:768
    ds_read_b64_tr_b16 a[234:235], v21 offset:6912
    v_mfma_f32_16x16x32_bf16 v[88:91], v[172:175], a[4:7], 0
    ds_read_b64_tr_b16 a[236:237], v8 offset:25600
    ds_read_b64_tr_b16 a[238:239], v8 offset:29696
    v_mfma_f32_16x16x32_bf16 v[92:95], v[176:179], a[64:67], 0
    s_waitcnt lgkmcnt(8)
    ds_read_b64_tr_b16 a[240:241], v9 offset:25600
    ds_read_b64_tr_b16 a[242:243], v9 offset:29696
    v_mfma_f32_16x16x32_bf16 v[76:79], v[168:171], a[8:11], v[76:79]
    ds_read_b64_tr_b16 a[244:245], v10 offset:25600
    ds_read_b64_tr_b16 a[246:247], v10 offset:29696
    v_mfma_f32_16x16x32_bf16 v[80:83], v[172:175], a[8:11], v[80:83]
    s_waitcnt lgkmcnt(8)
    ds_read_b64_tr_b16 a[248:249], v11 offset:25600
    ds_read_b64_tr_b16 a[250:251], v11 offset:29696
    v_mfma_f32_16x16x32_bf16 v[84:87], v[168:171], a[12:15], v[84:87]
    ds_read_b64_tr_b16 a[252:253], v21 offset:896
    ds_read_b64_tr_b16 a[254:255], v21 offset:7040
    v_mfma_f32_16x16x32_bf16 v[88:91], v[172:175], a[12:15], v[88:91]
    s_waitcnt lgkmcnt(8)
    ds_read_b64_tr_b16 v[180:181], v8 offset:32768
    ds_read_b64_tr_b16 v[182:183], v8 offset:36864
    v_mfma_f32_16x16x32_bf16 v[76:79], v[168:171], a[16:19], v[76:79]
    ds_read_b64_tr_b16 v[184:185], v9 offset:32768
    ds_read_b64_tr_b16 v[186:187], v9 offset:36864
    v_mfma_f32_16x16x32_bf16 v[80:83], v[172:175], a[16:19], v[80:83]
    s_waitcnt lgkmcnt(8)
    ds_read_b64_tr_b16 v[188:189], v10 offset:32768
    ds_read_b64_tr_b16 v[190:191], v10 offset:36864
    v_mfma_f32_16x16x32_bf16 v[84:87], v[168:171], a[20:23], v[84:87]
    ds_read_b64_tr_b16 v[192:193], v11 offset:32768
    ds_read_b64_tr_b16 v[194:195], v11 offset:36864
    v_mfma_f32_16x16x32_bf16 v[88:91], v[172:175], a[20:23], v[88:91]
    s_waitcnt lgkmcnt(8)
    ds_read_b64_tr_b16 v[196:197], v21 offset:1024
    ds_read_b64_tr_b16 v[198:199], v21 offset:7168
    v_mfma_f32_16x16x32_bf16 v[92:95], v[176:179], a[68:71], v[92:95]
    ds_read_b64_tr_b16 v[200:201], v8 offset:33792
    ds_read_b64_tr_b16 v[202:203], v8 offset:37888
    v_mfma_f32_16x16x32_bf16 v[76:79], v[168:171], a[24:27], v[76:79]
    s_waitcnt lgkmcnt(8)
    ds_read_b64_tr_b16 v[204:205], v9 offset:33792
    ds_read_b64_tr_b16 v[206:207], v9 offset:37888
    v_mfma_f32_16x16x32_bf16 v[80:83], v[172:175], a[24:27], v[80:83]
    ds_read_b64_tr_b16 v[208:209], v10 offset:33792
    ds_read_b64_tr_b16 v[210:211], v10 offset:37888
    v_mfma_f32_16x16x32_bf16 v[84:87], v[168:171], a[28:31], v[84:87]
    s_waitcnt lgkmcnt(8)
    ds_read_b64_tr_b16 v[212:213], v11 offset:33792
    ds_read_b64_tr_b16 v[214:215], v11 offset:37888
    v_mfma_f32_16x16x32_bf16 v[88:91], v[172:175], a[28:31], v[88:91]
    ds_read_b64_tr_b16 v[216:217], v21 offset:1152
    ds_read_b64_tr_b16 v[218:219], v21 offset:7296
    v_mfma_f32_16x16x32_bf16 v[76:79], v[168:171], a[32:35], v[76:79]
    s_waitcnt lgkmcnt(8)
    ds_read_b64_tr_b16 v[220:221], v8 offset:40960
    ds_read_b64_tr_b16 v[222:223], v8 offset:45056
    v_mfma_f32_16x16x32_bf16 v[80:83], v[172:175], a[32:35], v[80:83]
    ds_read_b64_tr_b16 v[224:225], v9 offset:40960
    ds_read_b64_tr_b16 v[226:227], v9 offset:45056
    v_mfma_f32_16x16x32_bf16 v[84:87], v[168:171], a[36:39], v[84:87]
    s_waitcnt lgkmcnt(8)
    ds_read_b64_tr_b16 v[228:229], v10 offset:40960
    ds_read_b64_tr_b16 v[230:231], v10 offset:45056
    v_mfma_f32_16x16x32_bf16 v[88:91], v[172:175], a[36:39], v[88:91]
    ds_read_b64_tr_b16 v[232:233], v11 offset:40960
    ds_read_b64_tr_b16 v[234:235], v11 offset:45056
    v_mfma_f32_16x16x32_bf16 v[92:95], v[176:179], a[72:75], v[92:95]
    s_waitcnt lgkmcnt(8)
    ds_read_b64_tr_b16 v[236:237], v21 offset:1280
    ds_read_b64_tr_b16 v[238:239], v21 offset:7424
    v_mfma_f32_16x16x32_bf16 v[76:79], v[168:171], a[40:43], v[76:79]
    ds_read_b64_tr_b16 v[32:33], v8 offset:41984
    ds_read_b64_tr_b16 v[34:35], v8 offset:46080
    v_mfma_f32_16x16x32_bf16 v[80:83], v[172:175], a[40:43], v[80:83]
    s_waitcnt lgkmcnt(8)
    ds_read_b64_tr_b16 v[36:37], v9 offset:41984
    ds_read_b64_tr_b16 v[38:39], v9 offset:46080
    v_mfma_f32_16x16x32_bf16 v[84:87], v[168:171], a[44:47], v[84:87]
    ds_read_b64_tr_b16 v[40:41], v10 offset:41984
    ds_read_b64_tr_b16 v[42:43], v10 offset:46080
    v_mfma_f32_16x16x32_bf16 v[88:91], v[172:175], a[44:47], v[88:91]
    s_waitcnt lgkmcnt(8)
    ds_read_b64_tr_b16 v[44:45], v11 offset:41984
    ds_read_b64_tr_b16 v[46:47], v11 offset:46080
    v_mfma_f32_16x16x32_bf16 v[76:79], v[168:171], a[48:51], v[76:79]
    ds_read_b64_tr_b16 v[48:49], v21 offset:1408
    ds_read_b64_tr_b16 v[50:51], v21 offset:7552
    v_mfma_f32_16x16x32_bf16 v[80:83], v[172:175], a[48:51], v[80:83]
    s_waitcnt lgkmcnt(8)
    ds_read_b64_tr_b16 v[52:53], v8 offset:49152
    ds_read_b64_tr_b16 v[54:55], v8 offset:53248
    v_mfma_f32_16x16x32_bf16 v[84:87], v[168:171], a[52:55], v[84:87]
    ds_read_b64_tr_b16 v[56:57], v9 offset:49152
    ds_read_b64_tr_b16 v[58:59], v9 offset:53248
    v_mfma_f32_16x16x32_bf16 v[88:91], v[172:175], a[52:55], v[88:91]
    s_waitcnt lgkmcnt(8)
    ds_read_b64_tr_b16 v[60:61], v10 offset:49152
    ds_read_b64_tr_b16 v[62:63], v10 offset:53248
    v_mfma_f32_16x16x32_bf16 v[92:95], v[176:179], a[76:79], v[92:95]
    ds_read_b64_tr_b16 a[0:1], v11 offset:49152
    ds_read_b64_tr_b16 a[2:3], v11 offset:53248
    v_mfma_f32_16x16x32_bf16 v[76:79], v[168:171], a[56:59], v[76:79]
    s_waitcnt lgkmcnt(8)
    ds_read_b64_tr_b16 a[4:5], v21 offset:1536
    ds_read_b64_tr_b16 a[6:7], v21 offset:7680
    v_mfma_f32_16x16x32_bf16 v[80:83], v[172:175], a[56:59], v[80:83]
    ds_read_b64_tr_b16 a[64:65], v8 offset:50176
    ds_read_b64_tr_b16 a[66:67], v8 offset:54272
    v_mfma_f32_16x16x32_bf16 v[84:87], v[168:171], a[60:63], v[84:87]
    s_waitcnt lgkmcnt(8)
    ds_read_b64_tr_b16 a[8:9], v9 offset:50176
    ds_read_b64_tr_b16 a[10:11], v9 offset:54272
    v_mfma_f32_16x16x32_bf16 v[88:91], v[172:175], a[60:63], v[88:91]
    ds_read_b64_tr_b16 a[12:13], v10 offset:50176
    ds_read_b64_tr_b16 a[14:15], v10 offset:54272
    v_mfma_f32_16x16x32_bf16 v[76:79], v[168:171], a[80:83], v[76:79]
    s_waitcnt lgkmcnt(8)
    ds_read_b64_tr_b16 a[16:17], v11 offset:50176
    ds_read_b64_tr_b16 a[18:19], v11 offset:54272
    v_mfma_f32_16x16x32_bf16 v[80:83], v[172:175], a[80:83], v[80:83]
    ds_read_b64_tr_b16 a[20:21], v21 offset:1664
    ds_read_b64_tr_b16 a[22:23], v21 offset:7808
    v_mfma_f32_16x16x32_bf16 v[84:87], v[168:171], a[84:87], v[84:87]
    s_waitcnt lgkmcnt(8)
    ds_read_b64_tr_b16 a[68:69], v8 offset:57344
    ds_read_b64_tr_b16 a[70:71], v8 offset:61440
    v_mfma_f32_16x16x32_bf16 v[88:91], v[172:175], a[84:87], v[88:91]
    ds_read_b64_tr_b16 a[24:25], v9 offset:57344
    ds_read_b64_tr_b16 a[26:27], v9 offset:61440
    v_mfma_f32_16x16x32_bf16 v[92:95], v[168:171], a[88:91], v[92:95]
    s_waitcnt lgkmcnt(8)
    ds_read_b64_tr_b16 a[28:29], v10 offset:57344
    ds_read_b64_tr_b16 a[30:31], v10 offset:61440
    s_or_b32 s94, s2, s3
    s_cmp_eq_u32 s94, 0
    s_cselect_b32 s94, 49733632, s55
L_page14:
    s_cbranch_execz L_pagedone
    s_cselect_b32 s95, 0, 1073741824
    s_add_u32 s94, s94, s95
    s_mul_i32 s95, s3, 2304
    s_add_u32 s95, s95, 86016
    v_and_b32 v241, 15, v0
    v_mul_u32_u24 v241, 144, v241
    v_bfe_u32 v242, v0, 4, 2
    v_lshl_add_u32 v241, v242, 3, v241
    v_add_u32 v241, s95, v241
    v_bfe_u32 v243, v0, 3, 3
    v_mul_u32_u24 v242, 144, v243
    v_mul_u32_u24 v243, 1152, v243
    v_and_b32 v249, 7, v0
    v_lshl_add_u32 v242, v249, 4, v242
    v_add_u32 v242, s95, v242
    v_lshl_add_u32 v243, v249, 4, v243
    s_waitcnt vmcnt(0)
    v_cmp_eq_u32 vcc, s40, v6
    s_nop 0
    s_cmp_eq_u32 vcc_lo, -1
    s_cbranch_scc0 L_spin7
L_back7:
    s_lshl_b32 s96, s5, 2
    s_add_u32 s96, s96, s3
    s_mul_i32 s96, s96, 18432
    s_add_u32 s96, s96, s75
    s_add_u32 s95, s96, 9216
    buffer_load_dwordx4 v[96:99], v24, s[8:11], s12 offen sc1
    buffer_load_dwordx4 v[100:103], v24, s[8:11], s13 offen sc1
    buffer_load_dwordx4 v[104:107], v24, s[8:11], s14 offen sc1
    buffer_load_dwordx4 v[108:111], v24, s[8:11], s15 offen sc1
    ds_read_b64_tr_b16 a[32:33], v11 offset:57344
    ds_read_b64_tr_b16 a[34:35], v11 offset:61440
    s_waitcnt lgkmcnt(8)
    ds_read_b64_tr_b16 a[36:37], v21 offset:1792
    ds_read_b64_tr_b16 a[38:39], v21 offset:7936
    ds_read_b64_tr_b16 a[72:73], v8 offset:58368
    ds_read_b64_tr_b16 a[74:75], v8 offset:62464
    s_waitcnt lgkmcnt(8)
    ds_read_b64_tr_b16 a[40:41], v9 offset:58368
    ds_read_b64_tr_b16 a[42:43], v9 offset:62464
    ds_read_b64_tr_b16 a[44:45], v10 offset:58368
    ds_read_b64_tr_b16 a[46:47], v10 offset:62464
    s_waitcnt lgkmcnt(8)
    ds_read_b64_tr_b16 a[48:49], v11 offset:58368
    ds_read_b64_tr_b16 a[50:51], v11 offset:62464
    ds_read_b64_tr_b16 a[52:53], v21 offset:1920
    ds_read_b64_tr_b16 a[54:55], v21 offset:8064
    s_waitcnt lgkmcnt(8)
    ds_read_b64_tr_b16 a[76:77], v12 offset:0
    ds_read_b64_tr_b16 a[78:79], v12 offset:4096
    ds_read_b64_tr_b16 a[56:57], v13 offset:0
    ds_read_b64_tr_b16 a[58:59], v13 offset:4096
    s_waitcnt lgkmcnt(8)
    ds_read_b64_tr_b16 a[60:61], v14 offset:0
    ds_read_b64_tr_b16 a[62:63], v14 offset:4096
    ds_read_b64_tr_b16 a[80:81], v15 offset:0
    ds_read_b64_tr_b16 a[82:83], v15 offset:4096
    s_waitcnt lgkmcnt(8)
    ds_read_b64_tr_b16 a[84:85], v21 offset:2048
    ds_read_b64_tr_b16 a[86:87], v21 offset:8192
    ds_read_b64_tr_b16 a[88:89], v12 offset:1024
    ds_read_b64_tr_b16 a[90:91], v12 offset:5120
    s_waitcnt vmcnt(3)
    v_mfma_f32_16x16x32_bf16 v[76:79], a[96:99], v[96:99], v[76:79]
    buffer_load_dwordx4 v[112:115], v24, s[8:11], s16 offen sc1
    s_waitcnt lgkmcnt(8)
    ds_read_b64_tr_b16 a[96:97], v13 offset:1024
    ds_read_b64_tr_b16 a[98:99], v13 offset:5120
    v_mfma_f32_16x16x32_bf16 v[80:83], a[100:103], v[96:99], v[80:83]
    ds_read_b64_tr_b16 a[100:101], v14 offset:1024
    ds_read_b64_tr_b16 a[102:103], v14 offset:5120
    v_mfma_f32_16x16x32_bf16 v[84:87], a[104:107], v[96:99], v[84:87]
    buffer_load_dwordx4 v[116:119], v24, s[8:11], s17 offen sc1
    s_waitcnt lgkmcnt(8)
    ds_read_b64_tr_b16 a[104:105], v15 offset:1024
    ds_read_b64_tr_b16 a[106:107], v15 offset:5120
    v_mfma_f32_16x16x32_bf16 v[88:91], a[108:111], v[96:99], v[88:91]
    ds_read_b64_tr_b16 a[108:109], v21 offset:2176
    ds_read_b64_tr_b16 a[110:111], v21 offset:8320
    v_mfma_f32_16x16x32_bf16 v[92:95], a[112:115], v[96:99], v[92:95]
    s_waitcnt vmcnt(4)
    v_mfma_f32_16x16x32_bf16 v[76:79], a[116:119], v[100:103], v[76:79]
    buffer_load_dwordx4 v[120:123], v24, s[8:11], s18 offen sc1
    v_mfma_f32_16x16x32_bf16 v[80:83], a[120:123], v[100:103], v[80:83]
    v_mfma_f32_16x16x32_bf16 v[84:87], a[124:127], v[100:103], v[84:87]
    buffer_load_dwordx4 v[124:127], v24, s[8:11], s19 offen sc1
    v_mfma_f32_16x16x32_bf16 v[88:91], a[128:131], v[100:103], v[88:91]
    v_mfma_f32_16x16x32_bf16 v[92:95], a[132:135], v[100:103], v[92:95]
    s_waitcnt vmcnt(5)
    v_mfma_f32_16x16x32_bf16 v[76:79], a[136:139], v[104:107], v[76:79]
    buffer_load_dwordx4 v[128:131], v24, s[8:11], s28 offen sc1
    v_mfma_f32_16x16x32_bf16 v[80:83], a[140:143], v[104:107], v[80:83]
    v_mfma_f32_16x16x32_bf16 v[84:87], a[144:147], v[104:107], v[84:87]
    buffer_load_dwordx4 v[132:135], v24, s[8:11], s29 offen sc1
    v_mfma_f32_16x16x32_bf16 v[88:91], a[148:151], v[104:107], v[88:91]
    v_mfma_f32_16x16x32_bf16 v[92:95], a[152:155], v[104:107], v[92:95]
    s_waitcnt vmcnt(6)
    v_mfma_f32_16x16x32_bf16 v[76:79], a[156:159], v[108:111], v[76:79]
    buffer_load_dwordx4 v[136:139], v24, s[8:11], s30 offen sc1
    v_mfma_f32_16x16x32_bf16 v[80:83], a[160:163], v[108:111], v[80:83]
    v_mfma_f32_16x16x32_bf16 v[84:87], a[164:167], v[108:111], v[84:87]
    buffer_load_dwordx4 v[140:143], v24, s[8:11], s31 offen sc1
    v_mfma_f32_16x16x32_bf16 v[88:91], a[168:171], v[108:111], v[88:91]
    v_mfma_f32_16x16x32_bf16 v[92:95], a[172:175], v[108:111], v[92:95]
    s_waitcnt vmcnt(7)
    v_mfma_f32_16x16x32_bf16 v[76:79], a[176:179], v[112:115], v[76:79]
    buffer_load_dwordx4 v[144:147], v24, s[8:11], s32 offen sc1
    v_mfma_f32_16x16x32_bf16 v[80:83], a[180:183], v[112:115], v[80:83]
    v_mfma_f32_16x16x32_bf16 v[84:87], a[184:187], v[112:115], v[84:87]
    buffer_load_dwordx4 v[148:151], v24, s[8:11], s33 offen sc1
    v_mfma_f32_16x16x32_bf16 v[88:91], a[188:191], v[112:115], v[88:91]
    v_mfma_f32_16x16x32_bf16 v[92:95], a[192:195], v[112:115], v[92:95]
    s_waitcnt vmcnt(8)
    v_mfma_f32_16x16x32_bf16 v[76:79], a[196:199], v[116:119], v[76:79]
    buffer_load_dwordx4 v[152:155], v24, s[8:11], s34 offen sc1
    v_mfma_f32_16x16x32_bf16 v[80:83], a[200:203], v[116:119], v[80:83]
    v_mfma_f32_16x16x32_bf16 v[84:87], a[204:207], v[116:119], v[84:87]
    buffer_load_dwordx4 v[156:159], v24, s[8:11], s35 offen sc1
    v_mfma_f32_16x16x32_bf16 v[88:91], a[208:211], v[116:119], v[88:91]
    v_mfma_f32_16x16x32_bf16 v[92:95], a[212:215], v[116:119], v[92:95]
    s_waitcnt vmcnt(9)
    v_mfma_f32_16x16x32_bf16 v[76:79], a[216:219], v[120:123], v[76:79]
    buffer_load_dword v160, v27, s[8:11], s64 offen sc1
    v_mfma_f32_16x16x32_bf16 v[80:83], a[220:223], v[120:123], v[80:83]
    v_mfma_f32_16x16x32_bf16 v[84:87], a[224:227], v[120:123], v[84:87]
    buffer_load_dword v161, v27, s[8:11], s65 offen sc1
    v_mfma_f32_16x16x32_bf16 v[88:91], a[228:231], v[120:123], v[88:91]
    v_mfma_f32_16x16x32_bf16 v[92:95], a[232:235], v[120:123], v[92:95]
    s_waitcnt vmcnt(10)
    v_mfma_f32_16x16x32_bf16 v[76:79], a[236:239], v[124:127], v[76:79]
    buffer_load_dword v162, v27, s[8:11], s66 offen sc1
    v_mfma_f32_16x16x32_bf16 v[80:83], a[240:243], v[124:127], v[80:83]
    v_mfma_f32_16x16x32_bf16 v[84:87], a[244:247], v[124:127], v[84:87]
    buffer_load_dword v163, v27, s[8:11], s67 offen sc1
    v_mfma_f32_16x16x32_bf16 v[88:91], a[248:251], v[124:127], v[88:91]
    v_mfma_f32_16x16x32_bf16 v[92:95], a[252:255], v[124:127], v[92:95]
    s_waitcnt vmcnt(11)
    v_mfma_f32_16x16x32_bf16 v[76:79], v[180:183], v[128:131], v[76:79]
    buffer_load_dword v164, v27, s[8:11], s68 offen sc1
    v_mfma_f32_16x16x32_bf16 v[80:83], v[184:187], v[128:131], v[80:83]
    v_mfma_f32_16x16x32_bf16 v[84:87], v[188:191], v[128:131], v[84:87]
    buffer_load_dword v165, v27, s[8:11], s69 offen sc1
    v_mfma_f32_16x16x32_bf16 v[88:91], v[192:195], v[128:131], v[88:91]
    v_mfma_f32_16x16x32_bf16 v[92:95], v[196:199], v[128:131], v[92:95]
    s_waitcnt vmcnt(12)
    v_mfma_f32_16x16x32_bf16 v[76:79], v[200:203], v[132:135], v[76:79]
    buffer_load_dword v166, v27, s[8:11], s70 offen sc1
    v_mfma_f32_16x16x32_bf16 v[80:83], v[204:207], v[132:135], v[80:83]
    v_mfma_f32_16x16x32_bf16 v[84:87], v[208:211], v[132:135], v[84:87]
    buffer_load_dword v167, v27, s[8:11], s71 offen sc1
    v_mfma_f32_16x16x32_bf16 v[88:91], v[212:215], v[132:135], v[88:91]
    v_mfma_f32_16x16x32_bf16 v[92:95], v[216:219], v[132:135], v[92:95]
    s_waitcnt vmcnt(13)
    v_mfma_f32_16x16x32_bf16 v[76:79], v[220:223], v[136:139], v[76:79]
    v_mfma_f32_16x16x32_bf16 v[80:83], v[224:227], v[136:139], v[80:83]
    v_mfma_f32_16x16x32_bf16 v[84:87], v[228:231], v[136:139], v[84:87]
    v_mfma_f32_16x16x32_bf16 v[88:91], v[232:235], v[136:139], v[88:91]
    v_mfma_f32_16x16x32_bf16 v[92:95], v[236:239], v[136:139], v[92:95]
    s_waitcnt vmcnt(12)
    v_mfma_f32_16x16x32_bf16 v[76:79], v[32:35], v[140:143], v[76:79]
    v_mfma_f32_16x16x32_bf16 v[80:83], v[36:39], v[140:143], v[80:83]
    v_mfma_f32_16x16x32_bf16 v[84:87], v[40:43], v[140:143], v[84:87]
    v_mfma_f32_16x16x32_bf16 v[88:91], v[44:47], v[140:143], v[88:91]
    v_mfma_f32_16x16x32_bf16 v[92:95], v[48:51], v[140:143], v[92:95]
    s_waitcnt vmcnt(11)
    v_mfma_f32_16x16x32_bf16 v[76:79], v[52:55], v[144:147], v[76:79]
    v_mfma_f32_16x16x32_bf16 v[80:83], v[56:59], v[144:147], v[80:83]
    v_mfma_f32_16x16x32_bf16 v[84:87], v[60:63], v[144:147], v[84:87]
    v_mfma_f32_16x16x32_bf16 v[88:91], a[0:3], v[144:147], v[88:91]
    v_mfma_f32_16x16x32_bf16 v[92:95], a[4:7], v[144:147], v[92:95]
    s_waitcnt vmcnt(10)
    v_mfma_f32_16x16x32_bf16 v[76:79], a[64:67], v[148:151], v[76:79]
    v_mfma_f32_16x16x32_bf16 v[80:83], a[8:11], v[148:151], v[80:83]
    v_mfma_f32_16x16x32_bf16 v[84:87], a[12:15], v[148:151], v[84:87]
    v_mfma_f32_16x16x32_bf16 v[88:91], a[16:19], v[148:151], v[88:91]
    v_mfma_f32_16x16x32_bf16 v[92:95], a[20:23], v[148:151], v[92:95]
    s_waitcnt vmcnt(9)
    v_mfma_f32_16x16x32_bf16 v[76:79], a[68:71], v[152:155], v[76:79]
    v_mfma_f32_16x16x32_bf16 v[80:83], a[24:27], v[152:155], v[80:83]
    v_mfma_f32_16x16x32_bf16 v[84:87], a[28:31], v[152:155], v[84:87]
    v_mfma_f32_16x16x32_bf16 v[88:91], a[32:35], v[152:155], v[88:91]
    v_mfma_f32_16x16x32_bf16 v[92:95], a[36:39], v[152:155], v[92:95]
    s_waitcnt vmcnt(8)
    v_mfma_f32_16x16x32_bf16 v[76:79], a[72:75], v[156:159], v[76:79]
    v_mfma_f32_16x16x32_bf16 v[80:83], a[40:43], v[156:159], v[80:83]
    v_mfma_f32_16x16x32_bf16 v[84:87], a[44:47], v[156:159], v[84:87]
    v_mfma_f32_16x16x32_bf16 v[88:91], a[48:51], v[156:159], v[88:91]
    v_mfma_f32_16x16x32_bf16 v[92:95], a[52:55], v[156:159], v[92:95]
    s_waitcnt vmcnt(4)
    v_mfma_f32_16x16x32_bf16 v[76:79], a[76:79], v[160:163], v[76:79]
    v_mfma_f32_16x16x32_bf16 v[80:83], a[56:59], v[160:163], v[80:83]
    v_mfma_f32_16x16x32_bf16 v[84:87], a[60:63], v[160:163], v[84:87]
    v_mfma_f32_16x16x32_bf16 v[88:91], a[80:83], v[160:163], v[88:91]
    s_waitcnt lgkmcnt(10)
    v_mfma_f32_16x16x32_bf16 v[92:95], a[84:87], v[160:163], v[92:95]
    s_waitcnt vmcnt(0)
    s_waitcnt lgkmcnt(8)
    v_mfma_f32_16x16x32_bf16 v[76:79], a[88:91], v[164:167], v[76:79]
    s_waitcnt lgkmcnt(6)
    v_mfma_f32_16x16x32_bf16 v[80:83], a[96:99], v[164:167], v[80:83]
    s_waitcnt lgkmcnt(4)
    v_mfma_f32_16x16x32_bf16 v[84:87], a[100:103], v[164:167], v[84:87]
    s_waitcnt lgkmcnt(2)
    v_mfma_f32_16x16x32_bf16 v[88:91], a[104:107], v[164:167], v[88:91]
    s_waitcnt lgkmcnt(0)
    v_mfma_f32_16x16x32_bf16 v[92:95], a[108:111], v[164:167], v[92:95]
    buffer_store_dword v240, v5, s[8:11], s94 offen sc1
    s_nop 6
    v_cvt_pk_bf16_f32 v72, v92, v93
    v_cvt_pk_bf16_f32 v73, v94, v95
    buffer_store_dwordx2 v[72:73], v29, s[24:27], 0 offen
    v_cvt_pk_bf16_f32 v64, v76, v77
    v_cvt_pk_bf16_f32 v65, v78, v79
    ds_write_b64 v241, v[64:65] offset:0
    v_cvt_pk_bf16_f32 v66, v80, v81
    v_cvt_pk_bf16_f32 v67, v82, v83
    ds_write_b64 v241, v[66:67] offset:32
    v_cvt_pk_bf16_f32 v68, v84, v85
    v_cvt_pk_bf16_f32 v69, v86, v87
    ds_write_b64 v241, v[68:69] offset:64
    v_cvt_pk_bf16_f32 v70, v88, v89
    v_cvt_pk_bf16_f32 v71, v90, v91
    ds_write_b64 v241, v[70:71] offset:96
    ds_read_b128 v[96:99], v242 offset:0
    ds_read_b128 v[100:103], v242 offset:1152
    s_waitcnt lgkmcnt(1)
    buffer_store_dwordx4 v[96:99], v243, s[24:27], s96 offen
    s_waitcnt lgkmcnt(0)
    buffer_store_dwordx4 v[100:103], v243, s[24:27], s95 offen
    s_nop 1
L_end:
    s_endpgm
L_codeend:
.section .rodata,"a"
.p2align 6
.amdhsa_kernel parallel_sum__mha_block__glu_gated_bilinear__prompt_kernel
  .amdhsa_next_free_vgpr 512
  .amdhsa_next_free_sgpr 102
  .amdhsa_accum_offset 256
  .amdhsa_group_segment_fixed_size 0
  .amdhsa_kernarg_size 80
  .amdhsa_user_sgpr_count 2
  .amdhsa_user_sgpr_kernarg_segment_ptr 1
  .amdhsa_system_sgpr_workgroup_id_x 1
.end_amdhsa_kernel
```
